```python
import torch

def _softmax(x, axis=-1):
    return torch.softmax(x, dim=axis)
def _gelu(x):
    return torch.nn.functional.gelu(x, approximate="tanh")
def _silu(x):
    return torch.nn.functional.silu(x)
def _sigmoid(x):
    return torch.sigmoid(x)
def _layernorm(x, axis=-1, eps=1e-5):
    m = x.mean(dim=axis, keepdim=True)
    v = x.var(dim=axis, keepdim=True, unbiased=False)
    return (x - m) / torch.sqrt(v + eps)
def _scatter_add(tgt, idx, src, axis=0):
    return tgt.clone().index_add_(axis, idx, src)
def _segment_sum(src, seg, n):
    out = torch.zeros((n,) + src.shape[1:], dtype=src.dtype)
    return out.index_add_(0, seg, src)
def _pad(x, pw):
    flat = tuple(v for pair in reversed(pw) for v in pair)
    return torch.nn.functional.pad(x, flat)

kernel_name = 'sequential_preLN__softmax_full_mha__glu_gated_geglu__prompt'

def setup_inputs():

    _w = (lambda a: (lambda t: t.to(torch.bfloat16) if t.is_floating_point() else t)(torch.as_tensor(a)))
    def _A_setup():
        B, S, D = 1, 2048, 640
        return {
            "x": _w((lambda *s: torch.randn(*s, dtype=torch.bfloat16) * 0.05)(B, S, D)),
            "wqkv": _w((lambda *s: torch.randn(*s, dtype=torch.bfloat16) * 0.05)(D, 3 * D)),
            "wo": _w((lambda *s: torch.randn(*s, dtype=torch.bfloat16) * 0.05)(D, D)),
        }
    _A_in = _A_setup()

    def _B_setup():
        B, S, Dm, Df = 1, 2048, 640, 1536
        return {
            "x": _w((lambda *s: torch.randn(*s, dtype=torch.bfloat16) * 0.05)(B, S, Dm)),
            "w_gate": _w((lambda *s: torch.randn(*s, dtype=torch.bfloat16) * 0.8)(Dm, Df) * (Dm ** -0.5)),
            "w_up": _w((lambda *s: torch.randn(*s, dtype=torch.bfloat16) * 0.8)(Dm, Df) * (Dm ** -0.5)),
            "w_down": _w((lambda *s: torch.randn(*s, dtype=torch.bfloat16) * 0.8)(Df, Dm) * (Df ** -0.5)),
        }
    _B_in = _B_setup()

    return {
        "A_x": _A_in["x"],
        "A_wqkv": _A_in["wqkv"],
        "A_wo": _A_in["wo"],
        "B_x": _B_in["x"],
        "B_w_gate": _B_in["w_gate"],
        "B_w_up": _B_in["w_up"],
        "B_w_down": _B_in["w_down"],
    }

def reference(A_x, A_wqkv, A_wo, B_x, B_w_gate, B_w_up, B_w_down):
    def _A_ref(x, wqkv, wo):
        B, S, D = x.shape
        H = 32; Dh = D // H
        qkv = (lambda x, *d: x.permute(*d))((x @ wqkv).reshape(B, S, 3, H, Dh), 2, 0, 3, 1, 4)
        q, k, v = qkv[0], qkv[1], qkv[2]
        scale = Dh ** -0.5
        scores = torch.einsum("bhqd,bhkd->bhqk", q, k) * scale
        p = _softmax(scores, axis=-1)
        o = torch.einsum("bhqk,bhkd->bhqd", p, v)
        return (lambda x, *d: x.permute(*d))(o, 0, 2, 1, 3).reshape(B, S, D) @ wo

    def _B_ref(x, w_gate, w_up, w_down):
        g = torch.einsum("bsd,df->bsf", x, w_gate)
        u = torch.einsum("bsd,df->bsf", x, w_up)
        h = _gelu(g) * u
        return torch.einsum("bsf,fd->bsd", h, w_down)

    x = A_x
    h = x + _A_ref(_layernorm(x, axis=-1), A_wqkv, A_wo)
    h2 = h + _B_ref(_layernorm(h, axis=-1), B_w_gate, B_w_up, B_w_down)
    return h2
```

```asm
; @launch grid=(256,1,1) block=(512,1,1) lds=163840
.amdgcn_target "amdgcn-amd-amdhsa--gfx950"
.text
.globl sequential_preLN__softmax_full_mha__glu_gated_geglu__prompt_kernel
.p2align 8
.type sequential_preLN__softmax_full_mha__glu_gated_geglu__prompt_kernel,@function
sequential_preLN__softmax_full_mha__glu_gated_geglu__prompt_kernel:
    s_cmp_ge_u32 s2, 256
    s_cbranch_scc1 k_end
    s_load_dwordx16 s[40:55], s[0:1], 0
    s_load_dwordx2 s[56:57], s[0:1], 72
    v_lshrrev_b32 v1, 6, v0
    v_and_b32 v0, 63, v0
    v_readfirstlane_b32 s3, v1
    s_and_b32 s6, s2, 7
    s_lshr_b32 s7, s2, 3
    s_lshl_b32 s20, s6, 1
    s_and_b32 s21, s7, 1
    s_add_u32 s20, s20, s21
    s_and_b32 s22, s6, 3
    s_lshl_b32 s22, s22, 2
    s_lshr_b32 s23, s6, 2
    s_and_b32 s4, s7, 3
    s_add_u32 s4, s4, s22
    s_lshr_b32 s5, s7, 2
    s_lshl_b32 s28, s23, 3
    s_add_u32 s5, s5, s28
    s_lshl_b32 s28, s23, 1
    s_add_u32 s28, s28, s22
    s_add_u32 s28, s28, s21
    s_cmp_ge_u32 s7, 28
    s_cselect_b32 s4, s28, s4
    s_cselect_b32 s5, 7, s5
    s_cmp_ge_u32 s7, 30
    s_cbranch_scc1 p1_spare
    s_cmp_lt_u32 s3, 4
    s_cbranch_scc1 p1_comp
    s_sub_u32 s6, s3, 4
    v_lshrrev_b32 v2, 3, v0
    s_lshl_b32 s20, s6, 3
    v_add_u32 v3, s20, v2
    v_mul_u32_u24 v3, 1280, v3
    s_lshl_b32 s20, s6, 1
    v_bfe_u32 v4, v0, 4, 1
    v_or_b32 v4, s20, v4
    v_and_b32 v5, 7, v0
    v_xor_b32 v4, v4, v5
    v_lshl_add_u32 v3, v4, 4, v3
    v_bfe_u32 v4, v0, 2, 2
    s_lshl_b32 s20, s6, 2
    v_add_u32 v4, s20, v4
    v_mul_u32_u24 v4, 3840, v4
    v_lshrrev_b32 v5, 4, v0
    v_lshl_add_u32 v4, v5, 6, v4
    v_and_b32 v5, 3, v0
    s_and_b32 s20, s6, 2
    v_xor_b32 v5, s20, v5
    v_lshl_add_u32 v4, v5, 4, v4
    s_mul_i32 s20, s4, 163840
    s_lshl_b32 s30, s5, 8
    s_lshl_b32 s22, s6, 10
    s_add_u32 s21, s20, 1280
    s_add_u32 s31, s30, 2457600
    s_waitcnt lgkmcnt(0)
    s_mov_b32 s12, s40
    s_mov_b32 s13, s41
    s_mov_b32 s14, 2621440
    s_mov_b32 s15, 0x20000
    s_mov_b32 s16, s42
    s_mov_b32 s17, s43
    s_mov_b32 s18, 2457600
    s_mov_b32 s19, 0x20000
    s_add_u32 s23, s20, 0
    s_add_u32 m0, s22, 0
    s_nop 0
    buffer_load_dwordx4 v3, s[12:15], s23 offen lds
    s_add_u32 s28, s30, 0
    s_add_u32 m0, s22, 16384
    s_nop 0
    buffer_load_dwordx4 v4, s[16:19], s28 offen lds
    s_add_u32 s23, s20, 40960
    s_add_u32 m0, s22, 4096
    s_nop 0
    buffer_load_dwordx4 v3, s[12:15], s23 offen lds
    s_add_u32 s28, s30, 61440
    s_add_u32 m0, s22, 20480
    s_nop 0
    buffer_load_dwordx4 v4, s[16:19], s28 offen lds
    s_add_u32 s23, s20, 81920
    s_add_u32 m0, s22, 8192
    s_nop 0
    buffer_load_dwordx4 v3, s[12:15], s23 offen lds
    s_add_u32 s28, s30, 122880
    s_add_u32 m0, s22, 24576
    s_nop 0
    buffer_load_dwordx4 v4, s[16:19], s28 offen lds
    s_add_u32 s23, s20, 122880
    s_add_u32 m0, s22, 12288
    s_nop 0
    buffer_load_dwordx4 v3, s[12:15], s23 offen lds
    s_add_u32 s28, s30, 184320
    s_add_u32 m0, s22, 28672
    s_nop 0
    buffer_load_dwordx4 v4, s[16:19], s28 offen lds
    s_add_u32 s20, s20, 128
    s_add_u32 s30, s30, 245760
    s_add_u32 s23, s20, 0
    s_add_u32 m0, s22, 32768
    s_nop 0
    buffer_load_dwordx4 v3, s[12:15], s23 offen lds
    s_add_u32 s28, s30, 0
    s_add_u32 m0, s22, 49152
    s_nop 0
    buffer_load_dwordx4 v4, s[16:19], s28 offen lds
    s_add_u32 s23, s20, 40960
    s_add_u32 m0, s22, 36864
    s_nop 0
    buffer_load_dwordx4 v3, s[12:15], s23 offen lds
    s_add_u32 s28, s30, 61440
    s_add_u32 m0, s22, 53248
    s_nop 0
    buffer_load_dwordx4 v4, s[16:19], s28 offen lds
    s_add_u32 s23, s20, 81920
    s_add_u32 m0, s22, 40960
    s_nop 0
    buffer_load_dwordx4 v3, s[12:15], s23 offen lds
    s_add_u32 s28, s30, 122880
    s_add_u32 m0, s22, 57344
    s_nop 0
    buffer_load_dwordx4 v4, s[16:19], s28 offen lds
    s_add_u32 s23, s20, 122880
    s_add_u32 m0, s22, 45056
    s_nop 0
    buffer_load_dwordx4 v3, s[12:15], s23 offen lds
    s_add_u32 s28, s30, 184320
    s_add_u32 m0, s22, 61440
    s_nop 0
    buffer_load_dwordx4 v4, s[16:19], s28 offen lds
    s_add_u32 s20, s20, 128
    s_add_u32 s30, s30, 245760
    s_add_u32 s23, s20, 0
    s_add_u32 m0, s22, 65536
    s_nop 0
    buffer_load_dwordx4 v3, s[12:15], s23 offen lds
    s_add_u32 s28, s30, 0
    s_add_u32 m0, s22, 81920
    s_nop 0
    buffer_load_dwordx4 v4, s[16:19], s28 offen lds
    s_add_u32 s23, s20, 40960
    s_add_u32 m0, s22, 69632
    s_nop 0
    buffer_load_dwordx4 v3, s[12:15], s23 offen lds
    s_add_u32 s28, s30, 61440
    s_add_u32 m0, s22, 86016
    s_nop 0
    buffer_load_dwordx4 v4, s[16:19], s28 offen lds
    s_add_u32 s23, s20, 81920
    s_add_u32 m0, s22, 73728
    s_nop 0
    buffer_load_dwordx4 v3, s[12:15], s23 offen lds
    s_add_u32 s28, s30, 122880
    s_add_u32 m0, s22, 90112
    s_nop 0
    buffer_load_dwordx4 v4, s[16:19], s28 offen lds
    s_add_u32 s23, s20, 122880
    s_add_u32 m0, s22, 77824
    s_nop 0
    buffer_load_dwordx4 v3, s[12:15], s23 offen lds
    s_add_u32 s28, s30, 184320
    s_add_u32 m0, s22, 94208
    s_nop 0
    buffer_load_dwordx4 v4, s[16:19], s28 offen lds
    s_add_u32 s20, s20, 128
    s_add_u32 s30, s30, 245760
    s_add_u32 s56, s56, 67108864
    s_addc_u32 s57, s57, 0
    s_add_u32 s60, s56, 30672896
    s_addc_u32 s61, s57, 0
    s_load_dword s58, s[60:61], 0
    s_mov_b32 s8, s56
    s_mov_b32 s9, s57
    s_mov_b32 s10, 31268864
    s_mov_b32 s11, 0x20000
    s_waitcnt vmcnt(16)
    s_barrier
    s_add_u32 s23, s20, 0
    s_add_u32 m0, s22, 98304
    s_nop 0
    buffer_load_dwordx4 v3, s[12:15], s23 offen lds
    s_add_u32 s28, s30, 0
    s_add_u32 m0, s22, 114688
    s_nop 0
    buffer_load_dwordx4 v4, s[16:19], s28 offen lds
    s_add_u32 s23, s20, 40960
    s_add_u32 m0, s22, 102400
    s_nop 0
    buffer_load_dwordx4 v3, s[12:15], s23 offen lds
    s_add_u32 s28, s30, 61440
    s_add_u32 m0, s22, 118784
    s_nop 0
    buffer_load_dwordx4 v4, s[16:19], s28 offen lds
    s_add_u32 s23, s20, 81920
    s_add_u32 m0, s22, 106496
    s_nop 0
    buffer_load_dwordx4 v3, s[12:15], s23 offen lds
    s_add_u32 s28, s30, 122880
    s_add_u32 m0, s22, 122880
    s_nop 0
    buffer_load_dwordx4 v4, s[16:19], s28 offen lds
    s_add_u32 s23, s20, 122880
    s_add_u32 m0, s22, 110592
    s_nop 0
    buffer_load_dwordx4 v3, s[12:15], s23 offen lds
    s_add_u32 s28, s30, 184320
    s_add_u32 m0, s22, 126976
    s_nop 0
    buffer_load_dwordx4 v4, s[16:19], s28 offen lds
    s_add_u32 s20, s20, 128
    s_add_u32 s30, s30, 245760
    s_waitcnt vmcnt(16)
    s_barrier
    s_add_u32 s23, s20, 0
    s_add_u32 m0, s22, 0
    s_nop 0
    buffer_load_dwordx4 v3, s[12:15], s23 offen lds
    s_add_u32 s28, s30, 0
    s_add_u32 m0, s22, 16384
    s_nop 0
    buffer_load_dwordx4 v4, s[16:19], s28 offen lds
    s_add_u32 s23, s20, 40960
    s_add_u32 m0, s22, 4096
    s_nop 0
    buffer_load_dwordx4 v3, s[12:15], s23 offen lds
    s_add_u32 s28, s30, 61440
    s_add_u32 m0, s22, 20480
    s_nop 0
    buffer_load_dwordx4 v4, s[16:19], s28 offen lds
    s_add_u32 s23, s20, 81920
    s_add_u32 m0, s22, 8192
    s_nop 0
    buffer_load_dwordx4 v3, s[12:15], s23 offen lds
    s_add_u32 s28, s30, 122880
    s_add_u32 m0, s22, 24576
    s_nop 0
    buffer_load_dwordx4 v4, s[16:19], s28 offen lds
    s_add_u32 s23, s20, 122880
    s_add_u32 m0, s22, 12288
    s_nop 0
    buffer_load_dwordx4 v3, s[12:15], s23 offen lds
    s_add_u32 s28, s30, 184320
    s_add_u32 m0, s22, 28672
    s_nop 0
    buffer_load_dwordx4 v4, s[16:19], s28 offen lds
    s_add_u32 s20, s20, 128
    s_add_u32 s30, s30, 245760
    s_cmp_lg_u32 s6, 0
    s_cbranch_scc1 cpf_1
    s_getpc_b64 s[66:67]
pc_ref:
    s_sub_u32 s66, s66, pc_ref-sequential_preLN__softmax_full_mha__glu_gated_geglu__prompt_kernel
    s_subb_u32 s67, s67, 0
    s_bfe_u32 s28, s2, 0x40003
    s_lshl_b32 s28, s28, 13
    v_lshl_add_u32 v5, v0, 7, s28
    s_mov_b32 s28, code_end-sequential_preLN__softmax_full_mha__glu_gated_geglu__prompt_kernel-4
    v_min_u32 v5, s28, v5
    global_load_dword v250, v5, s[66:67]
cpf_1:
    s_cmp_lg_u32 s6, 0
    s_cbranch_scc1 vmw_3
    s_waitcnt vmcnt(17)
    s_branch vmw_2
vmw_3:
    s_waitcnt vmcnt(16)
vmw_2:
    s_barrier
    s_add_u32 s23, s20, 0
    s_add_u32 m0, s22, 32768
    s_nop 0
    buffer_load_dwordx4 v3, s[12:15], s23 offen lds
    s_add_u32 s28, s30, 0
    s_add_u32 m0, s22, 49152
    s_nop 0
    buffer_load_dwordx4 v4, s[16:19], s28 offen lds
    s_add_u32 s23, s20, 40960
    s_add_u32 m0, s22, 36864
    s_nop 0
    buffer_load_dwordx4 v3, s[12:15], s23 offen lds
    s_add_u32 s28, s30, 61440
    s_add_u32 m0, s22, 53248
    s_nop 0
    buffer_load_dwordx4 v4, s[16:19], s28 offen lds
    s_add_u32 s23, s20, 81920
    s_add_u32 m0, s22, 40960
    s_nop 0
    buffer_load_dwordx4 v3, s[12:15], s23 offen lds
    s_add_u32 s28, s30, 122880
    s_add_u32 m0, s22, 57344
    s_nop 0
    buffer_load_dwordx4 v4, s[16:19], s28 offen lds
    s_add_u32 s23, s20, 122880
    s_add_u32 m0, s22, 45056
    s_nop 0
    buffer_load_dwordx4 v3, s[12:15], s23 offen lds
    s_add_u32 s28, s30, 184320
    s_add_u32 m0, s22, 61440
    s_nop 0
    buffer_load_dwordx4 v4, s[16:19], s28 offen lds
    s_add_u32 s20, s20, 128
    s_add_u32 s30, s30, 245760
    s_waitcnt lgkmcnt(0)
    s_mul_i32 s58, s58, 0x9e3779b1
    s_add_u32 s58, s58, 0x7f4a7c15
    v_and_b32 v5, 15, v0
    s_cmp_eq_u32 s6, 1
    s_cselect_b32 s28, 1, 16
    s_mul_i32 s28, s28, 128
    v_mul_lo_u32 v47, v5, s28
    s_lshl_b32 s65, s5, 4
    s_cmp_eq_u32 s6, 1
    s_cselect_b32 s65, s65, s4
    s_mul_i32 s65, s65, 128
    s_add_u32 s65, s65, 30502912
    s_cmp_lg_u32 s6, 0
    s_cbranch_scc1 vmw_5
    s_waitcnt vmcnt(17)
    s_branch vmw_4
vmw_5:
    s_waitcnt vmcnt(16)
vmw_4:
    s_barrier
    s_add_u32 s23, s20, 0
    s_add_u32 m0, s22, 65536
    s_nop 0
    buffer_load_dwordx4 v3, s[12:15], s23 offen lds
    s_add_u32 s28, s30, 0
    s_add_u32 m0, s22, 81920
    s_nop 0
    buffer_load_dwordx4 v4, s[16:19], s28 offen lds
    s_add_u32 s23, s20, 40960
    s_add_u32 m0, s22, 69632
    s_nop 0
    buffer_load_dwordx4 v3, s[12:15], s23 offen lds
    s_add_u32 s28, s30, 61440
    s_add_u32 m0, s22, 86016
    s_nop 0
    buffer_load_dwordx4 v4, s[16:19], s28 offen lds
    s_add_u32 s23, s20, 81920
    s_add_u32 m0, s22, 73728
    s_nop 0
    buffer_load_dwordx4 v3, s[12:15], s23 offen lds
    s_add_u32 s28, s30, 122880
    s_add_u32 m0, s22, 90112
    s_nop 0
    buffer_load_dwordx4 v4, s[16:19], s28 offen lds
    s_add_u32 s23, s20, 122880
    s_add_u32 m0, s22, 77824
    s_nop 0
    buffer_load_dwordx4 v3, s[12:15], s23 offen lds
    s_add_u32 s28, s30, 184320
    s_add_u32 m0, s22, 94208
    s_nop 0
    buffer_load_dwordx4 v4, s[16:19], s28 offen lds
    s_add_u32 s20, s20, 128
    s_add_u32 s30, s30, 245760
    s_cmp_lg_u32 s6, 0
    s_cbranch_scc1 vmw_7
    s_waitcnt vmcnt(17)
    s_branch vmw_6
vmw_7:
    s_waitcnt vmcnt(16)
vmw_6:
    s_barrier
    s_add_u32 s23, s20, 0
    s_add_u32 m0, s22, 98304
    s_nop 0
    buffer_load_dwordx4 v3, s[12:15], s23 offen lds
    s_add_u32 s28, s30, 0
    s_add_u32 m0, s22, 114688
    s_nop 0
    buffer_load_dwordx4 v4, s[16:19], s28 offen lds
    s_add_u32 s23, s20, 40960
    s_add_u32 m0, s22, 102400
    s_nop 0
    buffer_load_dwordx4 v3, s[12:15], s23 offen lds
    s_add_u32 s28, s30, 61440
    s_add_u32 m0, s22, 118784
    s_nop 0
    buffer_load_dwordx4 v4, s[16:19], s28 offen lds
    s_add_u32 s23, s20, 81920
    s_add_u32 m0, s22, 106496
    s_nop 0
    buffer_load_dwordx4 v3, s[12:15], s23 offen lds
    s_add_u32 s28, s30, 122880
    s_add_u32 m0, s22, 122880
    s_nop 0
    buffer_load_dwordx4 v4, s[16:19], s28 offen lds
    s_add_u32 s23, s20, 122880
    s_add_u32 m0, s22, 110592
    s_nop 0
    buffer_load_dwordx4 v3, s[12:15], s23 offen lds
    s_add_u32 s28, s30, 184320
    s_add_u32 m0, s22, 126976
    s_nop 0
    buffer_load_dwordx4 v4, s[16:19], s28 offen lds
    s_add_u32 s20, s20, 128
    s_add_u32 s30, s30, 245760
    s_waitcnt vmcnt(16)
    s_barrier
    s_add_u32 s23, s20, 0
    s_add_u32 m0, s22, 0
    s_nop 0
    buffer_load_dwordx4 v3, s[12:15], s23 offen lds
    s_add_u32 s28, s30, 0
    s_add_u32 m0, s22, 16384
    s_nop 0
    buffer_load_dwordx4 v4, s[16:19], s28 offen lds
    s_add_u32 s23, s20, 40960
    s_add_u32 m0, s22, 4096
    s_nop 0
    buffer_load_dwordx4 v3, s[12:15], s23 offen lds
    s_add_u32 s28, s30, 61440
    s_add_u32 m0, s22, 20480
    s_nop 0
    buffer_load_dwordx4 v4, s[16:19], s28 offen lds
    s_add_u32 s23, s20, 81920
    s_add_u32 m0, s22, 8192
    s_nop 0
    buffer_load_dwordx4 v3, s[12:15], s23 offen lds
    s_add_u32 s28, s30, 122880
    s_add_u32 m0, s22, 24576
    s_nop 0
    buffer_load_dwordx4 v4, s[16:19], s28 offen lds
    s_add_u32 s23, s20, 122880
    s_add_u32 m0, s22, 12288
    s_nop 0
    buffer_load_dwordx4 v3, s[12:15], s23 offen lds
    s_add_u32 s28, s30, 184320
    s_add_u32 m0, s22, 28672
    s_nop 0
    buffer_load_dwordx4 v4, s[16:19], s28 offen lds
    s_add_u32 s20, s20, 128
    s_add_u32 s30, s30, 245760
    s_waitcnt vmcnt(16)
    s_barrier
    buffer_load_dword v74, v47, s[8:11], s65 offen sc1
    s_add_u32 s23, s20, 0
    s_add_u32 m0, s22, 32768
    s_nop 0
    buffer_load_dwordx4 v3, s[12:15], s23 offen lds
    s_add_u32 s28, s30, 0
    s_add_u32 m0, s22, 49152
    s_nop 0
    buffer_load_dwordx4 v4, s[16:19], s28 offen lds
    s_add_u32 s23, s20, 40960
    s_add_u32 m0, s22, 36864
    s_nop 0
    buffer_load_dwordx4 v3, s[12:15], s23 offen lds
    s_add_u32 s28, s30, 61440
    s_add_u32 m0, s22, 53248
    s_nop 0
    buffer_load_dwordx4 v4, s[16:19], s28 offen lds
    s_add_u32 s23, s20, 81920
    s_add_u32 m0, s22, 40960
    s_nop 0
    buffer_load_dwordx4 v3, s[12:15], s23 offen lds
    s_add_u32 s28, s30, 122880
    s_add_u32 m0, s22, 57344
    s_nop 0
    buffer_load_dwordx4 v4, s[16:19], s28 offen lds
    s_add_u32 s23, s20, 122880
    s_add_u32 m0, s22, 45056
    s_nop 0
    buffer_load_dwordx4 v3, s[12:15], s23 offen lds
    s_add_u32 s28, s30, 184320
    s_add_u32 m0, s22, 61440
    s_nop 0
    buffer_load_dwordx4 v4, s[16:19], s28 offen lds
    s_add_u32 s20, s20, 128
    s_add_u32 s30, s30, 245760
    s_waitcnt vmcnt(17)
    s_barrier
    s_waitcnt vmcnt(8)
    v_cmp_ne_u32 vcc, s58, v74
    s_nop 4
    s_cbranch_vccz f0ok_8
    s_mov_b32 s59, 0x40000
poll_9:
    buffer_load_dword v74, v47, s[8:11], s65 offen sc1
    s_waitcnt vmcnt(0)
    v_cmp_ne_u32 vcc, s58, v74
    s_sub_u32 s59, s59, 1
    s_nop 2
    s_cbranch_vccz pollok_10
    s_cmp_eq_u32 s59, 0
    s_cbranch_scc1 pollok_10
    s_sleep 1
    s_branch poll_9
pollok_10:
f0ok_8:
    s_cmp_lg_u32 s6, 1
    s_cbranch_scc1 only_11
    v_lshlrev_b32 v5, 3, v0
    s_lshl_b32 s28, s5, 13
    s_add_u32 s28, s28, 30371840
    s_add_u32 s29, s28, 4096
    buffer_load_dwordx2 v[80:81], v5, s[8:11], s28 offen offset:0 sc1
    buffer_load_dwordx2 v[82:83], v5, s[8:11], s28 offen offset:512 sc1
    buffer_load_dwordx2 v[84:85], v5, s[8:11], s28 offen offset:1024 sc1
    buffer_load_dwordx2 v[86:87], v5, s[8:11], s28 offen offset:1536 sc1
    buffer_load_dwordx2 v[88:89], v5, s[8:11], s28 offen offset:2048 sc1
    buffer_load_dwordx2 v[90:91], v5, s[8:11], s28 offen offset:2560 sc1
    buffer_load_dwordx2 v[92:93], v5, s[8:11], s28 offen offset:3072 sc1
    buffer_load_dwordx2 v[94:95], v5, s[8:11], s28 offen offset:3584 sc1
    buffer_load_dwordx2 v[96:97], v5, s[8:11], s29 offen offset:0 sc1
    buffer_load_dwordx2 v[98:99], v5, s[8:11], s29 offen offset:512 sc1
    buffer_load_dwordx2 v[100:101], v5, s[8:11], s29 offen offset:1024 sc1
    buffer_load_dwordx2 v[102:103], v5, s[8:11], s29 offen offset:1536 sc1
    buffer_load_dwordx2 v[104:105], v5, s[8:11], s29 offen offset:2048 sc1
    buffer_load_dwordx2 v[106:107], v5, s[8:11], s29 offen offset:2560 sc1
    buffer_load_dwordx2 v[108:109], v5, s[8:11], s29 offen offset:3072 sc1
    buffer_load_dwordx2 v[110:111], v5, s[8:11], s29 offen offset:3584 sc1
only_11:
    s_cmp_lg_u32 s6, 2
    s_cbranch_scc1 only_12
    v_bfe_u32 v5, v0, 1, 4
    v_lshlrev_b32 v5, 7, v5
    v_and_b32 v6, 1, v0
    v_lshl_add_u32 v5, v6, 4, v5
    v_lshrrev_b32 v6, 5, v0
    v_lshl_add_u32 v5, v6, 5, v5
    s_lshl_b32 s28, s4, 11
    s_add_u32 s28, s28, 30339072
    s_mov_b32 m0, 155648
    s_nop 0
    buffer_load_dwordx4 v5, s[8:11], s28 offen sc1 lds
only_12:
    s_barrier
    s_cmp_lg_u32 s6, 3
    s_cbranch_scc1 only_13
    s_mov_b32 s78, s4
    s_mov_b32 s79, s5
    s_mov_b32 s80, s6
    s_lshl_b32 s28, s5, 4
    s_add_u32 s28, s28, s4
    v_mov_b32 v242, s28
    s_and_b32 s4, s2, 7
    s_lshl_b32 s4, s4, 1
    s_lshr_b32 s5, s2, 7
    s_add_u32 s4, s4, s5
    s_bfe_u32 s5, s2, 0x40003
    s_lshl_b32 s28, s5, 4
    s_add_u32 s28, s28, s4
    v_writelane_b32 v242, s28, 2
    s_and_b32 s6, s2, 3
    s_lshl_b32 s6, s6, 3
    s_bfe_u32 s4, s2, 0x30003
    s_add_u32 s4, s4, s6
    s_bfe_u32 s6, s2, 0x10002
    s_lshl_b32 s6, s6, 2
    s_lshr_b32 s5, s2, 6
    s_add_u32 s5, s5, s6
    s_lshl_b32 s28, s4, 3
    s_add_u32 s28, s28, s5
    v_writelane_b32 v242, s28, 3
    s_and_b32 s6, s2, 1
    s_lshl_b32 s6, s6, 3
    s_bfe_u32 s4, s2, 0x30003
    s_add_u32 s4, s4, s6
    s_bfe_u32 s6, s2, 0x20001
    s_lshl_b32 s6, s6, 2
    s_lshr_b32 s5, s2, 6
    s_add_u32 s5, s5, s6
    s_lshl_b32 s28, s4, 4
    s_add_u32 s28, s28, s5
    v_writelane_b32 v242, s28, 4
    s_mov_b32 s4, s78
    s_mov_b32 s5, s79
    s_mov_b32 s6, s80
    v_lshl_add_u32 v242, v0, 8, v242
    v_mul_u32_u24 v242, 128, v242
    s_mov_b32 s28, 30502912
    s_mov_b64 exec, 0x1f
    buffer_load_dword v246, v242, s[8:11], s28 offen sc1
    s_mov_b64 exec, -1
nfs_14:
only_13:
    s_cmp_lg_u32 s6, 1
    s_cbranch_scc1 only_15
    s_waitcnt vmcnt(0)
    v_add_f32 v80, v80, v96
    v_add_f32 v81, v81, v97
    v_add_f32 v82, v82, v98
    v_add_f32 v83, v83, v99
    v_add_f32 v84, v84, v100
    v_add_f32 v85, v85, v101
    v_add_f32 v86, v86, v102
    v_add_f32 v87, v87, v103
    v_add_f32 v88, v88, v104
    v_add_f32 v89, v89, v105
    v_add_f32 v90, v90, v106
    v_add_f32 v91, v91, v107
    v_add_f32 v92, v92, v108
    v_add_f32 v93, v93, v109
    v_add_f32 v94, v94, v110
    v_add_f32 v95, v95, v111
    v_add_f32 v80, v80, v88
    v_add_f32 v81, v81, v89
    v_add_f32 v82, v82, v90
    v_add_f32 v83, v83, v91
    v_add_f32 v84, v84, v92
    v_add_f32 v85, v85, v93
    v_add_f32 v86, v86, v94
    v_add_f32 v87, v87, v95
    v_add_f32 v80, v80, v84
    v_add_f32 v81, v81, v85
    v_add_f32 v82, v82, v86
    v_add_f32 v83, v83, v87
    v_add_f32 v80, v80, v82
    v_add_f32 v81, v81, v83
    v_add_u32 v5, 156672, v5
    ds_write_b64 v5, v[80:81]
    s_waitcnt lgkmcnt(0)
only_15:
    s_cmp_lg_u32 s6, 3
    s_cbranch_scc1 vmw_17
    s_waitcnt vmcnt(1)
    s_branch vmw_16
vmw_17:
    s_waitcnt vmcnt(0)
vmw_16:
    s_barrier
    v_lshrrev_b32 v20, 3, v0
    v_and_b32 v240, 2, v20
    v_lshlrev_b32 v240, 1, v240
    v_and_b32 v21, 7, v0
    v_xor_b32 v21, v21, v240
    v_lshlrev_b32 v21, 4, v21
    v_lshrrev_b32_e64 v23, 5, v0
    v_bfe_u32 v24, v0, 4, 1
    v_and_b32_e64 v25, 15, v0
    v_bfe_u32 v240, v0, 2, 2
    v_lshl_add_u32 v22, v23, 3, v240
    v_lshlrev_b32 v22, 7, v22
    v_lshrrev_b32 v240, 1, v240
    v_lshl_add_u32 v22, v240, 6, v22
    v_lshl_add_u32 v22, v24, 5, v22
    v_and_b32_e64 v240, 3, v0
    v_lshl_add_u32 v22, v240, 3, v22
    v_bfe_u32 v240, v0, 2, 1
    v_lshlrev_b32 v26, 4, v240
    v_bfe_u32 v240, v0, 3, 1
    v_lshl_add_u32 v26, v240, 2, v26
    v_and_b32 v240, 3, v0
    v_add_u32_e64 v26, v26, v240
    v_lshl_add_u32 v26, v23, 5, v26
    v_lshlrev_b32 v26, 4, v26
    v_bfe_u32 v240, v0, 2, 1
    v_lshlrev_b32 v26, 11, v240
    v_bfe_u32 v240, v0, 3, 1
    v_lshl_add_u32 v26, v240, 6, v26
    v_and_b32 v240, 3, v0
    v_lshl_add_u32 v26, v240, 4, v26
    v_lshrrev_b32 v240, 1, v25
    v_xor_b32 v240, v240, v25
    v_and_b32 v240, 4, v240
    v_lshl_or_b32 v240, v240, 1, v240
    v_xor_b32 v27, v240, v25
    v_lshlrev_b32 v27, 4, v27
    v_bfe_u32 v240, v0, 2, 1
    v_lshlrev_b32 v27, 10, v240
    v_bfe_u32 v240, v0, 3, 1
    v_lshl_add_u32 v27, v240, 6, v27
    v_and_b32 v240, 3, v0
    v_lshl_add_u32 v27, v240, 4, v27
    s_and_b32 s69, s3, 3
    s_lshl_b32 s60, s2, 2
    s_add_u32 s60, s60, s69
    s_mul_i32 s69, s69, 6144
    s_add_u32 s69, s69, 131072
    v_add_u32 v34, s69, v22
    v_xor_b32 v35, 64, v34
    s_mul_i32 s33, s60, 2731
    s_lshr_b32 s33, s33, 16
    s_mul_i32 s34, s33, 24
    s_sub_u32 s34, s60, s34
    v_mul_u32_u24 v36, 3072, v20
    v_add_u32 v36, v36, v21
    s_mul_i32 s70, s33, 49152
    s_lshl_b32 s37, s34, 7
    s_add_u32 s70, s70, s37
    s_add_u32 s71, s70, 24576
    s_cmp_ge_u32 s60, 960
    s_cselect_b32 s39, 0x80000000, 0
    s_add_u32 s39, s39, 23887872
    s_lshl_b32 s38, s34, 2
    s_add_u32 s38, s38, 0
    v_add_u32 v241, s38, v24
    v_mul_u32_u24 v242, 171, v241
    v_lshrrev_b32 v242, 10, v242
    v_mul_u32_u24 v243, 6, v242
    v_sub_u32 v243, v241, v243
    v_mul_u32_u24 v242, 245760, v242
    s_lshr_b32 s35, s33, 1
    s_mul_i32 s35, s35, 12288
    s_and_b32 s36, s33, 1
    s_lshl_b32 s36, s36, 9
    s_add_u32 s35, s35, s36
    v_add_u32 v242, s35, v242
    v_lshl_add_u32 v242, v23, 8, v242
    v_cmp_lt_u32 vcc, 2, v243
    v_mov_b32 v241, 6144
    s_nop 0
    v_cndmask_b32 v241, 0, v241, vcc
    v_add_u32 v242, v242, v241
    v_and_b32 v241, 1, v243
    v_lshl_add_u32 v241, v241, 7, v26
    v_lshlrev_b32 v244, 4, v25
    v_add_u32 v244, 4096, v244
    v_and_b32 v243, 6, v243
    v_cmp_eq_u32 vcc, 2, v243
    s_nop 1
    v_cndmask_b32 v241, v241, v244, vcc
    v_add3_u32 v28, v242, v241, s39
    s_lshl_b32 s38, s34, 2
    s_add_u32 s38, s38, 2
    v_add_u32 v241, s38, v24
    v_mul_u32_u24 v242, 171, v241
    v_lshrrev_b32 v242, 10, v242
    v_mul_u32_u24 v243, 6, v242
    v_sub_u32 v243, v241, v243
    v_mul_u32_u24 v242, 245760, v242
    s_lshr_b32 s35, s33, 1
    s_mul_i32 s35, s35, 12288
    s_and_b32 s36, s33, 1
    s_lshl_b32 s36, s36, 9
    s_add_u32 s35, s35, s36
    v_add_u32 v242, s35, v242
    v_lshl_add_u32 v242, v23, 8, v242
    v_cmp_lt_u32 vcc, 2, v243
    v_mov_b32 v241, 6144
    s_nop 0
    v_cndmask_b32 v241, 0, v241, vcc
    v_add_u32 v242, v242, v241
    v_and_b32 v241, 1, v243
    v_lshl_add_u32 v241, v241, 7, v26
    v_lshlrev_b32 v244, 4, v25
    v_add_u32 v244, 4096, v244
    v_and_b32 v243, 6, v243
    v_cmp_eq_u32 vcc, 2, v243
    s_nop 1
    v_cndmask_b32 v241, v241, v244, vcc
    v_add3_u32 v29, v242, v241, s39
    s_mul_i32 s33, s60, 2731
    s_lshr_b32 s33, s33, 16
    s_mul_i32 s34, s33, 24
    s_sub_u32 s34, s60, s34
    v_mul_u32_u24 v37, 3072, v20
    v_add_u32 v37, v37, v21
    s_mul_i32 s72, s33, 49152
    s_lshl_b32 s37, s34, 7
    s_add_u32 s72, s72, s37
    s_add_u32 s73, s72, 24576
    s_cmp_ge_u32 s60, 960
    s_cselect_b32 s39, 0x80000000, 0
    s_add_u32 s39, s39, 23888896
    s_lshl_b32 s38, s34, 2
    s_add_u32 s38, s38, 0
    v_add_u32 v241, s38, v24
    v_mul_u32_u24 v242, 171, v241
    v_lshrrev_b32 v242, 10, v242
    v_mul_u32_u24 v243, 6, v242
    v_sub_u32 v243, v241, v243
    v_mul_u32_u24 v242, 245760, v242
    s_lshr_b32 s35, s33, 1
    s_mul_i32 s35, s35, 12288
    s_and_b32 s36, s33, 1
    s_lshl_b32 s36, s36, 9
    s_add_u32 s35, s35, s36
    v_add_u32 v242, s35, v242
    v_lshl_add_u32 v242, v23, 8, v242
    v_cmp_lt_u32 vcc, 2, v243
    v_mov_b32 v241, 6144
    s_nop 0
    v_cndmask_b32 v241, 0, v241, vcc
    v_add_u32 v242, v242, v241
    v_and_b32 v241, 1, v243
    v_lshl_add_u32 v241, v241, 7, v26
    v_lshlrev_b32 v244, 4, v25
    v_add_u32 v244, 4096, v244
    v_and_b32 v243, 6, v243
    v_cmp_eq_u32 vcc, 2, v243
    s_nop 1
    v_cndmask_b32 v241, v241, v244, vcc
    v_add3_u32 v30, v242, v241, s39
    s_lshl_b32 s38, s34, 2
    s_add_u32 s38, s38, 2
    v_add_u32 v241, s38, v24
    v_mul_u32_u24 v242, 171, v241
    v_lshrrev_b32 v242, 10, v242
    v_mul_u32_u24 v243, 6, v242
    v_sub_u32 v243, v241, v243
    v_mul_u32_u24 v242, 245760, v242
    s_lshr_b32 s35, s33, 1
    s_mul_i32 s35, s35, 12288
    s_and_b32 s36, s33, 1
    s_lshl_b32 s36, s36, 9
    s_add_u32 s35, s35, s36
    v_add_u32 v242, s35, v242
    v_lshl_add_u32 v242, v23, 8, v242
    v_cmp_lt_u32 vcc, 2, v243
    v_mov_b32 v241, 6144
    s_nop 0
    v_cndmask_b32 v241, 0, v241, vcc
    v_add_u32 v242, v242, v241
    v_and_b32 v241, 1, v243
    v_lshl_add_u32 v241, v241, 7, v26
    v_lshlrev_b32 v244, 4, v25
    v_add_u32 v244, 4096, v244
    v_and_b32 v243, 6, v243
    v_cmp_eq_u32 vcc, 2, v243
    s_nop 1
    v_cndmask_b32 v241, v241, v244, vcc
    v_add3_u32 v31, v242, v241, s39
    s_mul_i32 s33, s60, 6554
    s_lshr_b32 s33, s33, 16
    s_mul_i32 s34, s33, 10
    s_sub_u32 s34, s60, s34
    v_mul_u32_u24 v38, 1280, v20
    v_add_u32 v38, v38, v21
    s_mul_i32 s74, s33, 20480
    s_lshl_b32 s37, s34, 7
    s_add_u32 s74, s74, s37
    s_add_u32 s75, s74, 10240
    s_cmp_ge_u32 s60, 960
    s_cselect_b32 s39, 0x80000000, 0
    s_add_u32 s39, s39, 28082176
    s_lshl_b32 s38, s34, 2
    s_add_u32 s38, s38, 0
    v_add_u32 v241, s38, v24
    v_mul_u32_u24 v242, 205, v241
    v_lshrrev_b32 v242, 10, v242
    v_mul_u32_u24 v243, 5, v242
    v_sub_u32 v243, v241, v243
    v_mul_u32_u24 v242, 245760, v242
    s_lshr_b32 s35, s33, 1
    s_mul_i32 s35, s35, 5120
    s_and_b32 s36, s33, 1
    s_lshl_b32 s36, s36, 9
    s_add_u32 s35, s35, s36
    v_add_u32 v242, s35, v242
    v_lshl_add_u32 v242, v23, 8, v242
    v_lshrrev_b32 v241, 1, v243
    v_lshl_add_u32 v242, v241, 11, v242
    v_and_b32 v241, 1, v243
    v_lshl_add_u32 v241, v241, 7, v27
    v_lshlrev_b32 v244, 4, v25
    v_cmp_eq_u32 vcc, 4, v243
    s_nop 1
    v_cndmask_b32 v241, v241, v244, vcc
    v_add_u32 v242, v242, v241
    v_add_u32 v32, s39, v242
    s_lshl_b32 s38, s34, 2
    s_add_u32 s38, s38, 2
    v_add_u32 v241, s38, v24
    v_mul_u32_u24 v242, 205, v241
    v_lshrrev_b32 v242, 10, v242
    v_mul_u32_u24 v243, 5, v242
    v_sub_u32 v243, v241, v243
    v_mul_u32_u24 v242, 245760, v242
    s_lshr_b32 s35, s33, 1
    s_mul_i32 s35, s35, 5120
    s_and_b32 s36, s33, 1
    s_lshl_b32 s36, s36, 9
    s_add_u32 s35, s35, s36
    v_add_u32 v242, s35, v242
    v_lshl_add_u32 v242, v23, 8, v242
    v_lshrrev_b32 v241, 1, v243
    v_lshl_add_u32 v242, v241, 11, v242
    v_and_b32 v241, 1, v243
    v_lshl_add_u32 v241, v241, 7, v27
    v_lshlrev_b32 v244, 4, v25
    v_cmp_eq_u32 vcc, 4, v243
    s_nop 1
    v_cndmask_b32 v241, v241, v244, vcc
    v_add_u32 v242, v242, v241
    v_add_u32 v33, s39, v242
    v_mov_b32 v248, 0
    v_mov_b32 v249, 0
    s_mov_b32 s68, 1
    s_mov_b32 s82, 1
    s_mov_b32 s81, 0
    s_branch p2_start
p1_comp:
    s_mov_b32 s6, s3
    v_lshrrev_b32 v42, 5, v0
    s_lshl_b32 s28, s6, 1
    v_add_u32_e64 v42, s28, v42
    v_mul_u32_u24 v40, 1280, v42
    v_and_b32 v43, 31, v0
    v_lshl_add_u32 v40, v43, 4, v40
    v_bfe_u32 v41, v0, 4, 1
    v_lshl_or_b32 v41, v41, 31, v40
    v_lshlrev_b32 v42, 2, v42
    v_add_u32 v42, 157184, v42
    s_lshl_b32 s63, s4, 4
    s_add_u32 s63, s63, s5
    s_mul_i32 s62, s63, 10240
    s_lshl_b32 s63, s63, 7
    s_add_u32 s63, s63, 30339072
    v_lshrrev_b32 v45, 4, v0
    s_mul_i32 s28, s6, 10
    v_add_u32 v44, s28, v45
    v_mul_u32_u24 v44, 3840, v44
    v_and_b32 v46, 15, v0
    v_lshl_add_u32 v44, v46, 4, v44
    v_lshlrev_b32 v46, 5, v46
    v_lshl_add_u32 v46, v45, 3, v46
    s_lshl_b32 s28, s6, 9
    s_add_u32 s28, s28, 157696
    v_add_u32 v46, s28, v46
    v_lshrrev_b32 v45, 5, v0
    v_lshl_or_b32 v45, v45, 31, v44
    s_mul_i32 s64, s4, 153600
    s_lshl_b32 s28, s5, 8
    s_add_u32 s64, s64, s28
    s_waitcnt lgkmcnt(0)
    s_mov_b32 s12, s40
    s_mov_b32 s13, s41
    s_mov_b32 s14, 2621440
    s_mov_b32 s15, 0x20000
    s_mov_b32 s16, s42
    s_mov_b32 s17, s43
    s_mov_b32 s18, 2457600
    s_mov_b32 s19, 0x20000
    s_add_u32 s56, s56, 67108864
    s_addc_u32 s57, s57, 0
    s_mov_b32 s8, s56
    s_mov_b32 s9, s57
    s_mov_b32 s10, 31268864
    s_mov_b32 s11, 0x20000
    s_cmp_ge_u32 s5, 10
    s_cbranch_scc1 p1_vpath
    s_and_b32 s6, s3, 1
    s_lshr_b32 s7, s3, 1
    v_and_b32 v2, 15, v0
    v_lshrrev_b32 v3, 4, v0
    v_lshrrev_b32 v5, 2, v2
    v_and_b32 v4, 3, v0
    v_lshl_add_u32 v4, v5, 3, v4
    v_bfe_u32 v6, v0, 1, 1
    v_lshl_or_b32 v5, v5, 1, v6
    v_xor_b32 v5, v5, v3
    v_lshlrev_b32 v5, 4, v5
    v_lshl_add_u32 v5, v4, 7, v5
    s_lshl_b32 s28, s6, 13
    v_add_u32 v8, s28, v5
    v_xor_b32 v9, 64, v8
    v_bfe_u32 v5, v0, 2, 2
    v_lshlrev_b32 v5, 6, v5
    v_lshl_add_u32 v5, v3, 11, v5
    v_bfe_u32 v6, v0, 4, 1
    v_lshl_add_u32 v5, v6, 5, v5
    v_and_b32 v6, 3, v0
    v_lshl_add_u32 v5, v6, 3, v5
    s_lshl_b32 s28, s7, 9
    s_add_u32 s28, s28, 16384
    v_add_u32 v12, s28, v5
    v_xor_b32 v13, 32, v12
    v_add_u32 v10, 0x10000, v8
    v_add_u32 v14, 0x10000, v12
    v_add_u32 v11, 0x10000, v9
    v_add_u32 v15, 0x10000, v13
    s_barrier
    ds_read_b128 v[128:131], v8 offset:0
    ds_read_b64_tr_b16 v[144:145], v12 offset:0
    ds_read_b64_tr_b16 v[146:147], v12 offset:1024
    ds_read_b128 v[132:135], v8 offset:512
    ds_read_b128 v[136:139], v8 offset:4096
    ds_read_b128 v[140:143], v8 offset:4608
    ds_read_b64_tr_b16 v[148:149], v13 offset:0
    ds_read_b64_tr_b16 v[150:151], v13 offset:1024
    ds_read_b64_tr_b16 v[152:153], v12 offset:256
    ds_read_b64_tr_b16 v[154:155], v12 offset:1280
    ds_read_b64_tr_b16 v[156:157], v13 offset:256
    ds_read_b64_tr_b16 v[158:159], v13 offset:1280
    buffer_load_dwordx4 v[48:51], v40, s[12:15], s62 offen
    buffer_load_dwordx4 v[52:55], v40, s[12:15], s62 offen offset:512
    buffer_load_dwordx4 v[56:59], v41, s[12:15], s62 offen offset:1024
    buffer_load_dwordx4 v[192:195], v44, s[16:19], s64 offen
    s_add_u32 s28, s64, 15360
    buffer_load_dwordx4 v[196:199], v44, s[16:19], s28 offen
    s_add_u32 s28, s64, 30720
    buffer_load_dwordx4 v[200:203], v45, s[16:19], s28 offen
    v_mov_b32 v232, 0
    s_mov_b32 s28, 30672896
    buffer_load_dword v232, v232, s[8:11], s28 offen sc1
    s_waitcnt lgkmcnt(0)
    v_mfma_f32_16x16x32_bf16 v[64:67], v[144:147], v[128:131], 0
    ds_read_b128 v[160:163], v9 offset:0
    v_mfma_f32_16x16x32_bf16 v[68:71], v[144:147], v[132:135], 0
    ds_read_b64_tr_b16 v[176:177], v12 offset:8192
    v_mfma_f32_16x16x32_bf16 v[72:75], v[144:147], v[136:139], 0
    ds_read_b64_tr_b16 v[178:179], v12 offset:9216
    v_mfma_f32_16x16x32_bf16 v[76:79], v[144:147], v[140:143], 0
    ds_read_b128 v[164:167], v9 offset:512
    v_mfma_f32_16x16x32_bf16 v[80:83], v[148:151], v[128:131], 0
    ds_read_b128 v[168:171], v9 offset:4096
    v_mfma_f32_16x16x32_bf16 v[84:87], v[148:151], v[132:135], 0
    ds_read_b128 v[172:175], v9 offset:4608
    v_mfma_f32_16x16x32_bf16 v[88:91], v[148:151], v[136:139], 0
    ds_read_b64_tr_b16 v[180:181], v13 offset:8192
    v_mfma_f32_16x16x32_bf16 v[92:95], v[148:151], v[140:143], 0
    ds_read_b64_tr_b16 v[182:183], v13 offset:9216
    v_mfma_f32_16x16x32_bf16 v[96:99], v[152:155], v[128:131], 0
    ds_read_b64_tr_b16 v[184:185], v12 offset:8448
    v_mfma_f32_16x16x32_bf16 v[100:103], v[152:155], v[132:135], 0
    ds_read_b64_tr_b16 v[186:187], v12 offset:9472
    v_mfma_f32_16x16x32_bf16 v[104:107], v[152:155], v[136:139], 0
    ds_read_b64_tr_b16 v[188:189], v13 offset:8448
    v_mfma_f32_16x16x32_bf16 v[108:111], v[152:155], v[140:143], 0
    ds_read_b64_tr_b16 v[190:191], v13 offset:9472
    v_mfma_f32_16x16x32_bf16 v[112:115], v[156:159], v[128:131], 0
    v_mfma_f32_16x16x32_bf16 v[116:119], v[156:159], v[132:135], 0
    v_mfma_f32_16x16x32_bf16 v[120:123], v[156:159], v[136:139], 0
    v_mfma_f32_16x16x32_bf16 v[124:127], v[156:159], v[140:143], 0
    s_waitcnt lgkmcnt(0)
    v_mfma_f32_16x16x32_bf16 v[64:67], v[176:179], v[160:163], v[64:67]
    s_barrier
    ds_read_b128 v[128:131], v8 offset:32768
    v_mfma_f32_16x16x32_bf16 v[68:71], v[176:179], v[164:167], v[68:71]
    ds_read_b64_tr_b16 v[144:145], v12 offset:32768
    v_mfma_f32_16x16x32_bf16 v[72:75], v[176:179], v[168:171], v[72:75]
    ds_read_b64_tr_b16 v[146:147], v12 offset:33792
    v_mfma_f32_16x16x32_bf16 v[76:79], v[176:179], v[172:175], v[76:79]
    ds_read_b128 v[132:135], v8 offset:33280
    v_mfma_f32_16x16x32_bf16 v[80:83], v[180:183], v[160:163], v[80:83]
    ds_read_b128 v[136:139], v8 offset:36864
    v_mfma_f32_16x16x32_bf16 v[84:87], v[180:183], v[164:167], v[84:87]
    ds_read_b128 v[140:143], v8 offset:37376
    v_mfma_f32_16x16x32_bf16 v[88:91], v[180:183], v[168:171], v[88:91]
    ds_read_b64_tr_b16 v[148:149], v13 offset:32768
    v_mfma_f32_16x16x32_bf16 v[92:95], v[180:183], v[172:175], v[92:95]
    ds_read_b64_tr_b16 v[150:151], v13 offset:33792
    v_mfma_f32_16x16x32_bf16 v[96:99], v[184:187], v[160:163], v[96:99]
    ds_read_b64_tr_b16 v[152:153], v12 offset:33024
    v_mfma_f32_16x16x32_bf16 v[100:103], v[184:187], v[164:167], v[100:103]
    ds_read_b64_tr_b16 v[154:155], v12 offset:34048
    v_mfma_f32_16x16x32_bf16 v[104:107], v[184:187], v[168:171], v[104:107]
    ds_read_b64_tr_b16 v[156:157], v13 offset:33024
    v_mfma_f32_16x16x32_bf16 v[108:111], v[184:187], v[172:175], v[108:111]
    ds_read_b64_tr_b16 v[158:159], v13 offset:34048
    v_mfma_f32_16x16x32_bf16 v[112:115], v[188:191], v[160:163], v[112:115]
    v_mfma_f32_16x16x32_bf16 v[116:119], v[188:191], v[164:167], v[116:119]
    v_mfma_f32_16x16x32_bf16 v[120:123], v[188:191], v[168:171], v[120:123]
    v_mfma_f32_16x16x32_bf16 v[124:127], v[188:191], v[172:175], v[124:127]
    s_waitcnt lgkmcnt(0)
    v_mfma_f32_16x16x32_bf16 v[64:67], v[144:147], v[128:131], v[64:67]
    ds_read_b128 v[160:163], v9 offset:32768
    v_mfma_f32_16x16x32_bf16 v[68:71], v[144:147], v[132:135], v[68:71]
    ds_read_b64_tr_b16 v[176:177], v12 offset:40960
    v_mfma_f32_16x16x32_bf16 v[72:75], v[144:147], v[136:139], v[72:75]
    ds_read_b64_tr_b16 v[178:179], v12 offset:41984
    v_mfma_f32_16x16x32_bf16 v[76:79], v[144:147], v[140:143], v[76:79]
    ds_read_b128 v[164:167], v9 offset:33280
    v_mfma_f32_16x16x32_bf16 v[80:83], v[148:151], v[128:131], v[80:83]
    ds_read_b128 v[168:171], v9 offset:36864
    v_mfma_f32_16x16x32_bf16 v[84:87], v[148:151], v[132:135], v[84:87]
    ds_read_b128 v[172:175], v9 offset:37376
    v_mfma_f32_16x16x32_bf16 v[88:91], v[148:151], v[136:139], v[88:91]
    ds_read_b64_tr_b16 v[180:181], v13 offset:40960
    v_mfma_f32_16x16x32_bf16 v[92:95], v[148:151], v[140:143], v[92:95]
    ds_read_b64_tr_b16 v[182:183], v13 offset:41984
    v_mfma_f32_16x16x32_bf16 v[96:99], v[152:155], v[128:131], v[96:99]
    ds_read_b64_tr_b16 v[184:185], v12 offset:41216
    v_mfma_f32_16x16x32_bf16 v[100:103], v[152:155], v[132:135], v[100:103]
    ds_read_b64_tr_b16 v[186:187], v12 offset:42240
    v_mfma_f32_16x16x32_bf16 v[104:107], v[152:155], v[136:139], v[104:107]
    ds_read_b64_tr_b16 v[188:189], v13 offset:41216
    v_mfma_f32_16x16x32_bf16 v[108:111], v[152:155], v[140:143], v[108:111]
    ds_read_b64_tr_b16 v[190:191], v13 offset:42240
    v_mfma_f32_16x16x32_bf16 v[112:115], v[156:159], v[128:131], v[112:115]
    v_mfma_f32_16x16x32_bf16 v[116:119], v[156:159], v[132:135], v[116:119]
    v_mfma_f32_16x16x32_bf16 v[120:123], v[156:159], v[136:139], v[120:123]
    v_mfma_f32_16x16x32_bf16 v[124:127], v[156:159], v[140:143], v[124:127]
    s_waitcnt lgkmcnt(0)
    v_mfma_f32_16x16x32_bf16 v[64:67], v[176:179], v[160:163], v[64:67]
    s_waitcnt vmcnt(0)
    s_nop 0
    v_mov_b32 v204, 0x3f803f80
    v_dot2_f32_bf16 v208, v48, v204, 0
    v_dot2_f32_bf16 v210, v48, v48, 0
    v_dot2_f32_bf16 v209, v49, v204, 0
    v_dot2_f32_bf16 v211, v49, v49, 0
    v_dot2_f32_bf16 v208, v50, v204, v208
    v_dot2_f32_bf16 v210, v50, v50, v210
    v_dot2_f32_bf16 v209, v51, v204, v209
    v_dot2_f32_bf16 v211, v51, v51, v211
    v_dot2_f32_bf16 v208, v52, v204, v208
    v_dot2_f32_bf16 v210, v52, v52, v210
    v_dot2_f32_bf16 v209, v53, v204, v209
    v_dot2_f32_bf16 v211, v53, v53, v211
    v_dot2_f32_bf16 v208, v54, v204, v208
    v_dot2_f32_bf16 v210, v54, v54, v210
    v_dot2_f32_bf16 v209, v55, v204, v209
    v_dot2_f32_bf16 v211, v55, v55, v211
    v_dot2_f32_bf16 v208, v56, v204, v208
    v_dot2_f32_bf16 v210, v56, v56, v210
    v_dot2_f32_bf16 v209, v57, v204, v209
    v_dot2_f32_bf16 v211, v57, v57, v211
    v_dot2_f32_bf16 v208, v58, v204, v208
    v_dot2_f32_bf16 v210, v58, v58, v210
    v_dot2_f32_bf16 v209, v59, v204, v209
    v_dot2_f32_bf16 v211, v59, v59, v211
    s_nop 1
    v_add_f32 v208, v208, v209
    v_add_f32 v210, v210, v211
    s_nop 0
    v_add_f32_dpp v208, v208, v208 quad_perm:[1,0,3,2] row_mask:0xf bank_mask:0xf
    v_add_f32_dpp v210, v210, v210 quad_perm:[1,0,3,2] row_mask:0xf bank_mask:0xf
    s_nop 0
    s_nop 0
    v_add_f32_dpp v208, v208, v208 quad_perm:[2,3,0,1] row_mask:0xf bank_mask:0xf
    v_add_f32_dpp v210, v210, v210 quad_perm:[2,3,0,1] row_mask:0xf bank_mask:0xf
    s_nop 0
    v_add_f32_dpp v208, v208, v208 row_half_mirror row_mask:0xf bank_mask:0xf
    v_add_f32_dpp v210, v210, v210 row_half_mirror row_mask:0xf bank_mask:0xf
    s_nop 0
    v_add_f32_dpp v208, v208, v208 row_mirror row_mask:0xf bank_mask:0xf
    v_add_f32_dpp v210, v210, v210 row_mirror row_mask:0xf bank_mask:0xf
    v_mov_b32 v209, v208
    v_mov_b32 v211, v210
    s_nop 0
    v_permlane16_swap_b32 v208, v209
    v_permlane16_swap_b32 v210, v211
    v_add_f32 v208, v208, v209
    v_add_f32 v210, v210, v211
    v_mul_f32 v208, 0x3acccccd, v208
    v_mul_f32 v210, 0x3acccccd, v210
    v_fma_f32 v210, -v208, v208, v210
    v_max_f32 v210, 0, v210
    v_add_f32 v210, 0x3727c5ac, v210
    v_rsq_f32 v210, v210
    ds_write_b32 v42, v208
    ds_write_b32 v42, v210 offset:32
    s_nop 0
    v_mov_b32 v205, 0x3f80
    v_mov_b32_e64 v206, 0x3f800000
    v_dot2_f32_bf16 v212, v192, v205, 0
    v_dot2_f32_bf16 v213, v192, v206, 0
    v_dot2_f32_bf16 v214, v193, v205, 0
    v_dot2_f32_bf16 v215, v193, v206, 0
    v_dot2_f32_bf16 v216, v194, v205, 0
    v_dot2_f32_bf16 v217, v194, v206, 0
    v_dot2_f32_bf16 v218, v195, v205, 0
    v_dot2_f32_bf16 v219, v195, v206, 0
    v_dot2_f32_bf16 v212, v196, v205, v212
    v_dot2_f32_bf16 v213, v196, v206, v213
    v_dot2_f32_bf16 v214, v197, v205, v214
    v_dot2_f32_bf16 v215, v197, v206, v215
    v_dot2_f32_bf16 v216, v198, v205, v216
    v_dot2_f32_bf16 v217, v198, v206, v217
    v_dot2_f32_bf16 v218, v199, v205, v218
    v_dot2_f32_bf16 v219, v199, v206, v219
    v_dot2_f32_bf16 v212, v200, v205, v212
    v_dot2_f32_bf16 v213, v200, v206, v213
    v_dot2_f32_bf16 v214, v201, v205, v214
    v_dot2_f32_bf16 v215, v201, v206, v215
    v_dot2_f32_bf16 v216, v202, v205, v216
    v_dot2_f32_bf16 v217, v202, v206, v217
    v_dot2_f32_bf16 v218, v203, v205, v218
    v_dot2_f32_bf16 v219, v203, v206, v219
    v_permlane32_swap_b32 v212, v216
    v_permlane32_swap_b32 v213, v217
    v_permlane32_swap_b32 v214, v218
    v_permlane32_swap_b32 v215, v219
    v_add_f32 v212, v212, v216
    v_add_f32 v213, v213, v217
    v_add_f32 v214, v214, v218
    v_add_f32 v215, v215, v219
    s_nop 0
    v_permlane16_swap_b32 v212, v214
    v_permlane16_swap_b32 v213, v215
    v_add_f32 v212, v212, v214
    v_add_f32 v213, v213, v215
    ds_write_b64 v46, v[212:213]
    v_lshlrev_b32 v222, 3, v0
    v_add_u32 v223, 157696, v222
    s_lshl_b32 s35, s5, 4
    s_add_u32 s35, s35, s4
    s_lshl_b32 s36, s35, 9
    s_add_u32 s36, s36, 30371840
    s_mul_i32 s35, s35, 128
    s_add_u32 s35, s35, 30502912
    v_readfirstlane_b32 s58, v232
    s_waitcnt lgkmcnt(0)
    s_mul_i32 s58, s58, 0x9e3779b1
    s_add_u32 s58, s58, 0x7f4a7c15
    s_barrier
    ds_read_b128 v[128:131], v10 offset:0
    v_mfma_f32_16x16x32_bf16 v[68:71], v[176:179], v[164:167], v[68:71]
    ds_read_b64_tr_b16 v[144:145], v14 offset:0
    v_mfma_f32_16x16x32_bf16 v[72:75], v[176:179], v[168:171], v[72:75]
    ds_read_b64_tr_b16 v[146:147], v14 offset:1024
    v_mfma_f32_16x16x32_bf16 v[76:79], v[176:179], v[172:175], v[76:79]
    ds_read_b128 v[132:135], v10 offset:512
    v_mfma_f32_16x16x32_bf16 v[80:83], v[180:183], v[160:163], v[80:83]
    ds_read_b128 v[136:139], v10 offset:4096
    v_mfma_f32_16x16x32_bf16 v[84:87], v[180:183], v[164:167], v[84:87]
    ds_read_b128 v[140:143], v10 offset:4608
    v_mfma_f32_16x16x32_bf16 v[88:91], v[180:183], v[168:171], v[88:91]
    ds_read_b64_tr_b16 v[148:149], v15 offset:0
    v_mfma_f32_16x16x32_bf16 v[92:95], v[180:183], v[172:175], v[92:95]
    ds_read_b64_tr_b16 v[150:151], v15 offset:1024
    v_mfma_f32_16x16x32_bf16 v[96:99], v[184:187], v[160:163], v[96:99]
    ds_read_b64_tr_b16 v[152:153], v14 offset:256
    v_mfma_f32_16x16x32_bf16 v[100:103], v[184:187], v[164:167], v[100:103]
    ds_read_b64_tr_b16 v[154:155], v14 offset:1280
    v_mfma_f32_16x16x32_bf16 v[104:107], v[184:187], v[168:171], v[104:107]
    ds_read_b64_tr_b16 v[156:157], v15 offset:256
    v_mfma_f32_16x16x32_bf16 v[108:111], v[184:187], v[172:175], v[108:111]
    ds_read_b64_tr_b16 v[158:159], v15 offset:1280
    v_mfma_f32_16x16x32_bf16 v[112:115], v[188:191], v[160:163], v[112:115]
    v_mfma_f32_16x16x32_bf16 v[116:119], v[188:191], v[164:167], v[116:119]
    v_mfma_f32_16x16x32_bf16 v[120:123], v[188:191], v[168:171], v[120:123]
    v_mfma_f32_16x16x32_bf16 v[124:127], v[188:191], v[172:175], v[124:127]
    s_cmp_lg_u32 s3, 0
    s_cbranch_scc1 cs0_20
    ds_read_b64 v[224:225], v223 offset:0
    ds_read_b64 v[226:227], v223 offset:512
    ds_read_b64 v[228:229], v223 offset:1024
    ds_read_b64 v[230:231], v223 offset:1536
    s_waitcnt lgkmcnt(0)
    v_add_f32 v224, v224, v226
    v_add_f32 v228, v228, v230
    v_add_f32 v225, v225, v227
    v_add_f32 v229, v229, v231
    v_add_f32 v224, v224, v228
    v_add_f32 v225, v225, v229
    buffer_store_dwordx2 v[224:225], v222, s[8:11], s36 offen sc1
    v_and_b32 v226, 31, v0
    v_lshlrev_b32 v226, 2, v226
    v_and_b32 v227, 63, v226
    v_add_u32 v227, 157184, v227
    ds_read_b32 v227, v227
    s_waitcnt lgkmcnt(0)
    buffer_store_dword v227, v226, s[8:11], s63 offen sc1
cs0_20:
    s_waitcnt lgkmcnt(0)
    v_mfma_f32_16x16x32_bf16 v[64:67], v[144:147], v[128:131], v[64:67]
    ds_read_b128 v[160:163], v11 offset:0
    v_mfma_f32_16x16x32_bf16 v[68:71], v[144:147], v[132:135], v[68:71]
    ds_read_b64_tr_b16 v[176:177], v14 offset:8192
    v_mfma_f32_16x16x32_bf16 v[72:75], v[144:147], v[136:139], v[72:75]
    ds_read_b64_tr_b16 v[178:179], v14 offset:9216
    v_mfma_f32_16x16x32_bf16 v[76:79], v[144:147], v[140:143], v[76:79]
    ds_read_b128 v[164:167], v11 offset:512
    v_mfma_f32_16x16x32_bf16 v[80:83], v[148:151], v[128:131], v[80:83]
    ds_read_b128 v[168:171], v11 offset:4096
    v_mfma_f32_16x16x32_bf16 v[84:87], v[148:151], v[132:135], v[84:87]
    ds_read_b128 v[172:175], v11 offset:4608
    v_mfma_f32_16x16x32_bf16 v[88:91], v[148:151], v[136:139], v[88:91]
    ds_read_b64_tr_b16 v[180:181], v15 offset:8192
    v_mfma_f32_16x16x32_bf16 v[92:95], v[148:151], v[140:143], v[92:95]
    ds_read_b64_tr_b16 v[182:183], v15 offset:9216
    v_mfma_f32_16x16x32_bf16 v[96:99], v[152:155], v[128:131], v[96:99]
    ds_read_b64_tr_b16 v[184:185], v14 offset:8448
    v_mfma_f32_16x16x32_bf16 v[100:103], v[152:155], v[132:135], v[100:103]
    ds_read_b64_tr_b16 v[186:187], v14 offset:9472
    v_mfma_f32_16x16x32_bf16 v[104:107], v[152:155], v[136:139], v[104:107]
    ds_read_b64_tr_b16 v[188:189], v15 offset:8448
    v_mfma_f32_16x16x32_bf16 v[108:111], v[152:155], v[140:143], v[108:111]
    ds_read_b64_tr_b16 v[190:191], v15 offset:9472
    v_mfma_f32_16x16x32_bf16 v[112:115], v[156:159], v[128:131], v[112:115]
    v_mfma_f32_16x16x32_bf16 v[116:119], v[156:159], v[132:135], v[116:119]
    v_mfma_f32_16x16x32_bf16 v[120:123], v[156:159], v[136:139], v[120:123]
    v_mfma_f32_16x16x32_bf16 v[124:127], v[156:159], v[140:143], v[124:127]
    s_waitcnt lgkmcnt(0)
    v_mfma_f32_16x16x32_bf16 v[64:67], v[176:179], v[160:163], v[64:67]
    s_barrier
    ds_read_b128 v[128:131], v10 offset:32768
    v_mfma_f32_16x16x32_bf16 v[68:71], v[176:179], v[164:167], v[68:71]
    ds_read_b64_tr_b16 v[144:145], v14 offset:32768
    v_mfma_f32_16x16x32_bf16 v[72:75], v[176:179], v[168:171], v[72:75]
    ds_read_b64_tr_b16 v[146:147], v14 offset:33792
    v_mfma_f32_16x16x32_bf16 v[76:79], v[176:179], v[172:175], v[76:79]
    ds_read_b128 v[132:135], v10 offset:33280
    v_mfma_f32_16x16x32_bf16 v[80:83], v[180:183], v[160:163], v[80:83]
    ds_read_b128 v[136:139], v10 offset:36864
    v_mfma_f32_16x16x32_bf16 v[84:87], v[180:183], v[164:167], v[84:87]
    ds_read_b128 v[140:143], v10 offset:37376
    v_mfma_f32_16x16x32_bf16 v[88:91], v[180:183], v[168:171], v[88:91]
    ds_read_b64_tr_b16 v[148:149], v15 offset:32768
    v_mfma_f32_16x16x32_bf16 v[92:95], v[180:183], v[172:175], v[92:95]
    ds_read_b64_tr_b16 v[150:151], v15 offset:33792
    v_mfma_f32_16x16x32_bf16 v[96:99], v[184:187], v[160:163], v[96:99]
    ds_read_b64_tr_b16 v[152:153], v14 offset:33024
    v_mfma_f32_16x16x32_bf16 v[100:103], v[184:187], v[164:167], v[100:103]
    ds_read_b64_tr_b16 v[154:155], v14 offset:34048
    v_mfma_f32_16x16x32_bf16 v[104:107], v[184:187], v[168:171], v[104:107]
    ds_read_b64_tr_b16 v[156:157], v15 offset:33024
    v_mfma_f32_16x16x32_bf16 v[108:111], v[184:187], v[172:175], v[108:111]
    ds_read_b64_tr_b16 v[158:159], v15 offset:34048
    v_mfma_f32_16x16x32_bf16 v[112:115], v[188:191], v[160:163], v[112:115]
    v_mfma_f32_16x16x32_bf16 v[116:119], v[188:191], v[164:167], v[116:119]
    v_mfma_f32_16x16x32_bf16 v[120:123], v[188:191], v[168:171], v[120:123]
    v_mfma_f32_16x16x32_bf16 v[124:127], v[188:191], v[172:175], v[124:127]
    s_waitcnt lgkmcnt(0)
    v_mfma_f32_16x16x32_bf16 v[64:67], v[144:147], v[128:131], v[64:67]
    ds_read_b128 v[160:163], v11 offset:32768
    v_mfma_f32_16x16x32_bf16 v[68:71], v[144:147], v[132:135], v[68:71]
    ds_read_b64_tr_b16 v[176:177], v14 offset:40960
    v_mfma_f32_16x16x32_bf16 v[72:75], v[144:147], v[136:139], v[72:75]
    ds_read_b64_tr_b16 v[178:179], v14 offset:41984
    v_mfma_f32_16x16x32_bf16 v[76:79], v[144:147], v[140:143], v[76:79]
    ds_read_b128 v[164:167], v11 offset:33280
    v_mfma_f32_16x16x32_bf16 v[80:83], v[148:151], v[128:131], v[80:83]
    ds_read_b128 v[168:171], v11 offset:36864
    v_mfma_f32_16x16x32_bf16 v[84:87], v[148:151], v[132:135], v[84:87]
    ds_read_b128 v[172:175], v11 offset:37376
    v_mfma_f32_16x16x32_bf16 v[88:91], v[148:151], v[136:139], v[88:91]
    ds_read_b64_tr_b16 v[180:181], v15 offset:40960
    v_mfma_f32_16x16x32_bf16 v[92:95], v[148:151], v[140:143], v[92:95]
    ds_read_b64_tr_b16 v[182:183], v15 offset:41984
    v_mfma_f32_16x16x32_bf16 v[96:99], v[152:155], v[128:131], v[96:99]
    ds_read_b64_tr_b16 v[184:185], v14 offset:41216
    v_mfma_f32_16x16x32_bf16 v[100:103], v[152:155], v[132:135], v[100:103]
    ds_read_b64_tr_b16 v[186:187], v14 offset:42240
    v_mfma_f32_16x16x32_bf16 v[104:107], v[152:155], v[136:139], v[104:107]
    ds_read_b64_tr_b16 v[188:189], v15 offset:41216
    v_mfma_f32_16x16x32_bf16 v[108:111], v[152:155], v[140:143], v[108:111]
    ds_read_b64_tr_b16 v[190:191], v15 offset:42240
    v_mfma_f32_16x16x32_bf16 v[112:115], v[156:159], v[128:131], v[112:115]
    v_mfma_f32_16x16x32_bf16 v[116:119], v[156:159], v[132:135], v[116:119]
    v_mfma_f32_16x16x32_bf16 v[120:123], v[156:159], v[136:139], v[120:123]
    v_mfma_f32_16x16x32_bf16 v[124:127], v[156:159], v[140:143], v[124:127]
    s_waitcnt lgkmcnt(0)
    v_mfma_f32_16x16x32_bf16 v[64:67], v[176:179], v[160:163], v[64:67]
    s_waitcnt vmcnt(0)
    s_barrier
    s_cmp_lg_u32 s3, 0
    s_cbranch_scc1 fl0_21
    v_mov_b32 v224, s58
    v_mov_b32 v225, 0
    s_mov_b64 exec, 1
    buffer_store_dword v224, v225, s[8:11], s35 offen sc1
    s_mov_b64 exec, -1
fl0_21:
    ds_read_b128 v[128:131], v8 offset:0
    v_mfma_f32_16x16x32_bf16 v[68:71], v[176:179], v[164:167], v[68:71]
    ds_read_b64_tr_b16 v[144:145], v12 offset:0
    v_mfma_f32_16x16x32_bf16 v[72:75], v[176:179], v[168:171], v[72:75]
    ds_read_b64_tr_b16 v[146:147], v12 offset:1024
    v_mfma_f32_16x16x32_bf16 v[76:79], v[176:179], v[172:175], v[76:79]
    ds_read_b128 v[132:135], v8 offset:512
    v_mfma_f32_16x16x32_bf16 v[80:83], v[180:183], v[160:163], v[80:83]
    ds_read_b128 v[136:139], v8 offset:4096
    v_mfma_f32_16x16x32_bf16 v[84:87], v[180:183], v[164:167], v[84:87]
    ds_read_b128 v[140:143], v8 offset:4608
    v_mfma_f32_16x16x32_bf16 v[88:91], v[180:183], v[168:171], v[88:91]
    ds_read_b64_tr_b16 v[148:149], v13 offset:0
    v_mfma_f32_16x16x32_bf16 v[92:95], v[180:183], v[172:175], v[92:95]
    ds_read_b64_tr_b16 v[150:151], v13 offset:1024
    v_mfma_f32_16x16x32_bf16 v[96:99], v[184:187], v[160:163], v[96:99]
    ds_read_b64_tr_b16 v[152:153], v12 offset:256
    v_mfma_f32_16x16x32_bf16 v[100:103], v[184:187], v[164:167], v[100:103]
    ds_read_b64_tr_b16 v[154:155], v12 offset:1280
    v_mfma_f32_16x16x32_bf16 v[104:107], v[184:187], v[168:171], v[104:107]
    ds_read_b64_tr_b16 v[156:157], v13 offset:256
    v_mfma_f32_16x16x32_bf16 v[108:111], v[184:187], v[172:175], v[108:111]
    ds_read_b64_tr_b16 v[158:159], v13 offset:1280
    v_mfma_f32_16x16x32_bf16 v[112:115], v[188:191], v[160:163], v[112:115]
    v_mfma_f32_16x16x32_bf16 v[116:119], v[188:191], v[164:167], v[116:119]
    v_mfma_f32_16x16x32_bf16 v[120:123], v[188:191], v[168:171], v[120:123]
    v_mfma_f32_16x16x32_bf16 v[124:127], v[188:191], v[172:175], v[124:127]
    s_waitcnt lgkmcnt(0)
    v_mfma_f32_16x16x32_bf16 v[64:67], v[144:147], v[128:131], v[64:67]
    ds_read_b128 v[160:163], v9 offset:0
    v_mfma_f32_16x16x32_bf16 v[68:71], v[144:147], v[132:135], v[68:71]
    ds_read_b64_tr_b16 v[176:177], v12 offset:8192
    v_mfma_f32_16x16x32_bf16 v[72:75], v[144:147], v[136:139], v[72:75]
    ds_read_b64_tr_b16 v[178:179], v12 offset:9216
    v_mfma_f32_16x16x32_bf16 v[76:79], v[144:147], v[140:143], v[76:79]
    ds_read_b128 v[164:167], v9 offset:512
    v_mfma_f32_16x16x32_bf16 v[80:83], v[148:151], v[128:131], v[80:83]
    ds_read_b128 v[168:171], v9 offset:4096
    v_mfma_f32_16x16x32_bf16 v[84:87], v[148:151], v[132:135], v[84:87]
    ds_read_b128 v[172:175], v9 offset:4608
    v_mfma_f32_16x16x32_bf16 v[88:91], v[148:151], v[136:139], v[88:91]
    ds_read_b64_tr_b16 v[180:181], v13 offset:8192
    v_mfma_f32_16x16x32_bf16 v[92:95], v[148:151], v[140:143], v[92:95]
    ds_read_b64_tr_b16 v[182:183], v13 offset:9216
    v_mfma_f32_16x16x32_bf16 v[96:99], v[152:155], v[128:131], v[96:99]
    ds_read_b64_tr_b16 v[184:185], v12 offset:8448
    v_mfma_f32_16x16x32_bf16 v[100:103], v[152:155], v[132:135], v[100:103]
    ds_read_b64_tr_b16 v[186:187], v12 offset:9472
    v_mfma_f32_16x16x32_bf16 v[104:107], v[152:155], v[136:139], v[104:107]
    ds_read_b64_tr_b16 v[188:189], v13 offset:8448
    v_mfma_f32_16x16x32_bf16 v[108:111], v[152:155], v[140:143], v[108:111]
    ds_read_b64_tr_b16 v[190:191], v13 offset:9472
    v_mfma_f32_16x16x32_bf16 v[112:115], v[156:159], v[128:131], v[112:115]
    v_mfma_f32_16x16x32_bf16 v[116:119], v[156:159], v[132:135], v[116:119]
    v_mfma_f32_16x16x32_bf16 v[120:123], v[156:159], v[136:139], v[120:123]
    v_mfma_f32_16x16x32_bf16 v[124:127], v[156:159], v[140:143], v[124:127]
    s_waitcnt lgkmcnt(0)
    v_mfma_f32_16x16x32_bf16 v[64:67], v[176:179], v[160:163], v[64:67]
    s_barrier
    ds_read_b128 v[128:131], v8 offset:32768
    v_mfma_f32_16x16x32_bf16 v[68:71], v[176:179], v[164:167], v[68:71]
    ds_read_b64_tr_b16 v[144:145], v12 offset:32768
    v_mfma_f32_16x16x32_bf16 v[72:75], v[176:179], v[168:171], v[72:75]
    ds_read_b64_tr_b16 v[146:147], v12 offset:33792
    v_mfma_f32_16x16x32_bf16 v[76:79], v[176:179], v[172:175], v[76:79]
    ds_read_b128 v[132:135], v8 offset:33280
    v_mfma_f32_16x16x32_bf16 v[80:83], v[180:183], v[160:163], v[80:83]
    ds_read_b128 v[136:139], v8 offset:36864
    v_mfma_f32_16x16x32_bf16 v[84:87], v[180:183], v[164:167], v[84:87]
    ds_read_b128 v[140:143], v8 offset:37376
    v_mfma_f32_16x16x32_bf16 v[88:91], v[180:183], v[168:171], v[88:91]
    ds_read_b64_tr_b16 v[148:149], v13 offset:32768
    v_mfma_f32_16x16x32_bf16 v[92:95], v[180:183], v[172:175], v[92:95]
    ds_read_b64_tr_b16 v[150:151], v13 offset:33792
    v_mfma_f32_16x16x32_bf16 v[96:99], v[184:187], v[160:163], v[96:99]
    ds_read_b64_tr_b16 v[152:153], v12 offset:33024
    v_mfma_f32_16x16x32_bf16 v[100:103], v[184:187], v[164:167], v[100:103]
    ds_read_b64_tr_b16 v[154:155], v12 offset:34048
    v_mfma_f32_16x16x32_bf16 v[104:107], v[184:187], v[168:171], v[104:107]
    ds_read_b64_tr_b16 v[156:157], v13 offset:33024
    v_mfma_f32_16x16x32_bf16 v[108:111], v[184:187], v[172:175], v[108:111]
    ds_read_b64_tr_b16 v[158:159], v13 offset:34048
    v_mfma_f32_16x16x32_bf16 v[112:115], v[188:191], v[160:163], v[112:115]
    v_mfma_f32_16x16x32_bf16 v[116:119], v[188:191], v[164:167], v[116:119]
    v_mfma_f32_16x16x32_bf16 v[120:123], v[188:191], v[168:171], v[120:123]
    v_mfma_f32_16x16x32_bf16 v[124:127], v[188:191], v[172:175], v[124:127]
    s_waitcnt lgkmcnt(0)
    v_mfma_f32_16x16x32_bf16 v[64:67], v[144:147], v[128:131], v[64:67]
    ds_read_b128 v[160:163], v9 offset:32768
    v_mfma_f32_16x16x32_bf16 v[68:71], v[144:147], v[132:135], v[68:71]
    ds_read_b64_tr_b16 v[176:177], v12 offset:40960
    v_mfma_f32_16x16x32_bf16 v[72:75], v[144:147], v[136:139], v[72:75]
    ds_read_b64_tr_b16 v[178:179], v12 offset:41984
    v_mfma_f32_16x16x32_bf16 v[76:79], v[144:147], v[140:143], v[76:79]
    ds_read_b128 v[164:167], v9 offset:33280
    v_mfma_f32_16x16x32_bf16 v[80:83], v[148:151], v[128:131], v[80:83]
    ds_read_b128 v[168:171], v9 offset:36864
    v_mfma_f32_16x16x32_bf16 v[84:87], v[148:151], v[132:135], v[84:87]
    ds_read_b128 v[172:175], v9 offset:37376
    v_mfma_f32_16x16x32_bf16 v[88:91], v[148:151], v[136:139], v[88:91]
    ds_read_b64_tr_b16 v[180:181], v13 offset:40960
    v_mfma_f32_16x16x32_bf16 v[92:95], v[148:151], v[140:143], v[92:95]
    ds_read_b64_tr_b16 v[182:183], v13 offset:41984
    v_mfma_f32_16x16x32_bf16 v[96:99], v[152:155], v[128:131], v[96:99]
    ds_read_b64_tr_b16 v[184:185], v12 offset:41216
    v_mfma_f32_16x16x32_bf16 v[100:103], v[152:155], v[132:135], v[100:103]
    ds_read_b64_tr_b16 v[186:187], v12 offset:42240
    v_mfma_f32_16x16x32_bf16 v[104:107], v[152:155], v[136:139], v[104:107]
    ds_read_b64_tr_b16 v[188:189], v13 offset:41216
    v_mfma_f32_16x16x32_bf16 v[108:111], v[152:155], v[140:143], v[108:111]
    ds_read_b64_tr_b16 v[190:191], v13 offset:42240
    v_mfma_f32_16x16x32_bf16 v[112:115], v[156:159], v[128:131], v[112:115]
    s_cmp_ge_u32 s5, 5
    s_cselect_b32 s28, 5, 0
    v_mfma_f32_16x16x32_bf16 v[116:119], v[156:159], v[132:135], v[116:119]
    s_sub_u32 s28, s5, s28
    s_lshl_b32 s28, s28, 4
    v_mfma_f32_16x16x32_bf16 v[120:123], v[156:159], v[136:139], v[120:123]
    s_lshl_b32 s29, s7, 3
    s_add_u32 s28, s28, s29
    v_mfma_f32_16x16x32_bf16 v[124:127], v[156:159], v[140:143], v[124:127]
    s_mov_b32 s30, 0x32410
    v_bfe_u32 v5, v0, 4, 1
    s_waitcnt lgkmcnt(0)
    v_mfma_f32_16x16x32_bf16 v[64:67], v[176:179], v[160:163], v[64:67]
    s_barrier
    ds_read_b128 v[128:131], v10 offset:0
    v_mfma_f32_16x16x32_bf16 v[68:71], v[176:179], v[164:167], v[68:71]
    ds_read_b64_tr_b16 v[144:145], v14 offset:0
    v_mfma_f32_16x16x32_bf16 v[72:75], v[176:179], v[168:171], v[72:75]
    ds_read_b64_tr_b16 v[146:147], v14 offset:1024
    v_mfma_f32_16x16x32_bf16 v[76:79], v[176:179], v[172:175], v[76:79]
    ds_read_b128 v[132:135], v10 offset:512
    v_mfma_f32_16x16x32_bf16 v[80:83], v[180:183], v[160:163], v[80:83]
    ds_read_b128 v[136:139], v10 offset:4096
    v_mfma_f32_16x16x32_bf16 v[84:87], v[180:183], v[164:167], v[84:87]
    ds_read_b128 v[140:143], v10 offset:4608
    v_mfma_f32_16x16x32_bf16 v[88:91], v[180:183], v[168:171], v[88:91]
    ds_read_b64_tr_b16 v[148:149], v15 offset:0
    v_mfma_f32_16x16x32_bf16 v[92:95], v[180:183], v[172:175], v[92:95]
    ds_read_b64_tr_b16 v[150:151], v15 offset:1024
    v_mfma_f32_16x16x32_bf16 v[96:99], v[184:187], v[160:163], v[96:99]
    ds_read_b64_tr_b16 v[152:153], v14 offset:256
    v_mfma_f32_16x16x32_bf16 v[100:103], v[184:187], v[164:167], v[100:103]
    ds_read_b64_tr_b16 v[154:155], v14 offset:1280
    v_mfma_f32_16x16x32_bf16 v[104:107], v[184:187], v[168:171], v[104:107]
    ds_read_b64_tr_b16 v[156:157], v15 offset:256
    v_mfma_f32_16x16x32_bf16 v[108:111], v[184:187], v[172:175], v[108:111]
    ds_read_b64_tr_b16 v[158:159], v15 offset:1280
    v_mfma_f32_16x16x32_bf16 v[112:115], v[188:191], v[160:163], v[112:115]
    v_lshl_add_u32 v16, v5, 2, v4
    v_lshrrev_b32 v17, 5, v0
    v_mfma_f32_16x16x32_bf16 v[116:119], v[188:191], v[164:167], v[116:119]
    v_add_u32 v17, s28, v17
    v_add_u32 v5, 0, v17
    v_mfma_f32_16x16x32_bf16 v[120:123], v[188:191], v[168:171], v[120:123]
    v_mul_u32_u24 v6, 205, v5
    v_lshrrev_b32 v6, 10, v6
    v_mfma_f32_16x16x32_bf16 v[124:127], v[188:191], v[172:175], v[124:127]
    v_mul_u32_u24 v7, 5, v6
    v_sub_u32 v5, v5, v7
    s_waitcnt lgkmcnt(0)
    v_mfma_f32_16x16x32_bf16 v[64:67], v[144:147], v[128:131], v[64:67]
    ds_read_b128 v[160:163], v11 offset:0
    v_mfma_f32_16x16x32_bf16 v[68:71], v[144:147], v[132:135], v[68:71]
    ds_read_b64_tr_b16 v[176:177], v14 offset:8192
    v_mfma_f32_16x16x32_bf16 v[72:75], v[144:147], v[136:139], v[72:75]
    ds_read_b64_tr_b16 v[178:179], v14 offset:9216
    v_mfma_f32_16x16x32_bf16 v[76:79], v[144:147], v[140:143], v[76:79]
    ds_read_b128 v[164:167], v11 offset:512
    v_mfma_f32_16x16x32_bf16 v[80:83], v[148:151], v[128:131], v[80:83]
    ds_read_b128 v[168:171], v11 offset:4096
    v_mfma_f32_16x16x32_bf16 v[84:87], v[148:151], v[132:135], v[84:87]
    ds_read_b128 v[172:175], v11 offset:4608
    v_mfma_f32_16x16x32_bf16 v[88:91], v[148:151], v[136:139], v[88:91]
    ds_read_b64_tr_b16 v[180:181], v15 offset:8192
    v_mfma_f32_16x16x32_bf16 v[92:95], v[148:151], v[140:143], v[92:95]
    ds_read_b64_tr_b16 v[182:183], v15 offset:9216
    v_mfma_f32_16x16x32_bf16 v[96:99], v[152:155], v[128:131], v[96:99]
    ds_read_b64_tr_b16 v[184:185], v14 offset:8448
    v_mfma_f32_16x16x32_bf16 v[100:103], v[152:155], v[132:135], v[100:103]
    ds_read_b64_tr_b16 v[186:187], v14 offset:9472
    v_mfma_f32_16x16x32_bf16 v[104:107], v[152:155], v[136:139], v[104:107]
    ds_read_b64_tr_b16 v[188:189], v15 offset:8448
    v_mfma_f32_16x16x32_bf16 v[108:111], v[152:155], v[140:143], v[108:111]
    ds_read_b64_tr_b16 v[190:191], v15 offset:9472
    v_mfma_f32_16x16x32_bf16 v[112:115], v[156:159], v[128:131], v[112:115]
    v_lshlrev_b32 v5, 2, v5
    v_bfe_u32 v5, s30, v5, 4
    v_mfma_f32_16x16x32_bf16 v[116:119], v[156:159], v[132:135], v[116:119]
    v_mul_u32_u24 v6, 163840, v6
    v_lshl_add_u32 v6, v5, 9, v6
    v_mfma_f32_16x16x32_bf16 v[120:123], v[156:159], v[136:139], v[120:123]
    v_lshl_add_u32 v24, v16, 4, v6
    v_add_u32 v5, 2, v17
    v_mfma_f32_16x16x32_bf16 v[124:127], v[156:159], v[140:143], v[124:127]
    v_mul_u32_u24 v6, 205, v5
    v_lshrrev_b32 v6, 10, v6
    s_waitcnt lgkmcnt(0)
    v_mfma_f32_16x16x32_bf16 v[64:67], v[176:179], v[160:163], v[64:67]
    s_barrier
    ds_read_b128 v[128:131], v10 offset:32768
    v_mfma_f32_16x16x32_bf16 v[68:71], v[176:179], v[164:167], v[68:71]
    ds_read_b64_tr_b16 v[144:145], v14 offset:32768
    v_mfma_f32_16x16x32_bf16 v[72:75], v[176:179], v[168:171], v[72:75]
    ds_read_b64_tr_b16 v[146:147], v14 offset:33792
    v_mfma_f32_16x16x32_bf16 v[76:79], v[176:179], v[172:175], v[76:79]
    ds_read_b128 v[132:135], v10 offset:33280
    v_mfma_f32_16x16x32_bf16 v[80:83], v[180:183], v[160:163], v[80:83]
    ds_read_b128 v[136:139], v10 offset:36864
    v_mfma_f32_16x16x32_bf16 v[84:87], v[180:183], v[164:167], v[84:87]
    ds_read_b128 v[140:143], v10 offset:37376
    v_mfma_f32_16x16x32_bf16 v[88:91], v[180:183], v[168:171], v[88:91]
    ds_read_b64_tr_b16 v[148:149], v15 offset:32768
    v_mfma_f32_16x16x32_bf16 v[92:95], v[180:183], v[172:175], v[92:95]
    ds_read_b64_tr_b16 v[150:151], v15 offset:33792
    v_mfma_f32_16x16x32_bf16 v[96:99], v[184:187], v[160:163], v[96:99]
    ds_read_b64_tr_b16 v[152:153], v14 offset:33024
    v_mfma_f32_16x16x32_bf16 v[100:103], v[184:187], v[164:167], v[100:103]
    ds_read_b64_tr_b16 v[154:155], v14 offset:34048
    v_mfma_f32_16x16x32_bf16 v[104:107], v[184:187], v[168:171], v[104:107]
    ds_read_b64_tr_b16 v[156:157], v15 offset:33024
    v_mfma_f32_16x16x32_bf16 v[108:111], v[184:187], v[172:175], v[108:111]
    ds_read_b64_tr_b16 v[158:159], v15 offset:34048
    v_mfma_f32_16x16x32_bf16 v[112:115], v[188:191], v[160:163], v[112:115]
    v_mul_u32_u24 v7, 5, v6
    v_sub_u32 v5, v5, v7
    v_mfma_f32_16x16x32_bf16 v[116:119], v[188:191], v[164:167], v[116:119]
    v_lshlrev_b32 v5, 2, v5
    v_bfe_u32 v5, s30, v5, 4
    v_mfma_f32_16x16x32_bf16 v[120:123], v[188:191], v[168:171], v[120:123]
    v_mul_u32_u24 v6, 163840, v6
    v_lshl_add_u32 v6, v5, 9, v6
    v_mfma_f32_16x16x32_bf16 v[124:127], v[188:191], v[172:175], v[124:127]
    v_lshl_add_u32 v25, v16, 4, v6
    v_add_u32 v5, 4, v17
    s_waitcnt lgkmcnt(0)
    v_mfma_f32_16x16x32_bf16 v[64:67], v[144:147], v[128:131], v[64:67]
    ds_read_b128 v[160:163], v11 offset:32768
    v_mfma_f32_16x16x32_bf16 v[68:71], v[144:147], v[132:135], v[68:71]
    ds_read_b64_tr_b16 v[176:177], v14 offset:40960
    v_mfma_f32_16x16x32_bf16 v[72:75], v[144:147], v[136:139], v[72:75]
    ds_read_b64_tr_b16 v[178:179], v14 offset:41984
    v_mfma_f32_16x16x32_bf16 v[76:79], v[144:147], v[140:143], v[76:79]
    ds_read_b128 v[164:167], v11 offset:33280
    v_mfma_f32_16x16x32_bf16 v[80:83], v[148:151], v[128:131], v[80:83]
    ds_read_b128 v[168:171], v11 offset:36864
    v_mfma_f32_16x16x32_bf16 v[84:87], v[148:151], v[132:135], v[84:87]
    ds_read_b128 v[172:175], v11 offset:37376
    v_mfma_f32_16x16x32_bf16 v[88:91], v[148:151], v[136:139], v[88:91]
    ds_read_b64_tr_b16 v[180:181], v15 offset:40960
    v_mfma_f32_16x16x32_bf16 v[92:95], v[148:151], v[140:143], v[92:95]
    ds_read_b64_tr_b16 v[182:183], v15 offset:41984
    v_mfma_f32_16x16x32_bf16 v[96:99], v[152:155], v[128:131], v[96:99]
    ds_read_b64_tr_b16 v[184:185], v14 offset:41216
    v_mfma_f32_16x16x32_bf16 v[100:103], v[152:155], v[132:135], v[100:103]
    ds_read_b64_tr_b16 v[186:187], v14 offset:42240
    v_mfma_f32_16x16x32_bf16 v[104:107], v[152:155], v[136:139], v[104:107]
    ds_read_b64_tr_b16 v[188:189], v15 offset:41216
    v_mfma_f32_16x16x32_bf16 v[108:111], v[152:155], v[140:143], v[108:111]
    ds_read_b64_tr_b16 v[190:191], v15 offset:42240
    v_mfma_f32_16x16x32_bf16 v[112:115], v[156:159], v[128:131], v[112:115]
    v_mul_u32_u24 v6, 205, v5
    v_lshrrev_b32 v6, 10, v6
    v_mfma_f32_16x16x32_bf16 v[116:119], v[156:159], v[132:135], v[116:119]
    v_mul_u32_u24 v7, 5, v6
    v_sub_u32 v5, v5, v7
    v_mfma_f32_16x16x32_bf16 v[120:123], v[156:159], v[136:139], v[120:123]
    v_lshlrev_b32 v5, 2, v5
    v_bfe_u32 v5, s30, v5, 4
    v_mfma_f32_16x16x32_bf16 v[124:127], v[156:159], v[140:143], v[124:127]
    v_mul_u32_u24 v6, 163840, v6
    v_lshl_add_u32 v6, v5, 9, v6
    s_waitcnt lgkmcnt(0)
    v_mfma_f32_16x16x32_bf16 v[64:67], v[176:179], v[160:163], v[64:67]
    s_barrier
    ds_read_b128 v[128:131], v8 offset:0
    v_mfma_f32_16x16x32_bf16 v[68:71], v[176:179], v[164:167], v[68:71]
    ds_read_b64_tr_b16 v[144:145], v12 offset:0
    v_mfma_f32_16x16x32_bf16 v[72:75], v[176:179], v[168:171], v[72:75]
    ds_read_b64_tr_b16 v[146:147], v12 offset:1024
    v_mfma_f32_16x16x32_bf16 v[76:79], v[176:179], v[172:175], v[76:79]
    ds_read_b128 v[132:135], v8 offset:512
    v_mfma_f32_16x16x32_bf16 v[80:83], v[180:183], v[160:163], v[80:83]
    ds_read_b128 v[136:139], v8 offset:4096
    v_mfma_f32_16x16x32_bf16 v[84:87], v[180:183], v[164:167], v[84:87]
    ds_read_b128 v[140:143], v8 offset:4608
    v_mfma_f32_16x16x32_bf16 v[88:91], v[180:183], v[168:171], v[88:91]
    ds_read_b64_tr_b16 v[148:149], v13 offset:0
    v_mfma_f32_16x16x32_bf16 v[92:95], v[180:183], v[172:175], v[92:95]
    ds_read_b64_tr_b16 v[150:151], v13 offset:1024
    v_mfma_f32_16x16x32_bf16 v[96:99], v[184:187], v[160:163], v[96:99]
    ds_read_b64_tr_b16 v[152:153], v12 offset:256
    v_mfma_f32_16x16x32_bf16 v[100:103], v[184:187], v[164:167], v[100:103]
    ds_read_b64_tr_b16 v[154:155], v12 offset:1280
    v_mfma_f32_16x16x32_bf16 v[104:107], v[184:187], v[168:171], v[104:107]
    ds_read_b64_tr_b16 v[156:157], v13 offset:256
    v_mfma_f32_16x16x32_bf16 v[108:111], v[184:187], v[172:175], v[108:111]
    ds_read_b64_tr_b16 v[158:159], v13 offset:1280
    v_mfma_f32_16x16x32_bf16 v[112:115], v[188:191], v[160:163], v[112:115]
    v_lshl_add_u32 v26, v16, 4, v6
    v_add_u32 v5, 6, v17
    v_mfma_f32_16x16x32_bf16 v[116:119], v[188:191], v[164:167], v[116:119]
    v_mul_u32_u24 v6, 205, v5
    v_lshrrev_b32 v6, 10, v6
    v_mfma_f32_16x16x32_bf16 v[120:123], v[188:191], v[168:171], v[120:123]
    v_mul_u32_u24 v7, 5, v6
    v_sub_u32 v5, v5, v7
    v_mfma_f32_16x16x32_bf16 v[124:127], v[188:191], v[172:175], v[124:127]
    v_lshlrev_b32 v5, 2, v5
    v_bfe_u32 v5, s30, v5, 4
    s_waitcnt lgkmcnt(0)
    v_mfma_f32_16x16x32_bf16 v[64:67], v[144:147], v[128:131], v[64:67]
    ds_read_b128 v[160:163], v9 offset:0
    v_mfma_f32_16x16x32_bf16 v[68:71], v[144:147], v[132:135], v[68:71]
    ds_read_b64_tr_b16 v[176:177], v12 offset:8192
    v_mfma_f32_16x16x32_bf16 v[72:75], v[144:147], v[136:139], v[72:75]
    ds_read_b64_tr_b16 v[178:179], v12 offset:9216
    v_mfma_f32_16x16x32_bf16 v[76:79], v[144:147], v[140:143], v[76:79]
    ds_read_b128 v[164:167], v9 offset:512
    v_mfma_f32_16x16x32_bf16 v[80:83], v[148:151], v[128:131], v[80:83]
    ds_read_b128 v[168:171], v9 offset:4096
    v_mfma_f32_16x16x32_bf16 v[84:87], v[148:151], v[132:135], v[84:87]
    ds_read_b128 v[172:175], v9 offset:4608
    v_mfma_f32_16x16x32_bf16 v[88:91], v[148:151], v[136:139], v[88:91]
    ds_read_b64_tr_b16 v[180:181], v13 offset:8192
    v_mfma_f32_16x16x32_bf16 v[92:95], v[148:151], v[140:143], v[92:95]
    ds_read_b64_tr_b16 v[182:183], v13 offset:9216
    v_mfma_f32_16x16x32_bf16 v[96:99], v[152:155], v[128:131], v[96:99]
    ds_read_b64_tr_b16 v[184:185], v12 offset:8448
    v_mfma_f32_16x16x32_bf16 v[100:103], v[152:155], v[132:135], v[100:103]
    ds_read_b64_tr_b16 v[186:187], v12 offset:9472
    v_mfma_f32_16x16x32_bf16 v[104:107], v[152:155], v[136:139], v[104:107]
    ds_read_b64_tr_b16 v[188:189], v13 offset:8448
    v_mfma_f32_16x16x32_bf16 v[108:111], v[152:155], v[140:143], v[108:111]
    ds_read_b64_tr_b16 v[190:191], v13 offset:9472
    v_mfma_f32_16x16x32_bf16 v[112:115], v[156:159], v[128:131], v[112:115]
    v_mul_u32_u24 v6, 163840, v6
    v_lshl_add_u32 v6, v5, 9, v6
    v_mfma_f32_16x16x32_bf16 v[116:119], v[156:159], v[132:135], v[116:119]
    v_lshl_add_u32 v27, v16, 4, v6
    s_cmp_ge_u32 s5, 5
    v_mfma_f32_16x16x32_bf16 v[120:123], v[156:159], v[136:139], v[120:123]
    s_cselect_b32 s30, 2621440, 0
    s_lshl_b32 s29, s4, 1
    v_mfma_f32_16x16x32_bf16 v[124:127], v[156:159], v[140:143], v[124:127]
    s_add_u32 s29, s29, s6
    s_mul_i32 s29, s29, 5120
    s_waitcnt lgkmcnt(0)
    v_mfma_f32_16x16x32_bf16 v[64:67], v[176:179], v[160:163], v[64:67]
    s_barrier
    ds_read_b128 v[128:131], v8 offset:32768
    v_mfma_f32_16x16x32_bf16 v[68:71], v[176:179], v[164:167], v[68:71]
    ds_read_b64_tr_b16 v[144:145], v12 offset:32768
    v_mfma_f32_16x16x32_bf16 v[72:75], v[176:179], v[168:171], v[72:75]
    ds_read_b64_tr_b16 v[146:147], v12 offset:33792
    v_mfma_f32_16x16x32_bf16 v[76:79], v[176:179], v[172:175], v[76:79]
    ds_read_b128 v[132:135], v8 offset:33280
    v_mfma_f32_16x16x32_bf16 v[80:83], v[180:183], v[160:163], v[80:83]
    ds_read_b128 v[136:139], v8 offset:36864
    v_mfma_f32_16x16x32_bf16 v[84:87], v[180:183], v[164:167], v[84:87]
    ds_read_b128 v[140:143], v8 offset:37376
    v_mfma_f32_16x16x32_bf16 v[88:91], v[180:183], v[168:171], v[88:91]
    ds_read_b64_tr_b16 v[148:149], v13 offset:32768
    v_mfma_f32_16x16x32_bf16 v[92:95], v[180:183], v[172:175], v[92:95]
    ds_read_b64_tr_b16 v[150:151], v13 offset:33792
    v_mfma_f32_16x16x32_bf16 v[96:99], v[184:187], v[160:163], v[96:99]
    ds_read_b64_tr_b16 v[152:153], v12 offset:33024
    v_mfma_f32_16x16x32_bf16 v[100:103], v[184:187], v[164:167], v[100:103]
    ds_read_b64_tr_b16 v[154:155], v12 offset:34048
    v_mfma_f32_16x16x32_bf16 v[104:107], v[184:187], v[168:171], v[104:107]
    ds_read_b64_tr_b16 v[156:157], v13 offset:33024
    v_mfma_f32_16x16x32_bf16 v[108:111], v[184:187], v[172:175], v[108:111]
    ds_read_b64_tr_b16 v[158:159], v13 offset:34048
    v_mfma_f32_16x16x32_bf16 v[112:115], v[188:191], v[160:163], v[112:115]
    s_add_u32 s32, s29, s30
    s_add_u32 s33, s32, 2560
    s_lshl_b32 s28, s6, 8
    s_add_u32 s28, s28, 155648
    v_lshl_add_u32 v28, v4, 2, s28
    s_lshl_b32 s28, s7, 8
    s_add_u32 s28, s28, 156672
    v_lshl_add_u32 v29, v3, 4, s28
    s_cmp_lt_u32 s5, 5
    s_cselect_b32 s34, 0x3ea52b5c, 1.0
    v_mfma_f32_16x16x32_bf16 v[116:119], v[188:191], v[164:167], v[116:119]
    v_mfma_f32_16x16x32_bf16 v[120:123], v[188:191], v[168:171], v[120:123]
    v_mfma_f32_16x16x32_bf16 v[124:127], v[188:191], v[172:175], v[124:127]
    s_waitcnt lgkmcnt(0)
    v_mfma_f32_16x16x32_bf16 v[64:67], v[144:147], v[128:131], v[64:67]
    ds_read_b128 v[160:163], v9 offset:32768
    ds_read_b64_tr_b16 v[176:177], v12 offset:40960
    v_mfma_f32_16x16x32_bf16 v[68:71], v[144:147], v[132:135], v[68:71]
    ds_read_b64_tr_b16 v[178:179], v12 offset:41984
    ds_read_b128 v[164:167], v9 offset:33280
    v_mfma_f32_16x16x32_bf16 v[72:75], v[144:147], v[136:139], v[72:75]
    ds_read_b128 v[168:171], v9 offset:36864
    ds_read_b128 v[172:175], v9 offset:37376
    v_mfma_f32_16x16x32_bf16 v[76:79], v[144:147], v[140:143], v[76:79]
    ds_read_b64_tr_b16 v[180:181], v13 offset:40960
    ds_read_b64_tr_b16 v[182:183], v13 offset:41984
    v_mfma_f32_16x16x32_bf16 v[80:83], v[148:151], v[128:131], v[80:83]
    ds_read_b64_tr_b16 v[184:185], v12 offset:41216
    v_mfma_f32_16x16x32_bf16 v[84:87], v[148:151], v[132:135], v[84:87]
    ds_read_b64_tr_b16 v[186:187], v12 offset:42240
    v_mfma_f32_16x16x32_bf16 v[88:91], v[148:151], v[136:139], v[88:91]
    ds_read_b64_tr_b16 v[188:189], v13 offset:41216
    v_mfma_f32_16x16x32_bf16 v[92:95], v[148:151], v[140:143], v[92:95]
    ds_read_b64_tr_b16 v[190:191], v13 offset:42240
    v_mfma_f32_16x16x32_bf16 v[96:99], v[152:155], v[128:131], v[96:99]
    ds_read_b32 v32, v28 offset:0
    v_mfma_f32_16x16x32_bf16 v[100:103], v[152:155], v[132:135], v[100:103]
    ds_read_b32 v34, v28 offset:512
    v_mfma_f32_16x16x32_bf16 v[104:107], v[152:155], v[136:139], v[104:107]
    ds_read_b32 v36, v28 offset:16
    v_mfma_f32_16x16x32_bf16 v[108:111], v[152:155], v[140:143], v[108:111]
    ds_read_b32 v38, v28 offset:528
    v_mfma_f32_16x16x32_bf16 v[112:115], v[156:159], v[128:131], v[112:115]
    ds_read_b32 v40, v28 offset:128
    v_mfma_f32_16x16x32_bf16 v[116:119], v[156:159], v[132:135], v[116:119]
    ds_read_b32 v42, v28 offset:640
    v_mfma_f32_16x16x32_bf16 v[120:123], v[156:159], v[136:139], v[120:123]
    v_mfma_f32_16x16x32_bf16 v[124:127], v[156:159], v[140:143], v[124:127]
    s_waitcnt lgkmcnt(0)
    v_mfma_f32_16x16x32_bf16 v[64:67], v[176:179], v[160:163], v[64:67]
    ds_read_b32 v44, v28 offset:144
    v_mfma_f32_16x16x32_bf16 v[68:71], v[176:179], v[164:167], v[68:71]
    ds_read_b32 v46, v28 offset:656
    v_mfma_f32_16x16x32_bf16 v[72:75], v[176:179], v[168:171], v[72:75]
    ds_read_b128 v[48:51], v29 offset:0
    v_mfma_f32_16x16x32_bf16 v[76:79], v[176:179], v[172:175], v[76:79]
    ds_read_b128 v[52:55], v29 offset:64
    v_mfma_f32_16x16x32_bf16 v[80:83], v[180:183], v[160:163], v[80:83]
    ds_read_b128 v[56:59], v29 offset:128
    v_mfma_f32_16x16x32_bf16 v[84:87], v[180:183], v[164:167], v[84:87]
    ds_read_b128 v[60:63], v29 offset:192
    v_mfma_f32_16x16x32_bf16 v[88:91], v[180:183], v[168:171], v[88:91]
    v_mfma_f32_16x16x32_bf16 v[92:95], v[180:183], v[172:175], v[92:95]
    v_mfma_f32_16x16x32_bf16 v[96:99], v[184:187], v[160:163], v[96:99]
    v_mfma_f32_16x16x32_bf16 v[100:103], v[184:187], v[164:167], v[100:103]
    v_mfma_f32_16x16x32_bf16 v[104:107], v[184:187], v[168:171], v[104:107]
    v_mfma_f32_16x16x32_bf16 v[108:111], v[184:187], v[172:175], v[108:111]
    v_mfma_f32_16x16x32_bf16 v[112:115], v[188:191], v[160:163], v[112:115]
    v_mfma_f32_16x16x32_bf16 v[116:119], v[188:191], v[164:167], v[116:119]
    v_mfma_f32_16x16x32_bf16 v[120:123], v[188:191], v[168:171], v[120:123]
    v_mfma_f32_16x16x32_bf16 v[124:127], v[188:191], v[172:175], v[124:127]
    s_waitcnt lgkmcnt(0)
    v_mul_f32 v32, -1.0, v32
    v_mul_f32 v34, s34, v34
    v_mul_f32 v36, -1.0, v36
    v_mul_f32 v38, s34, v38
    v_mul_f32 v40, -1.0, v40
    v_mul_f32 v42, s34, v42
    v_mul_f32 v44, -1.0, v44
    v_mul_f32_e64 v46, s34, v46
    v_pk_fma_f32 v[64:65], v[48:49], v[32:33], v[64:65] op_sel_hi:[1,0,1]
    v_pk_fma_f32 v[66:67], v[50:51], v[32:33], v[66:67] op_sel_hi:[1,0,1]
    v_pk_fma_f32 v[68:69], v[48:49], v[36:37], v[68:69] op_sel_hi:[1,0,1]
    v_pk_fma_f32 v[70:71], v[50:51], v[36:37], v[70:71] op_sel_hi:[1,0,1]
    v_pk_fma_f32 v[72:73], v[48:49], v[40:41], v[72:73] op_sel_hi:[1,0,1]
    v_pk_fma_f32 v[74:75], v[50:51], v[40:41], v[74:75] op_sel_hi:[1,0,1]
    v_pk_fma_f32 v[76:77], v[48:49], v[44:45], v[76:77] op_sel_hi:[1,0,1]
    v_pk_fma_f32 v[78:79], v[50:51], v[44:45], v[78:79] op_sel_hi:[1,0,1]
    v_pk_mul_f32 v[64:65], v[64:65], v[34:35] op_sel_hi:[1,0]
    v_pk_mul_f32 v[66:67], v[66:67], v[34:35] op_sel_hi:[1,0]
    v_pk_mul_f32 v[68:69], v[68:69], v[38:39] op_sel_hi:[1,0]
    v_pk_mul_f32 v[70:71], v[70:71], v[38:39] op_sel_hi:[1,0]
    v_pk_mul_f32 v[72:73], v[72:73], v[42:43] op_sel_hi:[1,0]
    v_pk_mul_f32 v[74:75], v[74:75], v[42:43] op_sel_hi:[1,0]
    v_pk_mul_f32 v[76:77], v[76:77], v[46:47] op_sel_hi:[1,0]
    v_pk_mul_f32 v[78:79], v[78:79], v[46:47] op_sel_hi:[1,0]
    v_cvt_pk_bf16_f32 v64, v64, v65
    v_cvt_pk_bf16_f32 v65, v66, v67
    v_cvt_pk_bf16_f32 v66, v68, v69
    v_cvt_pk_bf16_f32 v67, v70, v71
    v_cvt_pk_bf16_f32 v72, v72, v73
    v_cvt_pk_bf16_f32 v73, v74, v75
    v_cvt_pk_bf16_f32 v74, v76, v77
    v_cvt_pk_bf16_f32 v75, v78, v79
    v_permlane16_swap_b32 v64, v66
    v_permlane16_swap_b32 v65, v67
    v_permlane16_swap_b32 v72, v74
    v_permlane16_swap_b32 v73, v75
    buffer_store_dwordx4 v[64:67], v24, s[8:11], s32 offen sc1
    buffer_store_dwordx4 v[72:75], v24, s[8:11], s33 offen sc1
    v_pk_fma_f32 v[80:81], v[52:53], v[32:33], v[80:81] op_sel_hi:[1,0,1]
    v_pk_fma_f32 v[82:83], v[54:55], v[32:33], v[82:83] op_sel_hi:[1,0,1]
    v_pk_fma_f32 v[84:85], v[52:53], v[36:37], v[84:85] op_sel_hi:[1,0,1]
    v_pk_fma_f32 v[86:87], v[54:55], v[36:37], v[86:87] op_sel_hi:[1,0,1]
    v_pk_fma_f32 v[88:89], v[52:53], v[40:41], v[88:89] op_sel_hi:[1,0,1]
    v_pk_fma_f32 v[90:91], v[54:55], v[40:41], v[90:91] op_sel_hi:[1,0,1]
    v_pk_fma_f32 v[92:93], v[52:53], v[44:45], v[92:93] op_sel_hi:[1,0,1]
    v_pk_fma_f32 v[94:95], v[54:55], v[44:45], v[94:95] op_sel_hi:[1,0,1]
    v_pk_mul_f32 v[80:81], v[80:81], v[34:35] op_sel_hi:[1,0]
    v_pk_mul_f32 v[82:83], v[82:83], v[34:35] op_sel_hi:[1,0]
    v_pk_mul_f32 v[84:85], v[84:85], v[38:39] op_sel_hi:[1,0]
    v_pk_mul_f32 v[86:87], v[86:87], v[38:39] op_sel_hi:[1,0]
    v_pk_mul_f32 v[88:89], v[88:89], v[42:43] op_sel_hi:[1,0]
    v_pk_mul_f32 v[90:91], v[90:91], v[42:43] op_sel_hi:[1,0]
    v_pk_mul_f32 v[92:93], v[92:93], v[46:47] op_sel_hi:[1,0]
    v_pk_mul_f32 v[94:95], v[94:95], v[46:47] op_sel_hi:[1,0]
    v_cvt_pk_bf16_f32 v80, v80, v81
    v_cvt_pk_bf16_f32 v81, v82, v83
    v_cvt_pk_bf16_f32 v82, v84, v85
    v_cvt_pk_bf16_f32 v83, v86, v87
    v_cvt_pk_bf16_f32 v88, v88, v89
    v_cvt_pk_bf16_f32 v89, v90, v91
    v_cvt_pk_bf16_f32 v90, v92, v93
    v_cvt_pk_bf16_f32 v91, v94, v95
    v_permlane16_swap_b32 v80, v82
    v_permlane16_swap_b32 v81, v83
    v_permlane16_swap_b32 v88, v90
    v_permlane16_swap_b32 v89, v91
    buffer_store_dwordx4 v[80:83], v25, s[8:11], s32 offen sc1
    buffer_store_dwordx4 v[88:91], v25, s[8:11], s33 offen sc1
    v_pk_fma_f32 v[96:97], v[56:57], v[32:33], v[96:97] op_sel_hi:[1,0,1]
    v_pk_fma_f32 v[98:99], v[58:59], v[32:33], v[98:99] op_sel_hi:[1,0,1]
    v_pk_fma_f32 v[100:101], v[56:57], v[36:37], v[100:101] op_sel_hi:[1,0,1]
    v_pk_fma_f32 v[102:103], v[58:59], v[36:37], v[102:103] op_sel_hi:[1,0,1]
    v_pk_fma_f32 v[104:105], v[56:57], v[40:41], v[104:105] op_sel_hi:[1,0,1]
    v_pk_fma_f32 v[106:107], v[58:59], v[40:41], v[106:107] op_sel_hi:[1,0,1]
    v_pk_fma_f32 v[108:109], v[56:57], v[44:45], v[108:109] op_sel_hi:[1,0,1]
    v_pk_fma_f32 v[110:111], v[58:59], v[44:45], v[110:111] op_sel_hi:[1,0,1]
    v_pk_mul_f32 v[96:97], v[96:97], v[34:35] op_sel_hi:[1,0]
    v_pk_mul_f32 v[98:99], v[98:99], v[34:35] op_sel_hi:[1,0]
    v_pk_mul_f32 v[100:101], v[100:101], v[38:39] op_sel_hi:[1,0]
    v_pk_mul_f32 v[102:103], v[102:103], v[38:39] op_sel_hi:[1,0]
    v_pk_mul_f32 v[104:105], v[104:105], v[42:43] op_sel_hi:[1,0]
    v_pk_mul_f32 v[106:107], v[106:107], v[42:43] op_sel_hi:[1,0]
    v_pk_mul_f32 v[108:109], v[108:109], v[46:47] op_sel_hi:[1,0]
    v_pk_mul_f32 v[110:111], v[110:111], v[46:47] op_sel_hi:[1,0]
    v_cvt_pk_bf16_f32 v96, v96, v97
    v_cvt_pk_bf16_f32 v97, v98, v99
    v_cvt_pk_bf16_f32 v98, v100, v101
    v_cvt_pk_bf16_f32 v99, v102, v103
    v_cvt_pk_bf16_f32 v104, v104, v105
    v_cvt_pk_bf16_f32 v105, v106, v107
    v_cvt_pk_bf16_f32 v106, v108, v109
    v_cvt_pk_bf16_f32 v107, v110, v111
    v_permlane16_swap_b32 v96, v98
    v_permlane16_swap_b32 v97, v99
    v_permlane16_swap_b32 v104, v106
    v_permlane16_swap_b32 v105, v107
    buffer_store_dwordx4 v[96:99], v26, s[8:11], s32 offen sc1
    buffer_store_dwordx4 v[104:107], v26, s[8:11], s33 offen sc1
    v_pk_fma_f32 v[112:113], v[60:61], v[32:33], v[112:113] op_sel_hi:[1,0,1]
    v_pk_fma_f32 v[114:115], v[62:63], v[32:33], v[114:115] op_sel_hi:[1,0,1]
    v_pk_fma_f32 v[116:117], v[60:61], v[36:37], v[116:117] op_sel_hi:[1,0,1]
    v_pk_fma_f32 v[118:119], v[62:63], v[36:37], v[118:119] op_sel_hi:[1,0,1]
    v_pk_fma_f32 v[120:121], v[60:61], v[40:41], v[120:121] op_sel_hi:[1,0,1]
    v_pk_fma_f32 v[122:123], v[62:63], v[40:41], v[122:123] op_sel_hi:[1,0,1]
    v_pk_fma_f32 v[124:125], v[60:61], v[44:45], v[124:125] op_sel_hi:[1,0,1]
    v_pk_fma_f32 v[126:127], v[62:63], v[44:45], v[126:127] op_sel_hi:[1,0,1]
    v_pk_mul_f32 v[112:113], v[112:113], v[34:35] op_sel_hi:[1,0]
    v_pk_mul_f32 v[114:115], v[114:115], v[34:35] op_sel_hi:[1,0]
    v_pk_mul_f32 v[116:117], v[116:117], v[38:39] op_sel_hi:[1,0]
    v_pk_mul_f32 v[118:119], v[118:119], v[38:39] op_sel_hi:[1,0]
    v_pk_mul_f32 v[120:121], v[120:121], v[42:43] op_sel_hi:[1,0]
    v_pk_mul_f32 v[122:123], v[122:123], v[42:43] op_sel_hi:[1,0]
    v_pk_mul_f32 v[124:125], v[124:125], v[46:47] op_sel_hi:[1,0]
    v_pk_mul_f32 v[126:127], v[126:127], v[46:47] op_sel_hi:[1,0]
    v_cvt_pk_bf16_f32 v112, v112, v113
    v_cvt_pk_bf16_f32 v113, v114, v115
    v_cvt_pk_bf16_f32 v114, v116, v117
    v_cvt_pk_bf16_f32 v115, v118, v119
    v_cvt_pk_bf16_f32 v120, v120, v121
    v_cvt_pk_bf16_f32 v121, v122, v123
    v_cvt_pk_bf16_f32 v122, v124, v125
    v_cvt_pk_bf16_f32 v123, v126, v127
    v_permlane16_swap_b32 v112, v114
    v_permlane16_swap_b32 v113, v115
    v_permlane16_swap_b32 v120, v122
    v_permlane16_swap_b32 v121, v123
    buffer_store_dwordx4 v[112:115], v27, s[8:11], s32 offen sc1
    buffer_store_dwordx4 v[120:123], v27, s[8:11], s33 offen sc1
    s_lshl_b32 s81, s5, 4
    s_add_u32 s81, s81, s4
    s_mul_i32 s81, s81, 128
    s_add_u32 s81, s81, 30535680
    v_mov_b32 v28, 0x80000000
    v_mov_b32 v29, 0x80000000
    v_mov_b32 v30, 0x80000000
    v_mov_b32 v31, 0x80000000
    v_mov_b32 v32, 0x80000000
    v_mov_b32 v33, 0x80000000
    v_mov_b32 v34, 0x80000000
    v_mov_b32 v35, 0x80000000
    v_mov_b32 v36, 0x80000000
    v_mov_b32 v37, 0x80000000
    v_mov_b32 v38, 0x80000000
    s_waitcnt vmcnt(0)
    s_barrier
    s_mov_b32 s28, s81
    s_cmp_lg_u32 s3, 0
    s_cbranch_scc1 nf_22
    v_mov_b32 v4, s58
    v_mov_b32 v5, 0
    s_mov_b64 exec, 1
    buffer_store_dword v4, v5, s[8:11], s28 offen sc1
    s_mov_b64 exec, -1
nf_22:
    s_mov_b32 s68, 0
    s_mov_b32 s82, 0
    s_branch p2_start
p1_vpath:
    s_and_b32 s6, s3, 1
    s_lshr_b32 s7, s3, 1
    v_and_b32 v2, 15, v0
    v_lshrrev_b32 v3, 4, v0
    v_lshrrev_b32 v5, 2, v2
    v_and_b32 v4, 3, v0
    v_lshl_add_u32 v4, v5, 3, v4
    v_bfe_u32 v6, v0, 1, 1
    v_lshl_or_b32 v5, v5, 1, v6
    v_xor_b32 v5, v5, v3
    v_lshlrev_b32 v5, 4, v5
    v_lshl_add_u32 v5, v4, 7, v5
    s_lshl_b32 s28, s6, 13
    v_add_u32 v8, s28, v5
    v_xor_b32_e64 v9, 64, v8
    v_bfe_u32 v5, v0, 2, 2
    v_lshlrev_b32 v5, 6, v5
    v_lshl_add_u32 v5, v3, 11, v5
    v_bfe_u32 v6, v0, 4, 1
    v_lshl_add_u32 v5, v6, 5, v5
    v_and_b32 v6, 3, v0
    v_lshl_add_u32 v5, v6, 3, v5
    s_lshl_b32 s28, s7, 9
    s_add_u32 s28, s28, 16384
    v_add_u32 v12, s28, v5
    v_xor_b32 v13, 32, v12
    v_add_u32 v10, 0x10000, v8
    v_add_u32 v14, 0x10000, v12
    v_add_u32 v11, 0x10000, v9
    v_add_u32 v15, 0x10000, v13
    s_barrier
    ds_read_b128 v[128:131], v8 offset:0
    ds_read_b64_tr_b16 v[144:145], v12 offset:0
    ds_read_b64_tr_b16 v[146:147], v12 offset:1024
    ds_read_b128 v[132:135], v8 offset:512
    ds_read_b128 v[136:139], v8 offset:4096
    ds_read_b128 v[140:143], v8 offset:4608
    ds_read_b64_tr_b16 v[148:149], v13 offset:0
    ds_read_b64_tr_b16 v[150:151], v13 offset:1024
    ds_read_b64_tr_b16 v[152:153], v12 offset:256
    ds_read_b64_tr_b16 v[154:155], v12 offset:1280
    ds_read_b64_tr_b16 v[156:157], v13 offset:256
    ds_read_b64_tr_b16 v[158:159], v13 offset:1280
    buffer_load_dwordx4 v[48:51], v40, s[12:15], s62 offen
    buffer_load_dwordx4 v[52:55], v40, s[12:15], s62 offen offset:512
    buffer_load_dwordx4 v[56:59], v41, s[12:15], s62 offen offset:1024
    buffer_load_dwordx4 v[192:195], v44, s[16:19], s64 offen
    s_add_u32 s28, s64, 15360
    buffer_load_dwordx4 v[196:199], v44, s[16:19], s28 offen
    s_add_u32 s28, s64, 30720
    buffer_load_dwordx4 v[200:203], v45, s[16:19], s28 offen
    v_mov_b32 v232, 0
    s_mov_b32 s28, 30672896
    buffer_load_dword v232, v232, s[8:11], s28 offen sc1
    s_waitcnt lgkmcnt(0)
    v_mfma_f32_16x16x32_bf16 v[64:67], v[128:131], v[144:147], 0
    ds_read_b128 v[160:163], v9 offset:0
    v_mfma_f32_16x16x32_bf16 v[68:71], v[132:135], v[144:147], 0
    ds_read_b64_tr_b16 v[176:177], v12 offset:8192
    v_mfma_f32_16x16x32_bf16 v[72:75], v[136:139], v[144:147], 0
    ds_read_b64_tr_b16 v[178:179], v12 offset:9216
    v_mfma_f32_16x16x32_bf16 v[76:79], v[140:143], v[144:147], 0
    ds_read_b128 v[164:167], v9 offset:512
    v_mfma_f32_16x16x32_bf16 v[80:83], v[128:131], v[148:151], 0
    ds_read_b128 v[168:171], v9 offset:4096
    v_mfma_f32_16x16x32_bf16 v[84:87], v[132:135], v[148:151], 0
    ds_read_b128 v[172:175], v9 offset:4608
    v_mfma_f32_16x16x32_bf16 v[88:91], v[136:139], v[148:151], 0
    ds_read_b64_tr_b16 v[180:181], v13 offset:8192
    v_mfma_f32_16x16x32_bf16 v[92:95], v[140:143], v[148:151], 0
    ds_read_b64_tr_b16 v[182:183], v13 offset:9216
    v_mfma_f32_16x16x32_bf16 v[96:99], v[128:131], v[152:155], 0
    ds_read_b64_tr_b16 v[184:185], v12 offset:8448
    v_mfma_f32_16x16x32_bf16 v[100:103], v[132:135], v[152:155], 0
    ds_read_b64_tr_b16 v[186:187], v12 offset:9472
    v_mfma_f32_16x16x32_bf16 v[104:107], v[136:139], v[152:155], 0
    ds_read_b64_tr_b16 v[188:189], v13 offset:8448
    v_mfma_f32_16x16x32_bf16 v[108:111], v[140:143], v[152:155], 0
    ds_read_b64_tr_b16 v[190:191], v13 offset:9472
    v_mfma_f32_16x16x32_bf16 v[112:115], v[128:131], v[156:159], 0
    v_mfma_f32_16x16x32_bf16 v[116:119], v[132:135], v[156:159], 0
    v_mfma_f32_16x16x32_bf16 v[120:123], v[136:139], v[156:159], 0
    v_mfma_f32_16x16x32_bf16 v[124:127], v[140:143], v[156:159], 0
    s_waitcnt lgkmcnt(0)
    v_mfma_f32_16x16x32_bf16 v[64:67], v[160:163], v[176:179], v[64:67]
    s_barrier
    ds_read_b128 v[128:131], v8 offset:32768
    v_mfma_f32_16x16x32_bf16 v[68:71], v[164:167], v[176:179], v[68:71]
    ds_read_b64_tr_b16 v[144:145], v12 offset:32768
    v_mfma_f32_16x16x32_bf16 v[72:75], v[168:171], v[176:179], v[72:75]
    ds_read_b64_tr_b16 v[146:147], v12 offset:33792
    v_mfma_f32_16x16x32_bf16 v[76:79], v[172:175], v[176:179], v[76:79]
    ds_read_b128 v[132:135], v8 offset:33280
    v_mfma_f32_16x16x32_bf16 v[80:83], v[160:163], v[180:183], v[80:83]
    ds_read_b128 v[136:139], v8 offset:36864
    v_mfma_f32_16x16x32_bf16 v[84:87], v[164:167], v[180:183], v[84:87]
    ds_read_b128 v[140:143], v8 offset:37376
    v_mfma_f32_16x16x32_bf16 v[88:91], v[168:171], v[180:183], v[88:91]
    ds_read_b64_tr_b16 v[148:149], v13 offset:32768
    v_mfma_f32_16x16x32_bf16 v[92:95], v[172:175], v[180:183], v[92:95]
    ds_read_b64_tr_b16 v[150:151], v13 offset:33792
    v_mfma_f32_16x16x32_bf16 v[96:99], v[160:163], v[184:187], v[96:99]
    ds_read_b64_tr_b16 v[152:153], v12 offset:33024
    v_mfma_f32_16x16x32_bf16 v[100:103], v[164:167], v[184:187], v[100:103]
    ds_read_b64_tr_b16 v[154:155], v12 offset:34048
    v_mfma_f32_16x16x32_bf16 v[104:107], v[168:171], v[184:187], v[104:107]
    ds_read_b64_tr_b16 v[156:157], v13 offset:33024
    v_mfma_f32_16x16x32_bf16 v[108:111], v[172:175], v[184:187], v[108:111]
    ds_read_b64_tr_b16 v[158:159], v13 offset:34048
    v_mfma_f32_16x16x32_bf16 v[112:115], v[160:163], v[188:191], v[112:115]
    v_mfma_f32_16x16x32_bf16 v[116:119], v[164:167], v[188:191], v[116:119]
    v_mfma_f32_16x16x32_bf16 v[120:123], v[168:171], v[188:191], v[120:123]
    v_mfma_f32_16x16x32_bf16 v[124:127], v[172:175], v[188:191], v[124:127]
    s_waitcnt lgkmcnt(0)
    v_mfma_f32_16x16x32_bf16 v[64:67], v[128:131], v[144:147], v[64:67]
    ds_read_b128 v[160:163], v9 offset:32768
    v_mfma_f32_16x16x32_bf16 v[68:71], v[132:135], v[144:147], v[68:71]
    ds_read_b64_tr_b16 v[176:177], v12 offset:40960
    v_mfma_f32_16x16x32_bf16 v[72:75], v[136:139], v[144:147], v[72:75]
    ds_read_b64_tr_b16 v[178:179], v12 offset:41984
    v_mfma_f32_16x16x32_bf16 v[76:79], v[140:143], v[144:147], v[76:79]
    ds_read_b128 v[164:167], v9 offset:33280
    v_mfma_f32_16x16x32_bf16 v[80:83], v[128:131], v[148:151], v[80:83]
    ds_read_b128 v[168:171], v9 offset:36864
    v_mfma_f32_16x16x32_bf16 v[84:87], v[132:135], v[148:151], v[84:87]
    ds_read_b128 v[172:175], v9 offset:37376
    v_mfma_f32_16x16x32_bf16 v[88:91], v[136:139], v[148:151], v[88:91]
    ds_read_b64_tr_b16 v[180:181], v13 offset:40960
    v_mfma_f32_16x16x32_bf16 v[92:95], v[140:143], v[148:151], v[92:95]
    ds_read_b64_tr_b16 v[182:183], v13 offset:41984
    v_mfma_f32_16x16x32_bf16 v[96:99], v[128:131], v[152:155], v[96:99]
    ds_read_b64_tr_b16 v[184:185], v12 offset:41216
    v_mfma_f32_16x16x32_bf16 v[100:103], v[132:135], v[152:155], v[100:103]
    ds_read_b64_tr_b16 v[186:187], v12 offset:42240
    v_mfma_f32_16x16x32_bf16 v[104:107], v[136:139], v[152:155], v[104:107]
    ds_read_b64_tr_b16 v[188:189], v13 offset:41216
    v_mfma_f32_16x16x32_bf16 v[108:111], v[140:143], v[152:155], v[108:111]
    ds_read_b64_tr_b16 v[190:191], v13 offset:42240
    v_mfma_f32_16x16x32_bf16 v[112:115], v[128:131], v[156:159], v[112:115]
    v_mfma_f32_16x16x32_bf16 v[116:119], v[132:135], v[156:159], v[116:119]
    v_mfma_f32_16x16x32_bf16 v[120:123], v[136:139], v[156:159], v[120:123]
    v_mfma_f32_16x16x32_bf16 v[124:127], v[140:143], v[156:159], v[124:127]
    s_waitcnt lgkmcnt(0)
    v_mfma_f32_16x16x32_bf16 v[64:67], v[160:163], v[176:179], v[64:67]
    s_waitcnt vmcnt(0)
    s_nop 0
    v_mov_b32 v204, 0x3f803f80
    v_dot2_f32_bf16 v208, v48, v204, 0
    v_dot2_f32_bf16 v210, v48, v48, 0
    v_dot2_f32_bf16 v209, v49, v204, 0
    v_dot2_f32_bf16 v211, v49, v49, 0
    v_dot2_f32_bf16 v208, v50, v204, v208
    v_dot2_f32_bf16 v210, v50, v50, v210
    v_dot2_f32_bf16 v209, v51, v204, v209
    v_dot2_f32_bf16 v211, v51, v51, v211
    v_dot2_f32_bf16 v208, v52, v204, v208
    v_dot2_f32_bf16 v210, v52, v52, v210
    v_dot2_f32_bf16 v209, v53, v204, v209
    v_dot2_f32_bf16 v211, v53, v53, v211
    v_dot2_f32_bf16 v208, v54, v204, v208
    v_dot2_f32_bf16 v210, v54, v54, v210
    v_dot2_f32_bf16 v209, v55, v204, v209
    v_dot2_f32_bf16 v211, v55, v55, v211
    v_dot2_f32_bf16 v208, v56, v204, v208
    v_dot2_f32_bf16 v210, v56, v56, v210
    v_dot2_f32_bf16 v209, v57, v204, v209
    v_dot2_f32_bf16 v211, v57, v57, v211
    v_dot2_f32_bf16 v208, v58, v204, v208
    v_dot2_f32_bf16 v210, v58, v58, v210
    v_dot2_f32_bf16 v209, v59, v204, v209
    v_dot2_f32_bf16 v211, v59, v59, v211
    s_nop 1
    v_add_f32 v208, v208, v209
    v_add_f32 v210, v210, v211
    s_nop 0
    v_add_f32_dpp v208, v208, v208 quad_perm:[1,0,3,2] row_mask:0xf bank_mask:0xf
    v_add_f32_dpp v210, v210, v210 quad_perm:[1,0,3,2] row_mask:0xf bank_mask:0xf
    s_nop 0
    s_nop 0
    v_add_f32_dpp v208, v208, v208 quad_perm:[2,3,0,1] row_mask:0xf bank_mask:0xf
    v_add_f32_dpp v210, v210, v210 quad_perm:[2,3,0,1] row_mask:0xf bank_mask:0xf
    s_nop 0
    v_add_f32_dpp v208, v208, v208 row_half_mirror row_mask:0xf bank_mask:0xf
    v_add_f32_dpp v210, v210, v210 row_half_mirror row_mask:0xf bank_mask:0xf
    s_nop 0
    v_add_f32_dpp v208, v208, v208 row_mirror row_mask:0xf bank_mask:0xf
    v_add_f32_dpp v210, v210, v210 row_mirror row_mask:0xf bank_mask:0xf
    v_mov_b32 v209, v208
    v_mov_b32 v211, v210
    s_nop 0
    v_permlane16_swap_b32 v208, v209
    v_permlane16_swap_b32 v210, v211
    v_add_f32 v208, v208, v209
    v_add_f32 v210, v210, v211
    v_mul_f32 v208, 0x3acccccd, v208
    v_mul_f32 v210, 0x3acccccd, v210
    v_fma_f32 v210, -v208, v208, v210
    v_max_f32 v210, 0, v210
    v_add_f32 v210, 0x3727c5ac, v210
    v_rsq_f32 v210, v210
    ds_write_b32 v42, v208
    ds_write_b32 v42, v210 offset:32
    s_nop 0
    v_mov_b32 v205, 0x3f80
    v_mov_b32_e64 v206, 0x3f800000
    v_dot2_f32_bf16 v212, v192, v205, 0
    v_dot2_f32_bf16 v213, v192, v206, 0
    v_dot2_f32_bf16 v214, v193, v205, 0
    v_dot2_f32_bf16 v215, v193, v206, 0
    v_dot2_f32_bf16 v216, v194, v205, 0
    v_dot2_f32_bf16 v217, v194, v206, 0
    v_dot2_f32_bf16 v218, v195, v205, 0
    v_dot2_f32_bf16 v219, v195, v206, 0
    v_dot2_f32_bf16 v212, v196, v205, v212
    v_dot2_f32_bf16 v213, v196, v206, v213
    v_dot2_f32_bf16 v214, v197, v205, v214
    v_dot2_f32_bf16 v215, v197, v206, v215
    v_dot2_f32_bf16 v216, v198, v205, v216
    v_dot2_f32_bf16 v217, v198, v206, v217
    v_dot2_f32_bf16 v218, v199, v205, v218
    v_dot2_f32_bf16 v219, v199, v206, v219
    v_dot2_f32_bf16 v212, v200, v205, v212
    v_dot2_f32_bf16 v213, v200, v206, v213
    v_dot2_f32_bf16 v214, v201, v205, v214
    v_dot2_f32_bf16 v215, v201, v206, v215
    v_dot2_f32_bf16 v216, v202, v205, v216
    v_dot2_f32_bf16 v217, v202, v206, v217
    v_dot2_f32_bf16 v218, v203, v205, v218
    v_dot2_f32_bf16 v219, v203, v206, v219
    v_permlane32_swap_b32 v212, v216
    v_permlane32_swap_b32 v213, v217
    v_permlane32_swap_b32 v214, v218
    v_permlane32_swap_b32 v215, v219
    v_add_f32 v212, v212, v216
    v_add_f32 v213, v213, v217
    v_add_f32 v214, v214, v218
    v_add_f32 v215, v215, v219
    s_nop 0
    v_permlane16_swap_b32 v212, v214
    v_permlane16_swap_b32 v213, v215
    v_add_f32 v212, v212, v214
    v_add_f32 v213, v213, v215
    ds_write_b64 v46, v[212:213]
    v_lshlrev_b32 v222, 3, v0
    v_add_u32 v223, 157696, v222
    s_lshl_b32 s35, s5, 4
    s_add_u32 s35, s35, s4
    s_lshl_b32 s36, s35, 9
    s_add_u32 s36, s36, 30371840
    s_mul_i32 s35, s35, 128
    s_add_u32 s35, s35, 30502912
    v_readfirstlane_b32 s58, v232
    s_waitcnt lgkmcnt(0)
    s_mul_i32 s58, s58, 0x9e3779b1
    s_add_u32 s58, s58, 0x7f4a7c15
    s_barrier
    ds_read_b128 v[128:131], v10 offset:0
    v_mfma_f32_16x16x32_bf16 v[68:71], v[164:167], v[176:179], v[68:71]
    ds_read_b64_tr_b16 v[144:145], v14 offset:0
    v_mfma_f32_16x16x32_bf16 v[72:75], v[168:171], v[176:179], v[72:75]
    ds_read_b64_tr_b16 v[146:147], v14 offset:1024
    v_mfma_f32_16x16x32_bf16 v[76:79], v[172:175], v[176:179], v[76:79]
    ds_read_b128 v[132:135], v10 offset:512
    v_mfma_f32_16x16x32_bf16 v[80:83], v[160:163], v[180:183], v[80:83]
    ds_read_b128 v[136:139], v10 offset:4096
    v_mfma_f32_16x16x32_bf16 v[84:87], v[164:167], v[180:183], v[84:87]
    ds_read_b128 v[140:143], v10 offset:4608
    v_mfma_f32_16x16x32_bf16 v[88:91], v[168:171], v[180:183], v[88:91]
    ds_read_b64_tr_b16 v[148:149], v15 offset:0
    v_mfma_f32_16x16x32_bf16 v[92:95], v[172:175], v[180:183], v[92:95]
    ds_read_b64_tr_b16 v[150:151], v15 offset:1024
    v_mfma_f32_16x16x32_bf16 v[96:99], v[160:163], v[184:187], v[96:99]
    ds_read_b64_tr_b16 v[152:153], v14 offset:256
    v_mfma_f32_16x16x32_bf16 v[100:103], v[164:167], v[184:187], v[100:103]
    ds_read_b64_tr_b16 v[154:155], v14 offset:1280
    v_mfma_f32_16x16x32_bf16 v[104:107], v[168:171], v[184:187], v[104:107]
    ds_read_b64_tr_b16 v[156:157], v15 offset:256
    v_mfma_f32_16x16x32_bf16 v[108:111], v[172:175], v[184:187], v[108:111]
    ds_read_b64_tr_b16 v[158:159], v15 offset:1280
    v_mfma_f32_16x16x32_bf16 v[112:115], v[160:163], v[188:191], v[112:115]
    v_mfma_f32_16x16x32_bf16 v[116:119], v[164:167], v[188:191], v[116:119]
    v_mfma_f32_16x16x32_bf16 v[120:123], v[168:171], v[188:191], v[120:123]
    v_mfma_f32_16x16x32_bf16 v[124:127], v[172:175], v[188:191], v[124:127]
    s_cmp_lg_u32 s3, 0
    s_cbranch_scc1 cs0_25
    ds_read_b64 v[224:225], v223 offset:0
    ds_read_b64 v[226:227], v223 offset:512
    ds_read_b64 v[228:229], v223 offset:1024
    ds_read_b64 v[230:231], v223 offset:1536
    s_waitcnt lgkmcnt(0)
    v_add_f32 v224, v224, v226
    v_add_f32 v228, v228, v230
    v_add_f32 v225, v225, v227
    v_add_f32 v229, v229, v231
    v_add_f32 v224, v224, v228
    v_add_f32 v225, v225, v229
    buffer_store_dwordx2 v[224:225], v222, s[8:11], s36 offen sc1
    v_and_b32 v226, 31, v0
    v_lshlrev_b32 v226, 2, v226
    v_and_b32 v227, 63, v226
    v_add_u32 v227, 157184, v227
    ds_read_b32 v227, v227
    s_waitcnt lgkmcnt(0)
    buffer_store_dword v227, v226, s[8:11], s63 offen sc1
cs0_25:
    s_waitcnt lgkmcnt(0)
    v_mfma_f32_16x16x32_bf16 v[64:67], v[128:131], v[144:147], v[64:67]
    ds_read_b128 v[160:163], v11 offset:0
    v_mfma_f32_16x16x32_bf16 v[68:71], v[132:135], v[144:147], v[68:71]
    ds_read_b64_tr_b16 v[176:177], v14 offset:8192
    v_mfma_f32_16x16x32_bf16 v[72:75], v[136:139], v[144:147], v[72:75]
    ds_read_b64_tr_b16 v[178:179], v14 offset:9216
    v_mfma_f32_16x16x32_bf16 v[76:79], v[140:143], v[144:147], v[76:79]
    ds_read_b128 v[164:167], v11 offset:512
    v_mfma_f32_16x16x32_bf16 v[80:83], v[128:131], v[148:151], v[80:83]
    ds_read_b128 v[168:171], v11 offset:4096
    v_mfma_f32_16x16x32_bf16 v[84:87], v[132:135], v[148:151], v[84:87]
    ds_read_b128 v[172:175], v11 offset:4608
    v_mfma_f32_16x16x32_bf16 v[88:91], v[136:139], v[148:151], v[88:91]
    ds_read_b64_tr_b16 v[180:181], v15 offset:8192
    v_mfma_f32_16x16x32_bf16 v[92:95], v[140:143], v[148:151], v[92:95]
    ds_read_b64_tr_b16 v[182:183], v15 offset:9216
    v_mfma_f32_16x16x32_bf16 v[96:99], v[128:131], v[152:155], v[96:99]
    ds_read_b64_tr_b16 v[184:185], v14 offset:8448
    v_mfma_f32_16x16x32_bf16 v[100:103], v[132:135], v[152:155], v[100:103]
    ds_read_b64_tr_b16 v[186:187], v14 offset:9472
    v_mfma_f32_16x16x32_bf16 v[104:107], v[136:139], v[152:155], v[104:107]
    ds_read_b64_tr_b16 v[188:189], v15 offset:8448
    v_mfma_f32_16x16x32_bf16 v[108:111], v[140:143], v[152:155], v[108:111]
    ds_read_b64_tr_b16 v[190:191], v15 offset:9472
    v_mfma_f32_16x16x32_bf16 v[112:115], v[128:131], v[156:159], v[112:115]
    v_mfma_f32_16x16x32_bf16 v[116:119], v[132:135], v[156:159], v[116:119]
    v_mfma_f32_16x16x32_bf16 v[120:123], v[136:139], v[156:159], v[120:123]
    v_mfma_f32_16x16x32_bf16 v[124:127], v[140:143], v[156:159], v[124:127]
    s_waitcnt lgkmcnt(0)
    v_mfma_f32_16x16x32_bf16 v[64:67], v[160:163], v[176:179], v[64:67]
    s_barrier
    ds_read_b128 v[128:131], v10 offset:32768
    v_mfma_f32_16x16x32_bf16 v[68:71], v[164:167], v[176:179], v[68:71]
    ds_read_b64_tr_b16 v[144:145], v14 offset:32768
    v_mfma_f32_16x16x32_bf16 v[72:75], v[168:171], v[176:179], v[72:75]
    ds_read_b64_tr_b16 v[146:147], v14 offset:33792
    v_mfma_f32_16x16x32_bf16 v[76:79], v[172:175], v[176:179], v[76:79]
    ds_read_b128 v[132:135], v10 offset:33280
    v_mfma_f32_16x16x32_bf16 v[80:83], v[160:163], v[180:183], v[80:83]
    ds_read_b128 v[136:139], v10 offset:36864
    v_mfma_f32_16x16x32_bf16 v[84:87], v[164:167], v[180:183], v[84:87]
    ds_read_b128 v[140:143], v10 offset:37376
    v_mfma_f32_16x16x32_bf16 v[88:91], v[168:171], v[180:183], v[88:91]
    ds_read_b64_tr_b16 v[148:149], v15 offset:32768
    v_mfma_f32_16x16x32_bf16 v[92:95], v[172:175], v[180:183], v[92:95]
    ds_read_b64_tr_b16 v[150:151], v15 offset:33792
    v_mfma_f32_16x16x32_bf16 v[96:99], v[160:163], v[184:187], v[96:99]
    ds_read_b64_tr_b16 v[152:153], v14 offset:33024
    v_mfma_f32_16x16x32_bf16 v[100:103], v[164:167], v[184:187], v[100:103]
    ds_read_b64_tr_b16 v[154:155], v14 offset:34048
    v_mfma_f32_16x16x32_bf16 v[104:107], v[168:171], v[184:187], v[104:107]
    ds_read_b64_tr_b16 v[156:157], v15 offset:33024
    v_mfma_f32_16x16x32_bf16 v[108:111], v[172:175], v[184:187], v[108:111]
    ds_read_b64_tr_b16 v[158:159], v15 offset:34048
    v_mfma_f32_16x16x32_bf16 v[112:115], v[160:163], v[188:191], v[112:115]
    v_mfma_f32_16x16x32_bf16 v[116:119], v[164:167], v[188:191], v[116:119]
    v_mfma_f32_16x16x32_bf16 v[120:123], v[168:171], v[188:191], v[120:123]
    v_mfma_f32_16x16x32_bf16 v[124:127], v[172:175], v[188:191], v[124:127]
    s_waitcnt lgkmcnt(0)
    v_mfma_f32_16x16x32_bf16 v[64:67], v[128:131], v[144:147], v[64:67]
    ds_read_b128 v[160:163], v11 offset:32768
    v_mfma_f32_16x16x32_bf16 v[68:71], v[132:135], v[144:147], v[68:71]
    ds_read_b64_tr_b16 v[176:177], v14 offset:40960
    v_mfma_f32_16x16x32_bf16 v[72:75], v[136:139], v[144:147], v[72:75]
    ds_read_b64_tr_b16 v[178:179], v14 offset:41984
    v_mfma_f32_16x16x32_bf16 v[76:79], v[140:143], v[144:147], v[76:79]
    ds_read_b128 v[164:167], v11 offset:33280
    v_mfma_f32_16x16x32_bf16 v[80:83], v[128:131], v[148:151], v[80:83]
    ds_read_b128 v[168:171], v11 offset:36864
    v_mfma_f32_16x16x32_bf16 v[84:87], v[132:135], v[148:151], v[84:87]
    ds_read_b128 v[172:175], v11 offset:37376
    v_mfma_f32_16x16x32_bf16 v[88:91], v[136:139], v[148:151], v[88:91]
    ds_read_b64_tr_b16 v[180:181], v15 offset:40960
    v_mfma_f32_16x16x32_bf16 v[92:95], v[140:143], v[148:151], v[92:95]
    ds_read_b64_tr_b16 v[182:183], v15 offset:41984
    v_mfma_f32_16x16x32_bf16 v[96:99], v[128:131], v[152:155], v[96:99]
    ds_read_b64_tr_b16 v[184:185], v14 offset:41216
    v_mfma_f32_16x16x32_bf16 v[100:103], v[132:135], v[152:155], v[100:103]
    ds_read_b64_tr_b16 v[186:187], v14 offset:42240
    v_mfma_f32_16x16x32_bf16 v[104:107], v[136:139], v[152:155], v[104:107]
    ds_read_b64_tr_b16 v[188:189], v15 offset:41216
    v_mfma_f32_16x16x32_bf16 v[108:111], v[140:143], v[152:155], v[108:111]
    ds_read_b64_tr_b16 v[190:191], v15 offset:42240
    v_mfma_f32_16x16x32_bf16 v[112:115], v[128:131], v[156:159], v[112:115]
    v_mfma_f32_16x16x32_bf16 v[116:119], v[132:135], v[156:159], v[116:119]
    v_mfma_f32_16x16x32_bf16 v[120:123], v[136:139], v[156:159], v[120:123]
    v_mfma_f32_16x16x32_bf16 v[124:127], v[140:143], v[156:159], v[124:127]
    s_waitcnt lgkmcnt(0)
    v_mfma_f32_16x16x32_bf16 v[64:67], v[160:163], v[176:179], v[64:67]
    s_waitcnt vmcnt(0)
    s_barrier
    s_cmp_lg_u32 s3, 0
    s_cbranch_scc1 fl0_26
    v_mov_b32 v224, s58
    v_mov_b32 v225, 0
    s_mov_b64 exec, 1
    buffer_store_dword v224, v225, s[8:11], s35 offen sc1
    s_mov_b64 exec, -1
fl0_26:
    ds_read_b128 v[128:131], v8 offset:0
    v_mfma_f32_16x16x32_bf16 v[68:71], v[164:167], v[176:179], v[68:71]
    ds_read_b64_tr_b16 v[144:145], v12 offset:0
    v_mfma_f32_16x16x32_bf16 v[72:75], v[168:171], v[176:179], v[72:75]
    ds_read_b64_tr_b16 v[146:147], v12 offset:1024
    v_mfma_f32_16x16x32_bf16 v[76:79], v[172:175], v[176:179], v[76:79]
    ds_read_b128 v[132:135], v8 offset:512
    v_mfma_f32_16x16x32_bf16 v[80:83], v[160:163], v[180:183], v[80:83]
    ds_read_b128 v[136:139], v8 offset:4096
    v_mfma_f32_16x16x32_bf16 v[84:87], v[164:167], v[180:183], v[84:87]
    ds_read_b128 v[140:143], v8 offset:4608
    v_mfma_f32_16x16x32_bf16 v[88:91], v[168:171], v[180:183], v[88:91]
    ds_read_b64_tr_b16 v[148:149], v13 offset:0
    v_mfma_f32_16x16x32_bf16 v[92:95], v[172:175], v[180:183], v[92:95]
    ds_read_b64_tr_b16 v[150:151], v13 offset:1024
    v_mfma_f32_16x16x32_bf16 v[96:99], v[160:163], v[184:187], v[96:99]
    ds_read_b64_tr_b16 v[152:153], v12 offset:256
    v_mfma_f32_16x16x32_bf16 v[100:103], v[164:167], v[184:187], v[100:103]
    ds_read_b64_tr_b16 v[154:155], v12 offset:1280
    v_mfma_f32_16x16x32_bf16 v[104:107], v[168:171], v[184:187], v[104:107]
    ds_read_b64_tr_b16 v[156:157], v13 offset:256
    v_mfma_f32_16x16x32_bf16 v[108:111], v[172:175], v[184:187], v[108:111]
    ds_read_b64_tr_b16 v[158:159], v13 offset:1280
    v_mfma_f32_16x16x32_bf16 v[112:115], v[160:163], v[188:191], v[112:115]
    v_mfma_f32_16x16x32_bf16 v[116:119], v[164:167], v[188:191], v[116:119]
    v_mfma_f32_16x16x32_bf16 v[120:123], v[168:171], v[188:191], v[120:123]
    v_mfma_f32_16x16x32_bf16 v[124:127], v[172:175], v[188:191], v[124:127]
    s_waitcnt lgkmcnt(0)
    v_mfma_f32_16x16x32_bf16 v[64:67], v[128:131], v[144:147], v[64:67]
    ds_read_b128 v[160:163], v9 offset:0
    v_mfma_f32_16x16x32_bf16 v[68:71], v[132:135], v[144:147], v[68:71]
    ds_read_b64_tr_b16 v[176:177], v12 offset:8192
    v_mfma_f32_16x16x32_bf16 v[72:75], v[136:139], v[144:147], v[72:75]
    ds_read_b64_tr_b16 v[178:179], v12 offset:9216
    v_mfma_f32_16x16x32_bf16 v[76:79], v[140:143], v[144:147], v[76:79]
    ds_read_b128 v[164:167], v9 offset:512
    v_mfma_f32_16x16x32_bf16 v[80:83], v[128:131], v[148:151], v[80:83]
    ds_read_b128 v[168:171], v9 offset:4096
    v_mfma_f32_16x16x32_bf16 v[84:87], v[132:135], v[148:151], v[84:87]
    ds_read_b128 v[172:175], v9 offset:4608
    v_mfma_f32_16x16x32_bf16 v[88:91], v[136:139], v[148:151], v[88:91]
    ds_read_b64_tr_b16 v[180:181], v13 offset:8192
    v_mfma_f32_16x16x32_bf16 v[92:95], v[140:143], v[148:151], v[92:95]
    ds_read_b64_tr_b16 v[182:183], v13 offset:9216
    v_mfma_f32_16x16x32_bf16 v[96:99], v[128:131], v[152:155], v[96:99]
    ds_read_b64_tr_b16 v[184:185], v12 offset:8448
    v_mfma_f32_16x16x32_bf16 v[100:103], v[132:135], v[152:155], v[100:103]
    ds_read_b64_tr_b16 v[186:187], v12 offset:9472
    v_mfma_f32_16x16x32_bf16 v[104:107], v[136:139], v[152:155], v[104:107]
    ds_read_b64_tr_b16 v[188:189], v13 offset:8448
    v_mfma_f32_16x16x32_bf16 v[108:111], v[140:143], v[152:155], v[108:111]
    ds_read_b64_tr_b16 v[190:191], v13 offset:9472
    v_mfma_f32_16x16x32_bf16 v[112:115], v[128:131], v[156:159], v[112:115]
    v_mfma_f32_16x16x32_bf16 v[116:119], v[132:135], v[156:159], v[116:119]
    v_mfma_f32_16x16x32_bf16 v[120:123], v[136:139], v[156:159], v[120:123]
    v_mfma_f32_16x16x32_bf16 v[124:127], v[140:143], v[156:159], v[124:127]
    s_waitcnt lgkmcnt(0)
    v_mfma_f32_16x16x32_bf16 v[64:67], v[160:163], v[176:179], v[64:67]
    s_barrier
    ds_read_b128 v[128:131], v8 offset:32768
    v_mfma_f32_16x16x32_bf16 v[68:71], v[164:167], v[176:179], v[68:71]
    ds_read_b64_tr_b16 v[144:145], v12 offset:32768
    v_mfma_f32_16x16x32_bf16 v[72:75], v[168:171], v[176:179], v[72:75]
    ds_read_b64_tr_b16 v[146:147], v12 offset:33792
    v_mfma_f32_16x16x32_bf16 v[76:79], v[172:175], v[176:179], v[76:79]
    ds_read_b128 v[132:135], v8 offset:33280
    v_mfma_f32_16x16x32_bf16 v[80:83], v[160:163], v[180:183], v[80:83]
    ds_read_b128 v[136:139], v8 offset:36864
    v_mfma_f32_16x16x32_bf16 v[84:87], v[164:167], v[180:183], v[84:87]
    ds_read_b128 v[140:143], v8 offset:37376
    v_mfma_f32_16x16x32_bf16 v[88:91], v[168:171], v[180:183], v[88:91]
    ds_read_b64_tr_b16 v[148:149], v13 offset:32768
    v_mfma_f32_16x16x32_bf16 v[92:95], v[172:175], v[180:183], v[92:95]
    ds_read_b64_tr_b16 v[150:151], v13 offset:33792
    v_mfma_f32_16x16x32_bf16 v[96:99], v[160:163], v[184:187], v[96:99]
    ds_read_b64_tr_b16 v[152:153], v12 offset:33024
    v_mfma_f32_16x16x32_bf16 v[100:103], v[164:167], v[184:187], v[100:103]
    ds_read_b64_tr_b16 v[154:155], v12 offset:34048
    v_mfma_f32_16x16x32_bf16 v[104:107], v[168:171], v[184:187], v[104:107]
    ds_read_b64_tr_b16 v[156:157], v13 offset:33024
    v_mfma_f32_16x16x32_bf16 v[108:111], v[172:175], v[184:187], v[108:111]
    ds_read_b64_tr_b16 v[158:159], v13 offset:34048
    v_mfma_f32_16x16x32_bf16 v[112:115], v[160:163], v[188:191], v[112:115]
    v_mfma_f32_16x16x32_bf16 v[116:119], v[164:167], v[188:191], v[116:119]
    v_mfma_f32_16x16x32_bf16 v[120:123], v[168:171], v[188:191], v[120:123]
    v_mfma_f32_16x16x32_bf16 v[124:127], v[172:175], v[188:191], v[124:127]
    s_waitcnt lgkmcnt(0)
    v_mfma_f32_16x16x32_bf16 v[64:67], v[128:131], v[144:147], v[64:67]
    ds_read_b128 v[160:163], v9 offset:32768
    v_mfma_f32_16x16x32_bf16 v[68:71], v[132:135], v[144:147], v[68:71]
    ds_read_b64_tr_b16 v[176:177], v12 offset:40960
    v_mfma_f32_16x16x32_bf16 v[72:75], v[136:139], v[144:147], v[72:75]
    ds_read_b64_tr_b16 v[178:179], v12 offset:41984
    v_mfma_f32_16x16x32_bf16 v[76:79], v[140:143], v[144:147], v[76:79]
    ds_read_b128 v[164:167], v9 offset:33280
    v_mfma_f32_16x16x32_bf16 v[80:83], v[128:131], v[148:151], v[80:83]
    ds_read_b128 v[168:171], v9 offset:36864
    v_mfma_f32_16x16x32_bf16 v[84:87], v[132:135], v[148:151], v[84:87]
    ds_read_b128 v[172:175], v9 offset:37376
    v_mfma_f32_16x16x32_bf16 v[88:91], v[136:139], v[148:151], v[88:91]
    ds_read_b64_tr_b16 v[180:181], v13 offset:40960
    v_mfma_f32_16x16x32_bf16 v[92:95], v[140:143], v[148:151], v[92:95]
    ds_read_b64_tr_b16 v[182:183], v13 offset:41984
    v_mfma_f32_16x16x32_bf16 v[96:99], v[128:131], v[152:155], v[96:99]
    ds_read_b64_tr_b16 v[184:185], v12 offset:41216
    v_mfma_f32_16x16x32_bf16 v[100:103], v[132:135], v[152:155], v[100:103]
    ds_read_b64_tr_b16 v[186:187], v12 offset:42240
    v_mfma_f32_16x16x32_bf16 v[104:107], v[136:139], v[152:155], v[104:107]
    ds_read_b64_tr_b16 v[188:189], v13 offset:41216
    v_mfma_f32_16x16x32_bf16 v[108:111], v[140:143], v[152:155], v[108:111]
    ds_read_b64_tr_b16 v[190:191], v13 offset:42240
    v_mfma_f32_16x16x32_bf16 v[112:115], v[128:131], v[156:159], v[112:115]
    s_sub_u32 s28, s5, 10
    s_lshl_b32 s28, s28, 7
    v_mfma_f32_16x16x32_bf16 v[116:119], v[132:135], v[156:159], v[116:119]
    s_lshl_b32 s29, s7, 6
    s_add_u32 s28, s28, s29
    v_mfma_f32_16x16x32_bf16 v[120:123], v[136:139], v[156:159], v[120:123]
    v_add_u32 v17, s28, v2
    v_mul_u32_u24 v16, 10368, v3
    v_mfma_f32_16x16x32_bf16 v[124:127], v[140:143], v[156:159], v[124:127]
    v_lshl_add_u32 v16, v17, 4, v16
    v_add_u32 v24, 0, v16
    s_waitcnt lgkmcnt(0)
    v_mfma_f32_16x16x32_bf16 v[64:67], v[160:163], v[176:179], v[64:67]
    s_barrier
    ds_read_b128 v[128:131], v10 offset:0
    v_mfma_f32_16x16x32_bf16 v[68:71], v[164:167], v[176:179], v[68:71]
    ds_read_b64_tr_b16 v[144:145], v14 offset:0
    v_mfma_f32_16x16x32_bf16 v[72:75], v[168:171], v[176:179], v[72:75]
    ds_read_b64_tr_b16 v[146:147], v14 offset:1024
    v_mfma_f32_16x16x32_bf16 v[76:79], v[172:175], v[176:179], v[76:79]
    ds_read_b128 v[132:135], v10 offset:512
    v_mfma_f32_16x16x32_bf16 v[80:83], v[160:163], v[180:183], v[80:83]
    ds_read_b128 v[136:139], v10 offset:4096
    v_mfma_f32_16x16x32_bf16 v[84:87], v[164:167], v[180:183], v[84:87]
    ds_read_b128 v[140:143], v10 offset:4608
    v_mfma_f32_16x16x32_bf16 v[88:91], v[168:171], v[180:183], v[88:91]
    ds_read_b64_tr_b16 v[148:149], v15 offset:0
    v_mfma_f32_16x16x32_bf16 v[92:95], v[172:175], v[180:183], v[92:95]
    ds_read_b64_tr_b16 v[150:151], v15 offset:1024
    v_mfma_f32_16x16x32_bf16 v[96:99], v[160:163], v[184:187], v[96:99]
    ds_read_b64_tr_b16 v[152:153], v14 offset:256
    v_mfma_f32_16x16x32_bf16 v[100:103], v[164:167], v[184:187], v[100:103]
    ds_read_b64_tr_b16 v[154:155], v14 offset:1280
    v_mfma_f32_16x16x32_bf16 v[104:107], v[168:171], v[184:187], v[104:107]
    ds_read_b64_tr_b16 v[156:157], v15 offset:256
    v_mfma_f32_16x16x32_bf16 v[108:111], v[172:175], v[184:187], v[108:111]
    ds_read_b64_tr_b16 v[158:159], v15 offset:1280
    v_mfma_f32_16x16x32_bf16 v[112:115], v[160:163], v[188:191], v[112:115]
    v_add_u32 v25, 256, v16
    v_add_u32 v26, 512, v16
    v_mfma_f32_16x16x32_bf16 v[116:119], v[164:167], v[188:191], v[116:119]
    v_add_u32 v27, 768, v16
    s_lshl_b32 s29, s4, 1
    v_mfma_f32_16x16x32_bf16 v[120:123], v[168:171], v[188:191], v[120:123]
    s_add_u32 s29, s29, s6
    s_mul_i32 s29, s29, 82944
    v_mfma_f32_16x16x32_bf16 v[124:127], v[172:175], v[188:191], v[124:127]
    s_add_u32 s32, s29, 5242880
    s_add_u32 s33, s32, 41472
    s_waitcnt lgkmcnt(0)
    v_mfma_f32_16x16x32_bf16 v[64:67], v[128:131], v[144:147], v[64:67]
    ds_read_b128 v[160:163], v11 offset:0
    v_mfma_f32_16x16x32_bf16 v[68:71], v[132:135], v[144:147], v[68:71]
    ds_read_b64_tr_b16 v[176:177], v14 offset:8192
    v_mfma_f32_16x16x32_bf16 v[72:75], v[136:139], v[144:147], v[72:75]
    ds_read_b64_tr_b16 v[178:179], v14 offset:9216
    v_mfma_f32_16x16x32_bf16 v[76:79], v[140:143], v[144:147], v[76:79]
    ds_read_b128 v[164:167], v11 offset:512
    v_mfma_f32_16x16x32_bf16 v[80:83], v[128:131], v[148:151], v[80:83]
    ds_read_b128 v[168:171], v11 offset:4096
    v_mfma_f32_16x16x32_bf16 v[84:87], v[132:135], v[148:151], v[84:87]
    ds_read_b128 v[172:175], v11 offset:4608
    v_mfma_f32_16x16x32_bf16 v[88:91], v[136:139], v[148:151], v[88:91]
    ds_read_b64_tr_b16 v[180:181], v15 offset:8192
    v_mfma_f32_16x16x32_bf16 v[92:95], v[140:143], v[148:151], v[92:95]
    ds_read_b64_tr_b16 v[182:183], v15 offset:9216
    v_mfma_f32_16x16x32_bf16 v[96:99], v[128:131], v[152:155], v[96:99]
    ds_read_b64_tr_b16 v[184:185], v14 offset:8448
    v_mfma_f32_16x16x32_bf16 v[100:103], v[132:135], v[152:155], v[100:103]
    ds_read_b64_tr_b16 v[186:187], v14 offset:9472
    v_mfma_f32_16x16x32_bf16 v[104:107], v[136:139], v[152:155], v[104:107]
    ds_read_b64_tr_b16 v[188:189], v15 offset:8448
    v_mfma_f32_16x16x32_bf16 v[108:111], v[140:143], v[152:155], v[108:111]
    ds_read_b64_tr_b16 v[190:191], v15 offset:9472
    v_mfma_f32_16x16x32_bf16 v[112:115], v[128:131], v[156:159], v[112:115]
    s_lshl_b32 s28, s7, 8
    s_add_u32 s28, s28, 156672
    v_mfma_f32_16x16x32_bf16 v[116:119], v[132:135], v[156:159], v[116:119]
    v_lshl_add_u32 v28, v2, 2, s28
    s_lshl_b32 s28, s6, 8
    v_mfma_f32_16x16x32_bf16 v[120:123], v[136:139], v[156:159], v[120:123]
    s_add_u32 s28, s28, 155648
    v_lshl_add_u32 v29, v3, 5, s28
    v_mfma_f32_16x16x32_bf16 v[124:127], v[140:143], v[156:159], v[124:127]
    s_waitcnt lgkmcnt(0)
    v_mfma_f32_16x16x32_bf16 v[64:67], v[160:163], v[176:179], v[64:67]
    s_barrier
    ds_read_b128 v[128:131], v10 offset:32768
    v_mfma_f32_16x16x32_bf16 v[68:71], v[164:167], v[176:179], v[68:71]
    ds_read_b64_tr_b16 v[144:145], v14 offset:32768
    v_mfma_f32_16x16x32_bf16 v[72:75], v[168:171], v[176:179], v[72:75]
    ds_read_b64_tr_b16 v[146:147], v14 offset:33792
    v_mfma_f32_16x16x32_bf16 v[76:79], v[172:175], v[176:179], v[76:79]
    ds_read_b128 v[132:135], v10 offset:33280
    v_mfma_f32_16x16x32_bf16 v[80:83], v[160:163], v[180:183], v[80:83]
    ds_read_b128 v[136:139], v10 offset:36864
    v_mfma_f32_16x16x32_bf16 v[84:87], v[164:167], v[180:183], v[84:87]
    ds_read_b128 v[140:143], v10 offset:37376
    v_mfma_f32_16x16x32_bf16 v[88:91], v[168:171], v[180:183], v[88:91]
    ds_read_b64_tr_b16 v[148:149], v15 offset:32768
    v_mfma_f32_16x16x32_bf16 v[92:95], v[172:175], v[180:183], v[92:95]
    ds_read_b64_tr_b16 v[150:151], v15 offset:33792
    v_mfma_f32_16x16x32_bf16 v[96:99], v[160:163], v[184:187], v[96:99]
    ds_read_b64_tr_b16 v[152:153], v14 offset:33024
    v_mfma_f32_16x16x32_bf16 v[100:103], v[164:167], v[184:187], v[100:103]
    ds_read_b64_tr_b16 v[154:155], v14 offset:34048
    v_mfma_f32_16x16x32_bf16 v[104:107], v[168:171], v[184:187], v[104:107]
    ds_read_b64_tr_b16 v[156:157], v15 offset:33024
    v_mfma_f32_16x16x32_bf16 v[108:111], v[172:175], v[184:187], v[108:111]
    ds_read_b64_tr_b16 v[158:159], v15 offset:34048
    v_mfma_f32_16x16x32_bf16 v[112:115], v[160:163], v[188:191], v[112:115]
    v_mfma_f32_16x16x32_bf16 v[116:119], v[164:167], v[188:191], v[116:119]
    v_mfma_f32_16x16x32_bf16 v[120:123], v[168:171], v[188:191], v[120:123]
    v_mfma_f32_16x16x32_bf16 v[124:127], v[172:175], v[188:191], v[124:127]
    s_waitcnt lgkmcnt(0)
    v_mfma_f32_16x16x32_bf16 v[64:67], v[128:131], v[144:147], v[64:67]
    ds_read_b128 v[160:163], v11 offset:32768
    v_mfma_f32_16x16x32_bf16 v[68:71], v[132:135], v[144:147], v[68:71]
    ds_read_b64_tr_b16 v[176:177], v14 offset:40960
    v_mfma_f32_16x16x32_bf16 v[72:75], v[136:139], v[144:147], v[72:75]
    ds_read_b64_tr_b16 v[178:179], v14 offset:41984
    v_mfma_f32_16x16x32_bf16 v[76:79], v[140:143], v[144:147], v[76:79]
    ds_read_b128 v[164:167], v11 offset:33280
    v_mfma_f32_16x16x32_bf16 v[80:83], v[128:131], v[148:151], v[80:83]
    ds_read_b128 v[168:171], v11 offset:36864
    v_mfma_f32_16x16x32_bf16 v[84:87], v[132:135], v[148:151], v[84:87]
    ds_read_b128 v[172:175], v11 offset:37376
    v_mfma_f32_16x16x32_bf16 v[88:91], v[136:139], v[148:151], v[88:91]
    ds_read_b64_tr_b16 v[180:181], v15 offset:40960
    v_mfma_f32_16x16x32_bf16 v[92:95], v[140:143], v[148:151], v[92:95]
    ds_read_b64_tr_b16 v[182:183], v15 offset:41984
    v_mfma_f32_16x16x32_bf16 v[96:99], v[128:131], v[152:155], v[96:99]
    ds_read_b64_tr_b16 v[184:185], v14 offset:41216
    v_mfma_f32_16x16x32_bf16 v[100:103], v[132:135], v[152:155], v[100:103]
    ds_read_b64_tr_b16 v[186:187], v14 offset:42240
    v_mfma_f32_16x16x32_bf16 v[104:107], v[136:139], v[152:155], v[104:107]
    ds_read_b64_tr_b16 v[188:189], v15 offset:41216
    v_mfma_f32_16x16x32_bf16 v[108:111], v[140:143], v[152:155], v[108:111]
    ds_read_b64_tr_b16 v[190:191], v15 offset:42240
    v_mfma_f32_16x16x32_bf16 v[112:115], v[128:131], v[156:159], v[112:115]
    v_mfma_f32_16x16x32_bf16 v[116:119], v[132:135], v[156:159], v[116:119]
    v_mfma_f32_16x16x32_bf16 v[120:123], v[136:139], v[156:159], v[120:123]
    v_mfma_f32_16x16x32_bf16 v[124:127], v[140:143], v[156:159], v[124:127]
    s_waitcnt lgkmcnt(0)
    v_mfma_f32_16x16x32_bf16 v[64:67], v[160:163], v[176:179], v[64:67]
    s_barrier
    ds_read_b128 v[128:131], v8 offset:0
    v_mfma_f32_16x16x32_bf16 v[68:71], v[164:167], v[176:179], v[68:71]
    ds_read_b64_tr_b16 v[144:145], v12 offset:0
    v_mfma_f32_16x16x32_bf16 v[72:75], v[168:171], v[176:179], v[72:75]
    ds_read_b64_tr_b16 v[146:147], v12 offset:1024
    v_mfma_f32_16x16x32_bf16 v[76:79], v[172:175], v[176:179], v[76:79]
    ds_read_b128 v[132:135], v8 offset:512
    v_mfma_f32_16x16x32_bf16 v[80:83], v[160:163], v[180:183], v[80:83]
    ds_read_b128 v[136:139], v8 offset:4096
    v_mfma_f32_16x16x32_bf16 v[84:87], v[164:167], v[180:183], v[84:87]
    ds_read_b128 v[140:143], v8 offset:4608
    v_mfma_f32_16x16x32_bf16 v[88:91], v[168:171], v[180:183], v[88:91]
    ds_read_b64_tr_b16 v[148:149], v13 offset:0
    v_mfma_f32_16x16x32_bf16 v[92:95], v[172:175], v[180:183], v[92:95]
    ds_read_b64_tr_b16 v[150:151], v13 offset:1024
    v_mfma_f32_16x16x32_bf16 v[96:99], v[160:163], v[184:187], v[96:99]
    ds_read_b64_tr_b16 v[152:153], v12 offset:256
    v_mfma_f32_16x16x32_bf16 v[100:103], v[164:167], v[184:187], v[100:103]
    ds_read_b64_tr_b16 v[154:155], v12 offset:1280
    v_mfma_f32_16x16x32_bf16 v[104:107], v[168:171], v[184:187], v[104:107]
    ds_read_b64_tr_b16 v[156:157], v13 offset:256
    v_mfma_f32_16x16x32_bf16 v[108:111], v[172:175], v[184:187], v[108:111]
    ds_read_b64_tr_b16 v[158:159], v13 offset:1280
    v_mfma_f32_16x16x32_bf16 v[112:115], v[160:163], v[188:191], v[112:115]
    v_mfma_f32_16x16x32_bf16 v[116:119], v[164:167], v[188:191], v[116:119]
    v_mfma_f32_16x16x32_bf16 v[120:123], v[168:171], v[188:191], v[120:123]
    v_mfma_f32_16x16x32_bf16 v[124:127], v[172:175], v[188:191], v[124:127]
    s_waitcnt lgkmcnt(0)
    v_mfma_f32_16x16x32_bf16 v[64:67], v[128:131], v[144:147], v[64:67]
    ds_read_b128 v[160:163], v9 offset:0
    v_mfma_f32_16x16x32_bf16 v[68:71], v[132:135], v[144:147], v[68:71]
    ds_read_b64_tr_b16 v[176:177], v12 offset:8192
    v_mfma_f32_16x16x32_bf16 v[72:75], v[136:139], v[144:147], v[72:75]
    ds_read_b64_tr_b16 v[178:179], v12 offset:9216
    v_mfma_f32_16x16x32_bf16 v[76:79], v[140:143], v[144:147], v[76:79]
    ds_read_b128 v[164:167], v9 offset:512
    v_mfma_f32_16x16x32_bf16 v[80:83], v[128:131], v[148:151], v[80:83]
    ds_read_b128 v[168:171], v9 offset:4096
    v_mfma_f32_16x16x32_bf16 v[84:87], v[132:135], v[148:151], v[84:87]
    ds_read_b128 v[172:175], v9 offset:4608
    v_mfma_f32_16x16x32_bf16 v[88:91], v[136:139], v[148:151], v[88:91]
    ds_read_b64_tr_b16 v[180:181], v13 offset:8192
    v_mfma_f32_16x16x32_bf16 v[92:95], v[140:143], v[148:151], v[92:95]
    ds_read_b64_tr_b16 v[182:183], v13 offset:9216
    v_mfma_f32_16x16x32_bf16 v[96:99], v[128:131], v[152:155], v[96:99]
    ds_read_b64_tr_b16 v[184:185], v12 offset:8448
    v_mfma_f32_16x16x32_bf16 v[100:103], v[132:135], v[152:155], v[100:103]
    ds_read_b64_tr_b16 v[186:187], v12 offset:9472
    v_mfma_f32_16x16x32_bf16 v[104:107], v[136:139], v[152:155], v[104:107]
    ds_read_b64_tr_b16 v[188:189], v13 offset:8448
    v_mfma_f32_16x16x32_bf16 v[108:111], v[140:143], v[152:155], v[108:111]
    ds_read_b64_tr_b16 v[190:191], v13 offset:9472
    v_mfma_f32_16x16x32_bf16 v[112:115], v[128:131], v[156:159], v[112:115]
    v_mfma_f32_16x16x32_bf16 v[116:119], v[132:135], v[156:159], v[116:119]
    v_mfma_f32_16x16x32_bf16 v[120:123], v[136:139], v[156:159], v[120:123]
    v_mfma_f32_16x16x32_bf16 v[124:127], v[140:143], v[156:159], v[124:127]
    s_waitcnt lgkmcnt(0)
    v_mfma_f32_16x16x32_bf16 v[64:67], v[160:163], v[176:179], v[64:67]
    s_barrier
    ds_read_b128 v[128:131], v8 offset:32768
    v_mfma_f32_16x16x32_bf16 v[68:71], v[164:167], v[176:179], v[68:71]
    ds_read_b64_tr_b16 v[144:145], v12 offset:32768
    v_mfma_f32_16x16x32_bf16 v[72:75], v[168:171], v[176:179], v[72:75]
    ds_read_b64_tr_b16 v[146:147], v12 offset:33792
    v_mfma_f32_16x16x32_bf16 v[76:79], v[172:175], v[176:179], v[76:79]
    ds_read_b128 v[132:135], v8 offset:33280
    v_mfma_f32_16x16x32_bf16 v[80:83], v[160:163], v[180:183], v[80:83]
    ds_read_b128 v[136:139], v8 offset:36864
    v_mfma_f32_16x16x32_bf16 v[84:87], v[164:167], v[180:183], v[84:87]
    ds_read_b128 v[140:143], v8 offset:37376
    v_mfma_f32_16x16x32_bf16 v[88:91], v[168:171], v[180:183], v[88:91]
    ds_read_b64_tr_b16 v[148:149], v13 offset:32768
    v_mfma_f32_16x16x32_bf16 v[92:95], v[172:175], v[180:183], v[92:95]
    ds_read_b64_tr_b16 v[150:151], v13 offset:33792
    v_mfma_f32_16x16x32_bf16 v[96:99], v[160:163], v[184:187], v[96:99]
    ds_read_b64_tr_b16 v[152:153], v12 offset:33024
    v_mfma_f32_16x16x32_bf16 v[100:103], v[164:167], v[184:187], v[100:103]
    ds_read_b64_tr_b16 v[154:155], v12 offset:34048
    v_mfma_f32_16x16x32_bf16 v[104:107], v[168:171], v[184:187], v[104:107]
    ds_read_b64_tr_b16 v[156:157], v13 offset:33024
    v_mfma_f32_16x16x32_bf16 v[108:111], v[172:175], v[184:187], v[108:111]
    ds_read_b64_tr_b16 v[158:159], v13 offset:34048
    v_mfma_f32_16x16x32_bf16 v[112:115], v[160:163], v[188:191], v[112:115]
    v_mfma_f32_16x16x32_bf16 v[116:119], v[164:167], v[188:191], v[116:119]
    v_mfma_f32_16x16x32_bf16 v[120:123], v[168:171], v[188:191], v[120:123]
    v_mfma_f32_16x16x32_bf16 v[124:127], v[172:175], v[188:191], v[124:127]
    s_waitcnt lgkmcnt(0)
    v_mfma_f32_16x16x32_bf16 v[64:67], v[128:131], v[144:147], v[64:67]
    ds_read_b128 v[160:163], v9 offset:32768
    ds_read_b64_tr_b16 v[176:177], v12 offset:40960
    v_mfma_f32_16x16x32_bf16 v[68:71], v[132:135], v[144:147], v[68:71]
    ds_read_b64_tr_b16 v[178:179], v12 offset:41984
    ds_read_b128 v[164:167], v9 offset:33280
    v_mfma_f32_16x16x32_bf16 v[72:75], v[136:139], v[144:147], v[72:75]
    ds_read_b128 v[168:171], v9 offset:36864
    ds_read_b128 v[172:175], v9 offset:37376
    v_mfma_f32_16x16x32_bf16 v[76:79], v[140:143], v[144:147], v[76:79]
    ds_read_b64_tr_b16 v[180:181], v13 offset:40960
    ds_read_b64_tr_b16 v[182:183], v13 offset:41984
    v_mfma_f32_16x16x32_bf16 v[80:83], v[128:131], v[148:151], v[80:83]
    ds_read_b64_tr_b16 v[184:185], v12 offset:41216
    v_mfma_f32_16x16x32_bf16 v[84:87], v[132:135], v[148:151], v[84:87]
    ds_read_b64_tr_b16 v[186:187], v12 offset:42240
    v_mfma_f32_16x16x32_bf16 v[88:91], v[136:139], v[148:151], v[88:91]
    ds_read_b64_tr_b16 v[188:189], v13 offset:41216
    v_mfma_f32_16x16x32_bf16 v[92:95], v[140:143], v[148:151], v[92:95]
    ds_read_b64_tr_b16 v[190:191], v13 offset:42240
    v_mfma_f32_16x16x32_bf16 v[96:99], v[128:131], v[152:155], v[96:99]
    ds_read_b32 v32, v28 offset:0
    v_mfma_f32_16x16x32_bf16 v[100:103], v[132:135], v[152:155], v[100:103]
    ds_read_b32 v34, v28 offset:64
    v_mfma_f32_16x16x32_bf16 v[104:107], v[136:139], v[152:155], v[104:107]
    ds_read_b32 v36, v28 offset:128
    v_mfma_f32_16x16x32_bf16 v[108:111], v[140:143], v[152:155], v[108:111]
    ds_read_b32 v38, v28 offset:192
    v_mfma_f32_16x16x32_bf16 v[112:115], v[128:131], v[156:159], v[112:115]
    ds_read_b128 v[192:195], v29 offset:0
    v_mfma_f32_16x16x32_bf16 v[116:119], v[132:135], v[156:159], v[116:119]
    ds_read_b128 v[196:199], v29 offset:16
    v_mfma_f32_16x16x32_bf16 v[120:123], v[136:139], v[156:159], v[120:123]
    v_mfma_f32_16x16x32_bf16 v[124:127], v[140:143], v[156:159], v[124:127]
    s_waitcnt lgkmcnt(0)
    v_mfma_f32_16x16x32_bf16 v[64:67], v[160:163], v[176:179], v[64:67]
    ds_read_b128 v[200:203], v29 offset:512
    v_mfma_f32_16x16x32_bf16 v[68:71], v[164:167], v[176:179], v[68:71]
    ds_read_b128 v[204:207], v29 offset:528
    v_mfma_f32_16x16x32_bf16 v[72:75], v[168:171], v[176:179], v[72:75]
    ds_read_b128 v[208:211], v29 offset:128
    v_mfma_f32_16x16x32_bf16 v[76:79], v[172:175], v[176:179], v[76:79]
    ds_read_b128 v[212:215], v29 offset:144
    v_mfma_f32_16x16x32_bf16 v[80:83], v[160:163], v[180:183], v[80:83]
    ds_read_b128 v[216:219], v29 offset:640
    v_mfma_f32_16x16x32_bf16 v[84:87], v[164:167], v[180:183], v[84:87]
    ds_read_b128 v[220:223], v29 offset:656
    v_mfma_f32_16x16x32_bf16 v[88:91], v[168:171], v[180:183], v[88:91]
    v_mfma_f32_16x16x32_bf16 v[92:95], v[172:175], v[180:183], v[92:95]
    v_mfma_f32_16x16x32_bf16 v[96:99], v[160:163], v[184:187], v[96:99]
    v_mfma_f32_16x16x32_bf16 v[100:103], v[164:167], v[184:187], v[100:103]
    v_mfma_f32_16x16x32_bf16 v[104:107], v[168:171], v[184:187], v[104:107]
    v_mfma_f32_16x16x32_bf16 v[108:111], v[172:175], v[184:187], v[108:111]
    v_mfma_f32_16x16x32_bf16 v[112:115], v[160:163], v[188:191], v[112:115]
    v_mfma_f32_16x16x32_bf16 v[116:119], v[164:167], v[188:191], v[116:119]
    v_mfma_f32_16x16x32_bf16 v[120:123], v[168:171], v[188:191], v[120:123]
    v_mfma_f32_16x16x32_bf16 v[124:127], v[172:175], v[188:191], v[124:127]
    s_waitcnt lgkmcnt(0)
    v_mul_f32 v32, -1.0, v32
    v_mul_f32 v34, -1.0, v34
    v_mul_f32 v36, -1.0, v36
    v_mul_f32 v38, -1.0, v38
    v_pk_fma_f32 v[64:65], v[192:193], v[32:33], v[64:65] op_sel_hi:[1,0,1]
    v_pk_fma_f32 v[66:67], v[194:195], v[32:33], v[66:67] op_sel_hi:[1,0,1]
    v_pk_fma_f32 v[68:69], v[196:197], v[32:33], v[68:69] op_sel_hi:[1,0,1]
    v_pk_fma_f32 v[70:71], v[198:199], v[32:33], v[70:71] op_sel_hi:[1,0,1]
    v_pk_fma_f32 v[72:73], v[208:209], v[32:33], v[72:73] op_sel_hi:[1,0,1]
    v_pk_fma_f32 v[74:75], v[210:211], v[32:33], v[74:75] op_sel_hi:[1,0,1]
    v_pk_fma_f32 v[76:77], v[212:213], v[32:33], v[76:77] op_sel_hi:[1,0,1]
    v_pk_fma_f32 v[78:79], v[214:215], v[32:33], v[78:79] op_sel_hi:[1,0,1]
    v_pk_mul_f32 v[64:65], v[64:65], v[200:201]
    v_pk_mul_f32 v[66:67], v[66:67], v[202:203]
    v_pk_mul_f32 v[68:69], v[68:69], v[204:205]
    v_pk_mul_f32 v[70:71], v[70:71], v[206:207]
    v_pk_mul_f32 v[72:73], v[72:73], v[216:217]
    v_pk_mul_f32 v[74:75], v[74:75], v[218:219]
    v_pk_mul_f32 v[76:77], v[76:77], v[220:221]
    v_pk_mul_f32 v[78:79], v[78:79], v[222:223]
    v_cvt_pk_bf16_f32 v64, v64, v65
    v_cvt_pk_bf16_f32 v65, v66, v67
    v_cvt_pk_bf16_f32 v66, v68, v69
    v_cvt_pk_bf16_f32 v67, v70, v71
    v_cvt_pk_bf16_f32 v72, v72, v73
    v_cvt_pk_bf16_f32 v73, v74, v75
    v_cvt_pk_bf16_f32 v74, v76, v77
    v_cvt_pk_bf16_f32 v75, v78, v79
    buffer_store_dwordx4 v[64:67], v24, s[8:11], s32 offen sc1
    buffer_store_dwordx4 v[72:75], v24, s[8:11], s33 offen sc1
    v_pk_fma_f32 v[80:81], v[192:193], v[34:35], v[80:81] op_sel_hi:[1,0,1]
    v_pk_fma_f32 v[82:83], v[194:195], v[34:35], v[82:83] op_sel_hi:[1,0,1]
    v_pk_fma_f32 v[84:85], v[196:197], v[34:35], v[84:85] op_sel_hi:[1,0,1]
    v_pk_fma_f32 v[86:87], v[198:199], v[34:35], v[86:87] op_sel_hi:[1,0,1]
    v_pk_fma_f32 v[88:89], v[208:209], v[34:35], v[88:89] op_sel_hi:[1,0,1]
    v_pk_fma_f32 v[90:91], v[210:211], v[34:35], v[90:91] op_sel_hi:[1,0,1]
    v_pk_fma_f32 v[92:93], v[212:213], v[34:35], v[92:93] op_sel_hi:[1,0,1]
    v_pk_fma_f32 v[94:95], v[214:215], v[34:35], v[94:95] op_sel_hi:[1,0,1]
    v_pk_mul_f32 v[80:81], v[80:81], v[200:201]
    v_pk_mul_f32 v[82:83], v[82:83], v[202:203]
    v_pk_mul_f32 v[84:85], v[84:85], v[204:205]
    v_pk_mul_f32 v[86:87], v[86:87], v[206:207]
    v_pk_mul_f32 v[88:89], v[88:89], v[216:217]
    v_pk_mul_f32 v[90:91], v[90:91], v[218:219]
    v_pk_mul_f32 v[92:93], v[92:93], v[220:221]
    v_pk_mul_f32 v[94:95], v[94:95], v[222:223]
    v_cvt_pk_bf16_f32 v80, v80, v81
    v_cvt_pk_bf16_f32 v81, v82, v83
    v_cvt_pk_bf16_f32 v82, v84, v85
    v_cvt_pk_bf16_f32 v83, v86, v87
    v_cvt_pk_bf16_f32 v88, v88, v89
    v_cvt_pk_bf16_f32 v89, v90, v91
    v_cvt_pk_bf16_f32 v90, v92, v93
    v_cvt_pk_bf16_f32 v91, v94, v95
    buffer_store_dwordx4 v[80:83], v25, s[8:11], s32 offen sc1
    buffer_store_dwordx4 v[88:91], v25, s[8:11], s33 offen sc1
    v_pk_fma_f32 v[96:97], v[192:193], v[36:37], v[96:97] op_sel_hi:[1,0,1]
    v_pk_fma_f32 v[98:99], v[194:195], v[36:37], v[98:99] op_sel_hi:[1,0,1]
    v_pk_fma_f32 v[100:101], v[196:197], v[36:37], v[100:101] op_sel_hi:[1,0,1]
    v_pk_fma_f32 v[102:103], v[198:199], v[36:37], v[102:103] op_sel_hi:[1,0,1]
    v_pk_fma_f32 v[104:105], v[208:209], v[36:37], v[104:105] op_sel_hi:[1,0,1]
    v_pk_fma_f32 v[106:107], v[210:211], v[36:37], v[106:107] op_sel_hi:[1,0,1]
    v_pk_fma_f32 v[108:109], v[212:213], v[36:37], v[108:109] op_sel_hi:[1,0,1]
    v_pk_fma_f32 v[110:111], v[214:215], v[36:37], v[110:111] op_sel_hi:[1,0,1]
    v_pk_mul_f32 v[96:97], v[96:97], v[200:201]
    v_pk_mul_f32 v[98:99], v[98:99], v[202:203]
    v_pk_mul_f32 v[100:101], v[100:101], v[204:205]
    v_pk_mul_f32 v[102:103], v[102:103], v[206:207]
    v_pk_mul_f32 v[104:105], v[104:105], v[216:217]
    v_pk_mul_f32 v[106:107], v[106:107], v[218:219]
    v_pk_mul_f32 v[108:109], v[108:109], v[220:221]
    v_pk_mul_f32 v[110:111], v[110:111], v[222:223]
    v_cvt_pk_bf16_f32 v96, v96, v97
    v_cvt_pk_bf16_f32 v97, v98, v99
    v_cvt_pk_bf16_f32 v98, v100, v101
    v_cvt_pk_bf16_f32 v99, v102, v103
    v_cvt_pk_bf16_f32 v104, v104, v105
    v_cvt_pk_bf16_f32 v105, v106, v107
    v_cvt_pk_bf16_f32 v106, v108, v109
    v_cvt_pk_bf16_f32 v107, v110, v111
    buffer_store_dwordx4 v[96:99], v26, s[8:11], s32 offen sc1
    buffer_store_dwordx4 v[104:107], v26, s[8:11], s33 offen sc1
    v_pk_fma_f32 v[112:113], v[192:193], v[38:39], v[112:113] op_sel_hi:[1,0,1]
    v_pk_fma_f32 v[114:115], v[194:195], v[38:39], v[114:115] op_sel_hi:[1,0,1]
    v_pk_fma_f32 v[116:117], v[196:197], v[38:39], v[116:117] op_sel_hi:[1,0,1]
    v_pk_fma_f32 v[118:119], v[198:199], v[38:39], v[118:119] op_sel_hi:[1,0,1]
    v_pk_fma_f32 v[120:121], v[208:209], v[38:39], v[120:121] op_sel_hi:[1,0,1]
    v_pk_fma_f32 v[122:123], v[210:211], v[38:39], v[122:123] op_sel_hi:[1,0,1]
    v_pk_fma_f32 v[124:125], v[212:213], v[38:39], v[124:125] op_sel_hi:[1,0,1]
    v_pk_fma_f32 v[126:127], v[214:215], v[38:39], v[126:127] op_sel_hi:[1,0,1]
    v_pk_mul_f32 v[112:113], v[112:113], v[200:201]
    v_pk_mul_f32 v[114:115], v[114:115], v[202:203]
    v_pk_mul_f32 v[116:117], v[116:117], v[204:205]
    v_pk_mul_f32 v[118:119], v[118:119], v[206:207]
    v_pk_mul_f32 v[120:121], v[120:121], v[216:217]
    v_pk_mul_f32 v[122:123], v[122:123], v[218:219]
    v_pk_mul_f32 v[124:125], v[124:125], v[220:221]
    v_pk_mul_f32 v[126:127], v[126:127], v[222:223]
    v_cvt_pk_bf16_f32 v112, v112, v113
    v_cvt_pk_bf16_f32 v113, v114, v115
    v_cvt_pk_bf16_f32 v114, v116, v117
    v_cvt_pk_bf16_f32 v115, v118, v119
    v_cvt_pk_bf16_f32 v120, v120, v121
    v_cvt_pk_bf16_f32 v121, v122, v123
    v_cvt_pk_bf16_f32 v122, v124, v125
    v_cvt_pk_bf16_f32 v123, v126, v127
    buffer_store_dwordx4 v[112:115], v27, s[8:11], s32 offen sc1
    buffer_store_dwordx4 v[120:123], v27, s[8:11], s33 offen sc1
    s_lshl_b32 s81, s5, 4
    s_add_u32 s81, s81, s4
    s_mul_i32 s81, s81, 128
    s_add_u32 s81, s81, 30535680
    v_mov_b32 v28, 0x80000000
    v_mov_b32 v29, 0x80000000
    v_mov_b32 v30, 0x80000000
    v_mov_b32 v31, 0x80000000
    v_mov_b32 v32, 0x80000000
    v_mov_b32 v33, 0x80000000
    v_mov_b32 v34, 0x80000000
    v_mov_b32 v35, 0x80000000
    v_mov_b32 v36, 0x80000000
    v_mov_b32 v37, 0x80000000
    v_mov_b32 v38, 0x80000000
    s_waitcnt vmcnt(0)
    s_barrier
    s_mov_b32 s28, s81
    s_cmp_lg_u32 s3, 0
    s_cbranch_scc1 nf_27
    v_mov_b32 v4, s58
    v_mov_b32 v5, 0
    s_mov_b64 exec, 1
    buffer_store_dword v4, v5, s[8:11], s28 offen sc1
    s_mov_b64 exec, -1
nf_27:
    s_mov_b32 s68, 0
    s_mov_b32 s82, 0
    s_branch p2_start
p1_spare:
    s_waitcnt lgkmcnt(0)
    s_mov_b32 s12, s40
    s_mov_b32 s13, s41
    s_mov_b32 s14, 2621440
    s_mov_b32 s15, 0x20000
    s_mov_b32 s16, s42
    s_mov_b32 s17, s43
    s_mov_b32 s18, 2457600
    s_mov_b32 s19, 0x20000
    s_add_u32 s56, s56, 67108864
    s_addc_u32 s57, s57, 0
    s_add_u32 s60, s56, 30672896
    s_addc_u32 s61, s57, 0
    s_load_dword s58, s[60:61], 0
    s_mov_b32 s8, s56
    s_mov_b32 s9, s57
    s_mov_b32 s10, 31268864
    s_mov_b32 s11, 0x20000
    s_mov_b32 s24, s44
    s_mov_b32 s25, s45
    s_mov_b32 s26, 819200
    s_mov_b32 s27, 0x20000
    s_waitcnt lgkmcnt(0)
    s_mul_i32 s58, s58, 0x9e3779b1
    s_add_u32 s58, s58, 0x7f4a7c15
    s_mov_b32 s4, s20
    s_and_b32 s6, s3, 3
    v_lshrrev_b32 v42, 5, v0
    s_lshl_b32 s28, s6, 1
    v_add_u32_e64 v42, s28, v42
    v_mul_u32_u24 v40, 1280, v42
    v_and_b32 v43, 31, v0
    v_lshl_add_u32 v40, v43, 4, v40
    v_bfe_u32 v41, v0, 4, 1
    v_lshl_or_b32 v41, v41, 31, v40
    v_lshlrev_b32 v42, 2, v42
    v_add_u32 v42, 157184, v42
    s_lshl_b32 s63, s4, 4
    s_add_u32 s63, s63, 15
    s_mul_i32 s62, s63, 10240
    s_lshl_b32 s63, s63, 7
    s_add_u32 s63, s63, 30339072
    s_cmp_lt_u32 s3, 4
    s_cbranch_scc1 sp_t_28
    buffer_load_dwordx4 v[48:51], v40, s[12:15], s62 offen
    buffer_load_dwordx4 v[52:55], v40, s[12:15], s62 offen offset:512
    buffer_load_dwordx4 v[56:59], v41, s[12:15], s62 offen offset:1024
    s_waitcnt vmcnt(0)
    v_mov_b32 v188, 0x3f803f80
    v_dot2_f32_bf16 v192, v48, v188, 0
    v_dot2_f32_bf16 v194, v48, v48, 0
    v_dot2_f32_bf16 v193, v49, v188, 0
    v_dot2_f32_bf16 v195, v49, v49, 0
    v_dot2_f32_bf16 v192, v50, v188, v192
    v_dot2_f32_bf16 v194, v50, v50, v194
    v_dot2_f32_bf16 v193, v51, v188, v193
    v_dot2_f32_bf16 v195, v51, v51, v195
    v_dot2_f32_bf16 v192, v52, v188, v192
    v_dot2_f32_bf16 v194, v52, v52, v194
    v_dot2_f32_bf16 v193, v53, v188, v193
    v_dot2_f32_bf16 v195, v53, v53, v195
    v_dot2_f32_bf16 v192, v54, v188, v192
    v_dot2_f32_bf16 v194, v54, v54, v194
    v_dot2_f32_bf16 v193, v55, v188, v193
    v_dot2_f32_bf16 v195, v55, v55, v195
    v_dot2_f32_bf16 v192, v56, v188, v192
    v_dot2_f32_bf16 v194, v56, v56, v194
    v_dot2_f32_bf16 v193, v57, v188, v193
    v_dot2_f32_bf16 v195, v57, v57, v195
    v_dot2_f32_bf16 v192, v58, v188, v192
    v_dot2_f32_bf16 v194, v58, v58, v194
    v_dot2_f32_bf16 v193, v59, v188, v193
    v_dot2_f32_bf16 v195, v59, v59, v195
    s_nop 1
    v_add_f32 v192, v192, v193
    v_add_f32 v194, v194, v195
    s_nop 0
    v_add_f32_dpp v192, v192, v192 quad_perm:[1,0,3,2] row_mask:0xf bank_mask:0xf
    v_add_f32_dpp v194, v194, v194 quad_perm:[1,0,3,2] row_mask:0xf bank_mask:0xf
    s_nop 0
    s_nop 0
    v_add_f32_dpp v192, v192, v192 quad_perm:[2,3,0,1] row_mask:0xf bank_mask:0xf
    v_add_f32_dpp v194, v194, v194 quad_perm:[2,3,0,1] row_mask:0xf bank_mask:0xf
    s_nop 0
    v_add_f32_dpp v192, v192, v192 row_half_mirror row_mask:0xf bank_mask:0xf
    v_add_f32_dpp v194, v194, v194 row_half_mirror row_mask:0xf bank_mask:0xf
    s_nop 0
    v_add_f32_dpp v192, v192, v192 row_mirror row_mask:0xf bank_mask:0xf
    v_add_f32_dpp v194, v194, v194 row_mirror row_mask:0xf bank_mask:0xf
    v_mov_b32 v193, v192
    v_mov_b32 v195, v194
    s_nop 0
    v_permlane16_swap_b32 v192, v193
    v_permlane16_swap_b32 v194, v195
    v_add_f32 v192, v192, v193
    v_add_f32 v194, v194, v195
    v_mul_f32 v192, 0x3acccccd, v192
    v_mul_f32 v194, 0x3acccccd, v194
    v_fma_f32 v194, -v192, v192, v194
    v_max_f32 v194, 0, v194
    v_add_f32 v194, 0x3727c5ac, v194
    v_rsq_f32 v194, v194
    ds_write_b32 v42, v192
    ds_write_b32 v42, v194 offset:32
    s_waitcnt lgkmcnt(0)
sp_t_28:
    s_barrier
    s_cmp_lg_u32 s3, 4
    s_cbranch_scc1 sp_t_29
    v_and_b32 v4, 31, v0
    v_lshlrev_b32 v4, 2, v4
    v_and_b32 v5, 63, v4
    v_add_u32 v5, 157184, v5
    ds_read_b32 v5, v5
    s_waitcnt lgkmcnt(0)
    buffer_store_dword v5, v4, s[8:11], s63 offen sc1
    s_waitcnt vmcnt(0)
    s_add_u32 s28, s20, 240
    s_mul_i32 s28, s28, 128
    s_add_u32 s28, s28, 30502912
    v_mov_b32 v4, s58
    v_mov_b32 v5, 0
    s_mov_b64 exec, 1
    buffer_store_dword v4, v5, s[8:11], s28 offen sc1
    s_mov_b64 exec, -1
sp_t_29:
    s_and_b32 s64, s2, 7
    s_lshl_b32 s64, s64, 1
    s_lshr_b32 s65, s2, 7
    s_add_u32 s64, s64, s65
    s_bfe_u32 s65, s2, 0x40003
    s_mul_i32 s66, s64, 40
    s_add_u32 s67, s66, 39
    s_lshr_b32 s66, s66, 7
    s_lshr_b32 s67, s67, 7
    s_sub_u32 s67, s67, s66
    v_bfe_u32 v249, v0, 4, 1
    v_mul_lo_u32 v249, v249, s67
    v_add_u32 v249, s66, v249
    v_lshrrev_b32 v248, 5, v0
    v_mul_u32_u24 v248, 5, v248
    v_add3_u32 v248, v248, v249, 5
    v_and_b32_e64 v242, 15, v0
    v_lshl_add_u32 v248, v248, 4, v242
    v_mul_u32_u24 v248, 128, v248
    v_lshl_add_u32 v249, v249, 4, s65
    v_add_u32 v242, 240, v242
    v_cmp_gt_u32 vcc, 32, v0
    s_nop 1
    v_cndmask_b32 v249, v249, v242, vcc
    v_mul_u32_u24 v249, 128, v249
    s_cmp_lg_u32 s3, 1
    s_cbranch_scc1 nfs_30
    s_mov_b32 s78, s4
    s_mov_b32 s79, s5
    s_mov_b32 s80, s6
    s_lshl_b32 s28, 15, 4
    s_add_u32 s28, s28, s4
    v_mov_b32 v242, s28
    s_and_b32 s4, s2, 7
    s_lshl_b32 s4, s4, 1
    s_lshr_b32 s5, s2, 7
    s_add_u32 s4, s4, s5
    s_bfe_u32 s5, s2, 0x40003
    s_lshl_b32 s28, s5, 4
    s_add_u32 s28, s28, s4
    v_writelane_b32 v242, s28, 2
    s_and_b32 s6, s2, 3
    s_lshl_b32 s6, s6, 3
    s_bfe_u32 s4, s2, 0x30003
    s_add_u32 s4, s4, s6
    s_bfe_u32 s6, s2, 0x10002
    s_lshl_b32 s6, s6, 2
    s_lshr_b32 s5, s2, 6
    s_add_u32 s5, s5, s6
    s_lshl_b32 s28, s4, 3
    s_add_u32 s28, s28, s5
    v_writelane_b32 v242, s28, 3
    s_and_b32 s6, s2, 1
    s_lshl_b32 s6, s6, 3
    s_bfe_u32 s4, s2, 0x30003
    s_add_u32 s4, s4, s6
    s_bfe_u32 s6, s2, 0x20001
    s_lshl_b32 s6, s6, 2
    s_lshr_b32 s5, s2, 6
    s_add_u32 s5, s5, s6
    s_lshl_b32 s28, s4, 4
    s_add_u32 s28, s28, s5
    v_writelane_b32 v242, s28, 4
    s_mov_b32 s4, s78
    s_mov_b32 s5, s79
    s_mov_b32 s6, s80
    v_lshl_add_u32 v242, v0, 8, v242
    v_mul_u32_u24 v242, 128, v242
    s_mov_b32 s28, 30502912
    s_mov_b64 exec, 0x1f
    buffer_load_dword v246, v242, s[8:11], s28 offen sc1
    s_mov_b64 exec, -1
nfs_30:
    s_lshl_b32 s21, s20, 3
    s_add_u32 s21, s21, s3
    s_lshl_b32 s22, s21, 6
    v_add_u32 v2, s22, v0
    v_lshrrev_b32 v4, 3, v2
    v_mul_u32_u24 v4, 10368, v4
    v_and_b32 v2, 7, v2
    v_lshl_add_u32 v2, v2, 4, v4
    s_cmp_ge_u32 s21, 32
    s_cselect_b32 s23, 0x80000000, 0
    v_or_b32 v2, s23, v2
    v_mov_b32 v4, 0x3f803f80
    v_mov_b32 v5, 0x3f803f80
    v_mov_b32 v6, 0x3f803f80
    v_mov_b32 v7, 0x3f803f80
    s_mov_b32 s23, 5253120
    buffer_store_dwordx4 v[4:7], v2, s[8:11], s23 offen sc1
    v_lshrrev_b32 v16, 3, v0
    v_and_b32 v8, 2, v16
    v_lshlrev_b32 v8, 1, v8
    v_and_b32 v17, 7, v0
    v_xor_b32 v17, v17, v8
    v_lshlrev_b32 v17, 4, v17
    v_lshrrev_b32_e64 v19, 5, v0
    v_bfe_u32 v20, v0, 4, 1
    v_and_b32_e64 v21, 15, v0
    v_bfe_u32 v8, v0, 2, 2
    v_lshl_add_u32 v18, v19, 3, v8
    v_lshlrev_b32 v18, 7, v18
    v_lshrrev_b32 v8, 1, v8
    v_lshl_add_u32 v18, v8, 6, v18
    v_lshl_add_u32 v18, v20, 5, v18
    v_and_b32 v8, 3, v0
    v_lshl_add_u32 v18, v8, 3, v18
    v_lshrrev_b32 v8, 1, v21
    v_xor_b32 v8, v8, v21
    v_and_b32 v8, 4, v8
    v_lshl_or_b32 v8, v8, 1, v8
    v_xor_b32 v22, v8, v21
    v_bfe_u32 v8, v0, 2, 1
    v_lshlrev_b32 v22, 10, v8
    v_bfe_u32 v8, v0, 3, 1
    v_lshl_add_u32 v22, v8, 6, v22
    v_and_b32 v8, 3, v0
    v_lshl_add_u32 v22, v8, 4, v22
    s_lshl_b32 s30, s3, 13
    s_add_u32 s31, s21, 0
    s_mul_i32 s32, s31, 6554
    s_lshr_b32 s32, s32, 16
    s_mul_i32 s33, s32, 10
    s_sub_u32 s33, s31, s33
    s_mul_i32 s34, s32, 20
    s_mul_i32 s35, s32, 80
    s_sub_u32 s35, s35, 2544
    s_cmp_lt_u32 s32, 32
    s_cselect_b32 s34, s34, s35
    s_cselect_b32 s35, 4, 20
    v_lshrrev_b32 v8, 2, v16
    v_mul_lo_u32 v8, v8, s35
    v_and_b32 v9, 3, v16
    v_add_u32 v8, v8, v9
    v_mul_u32_u24 v8, 1280, v8
    v_add_u32 v8, v8, v17
    s_mul_i32 s36, s34, 1280
    s_lshl_b32 s37, s33, 7
    s_add_u32 s36, s36, s37
    s_mul_i32 s37, s35, 2560
    s_add_u32 s37, s37, s36
    s_add_u32 m0, s30, 0
    s_nop 0
    buffer_load_dwordx4 v8, s[24:27], s36 offen lds
    s_add_u32 m0, s30, 1024
    s_nop 0
    buffer_load_dwordx4 v8, s[24:27], s37 offen lds
    s_cmp_ge_u32 s31, 400
    s_cselect_b32 s39, 0x80000000, 0
    s_add_u32 s39, s39, 23068672
    s_lshl_b32 s38, s33, 2
    s_add_u32 s38, s38, 0
    v_add_u32 v9, s38, v20
    v_mul_u32_u24 v10, 205, v9
    v_lshrrev_b32 v10, 10, v10
    v_mul_u32_u24 v11, 5, v10
    v_sub_u32 v11, v9, v11
    v_mul_u32_u24 v10, 102400, v10
    s_lshr_b32 s35, s32, 1
    s_mul_i32 s35, s35, 5120
    s_and_b32 s36, s32, 1
    s_lshl_b32 s36, s36, 9
    s_add_u32 s35, s35, s36
    v_add_u32 v10, s35, v10
    v_lshl_add_u32 v10, v19, 8, v10
    v_lshrrev_b32 v9, 1, v11
    v_lshl_add_u32 v10, v9, 11, v10
    v_and_b32 v9, 1, v11
    v_lshl_add_u32 v9, v9, 7, v22
    v_lshlrev_b32 v12, 4, v21
    v_cmp_eq_u32 vcc, 4, v11
    s_nop 1
    v_cndmask_b32 v9, v9, v12, vcc
    v_add_u32 v10, v10, v9
    v_add_u32 v24, s39, v10
    s_lshl_b32 s38, s33, 2
    s_add_u32 s38, s38, 2
    v_add_u32 v9, s38, v20
    v_mul_u32_u24 v10, 205, v9
    v_lshrrev_b32 v10, 10, v10
    v_mul_u32_u24 v11, 5, v10
    v_sub_u32 v11, v9, v11
    v_mul_u32_u24 v10, 102400, v10
    s_lshr_b32 s35, s32, 1
    s_mul_i32 s35, s35, 5120
    s_and_b32 s36, s32, 1
    s_lshl_b32 s36, s36, 9
    s_add_u32 s35, s35, s36
    v_add_u32 v10, s35, v10
    v_lshl_add_u32 v10, v19, 8, v10
    v_lshrrev_b32 v9, 1, v11
    v_lshl_add_u32 v10, v9, 11, v10
    v_and_b32 v9, 1, v11
    v_lshl_add_u32 v9, v9, 7, v22
    v_lshlrev_b32 v12, 4, v21
    v_cmp_eq_u32 vcc, 4, v11
    s_nop 1
    v_cndmask_b32 v9, v9, v12, vcc
    v_add_u32 v10, v10, v9
    v_add_u32 v25, s39, v10
    s_add_u32 s31, s21, 128
    s_mul_i32 s32, s31, 6554
    s_lshr_b32 s32, s32, 16
    s_mul_i32 s33, s32, 10
    s_sub_u32 s33, s31, s33
    s_mul_i32 s34, s32, 20
    s_mul_i32 s35, s32, 80
    s_sub_u32 s35, s35, 2544
    s_cmp_lt_u32 s32, 32
    s_cselect_b32 s34, s34, s35
    s_cselect_b32 s35, 4, 20
    v_lshrrev_b32 v8, 2, v16
    v_mul_lo_u32 v8, v8, s35
    v_and_b32 v9, 3, v16
    v_add_u32 v8, v8, v9
    v_mul_u32_u24 v8, 1280, v8
    v_add_u32 v8, v8, v17
    s_mul_i32 s36, s34, 1280
    s_lshl_b32 s37, s33, 7
    s_add_u32 s36, s36, s37
    s_mul_i32 s37, s35, 2560
    s_add_u32 s37, s37, s36
    s_add_u32 m0, s30, 2048
    s_nop 0
    buffer_load_dwordx4 v8, s[24:27], s36 offen lds
    s_add_u32 m0, s30, 3072
    s_nop 0
    buffer_load_dwordx4 v8, s[24:27], s37 offen lds
    s_cmp_ge_u32 s31, 400
    s_cselect_b32 s39, 0x80000000, 0
    s_add_u32 s39, s39, 23068672
    s_lshl_b32 s38, s33, 2
    s_add_u32 s38, s38, 0
    v_add_u32 v9, s38, v20
    v_mul_u32_u24 v10, 205, v9
    v_lshrrev_b32 v10, 10, v10
    v_mul_u32_u24 v11, 5, v10
    v_sub_u32 v11, v9, v11
    v_mul_u32_u24 v10, 102400, v10
    s_lshr_b32 s35, s32, 1
    s_mul_i32 s35, s35, 5120
    s_and_b32 s36, s32, 1
    s_lshl_b32 s36, s36, 9
    s_add_u32 s35, s35, s36
    v_add_u32 v10, s35, v10
    v_lshl_add_u32 v10, v19, 8, v10
    v_lshrrev_b32 v9, 1, v11
    v_lshl_add_u32 v10, v9, 11, v10
    v_and_b32 v9, 1, v11
    v_lshl_add_u32 v9, v9, 7, v22
    v_lshlrev_b32 v12, 4, v21
    v_cmp_eq_u32 vcc, 4, v11
    s_nop 1
    v_cndmask_b32 v9, v9, v12, vcc
    v_add_u32 v10, v10, v9
    v_add_u32 v26, s39, v10
    s_lshl_b32 s38, s33, 2
    s_add_u32 s38, s38, 2
    v_add_u32 v9, s38, v20
    v_mul_u32_u24 v10, 205, v9
    v_lshrrev_b32 v10, 10, v10
    v_mul_u32_u24 v11, 5, v10
    v_sub_u32 v11, v9, v11
    v_mul_u32_u24 v10, 102400, v10
    s_lshr_b32 s35, s32, 1
    s_mul_i32 s35, s35, 5120
    s_and_b32 s36, s32, 1
    s_lshl_b32 s36, s36, 9
    s_add_u32 s35, s35, s36
    v_add_u32 v10, s35, v10
    v_lshl_add_u32 v10, v19, 8, v10
    v_lshrrev_b32 v9, 1, v11
    v_lshl_add_u32 v10, v9, 11, v10
    v_and_b32 v9, 1, v11
    v_lshl_add_u32 v9, v9, 7, v22
    v_lshlrev_b32 v12, 4, v21
    v_cmp_eq_u32 vcc, 4, v11
    s_nop 1
    v_cndmask_b32 v9, v9, v12, vcc
    v_add_u32 v10, v10, v9
    v_add_u32 v27, s39, v10
    s_add_u32 s31, s21, 256
    s_mul_i32 s32, s31, 6554
    s_lshr_b32 s32, s32, 16
    s_mul_i32 s33, s32, 10
    s_sub_u32 s33, s31, s33
    s_mul_i32 s34, s32, 20
    s_mul_i32 s35, s32, 80
    s_sub_u32 s35, s35, 2544
    s_cmp_lt_u32 s32, 32
    s_cselect_b32 s34, s34, s35
    s_cselect_b32 s35, 4, 20
    v_lshrrev_b32 v8, 2, v16
    v_mul_lo_u32 v8, v8, s35
    v_and_b32 v9, 3, v16
    v_add_u32 v8, v8, v9
    v_mul_u32_u24 v8, 1280, v8
    v_add_u32 v8, v8, v17
    s_mul_i32 s36, s34, 1280
    s_lshl_b32 s37, s33, 7
    s_add_u32 s36, s36, s37
    s_mul_i32 s37, s35, 2560
    s_add_u32 s37, s37, s36
    s_add_u32 m0, s30, 4096
    s_nop 0
    buffer_load_dwordx4 v8, s[24:27], s36 offen lds
    s_add_u32 m0, s30, 5120
    s_nop 0
    buffer_load_dwordx4 v8, s[24:27], s37 offen lds
    s_cmp_ge_u32 s31, 400
    s_cselect_b32 s39, 0x80000000, 0
    s_add_u32 s39, s39, 23068672
    s_lshl_b32 s38, s33, 2
    s_add_u32 s38, s38, 0
    v_add_u32 v9, s38, v20
    v_mul_u32_u24 v10, 205, v9
    v_lshrrev_b32 v10, 10, v10
    v_mul_u32_u24 v11, 5, v10
    v_sub_u32 v11, v9, v11
    v_mul_u32_u24 v10, 102400, v10
    s_lshr_b32 s35, s32, 1
    s_mul_i32 s35, s35, 5120
    s_and_b32 s36, s32, 1
    s_lshl_b32 s36, s36, 9
    s_add_u32 s35, s35, s36
    v_add_u32 v10, s35, v10
    v_lshl_add_u32 v10, v19, 8, v10
    v_lshrrev_b32 v9, 1, v11
    v_lshl_add_u32 v10, v9, 11, v10
    v_and_b32 v9, 1, v11
    v_lshl_add_u32 v9, v9, 7, v22
    v_lshlrev_b32 v12, 4, v21
    v_cmp_eq_u32 vcc, 4, v11
    s_nop 1
    v_cndmask_b32 v9, v9, v12, vcc
    v_add_u32 v10, v10, v9
    v_add_u32 v28, s39, v10
    s_lshl_b32 s38, s33, 2
    s_add_u32 s38, s38, 2
    v_add_u32 v9, s38, v20
    v_mul_u32_u24 v10, 205, v9
    v_lshrrev_b32 v10, 10, v10
    v_mul_u32_u24 v11, 5, v10
    v_sub_u32 v11, v9, v11
    v_mul_u32_u24 v10, 102400, v10
    s_lshr_b32 s35, s32, 1
    s_mul_i32 s35, s35, 5120
    s_and_b32 s36, s32, 1
    s_lshl_b32 s36, s36, 9
    s_add_u32 s35, s35, s36
    v_add_u32 v10, s35, v10
    v_lshl_add_u32 v10, v19, 8, v10
    v_lshrrev_b32 v9, 1, v11
    v_lshl_add_u32 v10, v9, 11, v10
    v_and_b32 v9, 1, v11
    v_lshl_add_u32 v9, v9, 7, v22
    v_lshlrev_b32 v12, 4, v21
    v_cmp_eq_u32 vcc, 4, v11
    s_nop 1
    v_cndmask_b32 v9, v9, v12, vcc
    v_add_u32 v10, v10, v9
    v_add_u32 v29, s39, v10
    s_add_u32 s31, s21, 384
    s_mul_i32 s32, s31, 6554
    s_lshr_b32 s32, s32, 16
    s_mul_i32 s33, s32, 10
    s_sub_u32 s33, s31, s33
    s_mul_i32 s34, s32, 20
    s_mul_i32 s35, s32, 80
    s_sub_u32 s35, s35, 2544
    s_cmp_lt_u32 s32, 32
    s_cselect_b32 s34, s34, s35
    s_cselect_b32 s35, 4, 20
    v_lshrrev_b32 v8, 2, v16
    v_mul_lo_u32 v8, v8, s35
    v_and_b32 v9, 3, v16
    v_add_u32 v8, v8, v9
    v_mul_u32_u24 v8, 1280, v8
    v_add_u32 v8, v8, v17
    s_mul_i32 s36, s34, 1280
    s_lshl_b32 s37, s33, 7
    s_add_u32 s36, s36, s37
    s_mul_i32 s37, s35, 2560
    s_add_u32 s37, s37, s36
    s_add_u32 m0, s30, 6144
    s_nop 0
    buffer_load_dwordx4 v8, s[24:27], s36 offen lds
    s_add_u32 m0, s30, 7168
    s_nop 0
    buffer_load_dwordx4 v8, s[24:27], s37 offen lds
    s_cmp_ge_u32 s31, 400
    s_cselect_b32 s39, 0x80000000, 0
    s_add_u32 s39, s39, 23068672
    s_lshl_b32 s38, s33, 2
    s_add_u32 s38, s38, 0
    v_add_u32 v9, s38, v20
    v_mul_u32_u24 v10, 205, v9
    v_lshrrev_b32 v10, 10, v10
    v_mul_u32_u24 v11, 5, v10
    v_sub_u32 v11, v9, v11
    v_mul_u32_u24 v10, 102400, v10
    s_lshr_b32 s35, s32, 1
    s_mul_i32 s35, s35, 5120
    s_and_b32 s36, s32, 1
    s_lshl_b32 s36, s36, 9
    s_add_u32 s35, s35, s36
    v_add_u32 v10, s35, v10
    v_lshl_add_u32 v10, v19, 8, v10
    v_lshrrev_b32 v9, 1, v11
    v_lshl_add_u32 v10, v9, 11, v10
    v_and_b32 v9, 1, v11
    v_lshl_add_u32 v9, v9, 7, v22
    v_lshlrev_b32 v12, 4, v21
    v_cmp_eq_u32 vcc, 4, v11
    s_nop 1
    v_cndmask_b32 v9, v9, v12, vcc
    v_add_u32 v10, v10, v9
    v_add_u32 v30, s39, v10
    s_lshl_b32 s38, s33, 2
    s_add_u32 s38, s38, 2
    v_add_u32 v9, s38, v20
    v_mul_u32_u24 v10, 205, v9
    v_lshrrev_b32 v10, 10, v10
    v_mul_u32_u24 v11, 5, v10
    v_sub_u32 v11, v9, v11
    v_mul_u32_u24 v10, 102400, v10
    s_lshr_b32 s35, s32, 1
    s_mul_i32 s35, s35, 5120
    s_and_b32 s36, s32, 1
    s_lshl_b32 s36, s36, 9
    s_add_u32 s35, s35, s36
    v_add_u32 v10, s35, v10
    v_lshl_add_u32 v10, v19, 8, v10
    v_lshrrev_b32 v9, 1, v11
    v_lshl_add_u32 v10, v9, 11, v10
    v_and_b32 v9, 1, v11
    v_lshl_add_u32 v9, v9, 7, v22
    v_lshlrev_b32 v12, 4, v21
    v_cmp_eq_u32 vcc, 4, v11
    s_nop 1
    v_cndmask_b32 v9, v9, v12, vcc
    v_add_u32 v10, v10, v9
    v_add_u32 v31, s39, v10
    s_sub_u32 s32, s21, 64
    s_cmp_ge_u32 s32, 40
    s_cselect_b32 s39, 0x80000000, 0
    s_cselect_b32 s32, 0, s32
    s_mul_i32 s34, s32, 20
    s_mul_i32 s35, s32, 80
    s_sub_u32 s35, s35, 2544
    s_cmp_lt_u32 s32, 32
    s_cselect_b32 s34, s34, s35
    s_cselect_b32 s35, 4, 20
    v_lshrrev_b32 v8, 4, v0
    v_mul_lo_u32 v8, v8, s35
    v_bfe_u32 v9, v0, 2, 2
    v_add_u32 v8, v8, v9
    v_mul_u32_u24 v8, 1280, v8
    v_and_b32 v9, 3, v0
    v_lshl_add_u32 v8, v9, 4, v8
    v_add_u32 v8, s39, v8
    s_mul_i32 s36, s34, 1280
    buffer_load_dwordx4 v[72:75], v8, s[24:27], s36 offen offset:0
    buffer_load_dwordx4 v[76:79], v8, s[24:27], s36 offen offset:64
    buffer_load_dwordx4 v[80:83], v8, s[24:27], s36 offen offset:128
    buffer_load_dwordx4 v[84:87], v8, s[24:27], s36 offen offset:192
    buffer_load_dwordx4 v[88:91], v8, s[24:27], s36 offen offset:256
    buffer_load_dwordx4 v[92:95], v8, s[24:27], s36 offen offset:320
    buffer_load_dwordx4 v[96:99], v8, s[24:27], s36 offen offset:384
    buffer_load_dwordx4 v[100:103], v8, s[24:27], s36 offen offset:448
    buffer_load_dwordx4 v[104:107], v8, s[24:27], s36 offen offset:512
    buffer_load_dwordx4 v[108:111], v8, s[24:27], s36 offen offset:576
    buffer_load_dwordx4 v[112:115], v8, s[24:27], s36 offen offset:640
    buffer_load_dwordx4 v[116:119], v8, s[24:27], s36 offen offset:704
    buffer_load_dwordx4 v[120:123], v8, s[24:27], s36 offen offset:768
    buffer_load_dwordx4 v[124:127], v8, s[24:27], s36 offen offset:832
    buffer_load_dwordx4 v[128:131], v8, s[24:27], s36 offen offset:896
    buffer_load_dwordx4 v[132:135], v8, s[24:27], s36 offen offset:960
    buffer_load_dwordx4 v[136:139], v8, s[24:27], s36 offen offset:1024
    buffer_load_dwordx4 v[140:143], v8, s[24:27], s36 offen offset:1088
    buffer_load_dwordx4 v[144:147], v8, s[24:27], s36 offen offset:1152
    buffer_load_dwordx4 v[148:151], v8, s[24:27], s36 offen offset:1216
    v_add_u32 v13, s30, v18
    v_xor_b32 v14, 64, v13
    s_waitcnt vmcnt(20)
    ds_read_b64_tr_b16 v[40:41], v13 offset:0
    ds_read_b64_tr_b16 v[42:43], v13 offset:512
    ds_read_b64_tr_b16 v[44:45], v14 offset:0
    ds_read_b64_tr_b16 v[46:47], v14 offset:512
    ds_read_b64_tr_b16 v[48:49], v13 offset:2048
    ds_read_b64_tr_b16 v[50:51], v13 offset:2560
    ds_read_b64_tr_b16 v[52:53], v14 offset:2048
    ds_read_b64_tr_b16 v[54:55], v14 offset:2560
    ds_read_b64_tr_b16 v[56:57], v13 offset:4096
    ds_read_b64_tr_b16 v[58:59], v13 offset:4608
    ds_read_b64_tr_b16 v[60:61], v14 offset:4096
    ds_read_b64_tr_b16 v[62:63], v14 offset:4608
    ds_read_b64_tr_b16 v[64:65], v13 offset:6144
    ds_read_b64_tr_b16 v[66:67], v13 offset:6656
    ds_read_b64_tr_b16 v[68:69], v14 offset:6144
    ds_read_b64_tr_b16 v[70:71], v14 offset:6656
    s_waitcnt lgkmcnt(0)
    buffer_store_dwordx4 v[40:43], v24, s[8:11], 0 offen sc1
    buffer_store_dwordx4 v[44:47], v25, s[8:11], 0 offen sc1
    buffer_store_dwordx4 v[48:51], v26, s[8:11], 0 offen sc1
    buffer_store_dwordx4 v[52:55], v27, s[8:11], 0 offen sc1
    buffer_store_dwordx4 v[56:59], v28, s[8:11], 0 offen sc1
    buffer_store_dwordx4 v[60:63], v29, s[8:11], 0 offen sc1
    buffer_store_dwordx4 v[64:67], v30, s[8:11], 0 offen sc1
    buffer_store_dwordx4 v[68:71], v31, s[8:11], 0 offen sc1
    v_mov_b32 v10, 0
    v_mov_b32 v11, 0
    v_mov_b32 v12, 0
    v_mov_b32_e64 v13, 0
    v_mov_b32 v14, 0x3f803f80
    s_waitcnt vmcnt(8)
    s_nop 0
    v_dot2_f32_bf16 v10, v72, v14, v10
    v_dot2_f32_bf16 v11, v73, v14, v11
    v_dot2_f32_bf16 v12, v74, v14, v12
    v_dot2_f32_bf16 v13, v75, v14, v13
    v_dot2_f32_bf16 v10, v76, v14, v10
    v_dot2_f32_bf16 v11, v77, v14, v11
    v_dot2_f32_bf16 v12, v78, v14, v12
    v_dot2_f32_bf16 v13, v79, v14, v13
    v_dot2_f32_bf16 v10, v80, v14, v10
    v_dot2_f32_bf16 v11, v81, v14, v11
    v_dot2_f32_bf16 v12, v82, v14, v12
    v_dot2_f32_bf16 v13, v83, v14, v13
    v_dot2_f32_bf16 v10, v84, v14, v10
    v_dot2_f32_bf16 v11, v85, v14, v11
    v_dot2_f32_bf16 v12, v86, v14, v12
    v_dot2_f32_bf16 v13, v87, v14, v13
    v_dot2_f32_bf16 v10, v88, v14, v10
    v_dot2_f32_bf16 v11, v89, v14, v11
    v_dot2_f32_bf16 v12, v90, v14, v12
    v_dot2_f32_bf16 v13, v91, v14, v13
    v_dot2_f32_bf16 v10, v92, v14, v10
    v_dot2_f32_bf16 v11, v93, v14, v11
    v_dot2_f32_bf16 v12, v94, v14, v12
    v_dot2_f32_bf16 v13, v95, v14, v13
    v_dot2_f32_bf16 v10, v96, v14, v10
    v_dot2_f32_bf16 v11, v97, v14, v11
    v_dot2_f32_bf16 v12, v98, v14, v12
    v_dot2_f32_bf16 v13, v99, v14, v13
    v_dot2_f32_bf16 v10, v100, v14, v10
    v_dot2_f32_bf16 v11, v101, v14, v11
    v_dot2_f32_bf16 v12, v102, v14, v12
    v_dot2_f32_bf16 v13, v103, v14, v13
    v_dot2_f32_bf16 v10, v104, v14, v10
    v_dot2_f32_bf16 v11, v105, v14, v11
    v_dot2_f32_bf16 v12, v106, v14, v12
    v_dot2_f32_bf16 v13, v107, v14, v13
    v_dot2_f32_bf16 v10, v108, v14, v10
    v_dot2_f32_bf16 v11, v109, v14, v11
    v_dot2_f32_bf16 v12, v110, v14, v12
    v_dot2_f32_bf16 v13, v111, v14, v13
    v_dot2_f32_bf16 v10, v112, v14, v10
    v_dot2_f32_bf16 v11, v113, v14, v11
    v_dot2_f32_bf16 v12, v114, v14, v12
    v_dot2_f32_bf16 v13, v115, v14, v13
    v_dot2_f32_bf16 v10, v116, v14, v10
    v_dot2_f32_bf16 v11, v117, v14, v11
    v_dot2_f32_bf16 v12, v118, v14, v12
    v_dot2_f32_bf16 v13, v119, v14, v13
    v_dot2_f32_bf16 v10, v120, v14, v10
    v_dot2_f32_bf16 v11, v121, v14, v11
    v_dot2_f32_bf16 v12, v122, v14, v12
    v_dot2_f32_bf16 v13, v123, v14, v13
    v_dot2_f32_bf16 v10, v124, v14, v10
    v_dot2_f32_bf16 v11, v125, v14, v11
    v_dot2_f32_bf16 v12, v126, v14, v12
    v_dot2_f32_bf16 v13, v127, v14, v13
    v_dot2_f32_bf16 v10, v128, v14, v10
    v_dot2_f32_bf16 v11, v129, v14, v11
    v_dot2_f32_bf16 v12, v130, v14, v12
    v_dot2_f32_bf16 v13, v131, v14, v13
    v_dot2_f32_bf16 v10, v132, v14, v10
    v_dot2_f32_bf16 v11, v133, v14, v11
    v_dot2_f32_bf16 v12, v134, v14, v12
    v_dot2_f32_bf16 v13, v135, v14, v13
    v_dot2_f32_bf16 v10, v136, v14, v10
    v_dot2_f32_bf16 v11, v137, v14, v11
    v_dot2_f32_bf16 v12, v138, v14, v12
    v_dot2_f32_bf16 v13, v139, v14, v13
    v_dot2_f32_bf16 v10, v140, v14, v10
    v_dot2_f32_bf16 v11, v141, v14, v11
    v_dot2_f32_bf16 v12, v142, v14, v12
    v_dot2_f32_bf16 v13, v143, v14, v13
    v_dot2_f32_bf16 v10, v144, v14, v10
    v_dot2_f32_bf16 v11, v145, v14, v11
    v_dot2_f32_bf16 v12, v146, v14, v12
    v_dot2_f32_bf16 v13, v147, v14, v13
    v_dot2_f32_bf16 v10, v148, v14, v10
    v_dot2_f32_bf16 v11, v149, v14, v11
    v_dot2_f32_bf16 v12, v150, v14, v12
    v_dot2_f32_bf16 v13, v151, v14, v13
    s_nop 0
    v_add_f32 v10, v10, v11
    s_nop 0
    v_add_f32 v12, v12, v13
    v_add_f32 v10, v10, v12
    s_nop 1
    v_add_f32_dpp v10, v10, v10 quad_perm:[1,0,3,2] row_mask:0xf bank_mask:0xf
    s_nop 1
    v_add_f32_dpp v10, v10, v10 quad_perm:[2,3,0,1] row_mask:0xf bank_mask:0xf
    v_mul_f32 v10, 0x3acccccd, v10
    v_cvt_pk_bf16_f32 v10, v10, v10
    v_lshrrev_b32 v9, 2, v0
    v_lshlrev_b32 v9, 1, v9
    v_add_u32 v9, s39, v9
    s_lshl_b32 s36, s32, 5
    s_add_u32 s36, s36, 30179328
    buffer_store_short v10, v9, s[8:11], s36 offen sc1
    s_waitcnt vmcnt(0)
    s_barrier
    s_cmp_ge_u32 s3, 4
    s_cbranch_scc1 sp_l_31
    s_add_u32 s28, s20, 240
    s_mul_i32 s28, s28, 128
    s_add_u32 s28, s28, 30535680
    s_cmp_lg_u32 s3, 0
    s_cbranch_scc1 nf_33
    v_mov_b32 v4, s58
    v_mov_b32 v5, 0
    s_mov_b64 exec, 1
    buffer_store_dword v4, v5, s[8:11], s28 offen sc1
    s_mov_b64 exec, -1
nf_33:
    s_nop 0
    v_mov_b32 v28, 0x80000000
    v_mov_b32 v29, 0x80000000
    v_mov_b32 v30, 0x80000000
    v_mov_b32 v31, 0x80000000
    v_mov_b32 v32, 0x80000000
    v_mov_b32 v33, 0x80000000
    v_mov_b32 v34, 0x80000000
    v_mov_b32 v35, 0x80000000
    s_mov_b32 s68, 0
    s_mov_b32 s82, 0
    s_mov_b32 s81, 0
    s_branch p2_start
sp_l_31:
    v_mov_b32 v28, 0x80000000
    v_mov_b32 v29, 0x80000000
    v_mov_b32 v30, 0x80000000
    v_mov_b32 v31, 0x80000000
    v_mov_b32 v32, 0x80000000
    v_mov_b32 v33, 0x80000000
    v_lshlrev_b32 v34, 3, v0
    v_mov_b32 v35, v34
    s_mov_b32 s68, 0
    s_mov_b32 s82, 0
    s_mov_b32 s81, 0
    s_branch p2_start
p2_start:
    s_cmp_ge_u32 s3, 4
    s_cbranch_scc1 p2l_34
    s_and_b32 s6, s2, 3
    s_lshl_b32 s6, s6, 3
    s_bfe_u32 s4, s2, 0x30003
    s_add_u32 s4, s4, s6
    s_bfe_u32 s6, s2, 0x10002
    s_lshl_b32 s6, s6, 2
    s_lshr_b32 s5, s2, 6
    s_add_u32 s5, s5, s6
    s_mov_b32 s39, 0
    s_mul_i32 s62, s5, 102400
    s_add_u32 s62, s62, 23068672
    s_mul_i32 s61, s3, 11264
    s_mul_i32 s39, s39, 10
    s_mul_i32 s29, s3, 11
    s_add_u32 s39, s39, s29
    s_cmp_ge_u32 s39, 100
    s_cselect_b32 s28, 100, 0
    s_sub_u32 s39, s39, s28
    s_add_u32 s63, s62, 102400
    s_mul_i32 s28, s39, 1024
    s_add_u32 s62, s62, s28
    s_and_b32 s4, s2, 7
    s_lshl_b32 s4, s4, 1
    s_lshr_b32 s5, s2, 7
    s_add_u32 s4, s4, s5
    s_bfe_u32 s5, s2, 0x40003
    s_lshr_b32 s6, s3, 2
    s_and_b32 s7, s3, 3
    v_and_b32 v8, 31, v0
    v_lshrrev_b32 v9, 5, v0
    v_lshlrev_b32 v19, 4, v0
    s_lshl_b32 s28, s6, 10
    v_lshl_add_u32 v3, v0, 4, s28
    s_lshl_b32 s28, s6, 3
    s_add_u32 s28, s28, 2048
    v_lshl_add_u32 v4, v8, 4, s28
    v_lshl_add_u32 v4, v9, 2, v4
    v_lshrrev_b32 v11, 1, v8
    v_xor_b32 v11, v11, v8
    v_and_b32 v11, 4, v11
    v_lshl_or_b32 v11, v11, 1, v11
    v_xor_b32 v10, v11, v8
    v_cmp_gt_u32 vcc, 16, v8
    s_nop 1
    v_cndmask_b32 v10, v8, v10, vcc
    s_lshl_b32 s28, s4, 1
    s_add_u32 s28, s28, s6
    s_mul_i32 s28, s28, 20
    s_sub_u32 s28, 640, s28
    v_mov_b32 v11, s28
    v_cmp_eq_u32 vcc, 20, v8
    s_nop 1
    v_cndmask_b32 v10, v10, v11, vcc
    v_mul_u32_u24 v11, 10368, v9
    v_lshl_add_u32 v5, v10, 4, v11
    v_cmp_lt_u32 vcc, 20, v8
    v_mov_b32 v11, 0x80000000
    s_nop 0
    v_cndmask_b32 v5, v5, v11, vcc
    s_mul_i32 s30, s4, 163840
    s_add_u32 s33, s30, 0
    s_add_u32 s30, s30, 2621440
    s_mul_i32 s31, s7, 40960
    s_add_u32 s31, s31, s30
    s_lshl_b32 s34, s4, 1
    s_add_u32 s34, s34, s6
    s_mul_i32 s34, s34, 320
    s_add_u32 s34, s34, 5242880
    s_mul_i32 s32, s7, 663552
    s_add_u32 s32, s32, s34
    s_mul_i32 s28, s5, 10240
    s_add_u32 s33, s33, s28
    s_add_u32 s28, s7, 1
    s_and_b32 s28, s28, 3
    s_mul_i32 s64, s28, 2560
    s_add_u32 s64, s64, s33
    s_lshl_b32 s29, s6, 2
    s_add_u32 s29, s29, s28
    s_mul_i32 s29, s29, 3
    s_add_u32 s29, s29, 0
    s_mul_i32 s29, s29, 3072
    s_add_u32 s29, s29, 90112
    v_add_u32 v16, s29, v19
    s_add_u32 s28, s7, 2
    s_and_b32 s28, s28, 3
    s_mul_i32 s65, s28, 2560
    s_add_u32 s65, s65, s33
    s_lshl_b32 s29, s6, 2
    s_add_u32 s29, s29, s28
    s_mul_i32 s29, s29, 3
    s_add_u32 s29, s29, 1
    s_mul_i32 s29, s29, 3072
    s_add_u32 s29, s29, 90112
    v_add_u32 v17, s29, v19
    s_add_u32 s28, s7, 3
    s_and_b32 s28, s28, 3
    s_mul_i32 s66, s28, 2560
    s_add_u32 s66, s66, s33
    s_lshl_b32 s29, s6, 2
    s_add_u32 s29, s29, s28
    s_mul_i32 s29, s29, 3
    s_add_u32 s29, s29, 2
    s_mul_i32 s29, s29, 3072
    s_add_u32 s29, s29, 90112
    v_add_u32 v18, s29, v19
    s_add_u32 s28, s7, 4
    s_and_b32 s28, s28, 3
    s_mul_i32 s67, s28, 2560
    s_add_u32 s67, s67, s33
    s_lshl_b32 s29, s6, 2
    s_add_u32 s29, s29, s7
    s_mul_i32 s29, s29, 9216
    s_add_u32 s29, s29, 90112
    v_add_u32 v7, s29, v19
    s_lshl_b32 s28, s5, 2
    s_add_u32 s28, s28, s7
    s_mul_i32 s28, s28, 40960
    s_add_u32 s28, s28, 8388608
    s_lshl_b32 s29, s4, 1
    s_add_u32 s29, s29, s6
    s_lshl_b32 s29, s29, 9
    s_add_u32 s36, s29, s28
    s_lshr_b32 s29, s4, 1
    s_add_u32 s29, s29, 32
    s_lshl_b32 s29, s29, 9
    s_add_u32 s29, s29, s28
    s_and_b32 s28, s4, 1
    s_lshl_b32 s28, s28, 8
    s_add_u32 s29, s29, s28
    s_lshl_b32 s28, s6, 3
    s_add_u32 s37, s29, s28
    s_lshl_b32 s29, s4, 1
    s_add_u32 s29, s29, s6
    s_mul_i32 s29, s29, 384
    s_sub_u32 s37, s36, s29
    s_add_u32 s37, s37, 16384
    v_bfe_u32 v10, v0, 4, 1
    v_mul_u32_u24 v10, 20480, v10
    v_and_b32 v1, 15, v0
    v_lshl_add_u32 v11, v1, 3, v10
    v_lshl_add_u32 v1, v1, 4, v10
    v_lshl_add_u32 v1, v9, 8, v1
    v_lshl_or_b32 v11, v9, 31, v11
    s_lshl_b32 s38, s5, 4
    s_add_u32 s38, s38, s4
    s_mul_i32 s38, s38, 128
    s_add_u32 s38, s38, 30568448
    v_mov_b32 v2, 0xdddddddd
    v_sub_u32 v6, 1, v9
    v_mul_u32_u24 v10, 0x3f80, v6
    v_mul_u32_u24 v6, 0xffff, v6
    v_mov_b32 v197, v10
    v_mov_b32 v211, v10
    v_mov_b32 v225, v10
    v_mov_b32 v239, v10
    v_mov_b32 v15, v10
    v_mov_b32 v57, 0
    v_mov_b32 v59, 0
    v_mov_b32 v61, 0
    v_mov_b32 v63, 0
    v_add_u32 v8, 20736, v5
    v_mov_b32 v64, 0
    v_mov_b32 v65, 0
    v_mov_b32 v66, 0
    v_mov_b32 v67, 0
    v_mov_b32 v68, 0
    v_mov_b32 v69, 0
    v_mov_b32 v70, 0
    v_mov_b32 v71, 0
    v_mov_b32 v72, 0
    v_mov_b32 v73, 0
    v_mov_b32 v74, 0
    v_mov_b32 v75, 0
    v_mov_b32 v76, 0
    v_mov_b32 v77, 0
    v_mov_b32 v78, 0
    v_mov_b32 v79, 0
    v_mov_b32 v80, 0
    v_mov_b32 v81, 0
    v_mov_b32 v82, 0
    v_mov_b32 v83, 0
    v_mov_b32 v84, 0
    v_mov_b32 v85, 0
    v_mov_b32 v86, 0
    v_mov_b32 v87, 0
    v_mov_b32 v88, 0
    v_mov_b32 v89, 0
    v_mov_b32 v90, 0
    v_mov_b32 v91, 0
    v_mov_b32 v92, 0
    v_mov_b32 v93, 0
    v_mov_b32 v94, 0
    v_mov_b32 v95, 0
    v_mov_b32 v96, 0
    v_mov_b32 v97, 0
    v_mov_b32 v98, 0
    v_mov_b32 v99, 0
    v_mov_b32 v100, 0
    v_mov_b32 v101, 0
    v_mov_b32 v102, 0
    v_mov_b32 v103, 0
    v_mov_b32 v104, 0
    v_mov_b32 v105, 0
    v_mov_b32 v106, 0
    v_mov_b32 v107, 0
    v_mov_b32 v108, 0
    v_mov_b32 v109, 0
    v_mov_b32 v110, 0
    v_mov_b32 v111, 0
    v_mov_b32 v112, 0
    v_mov_b32 v113, 0
    v_mov_b32 v114, 0
    v_mov_b32 v115, 0
    v_mov_b32 v116, 0
    v_mov_b32 v117, 0
    v_mov_b32 v118, 0
    v_mov_b32 v119, 0
    v_mov_b32 v120, 0
    v_mov_b32 v121, 0
    v_mov_b32 v122, 0
    v_mov_b32 v123, 0
    v_mov_b32 v124, 0
    v_mov_b32 v125, 0
    v_mov_b32 v126, 0
    v_mov_b32 v127, 0
    s_cmp_eq_u32 s82, 0
    s_cbranch_scc1 e2_36
    s_waitcnt vmcnt(0)
    s_barrier
    s_cmp_lg_u32 s3, 0
    s_cbranch_scc1 e2_36
    v_mov_b32 v12, s58
    v_mov_b32 v13, 0
    s_mov_b64 exec, 1
    buffer_store_dword v12, v13, s[8:11], s81 offen sc1
    s_mov_b64 exec, -1
e2_36:
    s_mov_b32 s84, s64
    s_mov_b32 s85, s65
    s_mov_b32 s86, s66
    s_mov_b32 s87, s67
    s_and_b32 s64, s2, 7
    s_lshl_b32 s64, s64, 1
    s_lshr_b32 s65, s2, 7
    s_add_u32 s64, s64, s65
    s_bfe_u32 s65, s2, 0x40003
    s_mul_i32 s66, s64, 40
    s_add_u32 s67, s66, 39
    s_lshr_b32 s66, s66, 7
    s_lshr_b32 s67, s67, 7
    s_sub_u32 s67, s67, s66
    v_bfe_u32 v249, v0, 4, 1
    v_mul_lo_u32 v249, v249, s67
    v_add_u32 v249, s66, v249
    v_lshrrev_b32 v248, 5, v0
    v_mul_u32_u24 v248, 5, v248
    s_nop 0
    v_add3_u32 v248, v248, v249, 5
    v_and_b32_e64 v12, 15, v0
    v_lshl_add_u32 v248, v248, 4, v12
    v_mul_u32_u24 v248, 128, v248
    v_lshl_add_u32 v249, v249, 4, s65
    v_add_u32 v12, 240, v12
    v_cmp_gt_u32 vcc, 32, v0
    s_nop 1
    v_cndmask_b32 v249, v249, v12, vcc
    v_mul_u32_u24 v249, 128, v249
    s_mov_b32 s64, s84
    s_mov_b32 s65, s85
    s_mov_b32 s66, s86
    s_mov_b32 s67, s87
    s_cmp_lg_u32 s3, 1
    s_cbranch_scc1 np_37
    s_mov_b32 s28, 30535680
    s_mov_b32 s59, 0x40000
poll_38:
    buffer_load_dword v12, v248, s[8:11], s28 offen sc1
    buffer_load_dword v13, v249, s[8:11], s28 offen sc1
    s_waitcnt vmcnt(0)
    v_xor_b32 v12, s58, v12
    v_xor_b32 v13, s58, v13
    v_or_b32 v12, v12, v13
    v_cmp_ne_u32 vcc, 0, v12
    s_sub_u32 s59, s59, 1
    s_nop 2
    s_cbranch_vccz pollok_39
    s_cmp_eq_u32 s59, 0
    s_cbranch_scc1 pollok_39
    s_sleep 1
    s_branch poll_38
pollok_39:
np_37:
    s_barrier
    s_branch p2j_35
p2l_34:
    s_cmp_eq_u32 s82, 0
    s_cbranch_scc1 e2_40
    s_waitcnt vmcnt(0)
    s_barrier
    s_cmp_lg_u32 s3, 0
    s_cbranch_scc1 e2_40
    v_mov_b32 v12, s58
    v_mov_b32 v13, 0
    s_mov_b64 exec, 1
    buffer_store_dword v12, v13, s[8:11], s81 offen sc1
    s_mov_b64 exec, -1
e2_40:
    s_mov_b32 s84, s64
    s_mov_b32 s85, s65
    s_mov_b32 s86, s66
    s_mov_b32 s87, s67
    s_and_b32 s64, s2, 7
    s_lshl_b32 s64, s64, 1
    s_lshr_b32 s65, s2, 7
    s_add_u32 s64, s64, s65
    s_bfe_u32 s65, s2, 0x40003
    s_mul_i32 s66, s64, 40
    s_add_u32 s67, s66, 39
    s_lshr_b32 s66, s66, 7
    s_lshr_b32 s67, s67, 7
    s_sub_u32 s67, s67, s66
    v_bfe_u32 v249, v0, 4, 1
    v_mul_lo_u32 v249, v249, s67
    v_add_u32 v249, s66, v249
    v_lshrrev_b32 v248, 5, v0
    v_mul_u32_u24 v248, 5, v248
    s_nop 0
    v_add3_u32 v248, v248, v249, 5
    v_and_b32_e64 v12, 15, v0
    v_lshl_add_u32 v248, v248, 4, v12
    v_mul_u32_u24 v248, 128, v248
    v_lshl_add_u32 v249, v249, 4, s65
    v_add_u32 v12, 240, v12
    v_cmp_gt_u32 vcc, 32, v0
    s_nop 1
    v_cndmask_b32 v249, v249, v12, vcc
    v_mul_u32_u24 v249, 128, v249
    s_mov_b32 s64, s84
    s_mov_b32 s65, s85
    s_mov_b32 s66, s86
    s_mov_b32 s67, s87
    s_cmp_lg_u32 s3, 1
    s_cbranch_scc1 np_41
    s_mov_b32 s28, 30535680
    s_mov_b32 s59, 0x40000
poll_42:
    buffer_load_dword v12, v248, s[8:11], s28 offen sc1
    buffer_load_dword v13, v249, s[8:11], s28 offen sc1
    s_waitcnt vmcnt(0)
    v_xor_b32 v12, s58, v12
    v_xor_b32 v13, s58, v13
    v_or_b32 v12, v12, v13
    v_cmp_ne_u32 vcc, 0, v12
    s_sub_u32 s59, s59, 1
    s_nop 2
    s_cbranch_vccz pollok_43
    s_cmp_eq_u32 s59, 0
    s_cbranch_scc1 pollok_43
    s_sleep 1
    s_branch poll_42
pollok_43:
np_41:
    s_barrier
    s_and_b32 s6, s2, 3
    s_lshl_b32 s6, s6, 3
    s_bfe_u32 s4, s2, 0x30003
    s_add_u32 s4, s4, s6
    s_bfe_u32 s6, s2, 0x10002
    s_lshl_b32 s6, s6, 2
    s_lshr_b32 s5, s2, 6
    s_add_u32 s5, s5, s6
    s_mov_b32 s39, 0
    s_mul_i32 s62, s5, 102400
    s_add_u32 s62, s62, 23068672
    s_mul_i32 s61, s3, 11264
    s_mul_i32 s39, s39, 10
    s_mul_i32 s29, s3, 11
    s_add_u32 s39, s39, s29
    s_cmp_ge_u32 s39, 100
    s_cselect_b32 s28, 100, 0
    s_sub_u32 s39, s39, s28
    s_add_u32 s63, s62, 102400
    s_mul_i32 s28, s39, 1024
    s_add_u32 s62, s62, s28
    s_and_b32 s4, s2, 7
    s_lshl_b32 s4, s4, 1
    s_lshr_b32 s5, s2, 7
    s_add_u32 s4, s4, s5
    s_bfe_u32 s5, s2, 0x40003
    s_lshr_b32 s6, s3, 2
    s_and_b32 s7, s3, 3
    v_and_b32 v8, 31, v0
    v_lshrrev_b32 v9, 5, v0
    v_lshlrev_b32 v19, 4, v0
    s_lshl_b32 s28, s6, 10
    v_lshl_add_u32 v3, v0, 4, s28
    s_lshl_b32 s28, s6, 3
    s_add_u32 s28, s28, 2048
    v_lshl_add_u32 v4, v8, 4, s28
    v_lshl_add_u32 v4, v9, 2, v4
    v_lshrrev_b32 v11, 1, v8
    v_xor_b32 v11, v11, v8
    v_and_b32 v11, 4, v11
    v_lshl_or_b32 v11, v11, 1, v11
    v_xor_b32 v10, v11, v8
    v_cmp_gt_u32 vcc, 16, v8
    s_nop 1
    v_cndmask_b32 v10, v8, v10, vcc
    s_lshl_b32 s28, s4, 1
    s_add_u32 s28, s28, s6
    s_mul_i32 s28, s28, 20
    s_sub_u32 s28, 640, s28
    v_mov_b32 v11, s28
    v_cmp_eq_u32 vcc, 20, v8
    s_nop 1
    v_cndmask_b32 v10, v10, v11, vcc
    v_mul_u32_u24 v11, 10368, v9
    v_lshl_add_u32 v5, v10, 4, v11
    v_cmp_lt_u32 vcc, 20, v8
    v_mov_b32 v11, 0x80000000
    s_nop 0
    v_cndmask_b32 v5, v5, v11, vcc
    s_mul_i32 s30, s4, 163840
    s_add_u32 s33, s30, 0
    s_add_u32 s30, s30, 2621440
    s_mul_i32 s31, s7, 40960
    s_add_u32 s31, s31, s30
    s_lshl_b32 s34, s4, 1
    s_add_u32 s34, s34, s6
    s_mul_i32 s34, s34, 320
    s_add_u32 s34, s34, 5242880
    s_mul_i32 s32, s7, 663552
    s_add_u32 s32, s32, s34
    s_mul_i32 s28, s5, 10240
    s_add_u32 s33, s33, s28
    s_add_u32 s28, s7, 1
    s_and_b32 s28, s28, 3
    s_mul_i32 s64, s28, 2560
    s_add_u32 s64, s64, s33
    s_lshl_b32 s29, s6, 2
    s_add_u32 s29, s29, s28
    s_mul_i32 s29, s29, 3
    s_add_u32 s29, s29, 0
    s_mul_i32 s29, s29, 3072
    s_add_u32 s29, s29, 90112
    v_add_u32 v16, s29, v19
    s_add_u32 s28, s7, 2
    s_and_b32 s28, s28, 3
    s_mul_i32 s65, s28, 2560
    s_add_u32 s65, s65, s33
    s_lshl_b32 s29, s6, 2
    s_add_u32 s29, s29, s28
    s_mul_i32 s29, s29, 3
    s_add_u32 s29, s29, 1
    s_mul_i32 s29, s29, 3072
    s_add_u32 s29, s29, 90112
    v_add_u32 v17, s29, v19
    s_add_u32 s28, s7, 3
    s_and_b32 s28, s28, 3
    s_mul_i32 s66, s28, 2560
    s_add_u32 s66, s66, s33
    s_lshl_b32 s29, s6, 2
    s_add_u32 s29, s29, s28
    s_mul_i32 s29, s29, 3
    s_add_u32 s29, s29, 2
    s_mul_i32 s29, s29, 3072
    s_add_u32 s29, s29, 90112
    v_add_u32 v18, s29, v19
    s_add_u32 s28, s7, 4
    s_and_b32 s28, s28, 3
    s_mul_i32 s67, s28, 2560
    s_add_u32 s67, s67, s33
    s_lshl_b32 s29, s6, 2
    s_add_u32 s29, s29, s7
    s_mul_i32 s29, s29, 9216
    s_add_u32 s29, s29, 90112
    v_add_u32 v7, s29, v19
    s_lshl_b32 s28, s5, 2
    s_add_u32 s28, s28, s7
    s_mul_i32 s28, s28, 40960
    s_add_u32 s28, s28, 8388608
    s_lshl_b32 s29, s4, 1
    s_add_u32 s29, s29, s6
    s_lshl_b32 s29, s29, 9
    s_add_u32 s36, s29, s28
    s_lshr_b32 s29, s4, 1
    s_add_u32 s29, s29, 32
    s_lshl_b32 s29, s29, 9
    s_add_u32 s29, s29, s28
    s_and_b32 s28, s4, 1
    s_lshl_b32 s28, s28, 8
    s_add_u32 s29, s29, s28
    s_lshl_b32 s28, s6, 3
    s_add_u32 s37, s29, s28
    s_lshl_b32 s29, s4, 1
    s_add_u32 s29, s29, s6
    s_mul_i32 s29, s29, 384
    s_sub_u32 s37, s36, s29
    s_add_u32 s37, s37, 16384
    v_bfe_u32 v10, v0, 4, 1
    v_mul_u32_u24 v10, 20480, v10
    v_and_b32 v1, 15, v0
    v_lshl_add_u32 v11, v1, 3, v10
    v_lshl_add_u32 v1, v1, 4, v10
    v_lshl_add_u32 v1, v9, 8, v1
    v_lshl_or_b32 v11, v9, 31, v11
    s_lshl_b32 s38, s5, 4
    s_add_u32 s38, s38, s4
    s_mul_i32 s38, s38, 128
    s_add_u32 s38, s38, 30568448
    v_mov_b32 v2, 0xdddddddd
    v_sub_u32 v6, 1, v9
    v_mul_u32_u24 v10, 0x3f80, v6
    v_mul_u32_u24 v6, 0xffff, v6
    v_mov_b32 v197, v10
    v_mov_b32 v211, v10
    v_mov_b32 v225, v10
    v_mov_b32 v239, v10
    v_mov_b32 v15, v10
    v_mov_b32 v57, 0
    v_mov_b32 v59, 0
    v_mov_b32 v61, 0
    v_mov_b32 v63, 0
    v_add_u32 v8, 20736, v5
    v_mov_b32 v64, 0
    v_mov_b32 v65, 0
    v_mov_b32 v66, 0
    v_mov_b32 v67, 0
    v_mov_b32 v68, 0
    v_mov_b32 v69, 0
    v_mov_b32 v70, 0
    v_mov_b32 v71, 0
    v_mov_b32 v72, 0
    v_mov_b32 v73, 0
    v_mov_b32 v74, 0
    v_mov_b32 v75, 0
    v_mov_b32 v76, 0
    v_mov_b32 v77, 0
    v_mov_b32 v78, 0
    v_mov_b32 v79, 0
    v_mov_b32 v80, 0
    v_mov_b32 v81, 0
    v_mov_b32 v82, 0
    v_mov_b32 v83, 0
    v_mov_b32 v84, 0
    v_mov_b32 v85, 0
    v_mov_b32 v86, 0
    v_mov_b32 v87, 0
    v_mov_b32 v88, 0
    v_mov_b32 v89, 0
    v_mov_b32 v90, 0
    v_mov_b32 v91, 0
    v_mov_b32 v92, 0
    v_mov_b32 v93, 0
    v_mov_b32 v94, 0
    v_mov_b32 v95, 0
    v_mov_b32 v96, 0
    v_mov_b32 v97, 0
    v_mov_b32 v98, 0
    v_mov_b32 v99, 0
    v_mov_b32 v100, 0
    v_mov_b32 v101, 0
    v_mov_b32 v102, 0
    v_mov_b32 v103, 0
    v_mov_b32 v104, 0
    v_mov_b32 v105, 0
    v_mov_b32 v106, 0
    v_mov_b32 v107, 0
    v_mov_b32 v108, 0
    v_mov_b32 v109, 0
    v_mov_b32 v110, 0
    v_mov_b32 v111, 0
    v_mov_b32 v112, 0
    v_mov_b32 v113, 0
    v_mov_b32 v114, 0
    v_mov_b32 v115, 0
    v_mov_b32 v116, 0
    v_mov_b32 v117, 0
    v_mov_b32 v118, 0
    v_mov_b32 v119, 0
    v_mov_b32 v120, 0
    v_mov_b32 v121, 0
    v_mov_b32 v122, 0
    v_mov_b32 v123, 0
    v_mov_b32 v124, 0
    v_mov_b32 v125, 0
    v_mov_b32 v126, 0
    v_mov_b32 v127, 0
p2j_35:
    s_setprio 3
    buffer_load_dwordx4 v[248:251], v3, s[8:11], s30 offen sc1
    buffer_load_dword v14, v4, s[8:11], s30 offen sc1
    buffer_load_dwordx4 v[40:43], v3, s[8:11], s64 offen sc1
    buffer_load_dword v56, v4, s[8:11], s64 offen sc1
    buffer_load_dwordx4 v[44:47], v3, s[8:11], s65 offen sc1
    buffer_load_dword v58, v4, s[8:11], s65 offen sc1
    buffer_load_dwordx4 v[48:51], v3, s[8:11], s66 offen sc1
    buffer_load_dword v60, v4, s[8:11], s66 offen sc1
    buffer_load_dwordx4 v[52:55], v3, s[8:11], s67 offen sc1
    buffer_load_dword v62, v4, s[8:11], s67 offen sc1
    s_add_u32 s28, s31, 0
    buffer_load_dwordx4 v[192:195], v3, s[8:11], s28 offen sc1
    buffer_load_dword v196, v4, s[8:11], s28 offen sc1
    s_add_u32 s29, s32, 0
    buffer_load_dwordx4 v[198:201], v5, s[8:11], s29 offen sc1
    buffer_load_dwordx4 v[202:205], v8, s[8:11], s29 offen sc1
    s_add_u32 s28, s31, 2560
    buffer_load_dwordx4 v[206:209], v3, s[8:11], s28 offen sc1
    buffer_load_dword v210, v4, s[8:11], s28 offen sc1
    s_waitcnt vmcnt(6)
    v_mfma_f32_32x32x16_bf16 v[128:143], v[248:251], v[40:43], 0
    v_mfma_f32_32x32x8_bf16 v[128:143], v[14:15], v[56:57], v[128:143]
    v_mfma_f32_32x32x16_bf16 v[144:159], v[248:251], v[44:47], 0
    v_mfma_f32_32x32x8_bf16 v[144:159], v[14:15], v[58:59], v[144:159]
    v_mfma_f32_32x32x16_bf16 v[160:175], v[248:251], v[48:51], 0
    v_mfma_f32_32x32x8_bf16 v[160:175], v[14:15], v[60:61], v[160:175]
    v_mfma_f32_32x32x16_bf16 v[176:191], v[248:251], v[52:55], 0
    v_mfma_f32_32x32x8_bf16 v[176:191], v[14:15], v[62:63], v[176:191]
    s_nop 5
    v_max3_f32 v128, v128, v129, v130
    v_max3_f32 v128, v128, v131, v132
    v_max3_f32 v128, v128, v133, v134
    v_max3_f32 v128, v128, v135, v136
    v_max3_f32 v128, v128, v137, v138
    v_max3_f32 v128, v128, v139, v140
    v_max3_f32 v128, v128, v141, v142
    v_max_f32 v128, v128, v143
    v_mov_b32 v129, v128
    s_nop 1
    v_permlane32_swap_b32 v128, v129
    v_max_f32 v128, v128, v129
    v_cvt_pk_bf16_f32 v128, -v128, 0
    v_and_b32 v57, v6, v128
    s_waitcnt vmcnt(4)
    s_nop 0
    v_mfma_f32_32x32x8_bf16 v[128:143], v[196:197], v[56:57], 0
    v_max3_f32 v144, v144, v145, v146
    v_max3_f32 v144, v144, v147, v148
    v_max3_f32 v144, v144, v149, v150
    v_max3_f32 v144, v144, v151, v152
    v_max3_f32 v144, v144, v153, v154
    v_max3_f32 v144, v144, v155, v156
    v_max3_f32 v144, v144, v157, v158
    v_max_f32 v144, v144, v159
    v_mov_b32 v145, v144
    s_nop 1
    v_permlane32_swap_b32 v144, v145
    v_max_f32_e64 v144, v144, v145
    v_cvt_pk_bf16_f32 v144, -v144, 0
    v_and_b32 v59, v6, v144
    v_mfma_f32_32x32x16_bf16 v[128:143], v[192:195], v[40:43], v[128:143]
    s_nop 0
    v_max3_f32 v160, v160, v161, v162
    v_max3_f32 v160, v160, v163, v164
    v_max3_f32 v160, v160, v165, v166
    v_max3_f32 v160, v160, v167, v168
    v_max3_f32 v160, v160, v169, v170
    v_max3_f32 v160, v160, v171, v172
    v_max3_f32 v160, v160, v173, v174
    v_max_f32 v160, v160, v175
    v_mov_b32 v161, v160
    v_max3_f32 v176, v176, v177, v178
    v_max3_f32 v176, v176, v179, v180
    v_max3_f32 v176, v176, v181, v182
    v_max3_f32 v176, v176, v183, v184
    v_max3_f32 v176, v176, v185, v186
    v_max3_f32 v176, v176, v187, v188
    v_max3_f32 v176, v176, v189, v190
    v_max_f32 v176, v176, v191
    v_mov_b32 v177, v176
    v_permlane32_swap_b32 v160, v161
    s_nop 0
    v_permlane32_swap_b32 v176, v177
    v_max_f32 v160, v160, v161
    v_cvt_pk_bf16_f32 v160, -v160, 0
    v_and_b32 v61, v6, v160
    v_max_f32 v176, v176, v177
    v_cvt_pk_bf16_f32 v176, -v176, 0
    v_and_b32 v63, v6, v176
    v_mfma_f32_32x32x8_bf16 v[144:159], v[196:197], v[58:59], 0
    v_exp_f32 v128, v128
    v_exp_f32 v129, v129
    v_exp_f32 v130, v130
    v_exp_f32 v131, v131
    v_mfma_f32_32x32x16_bf16 v[144:159], v[192:195], v[44:47], v[144:159]
    s_add_u32 s29, s32, 41472
    buffer_load_dwordx4 v[212:215], v5, s[8:11], s29 offen sc1
    buffer_load_dwordx4 v[216:219], v8, s[8:11], s29 offen sc1
    s_add_u32 s28, s31, 5120
    buffer_load_dwordx4 v[220:223], v3, s[8:11], s28 offen sc1
    buffer_load_dword v224, v4, s[8:11], s28 offen sc1
    v_exp_f32 v132, v132
    v_exp_f32 v133, v133
    v_exp_f32 v134, v134
    v_exp_f32 v135, v135
    v_exp_f32 v136, v136
    v_exp_f32 v137, v137
    v_exp_f32 v138, v138
    v_exp_f32 v139, v139
    s_waitcnt vmcnt(6)
    v_smfmac_f32_32x32x32_bf16 v[64:79], v[198:201], v[128:135], v2
    v_exp_f32 v140, v140
    v_exp_f32 v141, v141
    v_exp_f32 v142, v142
    v_exp_f32 v143, v143
    v_mfma_f32_32x32x8_bf16 v[160:175], v[196:197], v[60:61], 0
    v_exp_f32 v144, v144
    v_exp_f32 v145, v145
    v_exp_f32 v146, v146
    v_exp_f32 v147, v147
    v_mfma_f32_32x32x16_bf16 v[160:175], v[192:195], v[48:51], v[160:175]
    s_add_u32 s29, s32, 82944
    buffer_load_dwordx4 v[226:229], v5, s[8:11], s29 offen sc1
    buffer_load_dwordx4 v[230:233], v8, s[8:11], s29 offen sc1
    s_add_u32 s28, s31, 7680
    buffer_load_dwordx4 v[234:237], v3, s[8:11], s28 offen sc1
    buffer_load_dword v238, v4, s[8:11], s28 offen sc1
    v_exp_f32 v148, v148
    v_exp_f32 v149, v149
    v_exp_f32 v150, v150
    v_exp_f32 v151, v151
    v_smfmac_f32_32x32x32_bf16 v[64:79], v[202:205], v[136:143], v2
    v_exp_f32 v152, v152
    v_exp_f32 v153, v153
    v_exp_f32 v154, v154
    v_exp_f32 v155, v155
    v_smfmac_f32_32x32x32_bf16 v[80:95], v[198:201], v[144:151], v2
    v_exp_f32 v156, v156
    v_exp_f32 v157, v157
    v_exp_f32 v158, v158
    v_exp_f32 v159, v159
    v_mfma_f32_32x32x8_bf16 v[176:191], v[196:197], v[62:63], 0
    v_exp_f32 v160, v160
    v_exp_f32 v161, v161
    v_exp_f32 v162, v162
    v_exp_f32 v163, v163
    v_mfma_f32_32x32x16_bf16 v[176:191], v[192:195], v[52:55], v[176:191]
    s_add_u32 s29, s32, 124416
    buffer_load_dwordx4 v[240:243], v5, s[8:11], s29 offen sc1
    buffer_load_dwordx4 v[244:247], v8, s[8:11], s29 offen sc1
    s_cmp_eq_u32 s68, 0
    s_cbranch_scc1 lo_45
    s_mov_b32 s24, s48
    s_mov_b32 s25, s49
    s_mov_b32 s26, 1966080
    s_mov_b32 s27, 0x20000
    s_add_u32 m0, s69, 0
    s_nop 0
    buffer_load_dwordx4 v36, s[24:27], s70 offen lds
    s_add_u32 m0, s69, 1024
    s_nop 0
    buffer_load_dwordx4 v36, s[24:27], s71 offen lds
    s_mov_b32 s24, s50
    s_mov_b32 s25, s51
    s_mov_b32 s26, 1966080
    s_mov_b32 s27, 0x20000
    s_add_u32 m0, s69, 2048
    s_nop 0
    buffer_load_dwordx4 v37, s[24:27], s72 offen lds
    s_add_u32 m0, s69, 3072
    s_nop 0
    buffer_load_dwordx4 v37, s[24:27], s73 offen lds
    s_mov_b32 s24, s52
    s_mov_b32 s25, s53
    s_mov_b32 s26, 1966080
    s_mov_b32 s27, 0x20000
    s_add_u32 m0, s69, 4096
    s_nop 0
    buffer_load_dwordx4 v38, s[24:27], s74 offen lds
    s_add_u32 m0, s69, 5120
    s_nop 0
    buffer_load_dwordx4 v38, s[24:27], s75 offen lds
lo_45:
    v_exp_f32 v164, v164
    v_exp_f32 v165, v165
    v_exp_f32 v166, v166
    v_exp_f32 v167, v167
    v_smfmac_f32_32x32x32_bf16 v[80:95], v[202:205], v[152:159], v2
    v_exp_f32 v168, v168
    v_exp_f32 v169, v169
    v_exp_f32 v170, v170
    v_exp_f32 v171, v171
    v_smfmac_f32_32x32x32_bf16 v[96:111], v[198:201], v[160:167], v2
    v_exp_f32 v172, v172
    v_exp_f32 v173, v173
    v_exp_f32 v174, v174
    v_exp_f32 v175, v175
    s_cmp_lg_u32 s68, 1
    s_cbranch_scc1 vmw_47
    s_waitcnt vmcnt(16)
    s_branch vmw_46
vmw_47:
    s_waitcnt vmcnt(10)
vmw_46:
    v_mfma_f32_32x32x8_bf16 v[128:143], v[210:211], v[56:57], 0
    v_exp_f32 v176, v176
    v_exp_f32 v177, v177
    v_exp_f32 v178, v178
    v_exp_f32 v179, v179
    v_mfma_f32_32x32x16_bf16 v[128:143], v[206:209], v[40:43], v[128:143]
    v_exp_f32 v180, v180
    v_exp_f32 v181, v181
    v_exp_f32 v182, v182
    v_exp_f32 v183, v183
    v_smfmac_f32_32x32x32_bf16 v[96:111], v[202:205], v[168:175], v2
    s_add_u32 s28, s31, 10240
    buffer_load_dwordx4 v[192:195], v3, s[8:11], s28 offen sc1
    buffer_load_dword v196, v4, s[8:11], s28 offen sc1
    v_exp_f32 v184, v184
    v_exp_f32 v185, v185
    v_exp_f32 v186, v186
    v_exp_f32 v187, v187
    v_smfmac_f32_32x32x32_bf16 v[112:127], v[198:201], v[176:183], v2
    v_exp_f32 v188, v188
    v_exp_f32 v189, v189
    v_exp_f32 v190, v190
    v_exp_f32 v191, v191
    v_mfma_f32_32x32x8_bf16 v[144:159], v[210:211], v[58:59], 0
    v_exp_f32 v128, v128
    v_exp_f32 v129, v129
    v_exp_f32 v130, v130
    v_exp_f32 v131, v131
    v_mfma_f32_32x32x16_bf16 v[144:159], v[206:209], v[44:47], v[144:159]
    v_exp_f32 v132, v132
    v_exp_f32 v133, v133
    v_exp_f32 v134, v134
    v_exp_f32 v135, v135
    v_smfmac_f32_32x32x32_bf16 v[112:127], v[202:205], v[184:191], v2
    v_exp_f32 v136, v136
    v_exp_f32 v137, v137
    v_exp_f32 v138, v138
    v_exp_f32 v139, v139
    s_cmp_lg_u32 s68, 1
    s_cbranch_scc1 vmw_49
    s_waitcnt vmcnt(16)
    s_branch vmw_48
vmw_49:
    s_waitcnt vmcnt(10)
vmw_48:
    v_smfmac_f32_32x32x32_bf16 v[64:79], v[212:215], v[128:135], v2
    v_exp_f32 v140, v140
    v_exp_f32 v141, v141
    v_exp_f32 v142, v142
    v_exp_f32 v143, v143
    v_mfma_f32_32x32x8_bf16 v[160:175], v[210:211], v[60:61], 0
    v_exp_f32 v144, v144
    v_exp_f32 v145, v145
    v_exp_f32 v146, v146
    v_exp_f32 v147, v147
    v_mfma_f32_32x32x16_bf16 v[160:175], v[206:209], v[48:51], v[160:175]
    v_exp_f32 v148, v148
    v_exp_f32 v149, v149
    v_exp_f32 v150, v150
    v_exp_f32 v151, v151
    v_smfmac_f32_32x32x32_bf16 v[64:79], v[216:219], v[136:143], v2
    s_add_u32 s29, s32, 165888
    buffer_load_dwordx4 v[198:201], v5, s[8:11], s29 offen sc1
    buffer_load_dwordx4 v[202:205], v8, s[8:11], s29 offen sc1
    v_exp_f32 v152, v152
    v_exp_f32 v153, v153
    v_exp_f32 v154, v154
    v_exp_f32 v155, v155
    v_smfmac_f32_32x32x32_bf16 v[80:95], v[212:215], v[144:151], v2
    v_exp_f32 v156, v156
    v_exp_f32 v157, v157
    v_exp_f32 v158, v158
    v_exp_f32 v159, v159
    v_mfma_f32_32x32x8_bf16 v[176:191], v[210:211], v[62:63], 0
    v_exp_f32 v160, v160
    v_exp_f32 v161, v161
    v_exp_f32 v162, v162
    v_exp_f32 v163, v163
    v_mfma_f32_32x32x16_bf16 v[176:191], v[206:209], v[52:55], v[176:191]
    v_exp_f32 v164, v164
    v_exp_f32 v165, v165
    v_exp_f32 v166, v166
    v_exp_f32 v167, v167
    v_smfmac_f32_32x32x32_bf16 v[80:95], v[216:219], v[152:159], v2
    v_exp_f32 v168, v168
    v_exp_f32 v169, v169
    v_exp_f32 v170, v170
    v_exp_f32 v171, v171
    v_smfmac_f32_32x32x32_bf16 v[96:111], v[212:215], v[160:167], v2
    v_exp_f32 v172, v172
    v_exp_f32 v173, v173
    v_exp_f32 v174, v174
    v_exp_f32 v175, v175
    s_cmp_lg_u32 s68, 1
    s_cbranch_scc1 vmw_51
    s_waitcnt vmcnt(16)
    s_branch vmw_50
vmw_51:
    s_waitcnt vmcnt(10)
vmw_50:
    v_mfma_f32_32x32x8_bf16 v[128:143], v[224:225], v[56:57], 0
    v_exp_f32 v176, v176
    v_exp_f32 v177, v177
    v_exp_f32 v178, v178
    v_exp_f32 v179, v179
    v_mfma_f32_32x32x16_bf16 v[128:143], v[220:223], v[40:43], v[128:143]
    v_exp_f32 v180, v180
    v_exp_f32 v181, v181
    v_exp_f32 v182, v182
    v_exp_f32 v183, v183
    v_smfmac_f32_32x32x32_bf16 v[96:111], v[216:219], v[168:175], v2
    s_add_u32 s28, s31, 12800
    buffer_load_dwordx4 v[206:209], v3, s[8:11], s28 offen sc1
    buffer_load_dword v210, v4, s[8:11], s28 offen sc1
    v_exp_f32 v184, v184
    v_exp_f32 v185, v185
    v_exp_f32 v186, v186
    v_exp_f32 v187, v187
    v_smfmac_f32_32x32x32_bf16 v[112:127], v[212:215], v[176:183], v2
    v_exp_f32 v188, v188
    v_exp_f32 v189, v189
    v_exp_f32 v190, v190
    v_exp_f32 v191, v191
    v_mfma_f32_32x32x8_bf16 v[144:159], v[224:225], v[58:59], 0
    v_exp_f32 v128, v128
    v_exp_f32 v129, v129
    v_exp_f32 v130, v130
    v_exp_f32 v131, v131
    v_mfma_f32_32x32x16_bf16 v[144:159], v[220:223], v[44:47], v[144:159]
    v_exp_f32 v132, v132
    v_exp_f32 v133, v133
    v_exp_f32 v134, v134
    v_exp_f32 v135, v135
    v_smfmac_f32_32x32x32_bf16 v[112:127], v[216:219], v[184:191], v2
    v_exp_f32 v136, v136
    v_exp_f32 v137, v137
    v_exp_f32 v138, v138
    v_exp_f32 v139, v139
    s_cmp_lg_u32 s68, 1
    s_cbranch_scc1 vmw_53
    s_waitcnt vmcnt(16)
    s_branch vmw_52
vmw_53:
    s_waitcnt vmcnt(10)
vmw_52:
    v_smfmac_f32_32x32x32_bf16 v[64:79], v[226:229], v[128:135], v2
    v_exp_f32 v140, v140
    v_exp_f32 v141, v141
    v_exp_f32 v142, v142
    v_exp_f32 v143, v143
    v_mfma_f32_32x32x8_bf16 v[160:175], v[224:225], v[60:61], 0
    v_exp_f32 v144, v144
    v_exp_f32 v145, v145
    v_exp_f32 v146, v146
    v_exp_f32 v147, v147
    v_mfma_f32_32x32x16_bf16 v[160:175], v[220:223], v[48:51], v[160:175]
    v_exp_f32 v148, v148
    v_exp_f32 v149, v149
    v_exp_f32 v150, v150
    v_exp_f32 v151, v151
    v_smfmac_f32_32x32x32_bf16 v[64:79], v[230:233], v[136:143], v2
    s_add_u32 s29, s32, 207360
    buffer_load_dwordx4 v[212:215], v5, s[8:11], s29 offen sc1
    buffer_load_dwordx4 v[216:219], v8, s[8:11], s29 offen sc1
    v_exp_f32 v152, v152
    v_exp_f32 v153, v153
    v_exp_f32 v154, v154
    v_exp_f32 v155, v155
    v_smfmac_f32_32x32x32_bf16 v[80:95], v[226:229], v[144:151], v2
    v_exp_f32 v156, v156
    v_exp_f32 v157, v157
    v_exp_f32 v158, v158
    v_exp_f32 v159, v159
    v_mfma_f32_32x32x8_bf16 v[176:191], v[224:225], v[62:63], 0
    v_exp_f32 v160, v160
    v_exp_f32 v161, v161
    v_exp_f32 v162, v162
    v_exp_f32 v163, v163
    v_mfma_f32_32x32x16_bf16 v[176:191], v[220:223], v[52:55], v[176:191]
    v_exp_f32 v164, v164
    v_exp_f32 v165, v165
    v_exp_f32 v166, v166
    v_exp_f32 v167, v167
    v_smfmac_f32_32x32x32_bf16 v[80:95], v[230:233], v[152:159], v2
    v_exp_f32 v168, v168
    v_exp_f32 v169, v169
    v_exp_f32 v170, v170
    v_exp_f32 v171, v171
    v_smfmac_f32_32x32x32_bf16 v[96:111], v[226:229], v[160:167], v2
    v_exp_f32 v172, v172
    v_exp_f32 v173, v173
    v_exp_f32 v174, v174
    v_exp_f32 v175, v175
    s_cmp_lg_u32 s68, 1
    s_cbranch_scc1 vmw_55
    s_waitcnt vmcnt(16)
    s_branch vmw_54
vmw_55:
    s_waitcnt vmcnt(10)
vmw_54:
    v_mfma_f32_32x32x8_bf16 v[128:143], v[238:239], v[56:57], 0
    v_exp_f32 v176, v176
    v_exp_f32 v177, v177
    v_exp_f32 v178, v178
    v_exp_f32 v179, v179
    v_mfma_f32_32x32x16_bf16 v[128:143], v[234:237], v[40:43], v[128:143]
    v_exp_f32 v180, v180
    v_exp_f32 v181, v181
    v_exp_f32 v182, v182
    v_exp_f32 v183, v183
    v_smfmac_f32_32x32x32_bf16 v[96:111], v[230:233], v[168:175], v2
    s_add_u32 s28, s31, 15360
    buffer_load_dwordx4 v[220:223], v3, s[8:11], s28 offen sc1
    buffer_load_dword v224, v4, s[8:11], s28 offen sc1
    v_exp_f32 v184, v184
    v_exp_f32 v185, v185
    v_exp_f32 v186, v186
    v_exp_f32 v187, v187
    v_smfmac_f32_32x32x32_bf16 v[112:127], v[226:229], v[176:183], v2
    v_exp_f32 v188, v188
    v_exp_f32 v189, v189
    v_exp_f32 v190, v190
    v_exp_f32 v191, v191
    v_mfma_f32_32x32x8_bf16 v[144:159], v[238:239], v[58:59], 0
    v_exp_f32 v128, v128
    v_exp_f32 v129, v129
    v_exp_f32 v130, v130
    v_exp_f32 v131, v131
    v_mfma_f32_32x32x16_bf16 v[144:159], v[234:237], v[44:47], v[144:159]
    v_exp_f32 v132, v132
    v_exp_f32 v133, v133
    v_exp_f32 v134, v134
    v_exp_f32 v135, v135
    v_smfmac_f32_32x32x32_bf16 v[112:127], v[230:233], v[184:191], v2
    v_exp_f32 v136, v136
    v_exp_f32 v137, v137
    v_exp_f32 v138, v138
    v_exp_f32 v139, v139
    s_cmp_lg_u32 s68, 1
    s_cbranch_scc1 vmw_57
    s_waitcnt vmcnt(16)
    s_branch vmw_56
vmw_57:
    s_waitcnt vmcnt(10)
vmw_56:
    v_smfmac_f32_32x32x32_bf16 v[64:79], v[240:243], v[128:135], v2
    v_exp_f32 v140, v140
    v_exp_f32 v141, v141
    v_exp_f32 v142, v142
    v_exp_f32 v143, v143
    v_mfma_f32_32x32x8_bf16 v[160:175], v[238:239], v[60:61], 0
    v_exp_f32 v144, v144
    v_exp_f32 v145, v145
    v_exp_f32 v146, v146
    v_exp_f32 v147, v147
    v_mfma_f32_32x32x16_bf16 v[160:175], v[234:237], v[48:51], v[160:175]
    v_exp_f32 v148, v148
    v_exp_f32 v149, v149
    v_exp_f32 v150, v150
    v_exp_f32 v151, v151
    v_smfmac_f32_32x32x32_bf16 v[64:79], v[244:247], v[136:143], v2
    s_add_u32 s29, s32, 248832
    buffer_load_dwordx4 v[226:229], v5, s[8:11], s29 offen sc1
    buffer_load_dwordx4 v[230:233], v8, s[8:11], s29 offen sc1
    v_exp_f32 v152, v152
    v_exp_f32 v153, v153
    v_exp_f32 v154, v154
    v_exp_f32 v155, v155
    v_smfmac_f32_32x32x32_bf16 v[80:95], v[240:243], v[144:151], v2
    v_exp_f32 v156, v156
    v_exp_f32 v157, v157
    v_exp_f32 v158, v158
    v_exp_f32 v159, v159
    v_mfma_f32_32x32x8_bf16 v[176:191], v[238:239], v[62:63], 0
    v_exp_f32 v160, v160
    v_exp_f32 v161, v161
    v_exp_f32 v162, v162
    v_exp_f32 v163, v163
    v_mfma_f32_32x32x16_bf16 v[176:191], v[234:237], v[52:55], v[176:191]
    v_exp_f32 v164, v164
    v_exp_f32 v165, v165
    v_exp_f32 v166, v166
    v_exp_f32 v167, v167
    v_smfmac_f32_32x32x32_bf16 v[80:95], v[244:247], v[152:159], v2
    v_exp_f32 v168, v168
    v_exp_f32 v169, v169
    v_exp_f32 v170, v170
    v_exp_f32 v171, v171
    v_smfmac_f32_32x32x32_bf16 v[96:111], v[240:243], v[160:167], v2
    v_exp_f32 v172, v172
    v_exp_f32 v173, v173
    v_exp_f32 v174, v174
    v_exp_f32 v175, v175
    s_waitcnt vmcnt(10)
    v_mfma_f32_32x32x8_bf16 v[128:143], v[196:197], v[56:57], 0
    v_exp_f32 v176, v176
    v_exp_f32 v177, v177
    v_exp_f32 v178, v178
    v_exp_f32 v179, v179
    v_mfma_f32_32x32x16_bf16 v[128:143], v[192:195], v[40:43], v[128:143]
    v_exp_f32 v180, v180
    v_exp_f32 v181, v181
    v_exp_f32 v182, v182
    v_exp_f32 v183, v183
    v_smfmac_f32_32x32x32_bf16 v[96:111], v[244:247], v[168:175], v2
    s_add_u32 s28, s31, 17920
    buffer_load_dwordx4 v[234:237], v3, s[8:11], s28 offen sc1
    buffer_load_dword v238, v4, s[8:11], s28 offen sc1
    v_exp_f32 v184, v184
    v_exp_f32 v185, v185
    v_exp_f32 v186, v186
    v_exp_f32 v187, v187
    v_smfmac_f32_32x32x32_bf16 v[112:127], v[240:243], v[176:183], v2
    v_exp_f32 v188, v188
    v_exp_f32 v189, v189
    v_exp_f32 v190, v190
    v_exp_f32 v191, v191
    s_setprio 2
    s_cmp_eq_u32 s68, 0
    s_cbranch_scc1 lo_58
    ds_read_b64_tr_b16 v[20:21], v34 offset:0
    ds_read_b64_tr_b16 v[22:23], v34 offset:512
    ds_read_b64_tr_b16 v[24:25], v35 offset:0
    ds_read_b64_tr_b16 v[26:27], v35 offset:512
lo_58:
    v_mfma_f32_32x32x8_bf16 v[144:159], v[196:197], v[58:59], 0
    v_exp_f32 v128, v128
    v_exp_f32 v129, v129
    v_exp_f32 v130, v130
    v_exp_f32 v131, v131
    v_mfma_f32_32x32x16_bf16 v[144:159], v[192:195], v[44:47], v[144:159]
    v_exp_f32 v132, v132
    v_exp_f32 v133, v133
    v_exp_f32 v134, v134
    v_exp_f32 v135, v135
    v_smfmac_f32_32x32x32_bf16 v[112:127], v[244:247], v[184:191], v2
    v_exp_f32 v136, v136
    v_exp_f32 v137, v137
    v_exp_f32 v138, v138
    v_exp_f32 v139, v139
    s_waitcnt vmcnt(10)
    v_smfmac_f32_32x32x32_bf16 v[64:79], v[198:201], v[128:135], v2
    v_exp_f32 v140, v140
    v_exp_f32 v141, v141
    v_exp_f32 v142, v142
    v_exp_f32 v143, v143
    v_mfma_f32_32x32x8_bf16 v[160:175], v[196:197], v[60:61], 0
    v_exp_f32 v144, v144
    v_exp_f32 v145, v145
    v_exp_f32 v146, v146
    v_exp_f32 v147, v147
    v_mfma_f32_32x32x16_bf16 v[160:175], v[192:195], v[48:51], v[160:175]
    v_exp_f32 v148, v148
    v_exp_f32 v149, v149
    v_exp_f32 v150, v150
    v_exp_f32 v151, v151
    v_smfmac_f32_32x32x32_bf16 v[64:79], v[202:205], v[136:143], v2
    s_add_u32 s29, s32, 290304
    buffer_load_dwordx4 v[240:243], v5, s[8:11], s29 offen sc1
    buffer_load_dwordx4 v[244:247], v8, s[8:11], s29 offen sc1
    v_exp_f32 v152, v152
    v_exp_f32 v153, v153
    v_exp_f32 v154, v154
    v_exp_f32 v155, v155
    v_smfmac_f32_32x32x32_bf16 v[80:95], v[198:201], v[144:151], v2
    v_exp_f32 v156, v156
    v_exp_f32 v157, v157
    v_exp_f32 v158, v158
    v_exp_f32 v159, v159
    s_cmp_eq_u32 s68, 0
    s_cbranch_scc1 lo_59
    s_waitcnt lgkmcnt(0)
    buffer_store_dwordx4 v[20:23], v28, s[8:11], 0 offen sc1
    buffer_store_dwordx4 v[24:27], v29, s[8:11], 0 offen sc1
lo_59:
    v_mfma_f32_32x32x8_bf16 v[176:191], v[196:197], v[62:63], 0
    v_exp_f32 v160, v160
    v_exp_f32 v161, v161
    v_exp_f32 v162, v162
    v_exp_f32 v163, v163
    v_mfma_f32_32x32x16_bf16 v[176:191], v[192:195], v[52:55], v[176:191]
    v_exp_f32 v164, v164
    v_exp_f32 v165, v165
    v_exp_f32 v166, v166
    v_exp_f32 v167, v167
    v_smfmac_f32_32x32x32_bf16 v[80:95], v[202:205], v[152:159], v2
    v_exp_f32 v168, v168
    v_exp_f32 v169, v169
    v_exp_f32 v170, v170
    v_exp_f32 v171, v171
    v_smfmac_f32_32x32x32_bf16 v[96:111], v[198:201], v[160:167], v2
    v_exp_f32 v172, v172
    v_exp_f32 v173, v173
    v_exp_f32 v174, v174
    v_exp_f32 v175, v175
    s_cmp_lg_u32 s68, 1
    s_cbranch_scc1 vmw_61
    s_waitcnt vmcnt(12)
    s_branch vmw_60
vmw_61:
    s_waitcnt vmcnt(10)
vmw_60:
    v_mfma_f32_32x32x8_bf16 v[128:143], v[210:211], v[56:57], 0
    v_exp_f32 v176, v176
    v_exp_f32 v177, v177
    v_exp_f32 v178, v178
    v_exp_f32 v179, v179
    v_mfma_f32_32x32x16_bf16 v[128:143], v[206:209], v[40:43], v[128:143]
    v_exp_f32 v180, v180
    v_exp_f32 v181, v181
    v_exp_f32 v182, v182
    v_exp_f32 v183, v183
    v_smfmac_f32_32x32x32_bf16 v[96:111], v[202:205], v[168:175], v2
    s_add_u32 s28, s31, 20480
    buffer_load_dwordx4 v[192:195], v3, s[8:11], s28 offen sc1
    buffer_load_dword v196, v4, s[8:11], s28 offen sc1
    v_exp_f32 v184, v184
    v_exp_f32 v185, v185
    v_exp_f32 v186, v186
    v_exp_f32 v187, v187
    v_smfmac_f32_32x32x32_bf16 v[112:127], v[198:201], v[176:183], v2
    v_exp_f32 v188, v188
    v_exp_f32 v189, v189
    v_exp_f32 v190, v190
    v_exp_f32 v191, v191
    s_cmp_eq_u32 s68, 0
    s_cbranch_scc1 lo_62
    ds_read_b64_tr_b16 v[20:21], v34 offset:2048
    ds_read_b64_tr_b16 v[22:23], v34 offset:2560
    ds_read_b64_tr_b16 v[24:25], v35 offset:2048
    ds_read_b64_tr_b16 v[26:27], v35 offset:2560
lo_62:
    v_mfma_f32_32x32x8_bf16 v[144:159], v[210:211], v[58:59], 0
    v_exp_f32 v128, v128
    v_exp_f32 v129, v129
    v_exp_f32 v130, v130
    v_exp_f32 v131, v131
    v_mfma_f32_32x32x16_bf16 v[144:159], v[206:209], v[44:47], v[144:159]
    v_exp_f32 v132, v132
    v_exp_f32 v133, v133
    v_exp_f32 v134, v134
    v_exp_f32 v135, v135
    v_smfmac_f32_32x32x32_bf16 v[112:127], v[202:205], v[184:191], v2
    v_exp_f32 v136, v136
    v_exp_f32 v137, v137
    v_exp_f32 v138, v138
    v_exp_f32 v139, v139
    s_cmp_lg_u32 s68, 1
    s_cbranch_scc1 vmw_64
    s_waitcnt vmcnt(12)
    s_branch vmw_63
vmw_64:
    s_waitcnt vmcnt(10)
vmw_63:
    v_smfmac_f32_32x32x32_bf16 v[64:79], v[212:215], v[128:135], v2
    v_exp_f32 v140, v140
    v_exp_f32 v141, v141
    v_exp_f32 v142, v142
    v_exp_f32 v143, v143
    v_mfma_f32_32x32x8_bf16 v[160:175], v[210:211], v[60:61], 0
    v_exp_f32 v144, v144
    v_exp_f32 v145, v145
    v_exp_f32 v146, v146
    v_exp_f32 v147, v147
    v_mfma_f32_32x32x16_bf16 v[160:175], v[206:209], v[48:51], v[160:175]
    v_exp_f32 v148, v148
    v_exp_f32 v149, v149
    v_exp_f32 v150, v150
    v_exp_f32 v151, v151
    v_smfmac_f32_32x32x32_bf16 v[64:79], v[216:219], v[136:143], v2
    s_add_u32 s29, s32, 331776
    buffer_load_dwordx4 v[198:201], v5, s[8:11], s29 offen sc1
    buffer_load_dwordx4 v[202:205], v8, s[8:11], s29 offen sc1
    v_exp_f32 v152, v152
    v_exp_f32 v153, v153
    v_exp_f32 v154, v154
    v_exp_f32 v155, v155
    v_smfmac_f32_32x32x32_bf16 v[80:95], v[212:215], v[144:151], v2
    v_exp_f32 v156, v156
    v_exp_f32 v157, v157
    v_exp_f32 v158, v158
    v_exp_f32 v159, v159
    s_cmp_eq_u32 s68, 0
    s_cbranch_scc1 lo_65
    s_waitcnt lgkmcnt(0)
    buffer_store_dwordx4 v[20:23], v30, s[8:11], 0 offen sc1
    buffer_store_dwordx4 v[24:27], v31, s[8:11], 0 offen sc1
lo_65:
    v_mfma_f32_32x32x8_bf16 v[176:191], v[210:211], v[62:63], 0
    v_exp_f32 v160, v160
    v_exp_f32 v161, v161
    v_exp_f32 v162, v162
    v_exp_f32 v163, v163
    v_mfma_f32_32x32x16_bf16 v[176:191], v[206:209], v[52:55], v[176:191]
    v_exp_f32 v164, v164
    v_exp_f32 v165, v165
    v_exp_f32 v166, v166
    v_exp_f32 v167, v167
    v_smfmac_f32_32x32x32_bf16 v[80:95], v[216:219], v[152:159], v2
    v_exp_f32 v168, v168
    v_exp_f32 v169, v169
    v_exp_f32 v170, v170
    v_exp_f32 v171, v171
    v_smfmac_f32_32x32x32_bf16 v[96:111], v[212:215], v[160:167], v2
    v_exp_f32 v172, v172
    v_exp_f32 v173, v173
    v_exp_f32 v174, v174
    v_exp_f32 v175, v175
    s_cmp_lg_u32 s68, 1
    s_cbranch_scc1 vmw_67
    s_waitcnt vmcnt(14)
    s_branch vmw_66
vmw_67:
    s_waitcnt vmcnt(10)
vmw_66:
    v_mfma_f32_32x32x8_bf16 v[128:143], v[224:225], v[56:57], 0
    v_exp_f32 v176, v176
    v_exp_f32 v177, v177
    v_exp_f32 v178, v178
    v_exp_f32 v179, v179
    v_mfma_f32_32x32x16_bf16 v[128:143], v[220:223], v[40:43], v[128:143]
    v_exp_f32 v180, v180
    v_exp_f32 v181, v181
    v_exp_f32 v182, v182
    v_exp_f32 v183, v183
    v_smfmac_f32_32x32x32_bf16 v[96:111], v[216:219], v[168:175], v2
    s_add_u32 s28, s31, 23040
    buffer_load_dwordx4 v[206:209], v3, s[8:11], s28 offen sc1
    buffer_load_dword v210, v4, s[8:11], s28 offen sc1
    v_exp_f32 v184, v184
    v_exp_f32 v185, v185
    v_exp_f32 v186, v186
    v_exp_f32 v187, v187
    v_smfmac_f32_32x32x32_bf16 v[112:127], v[212:215], v[176:183], v2
    v_exp_f32 v188, v188
    v_exp_f32 v189, v189
    v_exp_f32 v190, v190
    v_exp_f32 v191, v191
    s_cmp_eq_u32 s68, 0
    s_cbranch_scc1 lo_68
    ds_read_b64_tr_b16 v[20:21], v34 offset:4096
    ds_read_b64_tr_b16 v[22:23], v34 offset:4608
    ds_read_b64_tr_b16 v[24:25], v35 offset:4096
    ds_read_b64_tr_b16 v[26:27], v35 offset:4608
lo_68:
    v_mfma_f32_32x32x8_bf16 v[144:159], v[224:225], v[58:59], 0
    v_exp_f32 v128, v128
    v_exp_f32 v129, v129
    v_exp_f32 v130, v130
    v_exp_f32 v131, v131
    v_mfma_f32_32x32x16_bf16 v[144:159], v[220:223], v[44:47], v[144:159]
    v_exp_f32 v132, v132
    v_exp_f32 v133, v133
    v_exp_f32 v134, v134
    v_exp_f32 v135, v135
    v_smfmac_f32_32x32x32_bf16 v[112:127], v[216:219], v[184:191], v2
    v_exp_f32 v136, v136
    v_exp_f32 v137, v137
    v_exp_f32 v138, v138
    v_exp_f32 v139, v139
    s_cmp_lg_u32 s68, 1
    s_cbranch_scc1 vmw_70
    s_waitcnt vmcnt(14)
    s_branch vmw_69
vmw_70:
    s_waitcnt vmcnt(10)
vmw_69:
    v_smfmac_f32_32x32x32_bf16 v[64:79], v[226:229], v[128:135], v2
    v_exp_f32 v140, v140
    v_exp_f32 v141, v141
    v_exp_f32 v142, v142
    v_exp_f32 v143, v143
    v_mfma_f32_32x32x8_bf16 v[160:175], v[224:225], v[60:61], 0
    v_exp_f32 v144, v144
    v_exp_f32 v145, v145
    v_exp_f32 v146, v146
    v_exp_f32 v147, v147
    v_mfma_f32_32x32x16_bf16 v[160:175], v[220:223], v[48:51], v[160:175]
    v_exp_f32 v148, v148
    v_exp_f32 v149, v149
    v_exp_f32 v150, v150
    v_exp_f32 v151, v151
    v_smfmac_f32_32x32x32_bf16 v[64:79], v[230:233], v[136:143], v2
    s_add_u32 s29, s32, 373248
    buffer_load_dwordx4 v[212:215], v5, s[8:11], s29 offen sc1
    buffer_load_dwordx4 v[216:219], v8, s[8:11], s29 offen sc1
    v_exp_f32 v152, v152
    v_exp_f32 v153, v153
    v_exp_f32 v154, v154
    v_exp_f32 v155, v155
    v_smfmac_f32_32x32x32_bf16 v[80:95], v[226:229], v[144:151], v2
    v_exp_f32 v156, v156
    v_exp_f32 v157, v157
    v_exp_f32 v158, v158
    v_exp_f32 v159, v159
    s_cmp_eq_u32 s68, 0
    s_cbranch_scc1 lo_71
    s_waitcnt lgkmcnt(0)
    buffer_store_dwordx4 v[20:23], v32, s[8:11], 0 offen sc1
    buffer_store_dwordx4 v[24:27], v33, s[8:11], 0 offen sc1
lo_71:
    v_mfma_f32_32x32x8_bf16 v[176:191], v[224:225], v[62:63], 0
    v_exp_f32 v160, v160
    v_exp_f32 v161, v161
    v_exp_f32 v162, v162
    v_exp_f32 v163, v163
    v_mfma_f32_32x32x16_bf16 v[176:191], v[220:223], v[52:55], v[176:191]
    v_exp_f32 v164, v164
    v_exp_f32 v165, v165
    v_exp_f32 v166, v166
    v_exp_f32 v167, v167
    v_smfmac_f32_32x32x32_bf16 v[80:95], v[230:233], v[152:159], v2
    v_exp_f32 v168, v168
    v_exp_f32 v169, v169
    v_exp_f32 v170, v170
    v_exp_f32 v171, v171
    v_smfmac_f32_32x32x32_bf16 v[96:111], v[226:229], v[160:167], v2
    v_exp_f32 v172, v172
    v_exp_f32 v173, v173
    v_exp_f32 v174, v174
    v_exp_f32 v175, v175
    s_cmp_lg_u32 s68, 1
    s_cbranch_scc1 vmw_73
    s_waitcnt vmcnt(16)
    s_branch vmw_72
vmw_73:
    s_waitcnt vmcnt(10)
vmw_72:
    v_mfma_f32_32x32x8_bf16 v[128:143], v[238:239], v[56:57], 0
    v_exp_f32 v176, v176
    v_exp_f32 v177, v177
    v_exp_f32 v178, v178
    v_exp_f32 v179, v179
    v_mfma_f32_32x32x16_bf16 v[128:143], v[234:237], v[40:43], v[128:143]
    v_exp_f32 v180, v180
    v_exp_f32 v181, v181
    v_exp_f32 v182, v182
    v_exp_f32 v183, v183
    v_smfmac_f32_32x32x32_bf16 v[96:111], v[230:233], v[168:175], v2
    s_add_u32 s28, s31, 25600
    buffer_load_dwordx4 v[220:223], v3, s[8:11], s28 offen sc1
    buffer_load_dword v224, v4, s[8:11], s28 offen sc1
    v_exp_f32 v184, v184
    v_exp_f32 v185, v185
    v_exp_f32 v186, v186
    v_exp_f32 v187, v187
    v_smfmac_f32_32x32x32_bf16 v[112:127], v[226:229], v[176:183], v2
    v_exp_f32 v188, v188
    v_exp_f32 v189, v189
    v_exp_f32 v190, v190
    v_exp_f32 v191, v191
    v_mfma_f32_32x32x8_bf16 v[144:159], v[238:239], v[58:59], 0
    v_exp_f32 v128, v128
    v_exp_f32 v129, v129
    v_exp_f32 v130, v130
    v_exp_f32 v131, v131
    v_mfma_f32_32x32x16_bf16 v[144:159], v[234:237], v[44:47], v[144:159]
    v_exp_f32 v132, v132
    v_exp_f32 v133, v133
    v_exp_f32 v134, v134
    v_exp_f32 v135, v135
    v_smfmac_f32_32x32x32_bf16 v[112:127], v[230:233], v[184:191], v2
    v_exp_f32 v136, v136
    v_exp_f32 v137, v137
    v_exp_f32 v138, v138
    v_exp_f32 v139, v139
    s_cmp_lg_u32 s68, 1
    s_cbranch_scc1 vmw_75
    s_waitcnt vmcnt(16)
    s_branch vmw_74
vmw_75:
    s_waitcnt vmcnt(10)
vmw_74:
    v_smfmac_f32_32x32x32_bf16 v[64:79], v[240:243], v[128:135], v2
    v_exp_f32 v140, v140
    v_exp_f32 v141, v141
    v_exp_f32 v142, v142
    v_exp_f32 v143, v143
    v_mfma_f32_32x32x8_bf16 v[160:175], v[238:239], v[60:61], 0
    v_exp_f32 v144, v144
    v_exp_f32 v145, v145
    v_exp_f32 v146, v146
    v_exp_f32 v147, v147
    v_mfma_f32_32x32x16_bf16 v[160:175], v[234:237], v[48:51], v[160:175]
    v_exp_f32 v148, v148
    v_exp_f32 v149, v149
    v_exp_f32 v150, v150
    v_exp_f32 v151, v151
    v_smfmac_f32_32x32x32_bf16 v[64:79], v[244:247], v[136:143], v2
    s_add_u32 s29, s32, 414720
    buffer_load_dwordx4 v[226:229], v5, s[8:11], s29 offen sc1
    buffer_load_dwordx4 v[230:233], v8, s[8:11], s29 offen sc1
    v_exp_f32 v152, v152
    v_exp_f32 v153, v153
    v_exp_f32 v154, v154
    v_exp_f32 v155, v155
    v_smfmac_f32_32x32x32_bf16 v[80:95], v[240:243], v[144:151], v2
    v_exp_f32 v156, v156
    v_exp_f32 v157, v157
    v_exp_f32 v158, v158
    v_exp_f32 v159, v159
    v_mfma_f32_32x32x8_bf16 v[176:191], v[238:239], v[62:63], 0
    v_exp_f32 v160, v160
    v_exp_f32 v161, v161
    v_exp_f32 v162, v162
    v_exp_f32 v163, v163
    v_mfma_f32_32x32x16_bf16 v[176:191], v[234:237], v[52:55], v[176:191]
    v_exp_f32 v164, v164
    v_exp_f32 v165, v165
    v_exp_f32 v166, v166
    v_exp_f32 v167, v167
    v_smfmac_f32_32x32x32_bf16 v[80:95], v[244:247], v[152:159], v2
    v_exp_f32 v168, v168
    v_exp_f32 v169, v169
    v_exp_f32 v170, v170
    v_exp_f32 v171, v171
    v_smfmac_f32_32x32x32_bf16 v[96:111], v[240:243], v[160:167], v2
    v_exp_f32 v172, v172
    v_exp_f32 v173, v173
    v_exp_f32 v174, v174
    v_exp_f32 v175, v175
    s_cmp_lg_u32 s68, 1
    s_cbranch_scc1 vmw_77
    s_waitcnt vmcnt(14)
    s_branch vmw_76
vmw_77:
    s_waitcnt vmcnt(10)
vmw_76:
    v_mfma_f32_32x32x8_bf16 v[128:143], v[196:197], v[56:57], 0
    v_exp_f32 v176, v176
    v_exp_f32 v177, v177
    v_exp_f32 v178, v178
    v_exp_f32 v179, v179
    v_mfma_f32_32x32x16_bf16 v[128:143], v[192:195], v[40:43], v[128:143]
    v_exp_f32 v180, v180
    v_exp_f32 v181, v181
    v_exp_f32 v182, v182
    v_exp_f32 v183, v183
    v_smfmac_f32_32x32x32_bf16 v[96:111], v[244:247], v[168:175], v2
    s_add_u32 s28, s31, 28160
    buffer_load_dwordx4 v[234:237], v3, s[8:11], s28 offen sc1
    buffer_load_dword v238, v4, s[8:11], s28 offen sc1
    v_exp_f32 v184, v184
    v_exp_f32 v185, v185
    v_exp_f32 v186, v186
    v_exp_f32 v187, v187
    v_smfmac_f32_32x32x32_bf16 v[112:127], v[240:243], v[176:183], v2
    v_exp_f32 v188, v188
    v_exp_f32 v189, v189
    v_exp_f32 v190, v190
    v_exp_f32 v191, v191
    s_setprio 1
    v_mfma_f32_32x32x8_bf16 v[144:159], v[196:197], v[58:59], 0
    v_exp_f32 v128, v128
    v_exp_f32 v129, v129
    v_exp_f32 v130, v130
    v_exp_f32 v131, v131
    v_mfma_f32_32x32x16_bf16 v[144:159], v[192:195], v[44:47], v[144:159]
    s_add_u32 m0, s61, 0
    s_nop 0
    buffer_load_dwordx4 v19, s[8:11], s62 offen sc1 lds
    s_add_u32 s62, s62, 1024
    s_cmp_ge_u32 s62, s63
    s_cselect_b32 s28, 102400, 0
    s_sub_u32 s62, s62, s28
    s_add_u32 m0, s61, 1024
    s_nop 0
    buffer_load_dwordx4 v19, s[8:11], s62 offen sc1 lds
    s_add_u32 s62, s62, 1024
    s_cmp_ge_u32 s62, s63
    s_cselect_b32 s28, 102400, 0
    s_sub_u32 s62, s62, s28
    v_exp_f32 v132, v132
    v_exp_f32 v133, v133
    v_exp_f32 v134, v134
    v_exp_f32 v135, v135
    v_smfmac_f32_32x32x32_bf16 v[112:127], v[244:247], v[184:191], v2
    v_exp_f32 v136, v136
    v_exp_f32 v137, v137
    v_exp_f32 v138, v138
    v_exp_f32 v139, v139
    s_cmp_lg_u32 s68, 1
    s_cbranch_scc1 vmw_79
    s_waitcnt vmcnt(16)
    s_branch vmw_78
vmw_79:
    s_waitcnt vmcnt(12)
vmw_78:
    v_smfmac_f32_32x32x32_bf16 v[64:79], v[198:201], v[128:135], v2
    v_exp_f32 v140, v140
    v_exp_f32 v141, v141
    v_exp_f32 v142, v142
    v_exp_f32 v143, v143
    v_mfma_f32_32x32x8_bf16 v[160:175], v[196:197], v[60:61], 0
    v_exp_f32 v144, v144
    v_exp_f32 v145, v145
    v_exp_f32 v146, v146
    v_exp_f32 v147, v147
    v_mfma_f32_32x32x16_bf16 v[160:175], v[192:195], v[48:51], v[160:175]
    v_exp_f32 v148, v148
    v_exp_f32 v149, v149
    v_exp_f32 v150, v150
    v_exp_f32 v151, v151
    v_smfmac_f32_32x32x32_bf16 v[64:79], v[202:205], v[136:143], v2
    s_add_u32 s29, s32, 456192
    buffer_load_dwordx4 v[240:243], v5, s[8:11], s29 offen sc1
    buffer_load_dwordx4 v[244:247], v8, s[8:11], s29 offen sc1
    v_exp_f32 v152, v152
    v_exp_f32 v153, v153
    v_exp_f32 v154, v154
    v_exp_f32 v155, v155
    v_smfmac_f32_32x32x32_bf16 v[80:95], v[198:201], v[144:151], v2
    v_exp_f32 v156, v156
    v_exp_f32 v157, v157
    v_exp_f32 v158, v158
    v_exp_f32 v159, v159
    v_mfma_f32_32x32x8_bf16 v[176:191], v[196:197], v[62:63], 0
    v_exp_f32 v160, v160
    v_exp_f32 v161, v161
    v_exp_f32 v162, v162
    v_exp_f32 v163, v163
    v_mfma_f32_32x32x16_bf16 v[176:191], v[192:195], v[52:55], v[176:191]
    s_add_u32 m0, s61, 2048
    s_nop 0
    buffer_load_dwordx4 v19, s[8:11], s62 offen sc1 lds
    s_add_u32 s62, s62, 1024
    s_cmp_ge_u32 s62, s63
    s_cselect_b32 s28, 102400, 0
    s_sub_u32 s62, s62, s28
    s_add_u32 m0, s61, 3072
    s_nop 0
    buffer_load_dwordx4 v19, s[8:11], s62 offen sc1 lds
    s_add_u32 s62, s62, 1024
    s_cmp_ge_u32 s62, s63
    s_cselect_b32 s28, 102400, 0
    s_sub_u32 s62, s62, s28
    v_exp_f32 v164, v164
    v_exp_f32 v165, v165
    v_exp_f32 v166, v166
    v_exp_f32 v167, v167
    v_smfmac_f32_32x32x32_bf16 v[80:95], v[202:205], v[152:159], v2
    v_exp_f32 v168, v168
    v_exp_f32 v169, v169
    v_exp_f32 v170, v170
    v_exp_f32 v171, v171
    v_smfmac_f32_32x32x32_bf16 v[96:111], v[198:201], v[160:167], v2
    v_exp_f32 v172, v172
    v_exp_f32 v173, v173
    v_exp_f32 v174, v174
    v_exp_f32 v175, v175
    s_cmp_lg_u32 s68, 1
    s_cbranch_scc1 vmw_81
    s_waitcnt vmcnt(16)
    s_branch vmw_80
vmw_81:
    s_waitcnt vmcnt(14)
vmw_80:
    v_mfma_f32_32x32x8_bf16 v[128:143], v[210:211], v[56:57], 0
    v_exp_f32 v176, v176
    v_exp_f32 v177, v177
    v_exp_f32 v178, v178
    v_exp_f32 v179, v179
    v_mfma_f32_32x32x16_bf16 v[128:143], v[206:209], v[40:43], v[128:143]
    v_exp_f32 v180, v180
    v_exp_f32 v181, v181
    v_exp_f32 v182, v182
    v_exp_f32 v183, v183
    v_smfmac_f32_32x32x32_bf16 v[96:111], v[202:205], v[168:175], v2
    s_add_u32 s28, s31, 30720
    buffer_load_dwordx4 v[192:195], v3, s[8:11], s28 offen sc1
    buffer_load_dword v196, v4, s[8:11], s28 offen sc1
    v_exp_f32 v184, v184
    v_exp_f32 v185, v185
    v_exp_f32 v186, v186
    v_exp_f32 v187, v187
    v_smfmac_f32_32x32x32_bf16 v[112:127], v[198:201], v[176:183], v2
    v_exp_f32 v188, v188
    v_exp_f32 v189, v189
    v_exp_f32 v190, v190
    v_exp_f32 v191, v191
    v_mfma_f32_32x32x8_bf16 v[144:159], v[210:211], v[58:59], 0
    v_exp_f32 v128, v128
    v_exp_f32 v129, v129
    v_exp_f32 v130, v130
    v_exp_f32 v131, v131
    v_mfma_f32_32x32x16_bf16 v[144:159], v[206:209], v[44:47], v[144:159]
    s_add_u32 m0, s61, 4096
    s_nop 0
    buffer_load_dwordx4 v19, s[8:11], s62 offen sc1 lds
    s_add_u32 s62, s62, 1024
    s_cmp_ge_u32 s62, s63
    s_cselect_b32 s28, 102400, 0
    s_sub_u32 s62, s62, s28
    s_add_u32 m0, s61, 5120
    s_nop 0
    buffer_load_dwordx4 v19, s[8:11], s62 offen sc1 lds
    s_add_u32 s62, s62, 1024
    s_cmp_ge_u32 s62, s63
    s_cselect_b32 s28, 102400, 0
    s_sub_u32 s62, s62, s28
    v_exp_f32 v132, v132
    v_exp_f32 v133, v133
    v_exp_f32 v134, v134
    v_exp_f32 v135, v135
    v_smfmac_f32_32x32x32_bf16 v[112:127], v[202:205], v[184:191], v2
    v_exp_f32 v136, v136
    v_exp_f32 v137, v137
    v_exp_f32 v138, v138
    v_exp_f32 v139, v139
    s_cmp_lg_u32 s68, 1
    s_cbranch_scc1 vmw_83
    s_waitcnt vmcnt(18)
    s_branch vmw_82
vmw_83:
    s_waitcnt vmcnt(16)
vmw_82:
    v_smfmac_f32_32x32x32_bf16 v[64:79], v[212:215], v[128:135], v2
    v_exp_f32 v140, v140
    v_exp_f32 v141, v141
    v_exp_f32 v142, v142
    v_exp_f32 v143, v143
    v_mfma_f32_32x32x8_bf16 v[160:175], v[210:211], v[60:61], 0
    v_exp_f32 v144, v144
    v_exp_f32 v145, v145
    v_exp_f32 v146, v146
    v_exp_f32 v147, v147
    v_mfma_f32_32x32x16_bf16 v[160:175], v[206:209], v[48:51], v[160:175]
    v_exp_f32 v148, v148
    v_exp_f32 v149, v149
    v_exp_f32 v150, v150
    v_exp_f32 v151, v151
    v_smfmac_f32_32x32x32_bf16 v[64:79], v[216:219], v[136:143], v2
    s_add_u32 s29, s32, 497664
    buffer_load_dwordx4 v[198:201], v5, s[8:11], s29 offen sc1
    buffer_load_dwordx4 v[202:205], v8, s[8:11], s29 offen sc1
    v_exp_f32 v152, v152
    v_exp_f32 v153, v153
    v_exp_f32 v154, v154
    v_exp_f32 v155, v155
    v_smfmac_f32_32x32x32_bf16 v[80:95], v[212:215], v[144:151], v2
    v_exp_f32 v156, v156
    v_exp_f32 v157, v157
    v_exp_f32 v158, v158
    v_exp_f32 v159, v159
    v_mfma_f32_32x32x8_bf16 v[176:191], v[210:211], v[62:63], 0
    v_exp_f32 v160, v160
    v_exp_f32 v161, v161
    v_exp_f32 v162, v162
    v_exp_f32 v163, v163
    v_mfma_f32_32x32x16_bf16 v[176:191], v[206:209], v[52:55], v[176:191]
    s_add_u32 m0, s61, 6144
    s_nop 0
    buffer_load_dwordx4 v19, s[8:11], s62 offen sc1 lds
    s_add_u32 s62, s62, 1024
    s_cmp_ge_u32 s62, s63
    s_cselect_b32 s28, 102400, 0
    s_sub_u32 s62, s62, s28
    s_add_u32 m0, s61, 7168
    s_nop 0
    buffer_load_dwordx4 v19, s[8:11], s62 offen sc1 lds
    s_add_u32 s62, s62, 1024
    s_cmp_ge_u32 s62, s63
    s_cselect_b32 s28, 102400, 0
    s_sub_u32 s62, s62, s28
    v_exp_f32 v164, v164
    v_exp_f32 v165, v165
    v_exp_f32 v166, v166
    v_exp_f32 v167, v167
    v_smfmac_f32_32x32x32_bf16 v[80:95], v[216:219], v[152:159], v2
    v_exp_f32 v168, v168
    v_exp_f32 v169, v169
    v_exp_f32 v170, v170
    v_exp_f32 v171, v171
    v_smfmac_f32_32x32x32_bf16 v[96:111], v[212:215], v[160:167], v2
    v_exp_f32 v172, v172
    v_exp_f32 v173, v173
    v_exp_f32 v174, v174
    v_exp_f32 v175, v175
    s_waitcnt vmcnt(18)
    v_mfma_f32_32x32x8_bf16 v[128:143], v[224:225], v[56:57], 0
    v_exp_f32 v176, v176
    v_exp_f32 v177, v177
    v_exp_f32 v178, v178
    v_exp_f32 v179, v179
    v_mfma_f32_32x32x16_bf16 v[128:143], v[220:223], v[40:43], v[128:143]
    v_exp_f32 v180, v180
    v_exp_f32 v181, v181
    v_exp_f32 v182, v182
    v_exp_f32 v183, v183
    v_smfmac_f32_32x32x32_bf16 v[96:111], v[216:219], v[168:175], v2
    s_add_u32 s28, s31, 33280
    buffer_load_dwordx4 v[206:209], v3, s[8:11], s28 offen sc1
    buffer_load_dword v210, v4, s[8:11], s28 offen sc1
    v_exp_f32 v184, v184
    v_exp_f32 v185, v185
    v_exp_f32 v186, v186
    v_exp_f32 v187, v187
    v_smfmac_f32_32x32x32_bf16 v[112:127], v[212:215], v[176:183], v2
    v_exp_f32 v188, v188
    v_exp_f32 v189, v189
    v_exp_f32 v190, v190
    v_exp_f32 v191, v191
    v_mfma_f32_32x32x8_bf16 v[144:159], v[224:225], v[58:59], 0
    v_exp_f32 v128, v128
    v_exp_f32 v129, v129
    v_exp_f32 v130, v130
    v_exp_f32 v131, v131
    v_mfma_f32_32x32x16_bf16 v[144:159], v[220:223], v[44:47], v[144:159]
    s_add_u32 m0, s61, 8192
    s_nop 0
    buffer_load_dwordx4 v19, s[8:11], s62 offen sc1 lds
    s_add_u32 s62, s62, 1024
    s_cmp_ge_u32 s62, s63
    s_cselect_b32 s28, 102400, 0
    s_sub_u32 s62, s62, s28
    s_add_u32 m0, s61, 9216
    s_nop 0
    buffer_load_dwordx4 v19, s[8:11], s62 offen sc1 lds
    s_add_u32 s62, s62, 1024
    s_cmp_ge_u32 s62, s63
    s_cselect_b32 s28, 102400, 0
    s_sub_u32 s62, s62, s28
    v_exp_f32 v132, v132
    v_exp_f32 v133, v133
    v_exp_f32 v134, v134
    v_exp_f32 v135, v135
    v_smfmac_f32_32x32x32_bf16 v[112:127], v[216:219], v[184:191], v2
    v_exp_f32 v136, v136
    v_exp_f32 v137, v137
    v_exp_f32 v138, v138
    v_exp_f32 v139, v139
    s_waitcnt vmcnt(20)
    v_smfmac_f32_32x32x32_bf16 v[64:79], v[226:229], v[128:135], v2
    v_exp_f32 v140, v140
    v_exp_f32 v141, v141
    v_exp_f32 v142, v142
    v_exp_f32 v143, v143
    v_mfma_f32_32x32x8_bf16 v[160:175], v[224:225], v[60:61], 0
    v_exp_f32 v144, v144
    v_exp_f32 v145, v145
    v_exp_f32 v146, v146
    v_exp_f32 v147, v147
    v_mfma_f32_32x32x16_bf16 v[160:175], v[220:223], v[48:51], v[160:175]
    v_exp_f32 v148, v148
    v_exp_f32 v149, v149
    v_exp_f32 v150, v150
    v_exp_f32 v151, v151
    v_smfmac_f32_32x32x32_bf16 v[64:79], v[230:233], v[136:143], v2
    s_add_u32 s29, s32, 539136
    buffer_load_dwordx4 v[212:215], v5, s[8:11], s29 offen sc1
    buffer_load_dwordx4 v[216:219], v8, s[8:11], s29 offen sc1
    v_exp_f32 v152, v152
    v_exp_f32 v153, v153
    v_exp_f32 v154, v154
    v_exp_f32 v155, v155
    v_smfmac_f32_32x32x32_bf16 v[80:95], v[226:229], v[144:151], v2
    v_exp_f32 v156, v156
    v_exp_f32 v157, v157
    v_exp_f32 v158, v158
    v_exp_f32 v159, v159
    v_mfma_f32_32x32x8_bf16 v[176:191], v[224:225], v[62:63], 0
    v_exp_f32 v160, v160
    v_exp_f32 v161, v161
    v_exp_f32 v162, v162
    v_exp_f32 v163, v163
    v_mfma_f32_32x32x16_bf16 v[176:191], v[220:223], v[52:55], v[176:191]
    s_add_u32 m0, s61, 10240
    s_nop 0
    buffer_load_dwordx4 v19, s[8:11], s62 offen sc1 lds
    s_add_u32 s62, s62, 1024
    s_cmp_ge_u32 s62, s63
    s_cselect_b32 s28, 102400, 0
    s_sub_u32 s62, s62, s28
    v_exp_f32 v164, v164
    v_exp_f32 v165, v165
    v_exp_f32 v166, v166
    v_exp_f32 v167, v167
    v_smfmac_f32_32x32x32_bf16 v[80:95], v[230:233], v[152:159], v2
    v_exp_f32 v168, v168
    v_exp_f32 v169, v169
    v_exp_f32 v170, v170
    v_exp_f32 v171, v171
    v_smfmac_f32_32x32x32_bf16 v[96:111], v[226:229], v[160:167], v2
    v_exp_f32 v172, v172
    v_exp_f32 v173, v173
    v_exp_f32 v174, v174
    v_exp_f32 v175, v175
    s_waitcnt vmcnt(21)
    s_cmp_lt_u32 s3, 4
    s_cbranch_scc1 nprep_84
    s_lshl_b32 s28, s2, 2
    s_add_u32 s28, s28, s7
    s_lshl_b32 s28, s28, 2
    s_add_u32 s28, s28, 30668800
    v_mov_b32 v12, s58
    v_mov_b32 v13, 0
    s_mov_b64 exec, 1
    buffer_store_dword v12, v13, s[8:11], s28 offen sc1
    s_mov_b64 exec, -1
nprep_84:
    v_mfma_f32_32x32x8_bf16 v[128:143], v[238:239], v[56:57], 0
    v_exp_f32 v176, v176
    v_exp_f32 v177, v177
    v_exp_f32 v178, v178
    v_exp_f32 v179, v179
    v_mfma_f32_32x32x16_bf16 v[128:143], v[234:237], v[40:43], v[128:143]
    v_exp_f32 v180, v180
    v_exp_f32 v181, v181
    v_exp_f32 v182, v182
    v_exp_f32 v183, v183
    v_smfmac_f32_32x32x32_bf16 v[96:111], v[230:233], v[168:175], v2
    s_add_u32 s28, s31, 35840
    buffer_load_dwordx4 v[220:223], v3, s[8:11], s28 offen sc1
    buffer_load_dword v224, v4, s[8:11], s28 offen sc1
    v_exp_f32 v184, v184
    v_exp_f32 v185, v185
    v_exp_f32 v186, v186
    v_exp_f32 v187, v187
    v_smfmac_f32_32x32x32_bf16 v[112:127], v[226:229], v[176:183], v2
    v_exp_f32 v188, v188
    v_exp_f32 v189, v189
    v_exp_f32 v190, v190
    v_exp_f32 v191, v191
    v_mfma_f32_32x32x8_bf16 v[144:159], v[238:239], v[58:59], 0
    v_exp_f32 v128, v128
    v_exp_f32 v129, v129
    v_exp_f32 v130, v130
    v_exp_f32 v131, v131
    v_mfma_f32_32x32x16_bf16 v[144:159], v[234:237], v[44:47], v[144:159]
    v_exp_f32 v132, v132
    v_exp_f32 v133, v133
    v_exp_f32 v134, v134
    v_exp_f32 v135, v135
    v_smfmac_f32_32x32x32_bf16 v[112:127], v[230:233], v[184:191], v2
    v_exp_f32 v136, v136
    v_exp_f32 v137, v137
    v_exp_f32 v138, v138
    v_exp_f32 v139, v139
    s_waitcnt vmcnt(19)
    v_smfmac_f32_32x32x32_bf16 v[64:79], v[240:243], v[128:135], v2
    v_exp_f32 v140, v140
    v_exp_f32 v141, v141
    v_exp_f32 v142, v142
    v_exp_f32 v143, v143
    v_mfma_f32_32x32x8_bf16 v[160:175], v[238:239], v[60:61], 0
    v_exp_f32 v144, v144
    v_exp_f32 v145, v145
    v_exp_f32 v146, v146
    v_exp_f32 v147, v147
    v_mfma_f32_32x32x16_bf16 v[160:175], v[234:237], v[48:51], v[160:175]
    v_exp_f32 v148, v148
    v_exp_f32 v149, v149
    v_exp_f32 v150, v150
    v_exp_f32 v151, v151
    v_smfmac_f32_32x32x32_bf16 v[64:79], v[244:247], v[136:143], v2
    s_add_u32 s29, s32, 580608
    buffer_load_dwordx4 v[226:229], v5, s[8:11], s29 offen sc1
    buffer_load_dwordx4 v[230:233], v8, s[8:11], s29 offen sc1
    v_exp_f32 v152, v152
    v_exp_f32 v153, v153
    v_exp_f32 v154, v154
    v_exp_f32 v155, v155
    v_smfmac_f32_32x32x32_bf16 v[80:95], v[240:243], v[144:151], v2
    v_exp_f32 v156, v156
    v_exp_f32 v157, v157
    v_exp_f32 v158, v158
    v_exp_f32 v159, v159
    v_mfma_f32_32x32x8_bf16 v[176:191], v[238:239], v[62:63], 0
    v_exp_f32 v160, v160
    v_exp_f32 v161, v161
    v_exp_f32 v162, v162
    v_exp_f32 v163, v163
    v_mfma_f32_32x32x16_bf16 v[176:191], v[234:237], v[52:55], v[176:191]
    v_exp_f32 v164, v164
    v_exp_f32 v165, v165
    v_exp_f32 v166, v166
    v_exp_f32 v167, v167
    v_smfmac_f32_32x32x32_bf16 v[80:95], v[244:247], v[152:159], v2
    v_exp_f32 v168, v168
    v_exp_f32 v169, v169
    v_exp_f32 v170, v170
    v_exp_f32 v171, v171
    v_smfmac_f32_32x32x32_bf16 v[96:111], v[240:243], v[160:167], v2
    v_exp_f32 v172, v172
    v_exp_f32 v173, v173
    v_exp_f32 v174, v174
    v_exp_f32 v175, v175
    s_waitcnt vmcnt(17)
    v_mfma_f32_32x32x8_bf16 v[128:143], v[196:197], v[56:57], 0
    v_exp_f32 v176, v176
    v_exp_f32 v177, v177
    v_exp_f32 v178, v178
    v_exp_f32 v179, v179
    v_mfma_f32_32x32x16_bf16 v[128:143], v[192:195], v[40:43], v[128:143]
    v_exp_f32 v180, v180
    v_exp_f32 v181, v181
    v_exp_f32 v182, v182
    v_exp_f32 v183, v183
    v_smfmac_f32_32x32x32_bf16 v[96:111], v[244:247], v[168:175], v2
    s_add_u32 s28, s31, 38400
    buffer_load_dwordx4 v[234:237], v3, s[8:11], s28 offen sc1
    buffer_load_dword v238, v4, s[8:11], s28 offen sc1
    v_exp_f32 v184, v184
    v_exp_f32 v185, v185
    v_exp_f32 v186, v186
    v_exp_f32 v187, v187
    v_smfmac_f32_32x32x32_bf16 v[112:127], v[240:243], v[176:183], v2
    v_exp_f32 v188, v188
    v_exp_f32 v189, v189
    v_exp_f32 v190, v190
    v_exp_f32 v191, v191
    s_setprio 0
    v_mfma_f32_32x32x8_bf16 v[144:159], v[196:197], v[58:59], 0
    v_exp_f32 v128, v128
    v_exp_f32 v129, v129
    v_exp_f32 v130, v130
    v_exp_f32 v131, v131
    v_mfma_f32_32x32x16_bf16 v[144:159], v[192:195], v[44:47], v[144:159]
    v_exp_f32 v132, v132
    v_exp_f32 v133, v133
    v_exp_f32 v134, v134
    v_exp_f32 v135, v135
    v_smfmac_f32_32x32x32_bf16 v[112:127], v[244:247], v[184:191], v2
    v_exp_f32 v136, v136
    v_exp_f32 v137, v137
    v_exp_f32 v138, v138
    v_exp_f32 v139, v139
    s_waitcnt vmcnt(15)
    v_smfmac_f32_32x32x32_bf16 v[64:79], v[198:201], v[128:135], v2
    v_exp_f32 v140, v140
    v_exp_f32 v141, v141
    v_exp_f32 v142, v142
    v_exp_f32 v143, v143
    v_mfma_f32_32x32x8_bf16 v[160:175], v[196:197], v[60:61], 0
    v_exp_f32 v144, v144
    v_exp_f32 v145, v145
    v_exp_f32 v146, v146
    v_exp_f32 v147, v147
    v_mfma_f32_32x32x16_bf16 v[160:175], v[192:195], v[48:51], v[160:175]
    v_exp_f32 v148, v148
    v_exp_f32 v149, v149
    v_exp_f32 v150, v150
    v_exp_f32 v151, v151
    v_smfmac_f32_32x32x32_bf16 v[64:79], v[202:205], v[136:143], v2
    s_add_u32 s29, s32, 622080
    buffer_load_dwordx4 v[240:243], v5, s[8:11], s29 offen sc1
    buffer_load_dwordx4 v[244:247], v8, s[8:11], s29 offen sc1
    v_exp_f32 v152, v152
    v_exp_f32 v153, v153
    v_exp_f32 v154, v154
    v_exp_f32 v155, v155
    v_smfmac_f32_32x32x32_bf16 v[80:95], v[198:201], v[144:151], v2
    v_exp_f32 v156, v156
    v_exp_f32 v157, v157
    v_exp_f32 v158, v158
    v_exp_f32 v159, v159
    v_mfma_f32_32x32x8_bf16 v[176:191], v[196:197], v[62:63], 0
    v_exp_f32 v160, v160
    v_exp_f32 v161, v161
    v_exp_f32 v162, v162
    v_exp_f32 v163, v163
    v_mfma_f32_32x32x16_bf16 v[176:191], v[192:195], v[52:55], v[176:191]
    s_cmp_lg_u32 s3, 7
    s_cbranch_scc1 cpf_85
    s_getpc_b64 s[88:89]
pc_ref2:
    s_bfe_u32 s28, s2, 0x30003
    s_lshl_b32 s28, s28, 13
    v_lshl_add_u32 v39, v0, 7, s28
    s_mov_b32 s28, code_end-pc_ref2-4
    v_min_u32 v39, s28, v39
    global_load_dword v251, v39, s[88:89]
cpf_85:
    v_exp_f32 v164, v164
    v_exp_f32 v165, v165
    v_exp_f32 v166, v166
    v_exp_f32 v167, v167
    v_smfmac_f32_32x32x32_bf16 v[80:95], v[202:205], v[152:159], v2
    v_exp_f32 v168, v168
    v_exp_f32 v169, v169
    v_exp_f32 v170, v170
    v_exp_f32 v171, v171
    v_smfmac_f32_32x32x32_bf16 v[96:111], v[198:201], v[160:167], v2
    v_exp_f32 v172, v172
    v_exp_f32 v173, v173
    v_exp_f32 v174, v174
    v_exp_f32 v175, v175
    s_waitcnt vmcnt(13)
    v_mfma_f32_32x32x8_bf16 v[128:143], v[210:211], v[56:57], 0
    v_exp_f32 v176, v176
    v_exp_f32 v177, v177
    v_exp_f32 v178, v178
    v_exp_f32 v179, v179
    v_mfma_f32_32x32x16_bf16 v[128:143], v[206:209], v[40:43], v[128:143]
    v_exp_f32 v180, v180
    v_exp_f32 v181, v181
    v_exp_f32 v182, v182
    v_exp_f32 v183, v183
    v_smfmac_f32_32x32x32_bf16 v[96:111], v[202:205], v[168:175], v2
    v_exp_f32 v184, v184
    v_exp_f32 v185, v185
    v_exp_f32 v186, v186
    v_exp_f32 v187, v187
    v_smfmac_f32_32x32x32_bf16 v[112:127], v[198:201], v[176:183], v2
    v_exp_f32 v188, v188
    v_exp_f32 v189, v189
    v_exp_f32 v190, v190
    v_exp_f32 v191, v191
    v_mfma_f32_32x32x8_bf16 v[144:159], v[210:211], v[58:59], 0
    v_exp_f32 v128, v128
    v_exp_f32 v129, v129
    v_exp_f32 v130, v130
    v_exp_f32 v131, v131
    v_mfma_f32_32x32x16_bf16 v[144:159], v[206:209], v[44:47], v[144:159]
    v_exp_f32 v132, v132
    v_exp_f32 v133, v133
    v_exp_f32 v134, v134
    v_exp_f32 v135, v135
    v_smfmac_f32_32x32x32_bf16 v[112:127], v[202:205], v[184:191], v2
    v_exp_f32 v136, v136
    v_exp_f32 v137, v137
    v_exp_f32 v138, v138
    v_exp_f32 v139, v139
    s_waitcnt vmcnt(9)
    v_smfmac_f32_32x32x32_bf16 v[64:79], v[212:215], v[128:135], v2
    v_exp_f32 v140, v140
    v_exp_f32 v141, v141
    v_exp_f32 v142, v142
    v_exp_f32 v143, v143
    v_mfma_f32_32x32x8_bf16 v[160:175], v[210:211], v[60:61], 0
    v_exp_f32 v144, v144
    v_exp_f32 v145, v145
    v_exp_f32 v146, v146
    v_exp_f32 v147, v147
    v_mfma_f32_32x32x16_bf16 v[160:175], v[206:209], v[48:51], v[160:175]
    v_exp_f32 v148, v148
    v_exp_f32 v149, v149
    v_exp_f32 v150, v150
    v_exp_f32 v151, v151
    v_smfmac_f32_32x32x32_bf16 v[64:79], v[216:219], v[136:143], v2
    v_exp_f32 v152, v152
    v_exp_f32 v153, v153
    v_exp_f32 v154, v154
    v_exp_f32 v155, v155
    v_smfmac_f32_32x32x32_bf16 v[80:95], v[212:215], v[144:151], v2
    v_exp_f32 v156, v156
    v_exp_f32 v157, v157
    v_exp_f32 v158, v158
    v_exp_f32 v159, v159
    v_mfma_f32_32x32x8_bf16 v[176:191], v[210:211], v[62:63], 0
    v_exp_f32 v160, v160
    v_exp_f32 v161, v161
    v_exp_f32 v162, v162
    v_exp_f32 v163, v163
    v_mfma_f32_32x32x16_bf16 v[176:191], v[206:209], v[52:55], v[176:191]
    v_exp_f32 v164, v164
    v_exp_f32 v165, v165
    v_exp_f32 v166, v166
    v_exp_f32 v167, v167
    v_smfmac_f32_32x32x32_bf16 v[80:95], v[216:219], v[152:159], v2
    v_exp_f32 v168, v168
    v_exp_f32 v169, v169
    v_exp_f32 v170, v170
    v_exp_f32 v171, v171
    v_smfmac_f32_32x32x32_bf16 v[96:111], v[212:215], v[160:167], v2
    v_exp_f32 v172, v172
    v_exp_f32 v173, v173
    v_exp_f32 v174, v174
    v_exp_f32 v175, v175
    s_waitcnt vmcnt(6)
    v_mfma_f32_32x32x8_bf16 v[128:143], v[224:225], v[56:57], 0
    v_exp_f32 v176, v176
    v_exp_f32 v177, v177
    v_exp_f32 v178, v178
    v_exp_f32 v179, v179
    v_mfma_f32_32x32x16_bf16 v[128:143], v[220:223], v[40:43], v[128:143]
    v_exp_f32 v180, v180
    v_exp_f32 v181, v181
    v_exp_f32 v182, v182
    v_exp_f32 v183, v183
    v_smfmac_f32_32x32x32_bf16 v[96:111], v[216:219], v[168:175], v2
    v_exp_f32 v184, v184
    v_exp_f32 v185, v185
    v_exp_f32 v186, v186
    v_exp_f32 v187, v187
    v_smfmac_f32_32x32x32_bf16 v[112:127], v[212:215], v[176:183], v2
    v_exp_f32 v188, v188
    v_exp_f32 v189, v189
    v_exp_f32 v190, v190
    v_exp_f32 v191, v191
    v_mfma_f32_32x32x8_bf16 v[144:159], v[224:225], v[58:59], 0
    v_exp_f32 v128, v128
    v_exp_f32 v129, v129
    v_exp_f32 v130, v130
    v_exp_f32 v131, v131
    v_mfma_f32_32x32x16_bf16 v[144:159], v[220:223], v[44:47], v[144:159]
    v_exp_f32 v132, v132
    v_exp_f32 v133, v133
    v_exp_f32 v134, v134
    v_exp_f32 v135, v135
    v_smfmac_f32_32x32x32_bf16 v[112:127], v[216:219], v[184:191], v2
    v_exp_f32 v136, v136
    v_exp_f32 v137, v137
    v_exp_f32 v138, v138
    v_exp_f32 v139, v139
    s_waitcnt vmcnt(4)
    v_smfmac_f32_32x32x32_bf16 v[64:79], v[226:229], v[128:135], v2
    v_exp_f32 v140, v140
    v_exp_f32 v141, v141
    v_exp_f32 v142, v142
    v_exp_f32 v143, v143
    v_mfma_f32_32x32x8_bf16 v[160:175], v[224:225], v[60:61], 0
    v_exp_f32 v144, v144
    v_exp_f32 v145, v145
    v_exp_f32 v146, v146
    v_exp_f32 v147, v147
    v_mfma_f32_32x32x16_bf16 v[160:175], v[220:223], v[48:51], v[160:175]
    v_exp_f32 v148, v148
    v_exp_f32 v149, v149
    v_exp_f32 v150, v150
    v_exp_f32 v151, v151
    v_smfmac_f32_32x32x32_bf16 v[64:79], v[230:233], v[136:143], v2
    v_exp_f32 v152, v152
    v_exp_f32 v153, v153
    v_exp_f32 v154, v154
    v_exp_f32 v155, v155
    v_smfmac_f32_32x32x32_bf16 v[80:95], v[226:229], v[144:151], v2
    v_exp_f32 v156, v156
    v_exp_f32 v157, v157
    v_exp_f32 v158, v158
    v_exp_f32 v159, v159
    v_mfma_f32_32x32x8_bf16 v[176:191], v[224:225], v[62:63], 0
    v_exp_f32 v160, v160
    v_exp_f32 v161, v161
    v_exp_f32 v162, v162
    v_exp_f32 v163, v163
    v_mfma_f32_32x32x16_bf16 v[176:191], v[220:223], v[52:55], v[176:191]
    v_exp_f32 v164, v164
    v_exp_f32 v165, v165
    v_exp_f32 v166, v166
    v_exp_f32 v167, v167
    v_smfmac_f32_32x32x32_bf16 v[80:95], v[230:233], v[152:159], v2
    v_exp_f32 v168, v168
    v_exp_f32 v169, v169
    v_exp_f32 v170, v170
    v_exp_f32 v171, v171
    v_smfmac_f32_32x32x32_bf16 v[96:111], v[226:229], v[160:167], v2
    v_exp_f32 v172, v172
    v_exp_f32 v173, v173
    v_exp_f32 v174, v174
    v_exp_f32 v175, v175
    s_waitcnt vmcnt(2)
    v_mfma_f32_32x32x8_bf16 v[128:143], v[238:239], v[56:57], 0
    v_exp_f32 v176, v176
    v_exp_f32 v177, v177
    v_exp_f32 v178, v178
    v_exp_f32 v179, v179
    v_mfma_f32_32x32x16_bf16 v[128:143], v[234:237], v[40:43], v[128:143]
    v_exp_f32 v180, v180
    v_exp_f32 v181, v181
    v_exp_f32 v182, v182
    v_exp_f32 v183, v183
    v_smfmac_f32_32x32x32_bf16 v[96:111], v[230:233], v[168:175], v2
    v_exp_f32 v184, v184
    v_exp_f32 v185, v185
    v_exp_f32 v186, v186
    v_exp_f32 v187, v187
    v_smfmac_f32_32x32x32_bf16 v[112:127], v[226:229], v[176:183], v2
    v_exp_f32 v188, v188
    v_exp_f32 v189, v189
    v_exp_f32 v190, v190
    v_exp_f32 v191, v191
    v_mfma_f32_32x32x8_bf16 v[144:159], v[238:239], v[58:59], 0
    v_exp_f32 v128, v128
    v_exp_f32 v129, v129
    v_exp_f32 v130, v130
    v_exp_f32 v131, v131
    v_mfma_f32_32x32x16_bf16 v[144:159], v[234:237], v[44:47], v[144:159]
    v_exp_f32 v132, v132
    v_exp_f32 v133, v133
    v_exp_f32 v134, v134
    v_exp_f32 v135, v135
    v_smfmac_f32_32x32x32_bf16 v[112:127], v[230:233], v[184:191], v2
    v_exp_f32 v136, v136
    v_exp_f32 v137, v137
    v_exp_f32 v138, v138
    v_exp_f32 v139, v139
    s_waitcnt vmcnt(0)
    v_smfmac_f32_32x32x32_bf16 v[64:79], v[240:243], v[128:135], v2
    v_exp_f32 v140, v140
    v_exp_f32 v141, v141
    v_exp_f32 v142, v142
    v_exp_f32 v143, v143
    v_mfma_f32_32x32x8_bf16 v[160:175], v[238:239], v[60:61], 0
    v_exp_f32 v144, v144
    v_exp_f32 v145, v145
    v_exp_f32 v146, v146
    v_exp_f32 v147, v147
    v_mfma_f32_32x32x16_bf16 v[160:175], v[234:237], v[48:51], v[160:175]
    v_exp_f32 v148, v148
    v_exp_f32 v149, v149
    v_exp_f32 v150, v150
    v_exp_f32 v151, v151
    v_smfmac_f32_32x32x32_bf16 v[64:79], v[244:247], v[136:143], v2
    v_exp_f32 v152, v152
    v_exp_f32 v153, v153
    v_exp_f32 v154, v154
    v_exp_f32 v155, v155
    v_smfmac_f32_32x32x32_bf16 v[80:95], v[240:243], v[144:151], v2
    v_exp_f32 v156, v156
    v_exp_f32 v157, v157
    v_exp_f32 v158, v158
    v_exp_f32 v159, v159
    v_mfma_f32_32x32x8_bf16 v[176:191], v[238:239], v[62:63], 0
    v_exp_f32 v160, v160
    v_exp_f32 v161, v161
    v_exp_f32 v162, v162
    v_exp_f32 v163, v163
    v_mfma_f32_32x32x16_bf16 v[176:191], v[234:237], v[52:55], v[176:191]
    v_exp_f32 v164, v164
    v_exp_f32 v165, v165
    v_exp_f32 v166, v166
    v_exp_f32 v167, v167
    v_smfmac_f32_32x32x32_bf16 v[80:95], v[244:247], v[152:159], v2
    v_exp_f32 v168, v168
    v_exp_f32 v169, v169
    v_exp_f32 v170, v170
    v_exp_f32 v171, v171
    v_smfmac_f32_32x32x32_bf16 v[96:111], v[240:243], v[160:167], v2
    ds_write_b128 v16, v[64:67] offset:0
    ds_write_b128 v16, v[68:71] offset:1024
    ds_write_b128 v16, v[72:75] offset:2048
    v_exp_f32 v172, v172
    v_exp_f32 v173, v173
    v_exp_f32 v174, v174
    v_exp_f32 v175, v175
    v_exp_f32 v176, v176
    v_exp_f32 v177, v177
    v_exp_f32 v178, v178
    v_exp_f32 v179, v179
    v_exp_f32 v180, v180
    v_exp_f32 v181, v181
    v_exp_f32 v182, v182
    v_exp_f32 v183, v183
    v_smfmac_f32_32x32x32_bf16 v[96:111], v[244:247], v[168:175], v2
    v_exp_f32 v184, v184
    v_exp_f32 v185, v185
    v_exp_f32 v186, v186
    v_exp_f32 v187, v187
    v_smfmac_f32_32x32x32_bf16 v[112:127], v[240:243], v[176:183], v2
    ds_write_b128 v17, v[80:83] offset:0
    ds_write_b128 v17, v[84:87] offset:1024
    ds_write_b128 v17, v[88:91] offset:2048
    v_exp_f32 v188, v188
    v_exp_f32 v189, v189
    v_exp_f32 v190, v190
    v_exp_f32 v191, v191
    s_nop 2
    v_smfmac_f32_32x32x32_bf16 v[112:127], v[244:247], v[184:191], v2
    s_setprio 0
    ds_write_b128 v18, v[96:99] offset:0
    ds_write_b128 v18, v[100:103] offset:1024
    ds_write_b128 v18, v[104:107] offset:2048
    s_waitcnt lgkmcnt(0)
    s_barrier
    ds_read_b128 v[128:131], v7 offset:0
    ds_read_b128 v[132:135], v7 offset:1024
    ds_read_b128 v[136:139], v7 offset:2048
    ds_read_b128 v[140:143], v7 offset:3072
    ds_read_b128 v[144:147], v7 offset:4096
    ds_read_b128 v[148:151], v7 offset:5120
    ds_read_b128 v[152:155], v7 offset:6144
    ds_read_b128 v[156:159], v7 offset:7168
    ds_read_b128 v[160:163], v7 offset:8192
    s_waitcnt lgkmcnt(6)
    v_pk_add_f32 v[112:113], v[112:113], v[128:129]
    v_pk_add_f32 v[114:115], v[114:115], v[130:131]
    v_pk_add_f32 v[116:117], v[116:117], v[132:133]
    v_pk_add_f32 v[118:119], v[118:119], v[134:135]
    v_pk_add_f32 v[120:121], v[120:121], v[136:137]
    v_pk_add_f32 v[122:123], v[122:123], v[138:139]
    s_waitcnt lgkmcnt(0)
    s_nop 0
    v_pk_add_f32 v[140:141], v[140:141], v[152:153]
    v_pk_add_f32 v[142:143], v[142:143], v[154:155]
    v_pk_add_f32 v[144:145], v[144:145], v[156:157]
    v_pk_add_f32 v[146:147], v[146:147], v[158:159]
    v_pk_add_f32 v[148:149], v[148:149], v[160:161]
    v_pk_add_f32 v[150:151], v[150:151], v[162:163]
    v_pk_add_f32 v[112:113], v[112:113], v[140:141]
    v_pk_add_f32 v[114:115], v[114:115], v[142:143]
    v_pk_add_f32 v[116:117], v[116:117], v[144:145]
    v_pk_add_f32 v[118:119], v[118:119], v[146:147]
    v_pk_add_f32 v[120:121], v[120:121], v[148:149]
    v_pk_add_f32 v[122:123], v[122:123], v[150:151]
    v_mov_b32 v12, v120
    v_mov_b32 v13, v120
    v_pk_mul_f32 v[128:129], v[112:113], 0 op_sel_hi:[1,0]
    s_nop 0
    v_permlane32_swap_b32 v12, v13
    v_pk_fma_f32 v[128:129], v[114:115], 0, v[128:129] op_sel_hi:[1,0,1]
    v_pk_fma_f32 v[128:129], v[116:117], 0, v[128:129] op_sel_hi:[1,0,1]
    v_pk_fma_f32 v[128:129], v[118:119], 0, v[128:129] op_sel_hi:[1,0,1]
    v_pk_fma_f32 v[128:129], v[120:121], 0, v[128:129] op_sel_hi:[1,0,1]
    v_pk_fma_f32 v[128:129], v[122:123], 0, v[128:129] op_sel_hi:[1,0,1]
    v_add_f32 v12, v128, v129
    v_add_f32 v12, v12, v13
    v_cmp_nle_f32 vcc, 0x2b800000, v12
    v_rcp_f32 v14, v13
    s_nop 3
    s_cbranch_vccnz p2_fallback
p2_fin:
    s_nop 0
    v_pk_mul_f32 v[112:113], v[112:113], v[14:15] op_sel_hi:[1,0]
    v_pk_mul_f32 v[114:115], v[114:115], v[14:15] op_sel_hi:[1,0]
    v_pk_mul_f32 v[116:117], v[116:117], v[14:15] op_sel_hi:[1,0]
    v_pk_mul_f32 v[118:119], v[118:119], v[14:15] op_sel_hi:[1,0]
    v_pk_mul_f32 v[120:121], v[120:121], v[14:15] op_sel_hi:[1,0]
    v_pk_mul_f32 v[122:123], v[122:123], v[14:15] op_sel_hi:[1,0]
    v_cvt_pk_bf16_f32 v112, v112, v113
    v_cvt_pk_bf16_f32 v113, v114, v115
    v_cvt_pk_bf16_f32 v114, v116, v117
    v_cvt_pk_bf16_f32 v115, v118, v119
    v_cvt_pk_bf16_f32 v116, v120, v121
    v_cvt_pk_bf16_f32 v117, v122, v123
    buffer_store_dwordx4 v[112:115], v1, s[8:11], s36 offen sc1
    buffer_store_dwordx2 v[116:117], v11, s[8:11], s37 offen sc1
    s_cmp_eq_u32 s3, 4
    s_cbranch_scc1 tail_l0
    s_cmp_eq_u32 s3, 5
    s_cbranch_scc1 tail_l1
    s_cmp_eq_u32 s3, 6
    s_cbranch_scc1 tail_l2
    s_cmp_eq_u32 s3, 7
    s_cbranch_scc1 tail_l3
    s_and_b32 s6, s2, 3
    s_lshl_b32 s6, s6, 3
    s_bfe_u32 s4, s2, 0x30003
    s_add_u32 s4, s4, s6
    s_bfe_u32 s6, s2, 0x10002
    s_lshl_b32 s6, s6, 2
    s_lshr_b32 s5, s2, 6
    s_add_u32 s5, s5, s6
    s_and_b32 s6, s3, 1
    s_lshr_b32 s7, s3, 1
    v_and_b32 v2, 15, v0
    v_lshrrev_b32 v3, 4, v0
    v_bfe_u32 v5, v0, 4, 1
    v_lshrrev_b32 v7, 5, v0
    v_lshlrev_b32 v22, 4, v0
    v_and_b32 v23, 31, v0
    v_lshlrev_b32 v23, 2, v23
    s_mul_i32 s28, s7, 5120
    v_add_u32_e64 v12, s28, v22
    v_add_u32 v13, 65536, v12
    v_add_u32 v14, 131072, v12
    s_lshl_b32 s20, s4, 1
    s_add_u32 s20, s20, s6
    v_mul_u32_u24 v30, 20480, v5
    v_lshl_add_u32 v30, v7, 8, v30
    v_lshl_add_u32 v30, v2, 4, v30
    s_mul_i32 s21, s20, 40960
    s_mul_i32 s28, s5, 2560
    s_add_u32 s21, s21, s28
    s_add_u32 s27, s21, 12060672
    s_lshl_b32 s28, s7, 10
    s_add_u32 s21, s21, s28
    s_add_u32 s21, s21, 12058624
    s_add_u32 s26, s21, 20480
    s_lshl_b32 s23, s20, 9
    s_add_u32 s23, s23, 30339072
    v_bfe_u32 v4, v0, 3, 2
    v_and_b32 v19, 7, v0
    v_lshlrev_b32 v19, 2, v19
    v_lshl_add_u32 v19, v4, 7, v19
    v_and_b32 v4, 3, v0
    v_min_u32 v4, 1, v4
    v_lshlrev_b32 v4, 18, v4
    v_lshl_add_u32 v4, v3, 4, v4
    s_lshl_b32 s28, s7, 6
    s_add_u32 s28, s28, 112640
    v_add_u32 v16, s28, v4
    v_add_u32 v31, 20480, v22
    v_lshlrev_b32 v20, 3, v2
    v_lshl_add_u32 v20, v3, 8, v20
    v_add_u32 v21, 20480, v20
    s_mul_i32 s24, s20, 40960
    s_lshl_b32 s28, s7, 10
    s_add_u32 s24, s24, s28
    s_add_u32 s24, s24, 8388608
    s_lshl_b32 s28, s6, 5
    v_add_u32 v4, s28, v2
    v_mul_u32_u24 v4, 160, v4
    v_add_u32 v4, 102400, v4
    s_lshl_b32 s28, s7, 6
    v_lshl_add_u32 v17, v3, 4, v4
    v_add_u32 v17, s28, v17
    v_mul_u32_u24 v18, 2560, v5
    v_add_u32 v18, v18, v4
    v_lshl_add_u32 v18, v7, 4, v18
    s_mul_i32 s28, s6, 12288
    s_add_u32 s28, s28, 139264
    v_add_u32 v6, s28, v22
    s_waitcnt vmcnt(0)
    s_barrier
    s_cmp_lg_u32 s3, 0
    s_cbranch_scc1 nf_86
    v_mov_b32 v246, s58
    v_mov_b32 v247, 0
    s_mov_b64 exec, 1
    buffer_store_dword v246, v247, s[8:11], s38 offen sc1
    s_mov_b64 exec, -1
nf_86:
    v_and_b32 v248, 15, v0
    v_mul_u32_u24 v248, 128, v248
    s_lshr_b32 s39, s4, 1
    s_mul_i32 s39, s39, 2048
    s_add_u32 s39, s39, 30568448
    s_cmp_lg_u32 s3, 1
    s_cbranch_scc1 np_87
    s_mov_b32 s59, 0x40000
    s_mov_b64 exec, 0xffff
poll_88:
    v_mov_b32 v249, 0
    buffer_atomic_or v249, v248, s[8:11], s39 offen sc0 sc1
    s_waitcnt vmcnt(0)
    v_cmp_ne_u32 vcc, s58, v249
    s_sub_u32 s59, s59, 1
    s_nop 2
    s_cbranch_vccz pollok_89
    s_cmp_eq_u32 s59, 0
    s_cbranch_scc1 pollok_89
    s_sleep 1
    s_branch poll_88
pollok_89:
    s_mov_b64 exec, -1
np_87:
    s_barrier
    buffer_load_dwordx4 v[160:163], v22, s[8:11], s24 offen sc1
    buffer_load_dwordx4 v[164:167], v31, s[8:11], s24 offen sc1
    s_add_u32 s24, s24, 2048
    buffer_load_dwordx4 v[168:171], v22, s[8:11], s24 offen sc1
    buffer_load_dwordx4 v[172:175], v31, s[8:11], s24 offen sc1
    s_add_u32 s24, s24, 2048
    buffer_load_dwordx4 v[176:179], v22, s[8:11], s24 offen sc1
    buffer_load_dwordx4 v[180:183], v31, s[8:11], s24 offen sc1
    s_add_u32 s24, s24, 2048
    buffer_load_dwordx4 v[184:187], v22, s[8:11], s24 offen sc1
    buffer_load_dwordx4 v[188:191], v31, s[8:11], s24 offen sc1
    s_add_u32 s24, s24, 2048
    ds_read_b128 v[112:115], v12 offset:0
    ds_read_b128 v[116:119], v12 offset:1024
    ds_read_b128 v[120:123], v12 offset:2048
    ds_read_b128 v[124:127], v12 offset:3072
    ds_read_b128 v[128:131], v12 offset:4096
    ds_read_b128 v[132:135], v16 offset:0
    s_waitcnt vmcnt(6)
    s_waitcnt lgkmcnt(0)
    v_mfma_f32_16x16x32_bf16 v[64:67], v[112:115], v[160:163], 0
    ds_read_b128 v[136:139], v12 offset:10240
    v_mfma_f32_16x16x32_bf16 v[68:71], v[112:115], v[164:167], 0
    ds_read_b128 v[140:143], v12 offset:11264
    v_mfma_f32_16x16x32_bf16 v[72:75], v[116:119], v[160:163], 0
    ds_read_b128 v[144:147], v12 offset:12288
    v_mfma_f32_16x16x32_bf16 v[76:79], v[116:119], v[164:167], 0
    ds_read_b128 v[148:151], v12 offset:13312
    v_mfma_f32_16x16x32_bf16 v[80:83], v[120:123], v[160:163], 0
    ds_read_b128 v[152:155], v12 offset:14336
    v_mfma_f32_16x16x32_bf16 v[84:87], v[120:123], v[164:167], 0
    ds_read_b128 v[156:159], v16 offset:128
    v_mfma_f32_16x16x32_bf16 v[88:91], v[124:127], v[160:163], 0
    buffer_load_dwordx4 v[192:195], v22, s[8:11], s24 offen sc1
    v_mfma_f32_16x16x32_bf16 v[92:95], v[124:127], v[164:167], 0
    buffer_load_dwordx4 v[196:199], v31, s[8:11], s24 offen sc1
    s_add_u32 s24, s24, 2048
    v_mfma_f32_16x16x32_bf16 v[96:99], v[128:131], v[160:163], 0
    buffer_load_dwordx4 v[200:203], v22, s[8:11], s24 offen sc1
    v_mfma_f32_16x16x32_bf16 v[100:103], v[128:131], v[164:167], 0
    v_mfma_f32_16x16x32_bf16 v[104:107], v[132:135], v[160:163], 0
    v_mfma_f32_16x16x32_bf16 v[108:111], v[132:135], v[164:167], 0
    s_waitcnt vmcnt(7)
    s_waitcnt lgkmcnt(0)
    v_mfma_f32_16x16x32_bf16 v[64:67], v[136:139], v[168:171], v[64:67]
    ds_read_b128 v[112:115], v12 offset:20480
    v_mfma_f32_16x16x32_bf16 v[68:71], v[136:139], v[172:175], v[68:71]
    ds_read_b128 v[116:119], v12 offset:21504
    v_mfma_f32_16x16x32_bf16 v[72:75], v[140:143], v[168:171], v[72:75]
    ds_read_b128 v[120:123], v12 offset:22528
    v_mfma_f32_16x16x32_bf16 v[76:79], v[140:143], v[172:175], v[76:79]
    ds_read_b128 v[124:127], v12 offset:23552
    v_mfma_f32_16x16x32_bf16 v[80:83], v[144:147], v[168:171], v[80:83]
    ds_read_b128 v[128:131], v12 offset:24576
    v_mfma_f32_16x16x32_bf16 v[84:87], v[144:147], v[172:175], v[84:87]
    ds_read_b128 v[132:135], v16 offset:256
    v_mfma_f32_16x16x32_bf16 v[88:91], v[148:151], v[168:171], v[88:91]
    buffer_load_dwordx4 v[204:207], v31, s[8:11], s24 offen sc1
    s_add_u32 s24, s24, 2048
    v_mfma_f32_16x16x32_bf16 v[92:95], v[148:151], v[172:175], v[92:95]
    buffer_load_dwordx4 v[208:211], v22, s[8:11], s24 offen sc1
    v_mfma_f32_16x16x32_bf16 v[96:99], v[152:155], v[168:171], v[96:99]
    buffer_load_dwordx4 v[212:215], v31, s[8:11], s24 offen sc1
    s_add_u32 s24, s24, 2048
    v_mfma_f32_16x16x32_bf16 v[100:103], v[152:155], v[172:175], v[100:103]
    v_mfma_f32_16x16x32_bf16 v[104:107], v[156:159], v[168:171], v[104:107]
    v_mfma_f32_16x16x32_bf16 v[108:111], v[156:159], v[172:175], v[108:111]
    s_waitcnt vmcnt(8)
    s_waitcnt lgkmcnt(0)
    v_mfma_f32_16x16x32_bf16 v[64:67], v[112:115], v[176:179], v[64:67]
    ds_read_b128 v[136:139], v12 offset:30720
    v_mfma_f32_16x16x32_bf16 v[68:71], v[112:115], v[180:183], v[68:71]
    ds_read_b128 v[140:143], v12 offset:31744
    v_mfma_f32_16x16x32_bf16 v[72:75], v[116:119], v[176:179], v[72:75]
    ds_read_b128 v[144:147], v12 offset:32768
    v_mfma_f32_16x16x32_bf16 v[76:79], v[116:119], v[180:183], v[76:79]
    ds_read_b128 v[148:151], v12 offset:33792
    v_mfma_f32_16x16x32_bf16 v[80:83], v[120:123], v[176:179], v[80:83]
    ds_read_b128 v[152:155], v12 offset:34816
    v_mfma_f32_16x16x32_bf16 v[84:87], v[120:123], v[180:183], v[84:87]
    ds_read_b128 v[156:159], v16 offset:384
    v_mfma_f32_16x16x32_bf16 v[88:91], v[124:127], v[176:179], v[88:91]
    buffer_load_dwordx4 v[216:219], v22, s[8:11], s24 offen sc1
    v_mfma_f32_16x16x32_bf16 v[92:95], v[124:127], v[180:183], v[92:95]
    buffer_load_dwordx4 v[220:223], v31, s[8:11], s24 offen sc1
    s_add_u32 s24, s24, 2048
    v_mfma_f32_16x16x32_bf16 v[96:99], v[128:131], v[176:179], v[96:99]
    buffer_load_dwordx2 v[224:225], v20, s[8:11], s24 offen offset:0 sc1
    buffer_load_dwordx2 v[226:227], v20, s[8:11], s24 offen offset:128 sc1
    v_mfma_f32_16x16x32_bf16 v[100:103], v[128:131], v[180:183], v[100:103]
    v_mfma_f32_16x16x32_bf16 v[104:107], v[132:135], v[176:179], v[104:107]
    v_mfma_f32_16x16x32_bf16 v[108:111], v[132:135], v[180:183], v[108:111]
    s_waitcnt vmcnt(10)
    s_waitcnt lgkmcnt(0)
    v_mfma_f32_16x16x32_bf16 v[64:67], v[136:139], v[184:187], v[64:67]
    ds_read_b128 v[112:115], v12 offset:40960
    v_mfma_f32_16x16x32_bf16 v[68:71], v[136:139], v[188:191], v[68:71]
    ds_read_b128 v[116:119], v12 offset:41984
    v_mfma_f32_16x16x32_bf16 v[72:75], v[140:143], v[184:187], v[72:75]
    ds_read_b128 v[120:123], v12 offset:43008
    v_mfma_f32_16x16x32_bf16 v[76:79], v[140:143], v[188:191], v[76:79]
    ds_read_b128 v[124:127], v12 offset:44032
    v_mfma_f32_16x16x32_bf16 v[80:83], v[144:147], v[184:187], v[80:83]
    ds_read_b128 v[128:131], v12 offset:45056
    v_mfma_f32_16x16x32_bf16 v[84:87], v[144:147], v[188:191], v[84:87]
    ds_read_b128 v[132:135], v16 offset:512
    v_mfma_f32_16x16x32_bf16 v[88:91], v[148:151], v[184:187], v[88:91]
    buffer_load_dwordx2 v[228:229], v21, s[8:11], s24 offen offset:0 sc1
    buffer_load_dwordx2 v[230:231], v21, s[8:11], s24 offen offset:128 sc1
    s_add_u32 s24, s24, 2048
    v_mfma_f32_16x16x32_bf16 v[92:95], v[148:151], v[188:191], v[92:95]
    buffer_load_dwordx2 v[232:233], v20, s[8:11], s24 offen offset:0 sc1
    buffer_load_dwordx2 v[234:235], v20, s[8:11], s24 offen offset:128 sc1
    v_mfma_f32_16x16x32_bf16 v[96:99], v[152:155], v[184:187], v[96:99]
    buffer_load_dwordx2 v[236:237], v21, s[8:11], s24 offen offset:0 sc1
    buffer_load_dwordx2 v[238:239], v21, s[8:11], s24 offen offset:128 sc1
    s_add_u32 s24, s24, 2048
    v_mfma_f32_16x16x32_bf16 v[100:103], v[152:155], v[188:191], v[100:103]
    v_mfma_f32_16x16x32_bf16 v[104:107], v[156:159], v[184:187], v[104:107]
    v_mfma_f32_16x16x32_bf16 v[108:111], v[156:159], v[188:191], v[108:111]
    s_waitcnt vmcnt(14)
    s_waitcnt lgkmcnt(0)
    v_mfma_f32_16x16x32_bf16 v[64:67], v[112:115], v[192:195], v[64:67]
    ds_read_b128 v[136:139], v12 offset:51200
    v_mfma_f32_16x16x32_bf16 v[68:71], v[112:115], v[196:199], v[68:71]
    ds_read_b128 v[140:143], v12 offset:52224
    v_mfma_f32_16x16x32_bf16 v[72:75], v[116:119], v[192:195], v[72:75]
    ds_read_b128 v[144:147], v12 offset:53248
    v_mfma_f32_16x16x32_bf16 v[76:79], v[116:119], v[196:199], v[76:79]
    ds_read_b128 v[148:151], v12 offset:54272
    v_mfma_f32_16x16x32_bf16 v[80:83], v[120:123], v[192:195], v[80:83]
    ds_read_b128 v[152:155], v12 offset:55296
    v_mfma_f32_16x16x32_bf16 v[84:87], v[120:123], v[196:199], v[84:87]
    ds_read_b128 v[156:159], v16 offset:640
    v_mfma_f32_16x16x32_bf16 v[88:91], v[124:127], v[192:195], v[88:91]
    v_mfma_f32_16x16x32_bf16 v[92:95], v[124:127], v[196:199], v[92:95]
    v_mfma_f32_16x16x32_bf16 v[96:99], v[128:131], v[192:195], v[96:99]
    v_mfma_f32_16x16x32_bf16 v[100:103], v[128:131], v[196:199], v[100:103]
    v_mfma_f32_16x16x32_bf16 v[104:107], v[132:135], v[192:195], v[104:107]
    v_mfma_f32_16x16x32_bf16 v[108:111], v[132:135], v[196:199], v[108:111]
    buffer_load_dword v24, v19, s[8:11], s23 offen sc1
    s_waitcnt vmcnt(13)
    s_waitcnt lgkmcnt(0)
    v_mfma_f32_16x16x32_bf16 v[64:67], v[136:139], v[200:203], v[64:67]
    ds_read_b128 v[112:115], v12 offset:61440
    v_mfma_f32_16x16x32_bf16 v[68:71], v[136:139], v[204:207], v[68:71]
    ds_read_b128 v[116:119], v12 offset:62464
    v_mfma_f32_16x16x32_bf16 v[72:75], v[140:143], v[200:203], v[72:75]
    ds_read_b128 v[120:123], v12 offset:63488
    v_mfma_f32_16x16x32_bf16 v[76:79], v[140:143], v[204:207], v[76:79]
    ds_read_b128 v[124:127], v12 offset:64512
    v_mfma_f32_16x16x32_bf16 v[80:83], v[144:147], v[200:203], v[80:83]
    ds_read_b128 v[128:131], v13 offset:0
    v_mfma_f32_16x16x32_bf16 v[84:87], v[144:147], v[204:207], v[84:87]
    ds_read_b128 v[132:135], v16 offset:768
    v_mfma_f32_16x16x32_bf16 v[88:91], v[148:151], v[200:203], v[88:91]
    v_mfma_f32_16x16x32_bf16 v[92:95], v[148:151], v[204:207], v[92:95]
    v_mfma_f32_16x16x32_bf16 v[96:99], v[152:155], v[200:203], v[96:99]
    v_mfma_f32_16x16x32_bf16 v[100:103], v[152:155], v[204:207], v[100:103]
    v_mfma_f32_16x16x32_bf16 v[104:107], v[156:159], v[200:203], v[104:107]
    v_mfma_f32_16x16x32_bf16 v[108:111], v[156:159], v[204:207], v[108:111]
    s_waitcnt vmcnt(11)
    s_waitcnt lgkmcnt(0)
    v_mfma_f32_16x16x32_bf16 v[64:67], v[112:115], v[208:211], v[64:67]
    ds_read_b128 v[136:139], v13 offset:6144
    v_mfma_f32_16x16x32_bf16 v[68:71], v[112:115], v[212:215], v[68:71]
    ds_read_b128 v[140:143], v13 offset:7168
    v_mfma_f32_16x16x32_bf16 v[72:75], v[116:119], v[208:211], v[72:75]
    ds_read_b128 v[144:147], v13 offset:8192
    v_mfma_f32_16x16x32_bf16 v[76:79], v[116:119], v[212:215], v[76:79]
    ds_read_b128 v[148:151], v13 offset:9216
    v_mfma_f32_16x16x32_bf16 v[80:83], v[120:123], v[208:211], v[80:83]
    ds_read_b128 v[152:155], v13 offset:10240
    v_mfma_f32_16x16x32_bf16 v[84:87], v[120:123], v[212:215], v[84:87]
    ds_read_b128 v[156:159], v16 offset:896
    v_mfma_f32_16x16x32_bf16 v[88:91], v[124:127], v[208:211], v[88:91]
    v_mfma_f32_16x16x32_bf16 v[92:95], v[124:127], v[212:215], v[92:95]
    v_mfma_f32_16x16x32_bf16 v[96:99], v[128:131], v[208:211], v[96:99]
    v_mfma_f32_16x16x32_bf16 v[100:103], v[128:131], v[212:215], v[100:103]
    v_mfma_f32_16x16x32_bf16 v[104:107], v[132:135], v[208:211], v[104:107]
    v_mfma_f32_16x16x32_bf16 v[108:111], v[132:135], v[212:215], v[108:111]
    s_waitcnt vmcnt(9)
    s_waitcnt lgkmcnt(0)
    v_mfma_f32_16x16x32_bf16 v[64:67], v[136:139], v[216:219], v[64:67]
    ds_read_b128 v[112:115], v13 offset:16384
    v_mfma_f32_16x16x32_bf16 v[68:71], v[136:139], v[220:223], v[68:71]
    ds_read_b128 v[116:119], v13 offset:17408
    v_mfma_f32_16x16x32_bf16 v[72:75], v[140:143], v[216:219], v[72:75]
    ds_read_b128 v[120:123], v13 offset:18432
    v_mfma_f32_16x16x32_bf16 v[76:79], v[140:143], v[220:223], v[76:79]
    ds_read_b128 v[124:127], v13 offset:19456
    v_mfma_f32_16x16x32_bf16 v[80:83], v[144:147], v[216:219], v[80:83]
    ds_read_b128 v[128:131], v13 offset:20480
    v_mfma_f32_16x16x32_bf16 v[84:87], v[144:147], v[220:223], v[84:87]
    ds_read_b128 v[132:135], v16 offset:1024
    v_mfma_f32_16x16x32_bf16 v[88:91], v[148:151], v[216:219], v[88:91]
    v_mfma_f32_16x16x32_bf16 v[92:95], v[148:151], v[220:223], v[92:95]
    v_mfma_f32_16x16x32_bf16 v[96:99], v[152:155], v[216:219], v[96:99]
    v_mfma_f32_16x16x32_bf16 v[100:103], v[152:155], v[220:223], v[100:103]
    v_mfma_f32_16x16x32_bf16 v[104:107], v[156:159], v[216:219], v[104:107]
    v_mfma_f32_16x16x32_bf16 v[108:111], v[156:159], v[220:223], v[108:111]
    s_waitcnt vmcnt(5)
    s_waitcnt lgkmcnt(0)
    v_mfma_f32_16x16x32_bf16 v[64:67], v[112:115], v[224:227], v[64:67]
    ds_read_b128 v[136:139], v13 offset:26624
    v_mfma_f32_16x16x32_bf16 v[68:71], v[112:115], v[228:231], v[68:71]
    ds_read_b128 v[140:143], v13 offset:27648
    v_mfma_f32_16x16x32_bf16 v[72:75], v[116:119], v[224:227], v[72:75]
    ds_read_b128 v[144:147], v13 offset:28672
    v_mfma_f32_16x16x32_bf16 v[76:79], v[116:119], v[228:231], v[76:79]
    ds_read_b128 v[148:151], v13 offset:29696
    v_mfma_f32_16x16x32_bf16 v[80:83], v[120:123], v[224:227], v[80:83]
    ds_read_b128 v[152:155], v13 offset:30720
    v_mfma_f32_16x16x32_bf16 v[84:87], v[120:123], v[228:231], v[84:87]
    ds_read_b128 v[156:159], v16 offset:1152
    v_mfma_f32_16x16x32_bf16 v[88:91], v[124:127], v[224:227], v[88:91]
    v_mfma_f32_16x16x32_bf16 v[92:95], v[124:127], v[228:231], v[92:95]
    v_mfma_f32_16x16x32_bf16 v[96:99], v[128:131], v[224:227], v[96:99]
    v_mfma_f32_16x16x32_bf16 v[100:103], v[128:131], v[228:231], v[100:103]
    v_mfma_f32_16x16x32_bf16 v[104:107], v[132:135], v[224:227], v[104:107]
    v_mfma_f32_16x16x32_bf16 v[108:111], v[132:135], v[228:231], v[108:111]
    s_waitcnt vmcnt(1)
    s_waitcnt lgkmcnt(0)
    v_mfma_f32_16x16x32_bf16 v[64:67], v[136:139], v[232:235], v[64:67]
    v_mfma_f32_16x16x32_bf16 v[68:71], v[136:139], v[236:239], v[68:71]
    v_mfma_f32_16x16x32_bf16 v[72:75], v[140:143], v[232:235], v[72:75]
    v_mfma_f32_16x16x32_bf16 v[76:79], v[140:143], v[236:239], v[76:79]
    v_mfma_f32_16x16x32_bf16 v[80:83], v[144:147], v[232:235], v[80:83]
    v_mfma_f32_16x16x32_bf16 v[84:87], v[144:147], v[236:239], v[84:87]
    v_mfma_f32_16x16x32_bf16 v[88:91], v[148:151], v[232:235], v[88:91]
    v_mfma_f32_16x16x32_bf16 v[92:95], v[148:151], v[236:239], v[92:95]
    v_mfma_f32_16x16x32_bf16 v[96:99], v[152:155], v[232:235], v[96:99]
    v_mfma_f32_16x16x32_bf16 v[100:103], v[152:155], v[236:239], v[100:103]
    v_mfma_f32_16x16x32_bf16 v[104:107], v[156:159], v[232:235], v[104:107]
    v_mfma_f32_16x16x32_bf16 v[108:111], v[156:159], v[236:239], v[108:111]
    s_cmp_eq_u32 s7, 1
    s_cbranch_scc1 p3_k1_90
    ds_write_b128 v6, v[80:83] offset:0
    ds_write_b128 v6, v[88:91] offset:1024
    ds_write_b128 v6, v[84:87] offset:2048
    ds_write_b128 v6, v[92:95] offset:3072
    s_nop 1
    v_mov_b32 v105, v108
    ds_write_b64 v6, v[104:105] offset:4096
    ds_read_b128 v[32:35], v17 offset:0
    ds_read_b128 v[36:39], v17 offset:2560
    ds_read_b128 v[40:43], v18 offset:128
    s_waitcnt lgkmcnt(0)
    s_barrier
    ds_read_b128 v[112:115], v6 offset:5120
    ds_read_b128 v[116:119], v6 offset:6144
    ds_read_b128 v[120:123], v6 offset:7168
    ds_read_b128 v[124:127], v6 offset:8192
    ds_read_b128 v[128:131], v6 offset:9216
    ds_read_b128 v[132:135], v6 offset:10240
    ds_read_b64 v[136:137], v6 offset:11264
    s_waitcnt vmcnt(0)
    v_mov_b32 v28, v24
    v_mov_b32 v26, v24
    v_lshlrev_b32 v144, 16, v32
    v_and_b32 v145, 0xffff0000, v32
    v_lshlrev_b32 v146, 16, v33
    v_and_b32 v147, 0xffff0000, v33
    v_lshlrev_b32 v148, 16, v34
    v_and_b32 v149, 0xffff0000, v34
    v_lshlrev_b32 v150, 16, v35
    v_and_b32 v151, 0xffff0000, v35
    v_lshlrev_b32 v152, 16, v36
    v_and_b32 v153, 0xffff0000, v36
    v_lshlrev_b32 v154, 16, v37
    v_and_b32 v155, 0xffff0000, v37
    v_lshlrev_b32 v156, 16, v38
    v_and_b32 v157, 0xffff0000, v38
    v_lshlrev_b32 v158, 16, v39
    v_and_b32 v159, 0xffff0000, v39
    v_lshlrev_b32 v160, 16, v40
    v_and_b32 v161, 0xffff0000, v40
    v_lshlrev_b32_e64 v162, 16, v41
    v_and_b32 v163, 0xffff0000, v41
    v_lshlrev_b32_e64 v164, 16, v42
    v_and_b32 v165, 0xffff0000, v42
    v_lshlrev_b32_e64 v166, 16, v43
    v_and_b32 v167, 0xffff0000, v43
    v_permlane16_swap_b32 v28, v26
    s_nop 0
    v_pk_add_f32 v[64:65], v[64:65], v[144:145]
    v_pk_add_f32 v[66:67], v[66:67], v[146:147]
    v_pk_add_f32 v[72:73], v[72:73], v[148:149]
    v_pk_add_f32 v[74:75], v[74:75], v[150:151]
    v_pk_add_f32 v[68:69], v[68:69], v[152:153]
    v_pk_add_f32 v[70:71], v[70:71], v[154:155]
    v_pk_add_f32 v[76:77], v[76:77], v[156:157]
    v_pk_add_f32 v[78:79], v[78:79], v[158:159]
    s_waitcnt lgkmcnt(0)
    v_add_f32 v136, v136, v104
    v_add_f32 v28, v28, v136
    v_add_f32 v137, v137, v105
    v_add_f32 v26, v26, v137
    v_cmp_eq_u32 vcc, 1, v5
    s_nop 1
    v_cndmask_b32 v24, v28, v26, vcc
    v_pk_add_f32 v[64:65], v[64:65], v[112:113]
    v_pk_add_f32 v[66:67], v[66:67], v[114:115]
    v_pk_add_f32 v[72:73], v[72:73], v[116:117]
    v_pk_add_f32 v[74:75], v[74:75], v[118:119]
    v_pk_add_f32 v[64:65], v[64:65], v[28:29] op_sel_hi:[1,0] neg_lo:[0,1] neg_hi:[0,1]
    v_pk_add_f32 v[66:67], v[66:67], v[28:29] op_sel_hi:[1,0] neg_lo:[0,1] neg_hi:[0,1]
    v_pk_add_f32 v[72:73], v[72:73], v[28:29] op_sel_hi:[1,0] neg_lo:[0,1] neg_hi:[0,1]
    v_pk_add_f32 v[74:75], v[74:75], v[28:29] op_sel_hi:[1,0] neg_lo:[0,1] neg_hi:[0,1]
    v_cvt_pk_bf16_f32 v112, v64, v65
    v_cvt_pk_bf16_f32 v113, v66, v67
    v_cvt_pk_bf16_f32 v114, v72, v73
    v_cvt_pk_bf16_f32 v115, v74, v75
    buffer_store_dwordx4 v[112:115], v22, s[8:11], s21 offen sc1
    v_pk_add_f32 v[68:69], v[68:69], v[120:121]
    v_pk_add_f32 v[70:71], v[70:71], v[122:123]
    v_pk_add_f32 v[76:77], v[76:77], v[124:125]
    v_pk_add_f32 v[78:79], v[78:79], v[126:127]
    v_pk_add_f32 v[68:69], v[68:69], v[26:27] op_sel_hi:[1,0] neg_lo:[0,1] neg_hi:[0,1]
    v_pk_add_f32 v[70:71], v[70:71], v[26:27] op_sel_hi:[1,0] neg_lo:[0,1] neg_hi:[0,1]
    v_pk_add_f32 v[76:77], v[76:77], v[26:27] op_sel_hi:[1,0] neg_lo:[0,1] neg_hi:[0,1]
    v_pk_add_f32 v[78:79], v[78:79], v[26:27] op_sel_hi:[1,0] neg_lo:[0,1] neg_hi:[0,1]
    v_cvt_pk_bf16_f32 v120, v68, v69
    v_cvt_pk_bf16_f32 v121, v70, v71
    v_cvt_pk_bf16_f32 v122, v76, v77
    v_cvt_pk_bf16_f32 v123, v78, v79
    buffer_store_dwordx4 v[120:123], v22, s[8:11], s26 offen sc1
    v_pk_add_f32 v[96:97], v[96:97], v[128:129]
    v_pk_add_f32 v[98:99], v[98:99], v[130:131]
    v_pk_add_f32 v[100:101], v[100:101], v[132:133]
    v_pk_add_f32 v[102:103], v[102:103], v[134:135]
    s_nop 0
    v_permlane16_swap_b32 v96, v100
    v_permlane16_swap_b32 v97, v101
    v_permlane16_swap_b32 v98, v102
    v_permlane16_swap_b32 v99, v103
    s_nop 0
    v_pk_add_f32 v[96:97], v[96:97], v[160:161]
    v_pk_add_f32 v[98:99], v[98:99], v[162:163]
    v_pk_add_f32 v[100:101], v[100:101], v[164:165]
    v_pk_add_f32 v[102:103], v[102:103], v[166:167]
    v_pk_add_f32 v[96:97], v[96:97], v[24:25] op_sel_hi:[1,0] neg_lo:[0,1] neg_hi:[0,1]
    v_pk_add_f32 v[98:99], v[98:99], v[24:25] op_sel_hi:[1,0] neg_lo:[0,1] neg_hi:[0,1]
    v_pk_add_f32 v[100:101], v[100:101], v[24:25] op_sel_hi:[1,0] neg_lo:[0,1] neg_hi:[0,1]
    v_pk_add_f32 v[102:103], v[102:103], v[24:25] op_sel_hi:[1,0] neg_lo:[0,1] neg_hi:[0,1]
    v_cvt_pk_bf16_f32 v128, v96, v97
    v_cvt_pk_bf16_f32 v129, v98, v99
    v_cvt_pk_bf16_f32 v130, v100, v101
    v_cvt_pk_bf16_f32 v131, v102, v103
    buffer_store_dwordx4 v[128:131], v30, s[8:11], s27 offen sc1
    v_pk_mul_f32 v[144:145], v[64:65], v[64:65]
    v_pk_fma_f32 v[144:145], v[66:67], v[66:67], v[144:145]
    v_pk_fma_f32 v[144:145], v[72:73], v[72:73], v[144:145]
    v_pk_fma_f32 v[144:145], v[74:75], v[74:75], v[144:145]
    v_pk_mul_f32 v[146:147], v[68:69], v[68:69]
    v_pk_fma_f32 v[146:147], v[70:71], v[70:71], v[146:147]
    v_pk_fma_f32 v[146:147], v[76:77], v[76:77], v[146:147]
    v_pk_fma_f32 v[146:147], v[78:79], v[78:79], v[146:147]
    v_pk_mul_f32 v[148:149], v[96:97], v[96:97]
    v_pk_fma_f32 v[148:149], v[98:99], v[98:99], v[148:149]
    v_pk_fma_f32 v[148:149], v[100:101], v[100:101], v[148:149]
    v_pk_fma_f32 v[148:149], v[102:103], v[102:103], v[148:149]
    v_add_f32 v144, v144, v145
    v_add_f32 v146, v146, v147
    v_add_f32 v148, v148, v149
    s_lshl_b32 s28, s5, 1
    s_add_u32 s28, s28, s7
    s_lshl_b32 s28, s28, 13
    v_permlane16_swap_b32 v144, v146
    v_add_f32 v144, v144, v146
    v_add_f32 v144, v144, v148
    v_mov_b32 v145, v144
    s_lshl_b32 s29, s20, 7
    s_add_u32 s28, s28, s29
    s_add_u32 s28, s28, 30199808
    v_permlane32_swap_b32 v144, v145
    v_add_f32 v144, v144, v145
    buffer_store_dword v144, v23, s[8:11], s28 offen sc1
    s_cmp_lg_u32 s5, 0
    s_cbranch_scc1 p3_nm_92
    s_add_u32 s28, s29, 30191616
    buffer_store_dword v24, v23, s[8:11], s28 offen sc1
p3_nm_92:
    s_branch p3_done_91
p3_k1_90:
    ds_write_b128 v6, v[64:67] offset:5120
    ds_write_b128 v6, v[72:75] offset:6144
    ds_write_b128 v6, v[68:71] offset:7168
    ds_write_b128 v6, v[76:79] offset:8192
    ds_write_b128 v6, v[96:99] offset:9216
    ds_write_b128 v6, v[100:103] offset:10240
    v_mov_b32 v105, v108
    ds_write_b64 v6, v[104:105] offset:11264
    ds_read_b128 v[32:35], v17 offset:0
    ds_read_b128 v[36:39], v17 offset:2560
    s_waitcnt lgkmcnt(0)
    s_barrier
    ds_read_b128 v[112:115], v6 offset:0
    ds_read_b128 v[116:119], v6 offset:1024
    ds_read_b128 v[120:123], v6 offset:2048
    ds_read_b128 v[124:127], v6 offset:3072
    ds_read_b64 v[136:137], v6 offset:4096
    s_waitcnt vmcnt(0)
    v_mov_b32 v28, v24
    v_mov_b32 v26, v24
    v_lshlrev_b32 v144, 16, v32
    v_and_b32 v145, 0xffff0000, v32
    v_lshlrev_b32 v146, 16, v33
    v_and_b32 v147, 0xffff0000, v33
    v_lshlrev_b32 v148, 16, v34
    v_and_b32 v149, 0xffff0000, v34
    v_lshlrev_b32 v150, 16, v35
    v_and_b32 v151, 0xffff0000, v35
    v_lshlrev_b32 v152, 16, v36
    v_and_b32 v153, 0xffff0000, v36
    v_lshlrev_b32_e64 v154, 16, v37
    v_and_b32 v155, 0xffff0000, v37
    v_lshlrev_b32_e64 v156, 16, v38
    v_and_b32 v157, 0xffff0000, v38
    v_lshlrev_b32_e64 v158, 16, v39
    v_and_b32 v159, 0xffff0000, v39
    v_permlane16_swap_b32 v28, v26
    s_nop 0
    v_pk_add_f32 v[80:81], v[80:81], v[144:145]
    v_pk_add_f32 v[82:83], v[82:83], v[146:147]
    v_pk_add_f32 v[88:89], v[88:89], v[148:149]
    v_pk_add_f32 v[90:91], v[90:91], v[150:151]
    v_pk_add_f32 v[84:85], v[84:85], v[152:153]
    v_pk_add_f32 v[86:87], v[86:87], v[154:155]
    v_pk_add_f32 v[92:93], v[92:93], v[156:157]
    v_pk_add_f32 v[94:95], v[94:95], v[158:159]
    s_waitcnt lgkmcnt(0)
    v_add_f32 v136, v136, v104
    v_add_f32 v28, v28, v136
    v_add_f32 v137, v137, v105
    v_add_f32 v26, v26, v137
    v_cmp_eq_u32 vcc, 1, v5
    s_nop 1
    v_cndmask_b32 v24, v28, v26, vcc
    v_pk_add_f32 v[80:81], v[80:81], v[112:113]
    v_pk_add_f32 v[82:83], v[82:83], v[114:115]
    v_pk_add_f32 v[88:89], v[88:89], v[116:117]
    v_pk_add_f32 v[90:91], v[90:91], v[118:119]
    v_pk_add_f32 v[80:81], v[80:81], v[28:29] op_sel_hi:[1,0] neg_lo:[0,1] neg_hi:[0,1]
    v_pk_add_f32 v[82:83], v[82:83], v[28:29] op_sel_hi:[1,0] neg_lo:[0,1] neg_hi:[0,1]
    v_pk_add_f32 v[88:89], v[88:89], v[28:29] op_sel_hi:[1,0] neg_lo:[0,1] neg_hi:[0,1]
    v_pk_add_f32 v[90:91], v[90:91], v[28:29] op_sel_hi:[1,0] neg_lo:[0,1] neg_hi:[0,1]
    v_cvt_pk_bf16_f32 v112, v80, v81
    v_cvt_pk_bf16_f32 v113, v82, v83
    v_cvt_pk_bf16_f32 v114, v88, v89
    v_cvt_pk_bf16_f32 v115, v90, v91
    buffer_store_dwordx4 v[112:115], v22, s[8:11], s21 offen sc1
    v_pk_add_f32 v[84:85], v[84:85], v[120:121]
    v_pk_add_f32 v[86:87], v[86:87], v[122:123]
    v_pk_add_f32 v[92:93], v[92:93], v[124:125]
    v_pk_add_f32 v[94:95], v[94:95], v[126:127]
    v_pk_add_f32 v[84:85], v[84:85], v[26:27] op_sel_hi:[1,0] neg_lo:[0,1] neg_hi:[0,1]
    v_pk_add_f32 v[86:87], v[86:87], v[26:27] op_sel_hi:[1,0] neg_lo:[0,1] neg_hi:[0,1]
    v_pk_add_f32 v[92:93], v[92:93], v[26:27] op_sel_hi:[1,0] neg_lo:[0,1] neg_hi:[0,1]
    v_pk_add_f32 v[94:95], v[94:95], v[26:27] op_sel_hi:[1,0] neg_lo:[0,1] neg_hi:[0,1]
    v_cvt_pk_bf16_f32 v120, v84, v85
    v_cvt_pk_bf16_f32 v121, v86, v87
    v_cvt_pk_bf16_f32 v122, v92, v93
    v_cvt_pk_bf16_f32 v123, v94, v95
    buffer_store_dwordx4 v[120:123], v22, s[8:11], s26 offen sc1
    v_pk_mul_f32 v[144:145], v[80:81], v[80:81]
    v_pk_fma_f32 v[144:145], v[82:83], v[82:83], v[144:145]
    v_pk_fma_f32 v[144:145], v[88:89], v[88:89], v[144:145]
    v_pk_fma_f32 v[144:145], v[90:91], v[90:91], v[144:145]
    v_pk_mul_f32 v[146:147], v[84:85], v[84:85]
    v_pk_fma_f32 v[146:147], v[86:87], v[86:87], v[146:147]
    v_pk_fma_f32 v[146:147], v[92:93], v[92:93], v[146:147]
    v_pk_fma_f32 v[146:147], v[94:95], v[94:95], v[146:147]
    v_add_f32 v144, v144, v145
    v_add_f32 v146, v146, v147
    s_lshl_b32 s28, s5, 1
    s_add_u32 s28, s28, s7
    s_lshl_b32 s28, s28, 13
    v_permlane16_swap_b32 v144, v146
    v_add_f32 v144, v144, v146
    v_mov_b32 v145, v144
    s_lshl_b32 s29, s20, 7
    s_add_u32 s28, s28, s29
    s_add_u32 s28, s28, 30199808
    v_permlane32_swap_b32 v144, v145
    v_add_f32 v144, v144, v145
    buffer_store_dword v144, v23, s[8:11], s28 offen sc1
p3_done_91:
    s_lshl_b32 s38, s4, 3
    s_add_u32 s38, s38, s5
    s_mul_i32 s38, s38, 128
    s_add_u32 s38, s38, 30601216
    s_and_b32 s6, s2, 1
    s_lshl_b32 s6, s6, 3
    s_bfe_u32 s4, s2, 0x30003
    s_add_u32 s4, s4, s6
    s_bfe_u32 s6, s2, 0x20001
    s_lshl_b32 s6, s6, 2
    s_lshr_b32 s5, s2, 6
    s_add_u32 s5, s5, s6
    s_and_b32 s6, s3, 1
    s_lshr_b32 s7, s3, 1
    s_lshl_b32 s28, s6, 12
    s_nop 0
    v_lshl_add_u32 v8, v0, 4, s28
    s_mul_i32 s28, s7, 6144
    v_lshl_add_u32 v12, v0, 4, s28
    v_add_u32 v9, 65536, v8
    v_add_u32 v10, 131072, v8
    v_add_u32 v13, 65536, v12
    v_add_u32 v14, 131072, v12
    v_and_b32_e64 v2, 15, v0
    v_bfe_u32 v5, v0, 4, 1
    v_lshrrev_b32 v6, 5, v0
    v_lshlrev_b32 v3, 4, v2
    v_lshl_add_u32 v7, v6, 9, v3
    v_lshl_add_u32 v7, v5, 8, v7
    v_lshl_add_u32 v3, v6, 10, v3
    v_lshl_add_u32 v3, v5, 9, v3
    v_lshlrev_b32 v3, 4, v0
    v_add_u32 v15, 49152, v3
    v_mul_u32_u24 v7, 49152, v5
    v_lshl_add_u32 v7, v6, 8, v7
    v_lshl_add_u32 v7, v2, 4, v7
    s_lshl_b32 s28, s4, 2
    s_lshl_b32 s29, s6, 1
    s_add_u32 s28, s28, s29
    s_add_u32 s28, s28, 0
    s_mul_i32 s28, s28, 98304
    s_mul_i32 s29, s5, 3072
    s_add_u32 s28, s28, s29
    s_add_u32 s28, s28, 15728640
    s_mul_i32 s29, s7, 2048
    s_add_u32 s20, s28, s29
    s_mul_i32 s29, s7, 512
    s_add_u32 s28, s28, s29
    s_add_u32 s22, s28, 1024
    s_lshl_b32 s28, s4, 2
    s_lshl_b32 s29, s6, 1
    s_add_u32 s28, s28, s29
    s_add_u32 s28, s28, 1
    s_mul_i32 s28, s28, 98304
    s_mul_i32 s29, s5, 3072
    s_add_u32 s28, s28, s29
    s_add_u32 s28, s28, 15728640
    s_mul_i32 s29, s7, 2048
    s_add_u32 s21, s28, s29
    s_mul_i32 s29, s7, 512
    s_add_u32 s28, s28, s29
    s_add_u32 s23, s28, 1024
    s_lshl_b32 s28, s6, 8
    s_add_u32 s28, s28, 159744
    v_lshl_add_u32 v4, v2, 2, s28
    v_mov_b32 v244, 114176
    v_mov_b32 v245, 1
    s_waitcnt vmcnt(0)
    s_mov_b64 exec, 1
    ds_add_rtn_u32 v245, v244, v245
    s_mov_b64 exec, -1
    s_waitcnt lgkmcnt(0)
    v_readfirstlane_b32 s28, v245
    s_nop 0
    s_cmp_lg_u32 s28, 3
    s_cbranch_scc1 nf_93
    v_mov_b32 v246, s58
    v_mov_b32 v247, 0
    s_mov_b64 exec, 1
    buffer_store_dword v246, v247, s[8:11], s38 offen sc1
    s_mov_b64 exec, -1
nf_93:
    v_and_b32 v248, 15, v0
    v_mul_u32_u24 v248, 128, v248
    s_lshr_b32 s39, s4, 0
    s_mul_i32 s39, s39, 2048
    s_add_u32 s39, s39, 30601216
    s_cmp_lg_u32 s3, 1
    s_cbranch_scc1 np_94
    s_mov_b32 s59, 0x40000
    s_mov_b64 exec, 0xffff
poll_95:
    v_mov_b32 v249, 0
    buffer_atomic_or v249, v248, s[8:11], s39 offen sc0 sc1
    s_waitcnt vmcnt(0)
    v_cmp_ne_u32 vcc, s58, v249
    s_sub_u32 s59, s59, 1
    s_nop 2
    s_cbranch_vccz pollok_96
    s_cmp_eq_u32 s59, 0
    s_cbranch_scc1 pollok_96
    s_sleep 1
    s_branch poll_95
pollok_96:
    s_mov_b64 exec, -1
np_94:
    s_barrier
    s_barrier
    ds_read_b128 v[160:163], v9 offset:32768
    ds_read_b128 v[176:179], v12 offset:0
    ds_read_b128 v[164:167], v9 offset:33792
    ds_read_b128 v[168:171], v9 offset:34816
    ds_read_b128 v[172:175], v9 offset:35840
    ds_read_b128 v[180:183], v12 offset:1024
    ds_read_b128 v[184:187], v12 offset:2048
    ds_read_b128 v[188:191], v12 offset:3072
    ds_read_b128 v[192:195], v12 offset:4096
    ds_read_b128 v[196:199], v12 offset:5120
    s_waitcnt lgkmcnt(0)
    v_mfma_f32_16x16x32_bf16 v[64:67], v[176:179], v[160:163], 0
    v_mfma_f32_16x16x32_bf16 v[68:71], v[176:179], v[164:167], 0
    s_barrier
    ds_read_b128 v[200:203], v9 offset:45056
    v_mfma_f32_16x16x32_bf16 v[72:75], v[176:179], v[168:171], 0
    ds_read_b128 v[216:219], v12 offset:12288
    v_mfma_f32_16x16x32_bf16 v[76:79], v[176:179], v[172:175], 0
    ds_read_b128 v[204:207], v9 offset:46080
    v_mfma_f32_16x16x32_bf16 v[80:83], v[180:183], v[160:163], 0
    ds_read_b128 v[208:211], v9 offset:47104
    v_mfma_f32_16x16x32_bf16 v[84:87], v[180:183], v[164:167], 0
    ds_read_b128 v[212:215], v9 offset:48128
    v_mfma_f32_16x16x32_bf16 v[88:91], v[180:183], v[168:171], 0
    ds_read_b128 v[220:223], v12 offset:13312
    v_mfma_f32_16x16x32_bf16 v[92:95], v[180:183], v[172:175], 0
    ds_read_b128 v[224:227], v12 offset:14336
    v_mfma_f32_16x16x32_bf16 v[96:99], v[184:187], v[160:163], 0
    ds_read_b128 v[228:231], v12 offset:15360
    v_mfma_f32_16x16x32_bf16 v[100:103], v[184:187], v[164:167], 0
    ds_read_b128 v[232:235], v12 offset:16384
    v_mfma_f32_16x16x32_bf16 v[104:107], v[184:187], v[168:171], 0
    ds_read_b128 v[236:239], v12 offset:17408
    v_mfma_f32_16x16x32_bf16 v[108:111], v[184:187], v[172:175], 0
    v_mfma_f32_16x16x32_bf16 v[112:115], v[188:191], v[160:163], 0
    v_mfma_f32_16x16x32_bf16 v[116:119], v[188:191], v[164:167], 0
    v_mfma_f32_16x16x32_bf16 v[120:123], v[188:191], v[168:171], 0
    v_mfma_f32_16x16x32_bf16 v[124:127], v[188:191], v[172:175], 0
    v_mfma_f32_16x16x32_bf16 v[128:131], v[192:195], v[160:163], 0
    v_mfma_f32_16x16x32_bf16 v[132:135], v[192:195], v[164:167], 0
    v_mfma_f32_16x16x32_bf16 v[136:139], v[192:195], v[168:171], 0
    v_mfma_f32_16x16x32_bf16 v[140:143], v[192:195], v[172:175], 0
    v_mfma_f32_16x16x32_bf16 v[144:147], v[196:199], v[160:163], 0
    v_mfma_f32_16x16x32_bf16 v[148:151], v[196:199], v[164:167], 0
    v_mfma_f32_16x16x32_bf16 v[152:155], v[196:199], v[168:171], 0
    v_mfma_f32_16x16x32_bf16 v[156:159], v[196:199], v[172:175], 0
    s_waitcnt lgkmcnt(0)
    v_mfma_f32_16x16x32_bf16 v[64:67], v[216:219], v[200:203], v[64:67]
    v_mfma_f32_16x16x32_bf16 v[68:71], v[216:219], v[204:207], v[68:71]
    s_barrier
    ds_read_b128 v[160:163], v9 offset:57344
    v_mfma_f32_16x16x32_bf16 v[72:75], v[216:219], v[208:211], v[72:75]
    ds_read_b128 v[176:179], v12 offset:24576
    v_mfma_f32_16x16x32_bf16 v[76:79], v[216:219], v[212:215], v[76:79]
    ds_read_b128 v[164:167], v9 offset:58368
    v_mfma_f32_16x16x32_bf16 v[80:83], v[220:223], v[200:203], v[80:83]
    ds_read_b128 v[168:171], v9 offset:59392
    v_mfma_f32_16x16x32_bf16 v[84:87], v[220:223], v[204:207], v[84:87]
    ds_read_b128 v[172:175], v9 offset:60416
    v_mfma_f32_16x16x32_bf16 v[88:91], v[220:223], v[208:211], v[88:91]
    ds_read_b128 v[180:183], v12 offset:25600
    v_mfma_f32_16x16x32_bf16 v[92:95], v[220:223], v[212:215], v[92:95]
    ds_read_b128 v[184:187], v12 offset:26624
    v_mfma_f32_16x16x32_bf16 v[96:99], v[224:227], v[200:203], v[96:99]
    ds_read_b128 v[188:191], v12 offset:27648
    v_mfma_f32_16x16x32_bf16 v[100:103], v[224:227], v[204:207], v[100:103]
    ds_read_b128 v[192:195], v12 offset:28672
    v_mfma_f32_16x16x32_bf16 v[104:107], v[224:227], v[208:211], v[104:107]
    ds_read_b128 v[196:199], v12 offset:29696
    v_mfma_f32_16x16x32_bf16 v[108:111], v[224:227], v[212:215], v[108:111]
    v_mfma_f32_16x16x32_bf16 v[112:115], v[228:231], v[200:203], v[112:115]
    v_mfma_f32_16x16x32_bf16 v[116:119], v[228:231], v[204:207], v[116:119]
    v_mfma_f32_16x16x32_bf16 v[120:123], v[228:231], v[208:211], v[120:123]
    v_mfma_f32_16x16x32_bf16 v[124:127], v[228:231], v[212:215], v[124:127]
    v_mfma_f32_16x16x32_bf16 v[128:131], v[232:235], v[200:203], v[128:131]
    v_mfma_f32_16x16x32_bf16 v[132:135], v[232:235], v[204:207], v[132:135]
    v_mfma_f32_16x16x32_bf16 v[136:139], v[232:235], v[208:211], v[136:139]
    v_mfma_f32_16x16x32_bf16 v[140:143], v[232:235], v[212:215], v[140:143]
    v_mfma_f32_16x16x32_bf16 v[144:147], v[236:239], v[200:203], v[144:147]
    v_mfma_f32_16x16x32_bf16 v[148:151], v[236:239], v[204:207], v[148:151]
    v_mfma_f32_16x16x32_bf16 v[152:155], v[236:239], v[208:211], v[152:155]
    v_mfma_f32_16x16x32_bf16 v[156:159], v[236:239], v[212:215], v[156:159]
    s_waitcnt lgkmcnt(0)
    v_mfma_f32_16x16x32_bf16 v[64:67], v[176:179], v[160:163], v[64:67]
    v_mfma_f32_16x16x32_bf16 v[68:71], v[176:179], v[164:167], v[68:71]
    s_barrier
    ds_read_b128 v[200:203], v10 offset:4096
    v_mfma_f32_16x16x32_bf16 v[72:75], v[176:179], v[168:171], v[72:75]
    ds_read_b128 v[216:219], v12 offset:36864
    v_mfma_f32_16x16x32_bf16 v[76:79], v[176:179], v[172:175], v[76:79]
    ds_read_b128 v[204:207], v10 offset:5120
    v_mfma_f32_16x16x32_bf16 v[80:83], v[180:183], v[160:163], v[80:83]
    ds_read_b128 v[208:211], v10 offset:6144
    v_mfma_f32_16x16x32_bf16 v[84:87], v[180:183], v[164:167], v[84:87]
    ds_read_b128 v[212:215], v10 offset:7168
    v_mfma_f32_16x16x32_bf16 v[88:91], v[180:183], v[168:171], v[88:91]
    ds_read_b128 v[220:223], v12 offset:37888
    v_mfma_f32_16x16x32_bf16 v[92:95], v[180:183], v[172:175], v[92:95]
    ds_read_b128 v[224:227], v12 offset:38912
    v_mfma_f32_16x16x32_bf16 v[96:99], v[184:187], v[160:163], v[96:99]
    ds_read_b128 v[228:231], v12 offset:39936
    v_mfma_f32_16x16x32_bf16 v[100:103], v[184:187], v[164:167], v[100:103]
    ds_read_b128 v[232:235], v12 offset:40960
    v_mfma_f32_16x16x32_bf16 v[104:107], v[184:187], v[168:171], v[104:107]
    ds_read_b128 v[236:239], v12 offset:41984
    v_mfma_f32_16x16x32_bf16 v[108:111], v[184:187], v[172:175], v[108:111]
    v_mfma_f32_16x16x32_bf16 v[112:115], v[188:191], v[160:163], v[112:115]
    v_mfma_f32_16x16x32_bf16 v[116:119], v[188:191], v[164:167], v[116:119]
    v_mfma_f32_16x16x32_bf16 v[120:123], v[188:191], v[168:171], v[120:123]
    v_mfma_f32_16x16x32_bf16 v[124:127], v[188:191], v[172:175], v[124:127]
    v_mfma_f32_16x16x32_bf16 v[128:131], v[192:195], v[160:163], v[128:131]
    v_mfma_f32_16x16x32_bf16 v[132:135], v[192:195], v[164:167], v[132:135]
    v_mfma_f32_16x16x32_bf16 v[136:139], v[192:195], v[168:171], v[136:139]
    v_mfma_f32_16x16x32_bf16 v[140:143], v[192:195], v[172:175], v[140:143]
    v_mfma_f32_16x16x32_bf16 v[144:147], v[196:199], v[160:163], v[144:147]
    v_mfma_f32_16x16x32_bf16 v[148:151], v[196:199], v[164:167], v[148:151]
    v_mfma_f32_16x16x32_bf16 v[152:155], v[196:199], v[168:171], v[152:155]
    v_mfma_f32_16x16x32_bf16 v[156:159], v[196:199], v[172:175], v[156:159]
    s_waitcnt lgkmcnt(0)
    v_mfma_f32_16x16x32_bf16 v[64:67], v[216:219], v[200:203], v[64:67]
    v_mfma_f32_16x16x32_bf16 v[68:71], v[216:219], v[204:207], v[68:71]
    s_barrier
    ds_read_b128 v[160:163], v10 offset:16384
    v_mfma_f32_16x16x32_bf16 v[72:75], v[216:219], v[208:211], v[72:75]
    ds_read_b128 v[176:179], v12 offset:49152
    v_mfma_f32_16x16x32_bf16 v[76:79], v[216:219], v[212:215], v[76:79]
    ds_read_b128 v[164:167], v10 offset:17408
    v_mfma_f32_16x16x32_bf16 v[80:83], v[220:223], v[200:203], v[80:83]
    ds_read_b128 v[168:171], v10 offset:18432
    v_mfma_f32_16x16x32_bf16 v[84:87], v[220:223], v[204:207], v[84:87]
    ds_read_b128 v[172:175], v10 offset:19456
    v_mfma_f32_16x16x32_bf16 v[88:91], v[220:223], v[208:211], v[88:91]
    ds_read_b128 v[180:183], v12 offset:50176
    v_mfma_f32_16x16x32_bf16 v[92:95], v[220:223], v[212:215], v[92:95]
    ds_read_b128 v[184:187], v12 offset:51200
    v_mfma_f32_16x16x32_bf16 v[96:99], v[224:227], v[200:203], v[96:99]
    ds_read_b128 v[188:191], v12 offset:52224
    v_mfma_f32_16x16x32_bf16 v[100:103], v[224:227], v[204:207], v[100:103]
    ds_read_b128 v[192:195], v12 offset:53248
    v_mfma_f32_16x16x32_bf16 v[104:107], v[224:227], v[208:211], v[104:107]
    ds_read_b128 v[196:199], v12 offset:54272
    v_mfma_f32_16x16x32_bf16 v[108:111], v[224:227], v[212:215], v[108:111]
    v_mfma_f32_16x16x32_bf16 v[112:115], v[228:231], v[200:203], v[112:115]
    v_mfma_f32_16x16x32_bf16 v[116:119], v[228:231], v[204:207], v[116:119]
    v_mfma_f32_16x16x32_bf16 v[120:123], v[228:231], v[208:211], v[120:123]
    v_mfma_f32_16x16x32_bf16 v[124:127], v[228:231], v[212:215], v[124:127]
    v_mfma_f32_16x16x32_bf16 v[128:131], v[232:235], v[200:203], v[128:131]
    v_mfma_f32_16x16x32_bf16 v[132:135], v[232:235], v[204:207], v[132:135]
    v_mfma_f32_16x16x32_bf16 v[136:139], v[232:235], v[208:211], v[136:139]
    v_mfma_f32_16x16x32_bf16 v[140:143], v[232:235], v[212:215], v[140:143]
    v_mfma_f32_16x16x32_bf16 v[144:147], v[236:239], v[200:203], v[144:147]
    v_mfma_f32_16x16x32_bf16 v[148:151], v[236:239], v[204:207], v[148:151]
    v_mfma_f32_16x16x32_bf16 v[152:155], v[236:239], v[208:211], v[152:155]
    v_mfma_f32_16x16x32_bf16 v[156:159], v[236:239], v[212:215], v[156:159]
    s_waitcnt lgkmcnt(0)
    v_mfma_f32_16x16x32_bf16 v[64:67], v[176:179], v[160:163], v[64:67]
    v_mfma_f32_16x16x32_bf16 v[68:71], v[176:179], v[164:167], v[68:71]
    s_barrier
    ds_read_b128 v[200:203], v8 offset:0
    v_mfma_f32_16x16x32_bf16 v[72:75], v[176:179], v[168:171], v[72:75]
    ds_read_b128 v[216:219], v12 offset:61440
    v_mfma_f32_16x16x32_bf16 v[76:79], v[176:179], v[172:175], v[76:79]
    ds_read_b128 v[204:207], v8 offset:1024
    v_mfma_f32_16x16x32_bf16 v[80:83], v[180:183], v[160:163], v[80:83]
    ds_read_b128 v[208:211], v8 offset:2048
    v_mfma_f32_16x16x32_bf16 v[84:87], v[180:183], v[164:167], v[84:87]
    ds_read_b128 v[212:215], v8 offset:3072
    v_mfma_f32_16x16x32_bf16 v[88:91], v[180:183], v[168:171], v[88:91]
    ds_read_b128 v[220:223], v12 offset:62464
    v_mfma_f32_16x16x32_bf16 v[92:95], v[180:183], v[172:175], v[92:95]
    ds_read_b128 v[224:227], v12 offset:63488
    v_mfma_f32_16x16x32_bf16 v[96:99], v[184:187], v[160:163], v[96:99]
    ds_read_b128 v[228:231], v12 offset:64512
    v_mfma_f32_16x16x32_bf16 v[100:103], v[184:187], v[164:167], v[100:103]
    ds_read_b128 v[232:235], v13 offset:0
    v_mfma_f32_16x16x32_bf16 v[104:107], v[184:187], v[168:171], v[104:107]
    ds_read_b128 v[236:239], v13 offset:1024
    v_mfma_f32_16x16x32_bf16 v[108:111], v[184:187], v[172:175], v[108:111]
    v_mfma_f32_16x16x32_bf16 v[112:115], v[188:191], v[160:163], v[112:115]
    v_mfma_f32_16x16x32_bf16 v[116:119], v[188:191], v[164:167], v[116:119]
    v_mfma_f32_16x16x32_bf16 v[120:123], v[188:191], v[168:171], v[120:123]
    v_mfma_f32_16x16x32_bf16 v[124:127], v[188:191], v[172:175], v[124:127]
    v_mfma_f32_16x16x32_bf16 v[128:131], v[192:195], v[160:163], v[128:131]
    v_mfma_f32_16x16x32_bf16 v[132:135], v[192:195], v[164:167], v[132:135]
    v_mfma_f32_16x16x32_bf16 v[136:139], v[192:195], v[168:171], v[136:139]
    v_mfma_f32_16x16x32_bf16 v[140:143], v[192:195], v[172:175], v[140:143]
    v_mfma_f32_16x16x32_bf16 v[144:147], v[196:199], v[160:163], v[144:147]
    v_mfma_f32_16x16x32_bf16 v[148:151], v[196:199], v[164:167], v[148:151]
    v_mfma_f32_16x16x32_bf16 v[152:155], v[196:199], v[168:171], v[152:155]
    v_mfma_f32_16x16x32_bf16 v[156:159], v[196:199], v[172:175], v[156:159]
    s_waitcnt lgkmcnt(0)
    v_mfma_f32_16x16x32_bf16 v[64:67], v[216:219], v[200:203], v[64:67]
    v_mfma_f32_16x16x32_bf16 v[68:71], v[216:219], v[204:207], v[68:71]
    s_barrier
    ds_read_b128 v[160:163], v9 offset:32768
    v_mfma_f32_16x16x32_bf16 v[72:75], v[216:219], v[208:211], v[72:75]
    ds_read_b128 v[176:179], v13 offset:8192
    v_mfma_f32_16x16x32_bf16 v[76:79], v[216:219], v[212:215], v[76:79]
    ds_read_b128 v[164:167], v9 offset:33792
    v_mfma_f32_16x16x32_bf16 v[80:83], v[220:223], v[200:203], v[80:83]
    ds_read_b128 v[168:171], v9 offset:34816
    v_mfma_f32_16x16x32_bf16 v[84:87], v[220:223], v[204:207], v[84:87]
    ds_read_b128 v[172:175], v9 offset:35840
    v_mfma_f32_16x16x32_bf16 v[88:91], v[220:223], v[208:211], v[88:91]
    ds_read_b128 v[180:183], v13 offset:9216
    v_mfma_f32_16x16x32_bf16 v[92:95], v[220:223], v[212:215], v[92:95]
    ds_read_b128 v[184:187], v13 offset:10240
    v_mfma_f32_16x16x32_bf16 v[96:99], v[224:227], v[200:203], v[96:99]
    ds_read_b128 v[188:191], v13 offset:11264
    v_mfma_f32_16x16x32_bf16 v[100:103], v[224:227], v[204:207], v[100:103]
    ds_read_b128 v[192:195], v13 offset:12288
    v_mfma_f32_16x16x32_bf16 v[104:107], v[224:227], v[208:211], v[104:107]
    ds_read_b128 v[196:199], v13 offset:13312
    v_mfma_f32_16x16x32_bf16 v[108:111], v[224:227], v[212:215], v[108:111]
    v_mfma_f32_16x16x32_bf16 v[112:115], v[228:231], v[200:203], v[112:115]
    v_mfma_f32_16x16x32_bf16 v[116:119], v[228:231], v[204:207], v[116:119]
    v_mfma_f32_16x16x32_bf16 v[120:123], v[228:231], v[208:211], v[120:123]
    v_mfma_f32_16x16x32_bf16 v[124:127], v[228:231], v[212:215], v[124:127]
    v_mfma_f32_16x16x32_bf16 v[128:131], v[232:235], v[200:203], v[128:131]
    v_mfma_f32_16x16x32_bf16 v[132:135], v[232:235], v[204:207], v[132:135]
    v_mfma_f32_16x16x32_bf16 v[136:139], v[232:235], v[208:211], v[136:139]
    v_mfma_f32_16x16x32_bf16 v[140:143], v[232:235], v[212:215], v[140:143]
    v_mfma_f32_16x16x32_bf16 v[144:147], v[236:239], v[200:203], v[144:147]
    v_mfma_f32_16x16x32_bf16 v[148:151], v[236:239], v[204:207], v[148:151]
    v_mfma_f32_16x16x32_bf16 v[152:155], v[236:239], v[208:211], v[152:155]
    v_mfma_f32_16x16x32_bf16 v[156:159], v[236:239], v[212:215], v[156:159]
    s_waitcnt lgkmcnt(0)
    v_mfma_f32_16x16x32_bf16 v[64:67], v[176:179], v[160:163], v[64:67]
    v_mfma_f32_16x16x32_bf16 v[68:71], v[176:179], v[164:167], v[68:71]
    s_barrier
    ds_read_b128 v[200:203], v8 offset:12288
    v_mfma_f32_16x16x32_bf16 v[72:75], v[176:179], v[168:171], v[72:75]
    ds_read_b128 v[216:219], v13 offset:20480
    v_mfma_f32_16x16x32_bf16 v[76:79], v[176:179], v[172:175], v[76:79]
    ds_read_b128 v[204:207], v8 offset:13312
    v_mfma_f32_16x16x32_bf16 v[80:83], v[180:183], v[160:163], v[80:83]
    ds_read_b128 v[208:211], v8 offset:14336
    v_mfma_f32_16x16x32_bf16 v[84:87], v[180:183], v[164:167], v[84:87]
    ds_read_b128 v[212:215], v8 offset:15360
    v_mfma_f32_16x16x32_bf16 v[88:91], v[180:183], v[168:171], v[88:91]
    ds_read_b128 v[220:223], v13 offset:21504
    v_mfma_f32_16x16x32_bf16 v[92:95], v[180:183], v[172:175], v[92:95]
    ds_read_b128 v[224:227], v13 offset:22528
    v_mfma_f32_16x16x32_bf16 v[96:99], v[184:187], v[160:163], v[96:99]
    ds_read_b128 v[228:231], v13 offset:23552
    v_mfma_f32_16x16x32_bf16 v[100:103], v[184:187], v[164:167], v[100:103]
    ds_read_b128 v[232:235], v13 offset:24576
    v_mfma_f32_16x16x32_bf16 v[104:107], v[184:187], v[168:171], v[104:107]
    ds_read_b128 v[236:239], v13 offset:25600
    v_mfma_f32_16x16x32_bf16 v[108:111], v[184:187], v[172:175], v[108:111]
    v_mfma_f32_16x16x32_bf16 v[112:115], v[188:191], v[160:163], v[112:115]
    v_mfma_f32_16x16x32_bf16 v[116:119], v[188:191], v[164:167], v[116:119]
    v_mfma_f32_16x16x32_bf16 v[120:123], v[188:191], v[168:171], v[120:123]
    v_mfma_f32_16x16x32_bf16 v[124:127], v[188:191], v[172:175], v[124:127]
    v_mfma_f32_16x16x32_bf16 v[128:131], v[192:195], v[160:163], v[128:131]
    v_mfma_f32_16x16x32_bf16 v[132:135], v[192:195], v[164:167], v[132:135]
    v_mfma_f32_16x16x32_bf16 v[136:139], v[192:195], v[168:171], v[136:139]
    v_mfma_f32_16x16x32_bf16 v[140:143], v[192:195], v[172:175], v[140:143]
    v_mfma_f32_16x16x32_bf16 v[144:147], v[196:199], v[160:163], v[144:147]
    v_mfma_f32_16x16x32_bf16 v[148:151], v[196:199], v[164:167], v[148:151]
    v_mfma_f32_16x16x32_bf16 v[152:155], v[196:199], v[168:171], v[152:155]
    v_mfma_f32_16x16x32_bf16 v[156:159], v[196:199], v[172:175], v[156:159]
    s_waitcnt lgkmcnt(0)
    v_mfma_f32_16x16x32_bf16 v[64:67], v[216:219], v[200:203], v[64:67]
    v_mfma_f32_16x16x32_bf16 v[68:71], v[216:219], v[204:207], v[68:71]
    s_barrier
    ds_read_b128 v[160:163], v9 offset:45056
    v_mfma_f32_16x16x32_bf16 v[72:75], v[216:219], v[208:211], v[72:75]
    ds_read_b128 v[176:179], v13 offset:57344
    v_mfma_f32_16x16x32_bf16 v[76:79], v[216:219], v[212:215], v[76:79]
    ds_read_b128 v[164:167], v9 offset:46080
    v_mfma_f32_16x16x32_bf16 v[80:83], v[220:223], v[200:203], v[80:83]
    ds_read_b128 v[168:171], v9 offset:47104
    v_mfma_f32_16x16x32_bf16 v[84:87], v[220:223], v[204:207], v[84:87]
    ds_read_b128 v[172:175], v9 offset:48128
    v_mfma_f32_16x16x32_bf16 v[88:91], v[220:223], v[208:211], v[88:91]
    ds_read_b128 v[180:183], v13 offset:58368
    v_mfma_f32_16x16x32_bf16 v[92:95], v[220:223], v[212:215], v[92:95]
    ds_read_b128 v[184:187], v13 offset:59392
    v_mfma_f32_16x16x32_bf16 v[96:99], v[224:227], v[200:203], v[96:99]
    ds_read_b128 v[188:191], v13 offset:60416
    v_mfma_f32_16x16x32_bf16 v[100:103], v[224:227], v[204:207], v[100:103]
    ds_read_b128 v[192:195], v13 offset:61440
    v_mfma_f32_16x16x32_bf16 v[104:107], v[224:227], v[208:211], v[104:107]
    ds_read_b128 v[196:199], v13 offset:62464
    v_mfma_f32_16x16x32_bf16 v[108:111], v[224:227], v[212:215], v[108:111]
    v_mfma_f32_16x16x32_bf16 v[112:115], v[228:231], v[200:203], v[112:115]
    v_mfma_f32_16x16x32_bf16 v[116:119], v[228:231], v[204:207], v[116:119]
    v_mfma_f32_16x16x32_bf16 v[120:123], v[228:231], v[208:211], v[120:123]
    v_mfma_f32_16x16x32_bf16 v[124:127], v[228:231], v[212:215], v[124:127]
    v_mfma_f32_16x16x32_bf16 v[128:131], v[232:235], v[200:203], v[128:131]
    v_mfma_f32_16x16x32_bf16 v[132:135], v[232:235], v[204:207], v[132:135]
    v_mfma_f32_16x16x32_bf16 v[136:139], v[232:235], v[208:211], v[136:139]
    v_mfma_f32_16x16x32_bf16 v[140:143], v[232:235], v[212:215], v[140:143]
    v_mfma_f32_16x16x32_bf16 v[144:147], v[236:239], v[200:203], v[144:147]
    v_mfma_f32_16x16x32_bf16 v[148:151], v[236:239], v[204:207], v[148:151]
    v_mfma_f32_16x16x32_bf16 v[152:155], v[236:239], v[208:211], v[152:155]
    v_mfma_f32_16x16x32_bf16 v[156:159], v[236:239], v[212:215], v[156:159]
    s_waitcnt lgkmcnt(0)
    v_mfma_f32_16x16x32_bf16 v[64:67], v[176:179], v[160:163], v[64:67]
    v_mfma_f32_16x16x32_bf16 v[68:71], v[176:179], v[164:167], v[68:71]
    s_barrier
    ds_read_b128 v[200:203], v8 offset:24576
    v_mfma_f32_16x16x32_bf16 v[72:75], v[176:179], v[168:171], v[72:75]
    ds_read_b128 v[216:219], v14 offset:4096
    v_mfma_f32_16x16x32_bf16 v[76:79], v[176:179], v[172:175], v[76:79]
    ds_read_b128 v[204:207], v8 offset:25600
    v_mfma_f32_16x16x32_bf16 v[80:83], v[180:183], v[160:163], v[80:83]
    ds_read_b128 v[208:211], v8 offset:26624
    v_mfma_f32_16x16x32_bf16 v[84:87], v[180:183], v[164:167], v[84:87]
    ds_read_b128 v[212:215], v8 offset:27648
    v_mfma_f32_16x16x32_bf16 v[88:91], v[180:183], v[168:171], v[88:91]
    ds_read_b128 v[220:223], v14 offset:5120
    v_mfma_f32_16x16x32_bf16 v[92:95], v[180:183], v[172:175], v[92:95]
    ds_read_b128 v[224:227], v14 offset:6144
    v_mfma_f32_16x16x32_bf16 v[96:99], v[184:187], v[160:163], v[96:99]
    ds_read_b128 v[228:231], v14 offset:7168
    v_mfma_f32_16x16x32_bf16 v[100:103], v[184:187], v[164:167], v[100:103]
    ds_read_b128 v[232:235], v14 offset:8192
    v_mfma_f32_16x16x32_bf16 v[104:107], v[184:187], v[168:171], v[104:107]
    ds_read_b128 v[236:239], v14 offset:9216
    v_mfma_f32_16x16x32_bf16 v[108:111], v[184:187], v[172:175], v[108:111]
    v_mfma_f32_16x16x32_bf16 v[112:115], v[188:191], v[160:163], v[112:115]
    v_mfma_f32_16x16x32_bf16 v[116:119], v[188:191], v[164:167], v[116:119]
    v_mfma_f32_16x16x32_bf16 v[120:123], v[188:191], v[168:171], v[120:123]
    v_mfma_f32_16x16x32_bf16 v[124:127], v[188:191], v[172:175], v[124:127]
    v_mfma_f32_16x16x32_bf16 v[128:131], v[192:195], v[160:163], v[128:131]
    v_mfma_f32_16x16x32_bf16 v[132:135], v[192:195], v[164:167], v[132:135]
    v_mfma_f32_16x16x32_bf16 v[136:139], v[192:195], v[168:171], v[136:139]
    v_mfma_f32_16x16x32_bf16 v[140:143], v[192:195], v[172:175], v[140:143]
    v_mfma_f32_16x16x32_bf16 v[144:147], v[196:199], v[160:163], v[144:147]
    v_mfma_f32_16x16x32_bf16 v[148:151], v[196:199], v[164:167], v[148:151]
    v_mfma_f32_16x16x32_bf16 v[152:155], v[196:199], v[168:171], v[152:155]
    v_mfma_f32_16x16x32_bf16 v[156:159], v[196:199], v[172:175], v[156:159]
    s_waitcnt lgkmcnt(0)
    v_mfma_f32_16x16x32_bf16 v[64:67], v[216:219], v[200:203], v[64:67]
    v_mfma_f32_16x16x32_bf16 v[68:71], v[216:219], v[204:207], v[68:71]
    s_barrier
    ds_read_b128 v[160:163], v8 offset:36864
    v_mfma_f32_16x16x32_bf16 v[72:75], v[216:219], v[208:211], v[72:75]
    ds_read_b128 v[176:179], v14 offset:16384
    v_mfma_f32_16x16x32_bf16 v[76:79], v[216:219], v[212:215], v[76:79]
    ds_read_b128 v[164:167], v8 offset:37888
    v_mfma_f32_16x16x32_bf16 v[80:83], v[220:223], v[200:203], v[80:83]
    ds_read_b128 v[168:171], v8 offset:38912
    v_mfma_f32_16x16x32_bf16 v[84:87], v[220:223], v[204:207], v[84:87]
    ds_read_b128 v[172:175], v8 offset:39936
    v_mfma_f32_16x16x32_bf16 v[88:91], v[220:223], v[208:211], v[88:91]
    ds_read_b128 v[180:183], v14 offset:17408
    v_mfma_f32_16x16x32_bf16 v[92:95], v[220:223], v[212:215], v[92:95]
    ds_read_b128 v[184:187], v14 offset:18432
    v_mfma_f32_16x16x32_bf16 v[96:99], v[224:227], v[200:203], v[96:99]
    ds_read_b128 v[188:191], v14 offset:19456
    v_mfma_f32_16x16x32_bf16 v[100:103], v[224:227], v[204:207], v[100:103]
    ds_read_b128 v[192:195], v14 offset:20480
    v_mfma_f32_16x16x32_bf16 v[104:107], v[224:227], v[208:211], v[104:107]
    ds_read_b128 v[196:199], v14 offset:21504
    v_mfma_f32_16x16x32_bf16 v[108:111], v[224:227], v[212:215], v[108:111]
    v_mfma_f32_16x16x32_bf16 v[112:115], v[228:231], v[200:203], v[112:115]
    v_mfma_f32_16x16x32_bf16 v[116:119], v[228:231], v[204:207], v[116:119]
    v_mfma_f32_16x16x32_bf16 v[120:123], v[228:231], v[208:211], v[120:123]
    v_mfma_f32_16x16x32_bf16 v[124:127], v[228:231], v[212:215], v[124:127]
    v_mfma_f32_16x16x32_bf16 v[128:131], v[232:235], v[200:203], v[128:131]
    v_mfma_f32_16x16x32_bf16 v[132:135], v[232:235], v[204:207], v[132:135]
    v_mfma_f32_16x16x32_bf16 v[136:139], v[232:235], v[208:211], v[136:139]
    v_mfma_f32_16x16x32_bf16 v[140:143], v[232:235], v[212:215], v[140:143]
    v_mfma_f32_16x16x32_bf16 v[144:147], v[236:239], v[200:203], v[144:147]
    v_mfma_f32_16x16x32_bf16 v[148:151], v[236:239], v[204:207], v[148:151]
    v_mfma_f32_16x16x32_bf16 v[152:155], v[236:239], v[208:211], v[152:155]
    v_mfma_f32_16x16x32_bf16 v[156:159], v[236:239], v[212:215], v[156:159]
    s_waitcnt lgkmcnt(0)
    v_mfma_f32_16x16x32_bf16 v[64:67], v[176:179], v[160:163], v[64:67]
    v_mfma_f32_16x16x32_bf16 v[68:71], v[176:179], v[164:167], v[68:71]
    s_barrier
    ds_read_b128 v[200:203], v8 offset:49152
    v_mfma_f32_16x16x32_bf16 v[72:75], v[176:179], v[168:171], v[72:75]
    ds_read_b128 v[216:219], v12 offset:0
    v_mfma_f32_16x16x32_bf16 v[76:79], v[176:179], v[172:175], v[76:79]
    ds_read_b128 v[204:207], v8 offset:50176
    v_mfma_f32_16x16x32_bf16 v[80:83], v[180:183], v[160:163], v[80:83]
    ds_read_b128 v[208:211], v8 offset:51200
    v_mfma_f32_16x16x32_bf16 v[84:87], v[180:183], v[164:167], v[84:87]
    ds_read_b128 v[212:215], v8 offset:52224
    v_mfma_f32_16x16x32_bf16 v[88:91], v[180:183], v[168:171], v[88:91]
    ds_read_b128 v[220:223], v12 offset:1024
    v_mfma_f32_16x16x32_bf16 v[92:95], v[180:183], v[172:175], v[92:95]
    ds_read_b128 v[224:227], v12 offset:2048
    v_mfma_f32_16x16x32_bf16 v[96:99], v[184:187], v[160:163], v[96:99]
    ds_read_b128 v[228:231], v12 offset:3072
    v_mfma_f32_16x16x32_bf16 v[100:103], v[184:187], v[164:167], v[100:103]
    ds_read_b128 v[232:235], v12 offset:4096
    v_mfma_f32_16x16x32_bf16 v[104:107], v[184:187], v[168:171], v[104:107]
    ds_read_b128 v[236:239], v12 offset:5120
    v_mfma_f32_16x16x32_bf16 v[108:111], v[184:187], v[172:175], v[108:111]
    v_mfma_f32_16x16x32_bf16 v[112:115], v[188:191], v[160:163], v[112:115]
    v_mfma_f32_16x16x32_bf16 v[116:119], v[188:191], v[164:167], v[116:119]
    v_mfma_f32_16x16x32_bf16 v[120:123], v[188:191], v[168:171], v[120:123]
    v_mfma_f32_16x16x32_bf16 v[124:127], v[188:191], v[172:175], v[124:127]
    v_mfma_f32_16x16x32_bf16 v[128:131], v[192:195], v[160:163], v[128:131]
    v_mfma_f32_16x16x32_bf16 v[132:135], v[192:195], v[164:167], v[132:135]
    v_mfma_f32_16x16x32_bf16 v[136:139], v[192:195], v[168:171], v[136:139]
    v_mfma_f32_16x16x32_bf16 v[140:143], v[192:195], v[172:175], v[140:143]
    v_mfma_f32_16x16x32_bf16 v[144:147], v[196:199], v[160:163], v[144:147]
    v_mfma_f32_16x16x32_bf16 v[148:151], v[196:199], v[164:167], v[148:151]
    v_mfma_f32_16x16x32_bf16 v[152:155], v[196:199], v[168:171], v[152:155]
    v_mfma_f32_16x16x32_bf16 v[156:159], v[196:199], v[172:175], v[156:159]
    s_waitcnt lgkmcnt(0)
    v_mfma_f32_16x16x32_bf16 v[64:67], v[216:219], v[200:203], v[64:67]
    v_mfma_f32_16x16x32_bf16 v[68:71], v[216:219], v[204:207], v[68:71]
    s_barrier
    ds_read_b128 v[160:163], v8 offset:61440
    v_mfma_f32_16x16x32_bf16 v[72:75], v[216:219], v[208:211], v[72:75]
    ds_read_b128 v[176:179], v13 offset:32768
    v_mfma_f32_16x16x32_bf16 v[76:79], v[216:219], v[212:215], v[76:79]
    ds_read_b128 v[164:167], v8 offset:62464
    v_mfma_f32_16x16x32_bf16 v[80:83], v[220:223], v[200:203], v[80:83]
    ds_read_b128 v[168:171], v8 offset:63488
    v_mfma_f32_16x16x32_bf16 v[84:87], v[220:223], v[204:207], v[84:87]
    ds_read_b128 v[172:175], v8 offset:64512
    v_mfma_f32_16x16x32_bf16 v[88:91], v[220:223], v[208:211], v[88:91]
    ds_read_b128 v[180:183], v13 offset:33792
    v_mfma_f32_16x16x32_bf16 v[92:95], v[220:223], v[212:215], v[92:95]
    ds_read_b128 v[184:187], v13 offset:34816
    v_mfma_f32_16x16x32_bf16 v[96:99], v[224:227], v[200:203], v[96:99]
    ds_read_b128 v[188:191], v13 offset:35840
    v_mfma_f32_16x16x32_bf16 v[100:103], v[224:227], v[204:207], v[100:103]
    ds_read_b128 v[192:195], v13 offset:36864
    v_mfma_f32_16x16x32_bf16 v[104:107], v[224:227], v[208:211], v[104:107]
    ds_read_b128 v[196:199], v13 offset:37888
    v_mfma_f32_16x16x32_bf16 v[108:111], v[224:227], v[212:215], v[108:111]
    v_mfma_f32_16x16x32_bf16 v[112:115], v[228:231], v[200:203], v[112:115]
    v_mfma_f32_16x16x32_bf16 v[116:119], v[228:231], v[204:207], v[116:119]
    v_mfma_f32_16x16x32_bf16 v[120:123], v[228:231], v[208:211], v[120:123]
    v_mfma_f32_16x16x32_bf16 v[124:127], v[228:231], v[212:215], v[124:127]
    v_mfma_f32_16x16x32_bf16 v[128:131], v[232:235], v[200:203], v[128:131]
    v_mfma_f32_16x16x32_bf16 v[132:135], v[232:235], v[204:207], v[132:135]
    v_mfma_f32_16x16x32_bf16 v[136:139], v[232:235], v[208:211], v[136:139]
    v_mfma_f32_16x16x32_bf16 v[140:143], v[232:235], v[212:215], v[140:143]
    v_mfma_f32_16x16x32_bf16 v[144:147], v[236:239], v[200:203], v[144:147]
    v_mfma_f32_16x16x32_bf16 v[148:151], v[236:239], v[204:207], v[148:151]
    v_mfma_f32_16x16x32_bf16 v[152:155], v[236:239], v[208:211], v[152:155]
    v_mfma_f32_16x16x32_bf16 v[156:159], v[236:239], v[212:215], v[156:159]
    s_waitcnt lgkmcnt(0)
    v_mfma_f32_16x16x32_bf16 v[64:67], v[176:179], v[160:163], v[64:67]
    v_mfma_f32_16x16x32_bf16 v[68:71], v[176:179], v[164:167], v[68:71]
    s_barrier
    ds_read_b128 v[200:203], v9 offset:8192
    v_mfma_f32_16x16x32_bf16 v[72:75], v[176:179], v[168:171], v[72:75]
    ds_read_b128 v[216:219], v12 offset:12288
    v_mfma_f32_16x16x32_bf16 v[76:79], v[176:179], v[172:175], v[76:79]
    ds_read_b128 v[204:207], v9 offset:9216
    v_mfma_f32_16x16x32_bf16 v[80:83], v[180:183], v[160:163], v[80:83]
    ds_read_b128 v[208:211], v9 offset:10240
    v_mfma_f32_16x16x32_bf16 v[84:87], v[180:183], v[164:167], v[84:87]
    ds_read_b128 v[212:215], v9 offset:11264
    v_mfma_f32_16x16x32_bf16 v[88:91], v[180:183], v[168:171], v[88:91]
    ds_read_b128 v[220:223], v12 offset:13312
    v_mfma_f32_16x16x32_bf16 v[92:95], v[180:183], v[172:175], v[92:95]
    ds_read_b128 v[224:227], v12 offset:14336
    v_mfma_f32_16x16x32_bf16 v[96:99], v[184:187], v[160:163], v[96:99]
    ds_read_b128 v[228:231], v12 offset:15360
    v_mfma_f32_16x16x32_bf16 v[100:103], v[184:187], v[164:167], v[100:103]
    ds_read_b128 v[232:235], v12 offset:16384
    v_mfma_f32_16x16x32_bf16 v[104:107], v[184:187], v[168:171], v[104:107]
    ds_read_b128 v[236:239], v12 offset:17408
    v_mfma_f32_16x16x32_bf16 v[108:111], v[184:187], v[172:175], v[108:111]
    v_mfma_f32_16x16x32_bf16 v[112:115], v[188:191], v[160:163], v[112:115]
    v_mfma_f32_16x16x32_bf16 v[116:119], v[188:191], v[164:167], v[116:119]
    v_mfma_f32_16x16x32_bf16 v[120:123], v[188:191], v[168:171], v[120:123]
    v_mfma_f32_16x16x32_bf16 v[124:127], v[188:191], v[172:175], v[124:127]
    v_mfma_f32_16x16x32_bf16 v[128:131], v[192:195], v[160:163], v[128:131]
    v_mfma_f32_16x16x32_bf16 v[132:135], v[192:195], v[164:167], v[132:135]
    v_mfma_f32_16x16x32_bf16 v[136:139], v[192:195], v[168:171], v[136:139]
    v_mfma_f32_16x16x32_bf16 v[140:143], v[192:195], v[172:175], v[140:143]
    v_mfma_f32_16x16x32_bf16 v[144:147], v[196:199], v[160:163], v[144:147]
    v_mfma_f32_16x16x32_bf16 v[148:151], v[196:199], v[164:167], v[148:151]
    v_mfma_f32_16x16x32_bf16 v[152:155], v[196:199], v[168:171], v[152:155]
    v_mfma_f32_16x16x32_bf16 v[156:159], v[196:199], v[172:175], v[156:159]
    s_waitcnt lgkmcnt(0)
    v_mfma_f32_16x16x32_bf16 v[64:67], v[216:219], v[200:203], v[64:67]
    v_mfma_f32_16x16x32_bf16 v[68:71], v[216:219], v[204:207], v[68:71]
    s_barrier
    ds_read_b128 v[160:163], v9 offset:20480
    v_mfma_f32_16x16x32_bf16 v[72:75], v[216:219], v[208:211], v[72:75]
    ds_read_b128 v[176:179], v13 offset:45056
    v_mfma_f32_16x16x32_bf16 v[76:79], v[216:219], v[212:215], v[76:79]
    ds_read_b128 v[164:167], v9 offset:21504
    v_mfma_f32_16x16x32_bf16 v[80:83], v[220:223], v[200:203], v[80:83]
    ds_read_b128 v[168:171], v9 offset:22528
    v_mfma_f32_16x16x32_bf16 v[84:87], v[220:223], v[204:207], v[84:87]
    ds_read_b128 v[172:175], v9 offset:23552
    v_mfma_f32_16x16x32_bf16 v[88:91], v[220:223], v[208:211], v[88:91]
    ds_read_b128 v[180:183], v13 offset:46080
    v_mfma_f32_16x16x32_bf16 v[92:95], v[220:223], v[212:215], v[92:95]
    ds_read_b128 v[184:187], v13 offset:47104
    v_mfma_f32_16x16x32_bf16 v[96:99], v[224:227], v[200:203], v[96:99]
    ds_read_b128 v[188:191], v13 offset:48128
    v_mfma_f32_16x16x32_bf16 v[100:103], v[224:227], v[204:207], v[100:103]
    ds_read_b128 v[192:195], v13 offset:49152
    v_mfma_f32_16x16x32_bf16 v[104:107], v[224:227], v[208:211], v[104:107]
    ds_read_b128 v[196:199], v13 offset:50176
    v_mfma_f32_16x16x32_bf16 v[108:111], v[224:227], v[212:215], v[108:111]
    v_mfma_f32_16x16x32_bf16 v[112:115], v[228:231], v[200:203], v[112:115]
    v_mfma_f32_16x16x32_bf16 v[116:119], v[228:231], v[204:207], v[116:119]
    v_mfma_f32_16x16x32_bf16 v[120:123], v[228:231], v[208:211], v[120:123]
    v_mfma_f32_16x16x32_bf16 v[124:127], v[228:231], v[212:215], v[124:127]
    v_mfma_f32_16x16x32_bf16 v[128:131], v[232:235], v[200:203], v[128:131]
    v_mfma_f32_16x16x32_bf16 v[132:135], v[232:235], v[204:207], v[132:135]
    v_mfma_f32_16x16x32_bf16 v[136:139], v[232:235], v[208:211], v[136:139]
    v_mfma_f32_16x16x32_bf16 v[140:143], v[232:235], v[212:215], v[140:143]
    v_mfma_f32_16x16x32_bf16 v[144:147], v[236:239], v[200:203], v[144:147]
    v_mfma_f32_16x16x32_bf16 v[148:151], v[236:239], v[204:207], v[148:151]
    v_mfma_f32_16x16x32_bf16 v[152:155], v[236:239], v[208:211], v[152:155]
    v_mfma_f32_16x16x32_bf16 v[156:159], v[236:239], v[212:215], v[156:159]
    s_waitcnt lgkmcnt(0)
    v_mfma_f32_16x16x32_bf16 v[64:67], v[176:179], v[160:163], v[64:67]
    v_mfma_f32_16x16x32_bf16 v[68:71], v[176:179], v[164:167], v[68:71]
    s_barrier
    ds_read_b128 v[200:203], v9 offset:57344
    v_mfma_f32_16x16x32_bf16 v[72:75], v[176:179], v[168:171], v[72:75]
    ds_read_b128 v[216:219], v12 offset:24576
    v_mfma_f32_16x16x32_bf16 v[76:79], v[176:179], v[172:175], v[76:79]
    ds_read_b128 v[204:207], v9 offset:58368
    v_mfma_f32_16x16x32_bf16 v[80:83], v[180:183], v[160:163], v[80:83]
    ds_read_b128 v[208:211], v9 offset:59392
    v_mfma_f32_16x16x32_bf16 v[84:87], v[180:183], v[164:167], v[84:87]
    ds_read_b128 v[212:215], v9 offset:60416
    v_mfma_f32_16x16x32_bf16 v[88:91], v[180:183], v[168:171], v[88:91]
    ds_read_b128 v[220:223], v12 offset:25600
    v_mfma_f32_16x16x32_bf16 v[92:95], v[180:183], v[172:175], v[92:95]
    ds_read_b128 v[224:227], v12 offset:26624
    v_mfma_f32_16x16x32_bf16 v[96:99], v[184:187], v[160:163], v[96:99]
    ds_read_b128 v[228:231], v12 offset:27648
    v_mfma_f32_16x16x32_bf16 v[100:103], v[184:187], v[164:167], v[100:103]
    ds_read_b128 v[232:235], v12 offset:28672
    v_mfma_f32_16x16x32_bf16 v[104:107], v[184:187], v[168:171], v[104:107]
    ds_read_b128 v[236:239], v12 offset:29696
    v_mfma_f32_16x16x32_bf16 v[108:111], v[184:187], v[172:175], v[108:111]
    v_mfma_f32_16x16x32_bf16 v[112:115], v[188:191], v[160:163], v[112:115]
    v_mfma_f32_16x16x32_bf16 v[116:119], v[188:191], v[164:167], v[116:119]
    v_mfma_f32_16x16x32_bf16 v[120:123], v[188:191], v[168:171], v[120:123]
    v_mfma_f32_16x16x32_bf16 v[124:127], v[188:191], v[172:175], v[124:127]
    v_mfma_f32_16x16x32_bf16 v[128:131], v[192:195], v[160:163], v[128:131]
    v_mfma_f32_16x16x32_bf16 v[132:135], v[192:195], v[164:167], v[132:135]
    v_mfma_f32_16x16x32_bf16 v[136:139], v[192:195], v[168:171], v[136:139]
    v_mfma_f32_16x16x32_bf16 v[140:143], v[192:195], v[172:175], v[140:143]
    v_mfma_f32_16x16x32_bf16 v[144:147], v[196:199], v[160:163], v[144:147]
    v_mfma_f32_16x16x32_bf16 v[148:151], v[196:199], v[164:167], v[148:151]
    v_mfma_f32_16x16x32_bf16 v[152:155], v[196:199], v[168:171], v[152:155]
    v_mfma_f32_16x16x32_bf16 v[156:159], v[196:199], v[172:175], v[156:159]
    s_waitcnt lgkmcnt(0)
    v_mfma_f32_16x16x32_bf16 v[64:67], v[216:219], v[200:203], v[64:67]
    v_mfma_f32_16x16x32_bf16 v[68:71], v[216:219], v[204:207], v[68:71]
    s_barrier
    ds_read_b128 v[160:163], v10 offset:4096
    v_mfma_f32_16x16x32_bf16 v[72:75], v[216:219], v[208:211], v[72:75]
    ds_read_b128 v[176:179], v12 offset:36864
    v_mfma_f32_16x16x32_bf16 v[76:79], v[216:219], v[212:215], v[76:79]
    ds_read_b128 v[164:167], v10 offset:5120
    v_mfma_f32_16x16x32_bf16 v[80:83], v[220:223], v[200:203], v[80:83]
    ds_read_b128 v[168:171], v10 offset:6144
    v_mfma_f32_16x16x32_bf16 v[84:87], v[220:223], v[204:207], v[84:87]
    ds_read_b128 v[172:175], v10 offset:7168
    v_mfma_f32_16x16x32_bf16 v[88:91], v[220:223], v[208:211], v[88:91]
    ds_read_b128 v[180:183], v12 offset:37888
    v_mfma_f32_16x16x32_bf16 v[92:95], v[220:223], v[212:215], v[92:95]
    ds_read_b128 v[184:187], v12 offset:38912
    v_mfma_f32_16x16x32_bf16 v[96:99], v[224:227], v[200:203], v[96:99]
    ds_read_b128 v[188:191], v12 offset:39936
    v_mfma_f32_16x16x32_bf16 v[100:103], v[224:227], v[204:207], v[100:103]
    ds_read_b128 v[192:195], v12 offset:40960
    v_mfma_f32_16x16x32_bf16 v[104:107], v[224:227], v[208:211], v[104:107]
    ds_read_b128 v[196:199], v12 offset:41984
    v_mfma_f32_16x16x32_bf16 v[108:111], v[224:227], v[212:215], v[108:111]
    v_mfma_f32_16x16x32_bf16 v[112:115], v[228:231], v[200:203], v[112:115]
    v_mfma_f32_16x16x32_bf16 v[116:119], v[228:231], v[204:207], v[116:119]
    v_mfma_f32_16x16x32_bf16 v[120:123], v[228:231], v[208:211], v[120:123]
    v_mfma_f32_16x16x32_bf16 v[124:127], v[228:231], v[212:215], v[124:127]
    v_mfma_f32_16x16x32_bf16 v[128:131], v[232:235], v[200:203], v[128:131]
    v_mfma_f32_16x16x32_bf16 v[132:135], v[232:235], v[204:207], v[132:135]
    v_mfma_f32_16x16x32_bf16 v[136:139], v[232:235], v[208:211], v[136:139]
    v_mfma_f32_16x16x32_bf16 v[140:143], v[232:235], v[212:215], v[140:143]
    v_mfma_f32_16x16x32_bf16 v[144:147], v[236:239], v[200:203], v[144:147]
    v_mfma_f32_16x16x32_bf16 v[148:151], v[236:239], v[204:207], v[148:151]
    v_mfma_f32_16x16x32_bf16 v[152:155], v[236:239], v[208:211], v[152:155]
    v_mfma_f32_16x16x32_bf16 v[156:159], v[236:239], v[212:215], v[156:159]
    s_waitcnt lgkmcnt(0)
    v_mfma_f32_16x16x32_bf16 v[64:67], v[176:179], v[160:163], v[64:67]
    v_mfma_f32_16x16x32_bf16 v[68:71], v[176:179], v[164:167], v[68:71]
    s_barrier
    ds_read_b128 v[200:203], v10 offset:16384
    v_mfma_f32_16x16x32_bf16 v[72:75], v[176:179], v[168:171], v[72:75]
    ds_read_b128 v[216:219], v12 offset:49152
    v_mfma_f32_16x16x32_bf16 v[76:79], v[176:179], v[172:175], v[76:79]
    ds_read_b128 v[204:207], v10 offset:17408
    v_mfma_f32_16x16x32_bf16 v[80:83], v[180:183], v[160:163], v[80:83]
    ds_read_b128 v[208:211], v10 offset:18432
    v_mfma_f32_16x16x32_bf16 v[84:87], v[180:183], v[164:167], v[84:87]
    ds_read_b128 v[212:215], v10 offset:19456
    v_mfma_f32_16x16x32_bf16 v[88:91], v[180:183], v[168:171], v[88:91]
    ds_read_b128 v[220:223], v12 offset:50176
    v_mfma_f32_16x16x32_bf16 v[92:95], v[180:183], v[172:175], v[92:95]
    ds_read_b128 v[224:227], v12 offset:51200
    v_mfma_f32_16x16x32_bf16 v[96:99], v[184:187], v[160:163], v[96:99]
    ds_read_b128 v[228:231], v12 offset:52224
    v_mfma_f32_16x16x32_bf16 v[100:103], v[184:187], v[164:167], v[100:103]
    ds_read_b128 v[232:235], v12 offset:53248
    v_mfma_f32_16x16x32_bf16 v[104:107], v[184:187], v[168:171], v[104:107]
    ds_read_b128 v[236:239], v12 offset:54272
    v_mfma_f32_16x16x32_bf16 v[108:111], v[184:187], v[172:175], v[108:111]
    v_mfma_f32_16x16x32_bf16 v[112:115], v[188:191], v[160:163], v[112:115]
    v_mfma_f32_16x16x32_bf16 v[116:119], v[188:191], v[164:167], v[116:119]
    v_mfma_f32_16x16x32_bf16 v[120:123], v[188:191], v[168:171], v[120:123]
    v_mfma_f32_16x16x32_bf16 v[124:127], v[188:191], v[172:175], v[124:127]
    v_mfma_f32_16x16x32_bf16 v[128:131], v[192:195], v[160:163], v[128:131]
    v_mfma_f32_16x16x32_bf16 v[132:135], v[192:195], v[164:167], v[132:135]
    v_mfma_f32_16x16x32_bf16 v[136:139], v[192:195], v[168:171], v[136:139]
    v_mfma_f32_16x16x32_bf16 v[140:143], v[192:195], v[172:175], v[140:143]
    v_mfma_f32_16x16x32_bf16 v[144:147], v[196:199], v[160:163], v[144:147]
    v_mfma_f32_16x16x32_bf16 v[148:151], v[196:199], v[164:167], v[148:151]
    v_mfma_f32_16x16x32_bf16 v[152:155], v[196:199], v[168:171], v[152:155]
    v_mfma_f32_16x16x32_bf16 v[156:159], v[196:199], v[172:175], v[156:159]
    s_waitcnt lgkmcnt(0)
    v_mfma_f32_16x16x32_bf16 v[64:67], v[216:219], v[200:203], v[64:67]
    v_mfma_f32_16x16x32_bf16 v[68:71], v[216:219], v[204:207], v[68:71]
    s_barrier
    ds_read_b128 v[160:163], v8 offset:0
    v_mfma_f32_16x16x32_bf16 v[72:75], v[216:219], v[208:211], v[72:75]
    ds_read_b128 v[176:179], v12 offset:61440
    v_mfma_f32_16x16x32_bf16 v[76:79], v[216:219], v[212:215], v[76:79]
    ds_read_b128 v[164:167], v8 offset:1024
    v_mfma_f32_16x16x32_bf16 v[80:83], v[220:223], v[200:203], v[80:83]
    ds_read_b128 v[168:171], v8 offset:2048
    v_mfma_f32_16x16x32_bf16 v[84:87], v[220:223], v[204:207], v[84:87]
    ds_read_b128 v[172:175], v8 offset:3072
    v_mfma_f32_16x16x32_bf16 v[88:91], v[220:223], v[208:211], v[88:91]
    ds_read_b128 v[180:183], v12 offset:62464
    v_mfma_f32_16x16x32_bf16 v[92:95], v[220:223], v[212:215], v[92:95]
    ds_read_b128 v[184:187], v12 offset:63488
    v_mfma_f32_16x16x32_bf16 v[96:99], v[224:227], v[200:203], v[96:99]
    ds_read_b128 v[188:191], v12 offset:64512
    v_mfma_f32_16x16x32_bf16 v[100:103], v[224:227], v[204:207], v[100:103]
    ds_read_b128 v[192:195], v13 offset:0
    v_mfma_f32_16x16x32_bf16 v[104:107], v[224:227], v[208:211], v[104:107]
    ds_read_b128 v[196:199], v13 offset:1024
    v_mfma_f32_16x16x32_bf16 v[108:111], v[224:227], v[212:215], v[108:111]
    v_mfma_f32_16x16x32_bf16 v[112:115], v[228:231], v[200:203], v[112:115]
    v_mfma_f32_16x16x32_bf16 v[116:119], v[228:231], v[204:207], v[116:119]
    v_mfma_f32_16x16x32_bf16 v[120:123], v[228:231], v[208:211], v[120:123]
    v_mfma_f32_16x16x32_bf16 v[124:127], v[228:231], v[212:215], v[124:127]
    v_mfma_f32_16x16x32_bf16 v[128:131], v[232:235], v[200:203], v[128:131]
    v_mfma_f32_16x16x32_bf16 v[132:135], v[232:235], v[204:207], v[132:135]
    v_mfma_f32_16x16x32_bf16 v[136:139], v[232:235], v[208:211], v[136:139]
    v_mfma_f32_16x16x32_bf16 v[140:143], v[232:235], v[212:215], v[140:143]
    v_mfma_f32_16x16x32_bf16 v[144:147], v[236:239], v[200:203], v[144:147]
    v_mfma_f32_16x16x32_bf16 v[148:151], v[236:239], v[204:207], v[148:151]
    v_mfma_f32_16x16x32_bf16 v[152:155], v[236:239], v[208:211], v[152:155]
    v_mfma_f32_16x16x32_bf16 v[156:159], v[236:239], v[212:215], v[156:159]
    s_waitcnt lgkmcnt(0)
    v_mfma_f32_16x16x32_bf16 v[64:67], v[176:179], v[160:163], v[64:67]
    v_mfma_f32_16x16x32_bf16 v[68:71], v[176:179], v[164:167], v[68:71]
    s_barrier
    ds_read_b128 v[200:203], v9 offset:32768
    v_mfma_f32_16x16x32_bf16 v[72:75], v[176:179], v[168:171], v[72:75]
    ds_read_b128 v[216:219], v12 offset:12288
    v_mfma_f32_16x16x32_bf16 v[76:79], v[176:179], v[172:175], v[76:79]
    ds_read_b128 v[204:207], v9 offset:33792
    v_mfma_f32_16x16x32_bf16 v[80:83], v[180:183], v[160:163], v[80:83]
    ds_read_b128 v[208:211], v9 offset:34816
    v_mfma_f32_16x16x32_bf16 v[84:87], v[180:183], v[164:167], v[84:87]
    ds_read_b128 v[212:215], v9 offset:35840
    v_mfma_f32_16x16x32_bf16 v[88:91], v[180:183], v[168:171], v[88:91]
    ds_read_b128 v[220:223], v12 offset:13312
    v_mfma_f32_16x16x32_bf16 v[92:95], v[180:183], v[172:175], v[92:95]
    ds_read_b128 v[224:227], v12 offset:14336
    v_mfma_f32_16x16x32_bf16 v[96:99], v[184:187], v[160:163], v[96:99]
    ds_read_b128 v[228:231], v12 offset:15360
    v_mfma_f32_16x16x32_bf16 v[100:103], v[184:187], v[164:167], v[100:103]
    ds_read_b128 v[232:235], v12 offset:16384
    v_mfma_f32_16x16x32_bf16 v[104:107], v[184:187], v[168:171], v[104:107]
    ds_read_b128 v[236:239], v12 offset:17408
    v_mfma_f32_16x16x32_bf16 v[108:111], v[184:187], v[172:175], v[108:111]
    ds_read_b32 v32, v4 offset:0
    v_mfma_f32_16x16x32_bf16 v[112:115], v[188:191], v[160:163], v[112:115]
    ds_read_b32 v34, v4 offset:512
    v_mfma_f32_16x16x32_bf16 v[116:119], v[188:191], v[164:167], v[116:119]
    ds_read_b32 v36, v4 offset:1024
    v_mfma_f32_16x16x32_bf16 v[120:123], v[188:191], v[168:171], v[120:123]
    ds_read_b32 v38, v4 offset:64
    v_mfma_f32_16x16x32_bf16 v[124:127], v[188:191], v[172:175], v[124:127]
    ds_read_b32 v40, v4 offset:576
    v_mfma_f32_16x16x32_bf16 v[128:131], v[192:195], v[160:163], v[128:131]
    ds_read_b32 v42, v4 offset:1088
    v_mfma_f32_16x16x32_bf16 v[132:135], v[192:195], v[164:167], v[132:135]
    ds_read_b32 v44, v4 offset:128
    v_mfma_f32_16x16x32_bf16 v[136:139], v[192:195], v[168:171], v[136:139]
    ds_read_b32 v46, v4 offset:640
    v_mfma_f32_16x16x32_bf16 v[140:143], v[192:195], v[172:175], v[140:143]
    ds_read_b32 v48, v4 offset:1152
    v_mfma_f32_16x16x32_bf16 v[144:147], v[196:199], v[160:163], v[144:147]
    ds_read_b32 v50, v4 offset:192
    v_mfma_f32_16x16x32_bf16 v[148:151], v[196:199], v[164:167], v[148:151]
    ds_read_b32 v52, v4 offset:704
    v_mfma_f32_16x16x32_bf16 v[152:155], v[196:199], v[168:171], v[152:155]
    ds_read_b32 v54, v4 offset:1216
    v_mfma_f32_16x16x32_bf16 v[156:159], v[196:199], v[172:175], v[156:159]
    s_waitcnt lgkmcnt(0)
    v_mfma_f32_16x16x32_bf16 v[64:67], v[216:219], v[200:203], v[64:67]
    v_mfma_f32_16x16x32_bf16 v[80:83], v[220:223], v[200:203], v[80:83]
    s_barrier
    v_mfma_f32_16x16x32_bf16 v[96:99], v[224:227], v[200:203], v[96:99]
    v_mfma_f32_16x16x32_bf16 v[112:115], v[228:231], v[200:203], v[112:115]
    v_mfma_f32_16x16x32_bf16 v[68:71], v[216:219], v[204:207], v[68:71]
    v_mfma_f32_16x16x32_bf16 v[84:87], v[220:223], v[204:207], v[84:87]
    v_mfma_f32_16x16x32_bf16 v[100:103], v[224:227], v[204:207], v[100:103]
    v_mfma_f32_16x16x32_bf16 v[116:119], v[228:231], v[204:207], v[116:119]
    v_mfma_f32_16x16x32_bf16 v[72:75], v[216:219], v[208:211], v[72:75]
    v_mfma_f32_16x16x32_bf16 v[88:91], v[220:223], v[208:211], v[88:91]
    v_mfma_f32_16x16x32_bf16 v[104:107], v[224:227], v[208:211], v[104:107]
    v_mfma_f32_16x16x32_bf16 v[120:123], v[228:231], v[208:211], v[120:123]
    v_mfma_f32_16x16x32_bf16 v[76:79], v[216:219], v[212:215], v[76:79]
    v_mfma_f32_16x16x32_bf16 v[92:95], v[220:223], v[212:215], v[92:95]
    v_mfma_f32_16x16x32_bf16 v[108:111], v[224:227], v[212:215], v[108:111]
    v_mfma_f32_16x16x32_bf16 v[124:127], v[228:231], v[212:215], v[124:127]
    v_mfma_f32_16x16x32_bf16 v[128:131], v[232:235], v[200:203], v[128:131]
    v_mfma_f32_16x16x32_bf16 v[144:147], v[236:239], v[200:203], v[144:147]
    v_mfma_f32_16x16x32_bf16 v[132:135], v[232:235], v[204:207], v[132:135]
    v_mfma_f32_16x16x32_bf16 v[148:151], v[236:239], v[204:207], v[148:151]
    v_mfma_f32_16x16x32_bf16 v[136:139], v[232:235], v[208:211], v[136:139]
    v_mfma_f32_16x16x32_bf16 v[152:155], v[236:239], v[208:211], v[152:155]
    v_mfma_f32_16x16x32_bf16 v[140:143], v[232:235], v[212:215], v[140:143]
    v_mfma_f32_16x16x32_bf16 v[156:159], v[236:239], v[212:215], v[156:159]
p4_epi:
    s_lshl_b32 s38, s4, 4
    s_add_u32 s38, s38, s5
    s_mul_i32 s38, s38, 128
    s_add_u32 s38, s38, 30633984
    v_pk_mul_f32 v[16:17], v[64:65], v[64:65]
    v_pk_mul_f32 v[18:19], v[66:67], v[66:67]
    v_pk_mul_f32 v[20:21], v[96:97], v[96:97]
    v_pk_mul_f32 v[22:23], v[98:99], v[98:99]
    v_pk_fma_f32 v[16:17], v[16:17], v[34:35], v[32:33] op_sel_hi:[1,0,0]
    v_pk_fma_f32 v[18:19], v[18:19], v[34:35], v[32:33] op_sel_hi:[1,0,0]
    v_pk_fma_f32 v[20:21], v[20:21], v[34:35], v[32:33] op_sel_hi:[1,0,0]
    v_pk_fma_f32 v[22:23], v[22:23], v[34:35], v[32:33] op_sel_hi:[1,0,0]
    v_pk_mul_f32 v[16:17], v[16:17], v[64:65]
    v_pk_mul_f32 v[18:19], v[18:19], v[66:67]
    v_pk_mul_f32 v[20:21], v[20:21], v[96:97]
    v_pk_mul_f32 v[22:23], v[22:23], v[98:99]
    v_exp_f32 v16, v16
    v_exp_f32 v17, v17
    v_exp_f32 v18, v18
    v_exp_f32 v19, v19
    v_exp_f32 v20, v20
    v_exp_f32 v21, v21
    v_exp_f32 v22, v22
    v_exp_f32 v23, v23
    v_pk_mul_f32 v[64:65], v[64:65], v[80:81]
    v_pk_mul_f32 v[66:67], v[66:67], v[82:83]
    v_pk_mul_f32 v[96:97], v[96:97], v[112:113]
    v_pk_mul_f32 v[98:99], v[98:99], v[114:115]
    v_pk_fma_f32 v[16:17], v[16:17], v[36:37], v[36:37] op_sel_hi:[1,0,0]
    v_pk_fma_f32 v[18:19], v[18:19], v[36:37], v[36:37] op_sel_hi:[1,0,0]
    v_pk_fma_f32 v[20:21], v[20:21], v[36:37], v[36:37] op_sel_hi:[1,0,0]
    v_pk_fma_f32 v[22:23], v[22:23], v[36:37], v[36:37] op_sel_hi:[1,0,0]
    v_rcp_f32 v16, v16
    v_rcp_f32 v17, v17
    v_rcp_f32 v18, v18
    v_rcp_f32 v19, v19
    v_rcp_f32 v20, v20
    v_rcp_f32 v21, v21
    v_rcp_f32 v22, v22
    v_rcp_f32 v23, v23
    v_pk_mul_f32 v[64:65], v[64:65], v[16:17]
    v_pk_mul_f32 v[66:67], v[66:67], v[18:19]
    v_pk_mul_f32 v[96:97], v[96:97], v[20:21]
    v_pk_mul_f32 v[98:99], v[98:99], v[22:23]
    v_cvt_pk_bf16_f32 v80, v64, v65
    v_cvt_pk_bf16_f32 v81, v66, v67
    v_cvt_pk_bf16_f32 v82, v96, v97
    v_cvt_pk_bf16_f32 v83, v98, v99
    buffer_store_dwordx4 v[80:83], v3, s[8:11], s20 offen offset:0 sc1
    v_pk_mul_f32 v[16:17], v[68:69], v[68:69]
    v_pk_mul_f32 v[18:19], v[70:71], v[70:71]
    v_pk_mul_f32 v[20:21], v[100:101], v[100:101]
    v_pk_mul_f32 v[22:23], v[102:103], v[102:103]
    v_pk_fma_f32 v[16:17], v[16:17], v[40:41], v[38:39] op_sel_hi:[1,0,0]
    v_pk_fma_f32 v[18:19], v[18:19], v[40:41], v[38:39] op_sel_hi:[1,0,0]
    v_pk_fma_f32 v[20:21], v[20:21], v[40:41], v[38:39] op_sel_hi:[1,0,0]
    v_pk_fma_f32 v[22:23], v[22:23], v[40:41], v[38:39] op_sel_hi:[1,0,0]
    v_pk_mul_f32 v[16:17], v[16:17], v[68:69]
    v_pk_mul_f32 v[18:19], v[18:19], v[70:71]
    v_pk_mul_f32 v[20:21], v[20:21], v[100:101]
    v_pk_mul_f32 v[22:23], v[22:23], v[102:103]
    v_exp_f32 v16, v16
    v_exp_f32 v17, v17
    v_exp_f32 v18, v18
    v_exp_f32 v19, v19
    v_exp_f32 v20, v20
    v_exp_f32 v21, v21
    v_exp_f32 v22, v22
    v_exp_f32 v23, v23
    v_pk_mul_f32 v[68:69], v[68:69], v[84:85]
    v_pk_mul_f32 v[70:71], v[70:71], v[86:87]
    v_pk_mul_f32 v[100:101], v[100:101], v[116:117]
    v_pk_mul_f32 v[102:103], v[102:103], v[118:119]
    v_pk_fma_f32 v[16:17], v[16:17], v[42:43], v[42:43] op_sel_hi:[1,0,0]
    v_pk_fma_f32 v[18:19], v[18:19], v[42:43], v[42:43] op_sel_hi:[1,0,0]
    v_pk_fma_f32 v[20:21], v[20:21], v[42:43], v[42:43] op_sel_hi:[1,0,0]
    v_pk_fma_f32 v[22:23], v[22:23], v[42:43], v[42:43] op_sel_hi:[1,0,0]
    v_rcp_f32 v16, v16
    v_rcp_f32 v17, v17
    v_rcp_f32 v18, v18
    v_rcp_f32 v19, v19
    v_rcp_f32 v20, v20
    v_rcp_f32 v21, v21
    v_rcp_f32 v22, v22
    v_rcp_f32 v23, v23
    v_pk_mul_f32 v[68:69], v[68:69], v[16:17]
    v_pk_mul_f32 v[70:71], v[70:71], v[18:19]
    v_pk_mul_f32 v[100:101], v[100:101], v[20:21]
    v_pk_mul_f32 v[102:103], v[102:103], v[22:23]
    v_cvt_pk_bf16_f32 v84, v68, v69
    v_cvt_pk_bf16_f32 v85, v70, v71
    v_cvt_pk_bf16_f32 v86, v100, v101
    v_cvt_pk_bf16_f32 v87, v102, v103
    buffer_store_dwordx4 v[84:87], v15, s[8:11], s20 offen offset:0 sc1
    v_pk_mul_f32 v[16:17], v[72:73], v[72:73]
    v_pk_mul_f32 v[18:19], v[74:75], v[74:75]
    v_pk_mul_f32 v[20:21], v[104:105], v[104:105]
    v_pk_mul_f32 v[22:23], v[106:107], v[106:107]
    v_pk_fma_f32 v[16:17], v[16:17], v[46:47], v[44:45] op_sel_hi:[1,0,0]
    v_pk_fma_f32 v[18:19], v[18:19], v[46:47], v[44:45] op_sel_hi:[1,0,0]
    v_pk_fma_f32 v[20:21], v[20:21], v[46:47], v[44:45] op_sel_hi:[1,0,0]
    v_pk_fma_f32 v[22:23], v[22:23], v[46:47], v[44:45] op_sel_hi:[1,0,0]
    v_pk_mul_f32 v[16:17], v[16:17], v[72:73]
    v_pk_mul_f32 v[18:19], v[18:19], v[74:75]
    v_pk_mul_f32 v[20:21], v[20:21], v[104:105]
    v_pk_mul_f32 v[22:23], v[22:23], v[106:107]
    v_exp_f32 v16, v16
    v_exp_f32 v17, v17
    v_exp_f32 v18, v18
    v_exp_f32 v19, v19
    v_exp_f32 v20, v20
    v_exp_f32 v21, v21
    v_exp_f32 v22, v22
    v_exp_f32 v23, v23
    v_pk_mul_f32 v[72:73], v[72:73], v[88:89]
    v_pk_mul_f32 v[74:75], v[74:75], v[90:91]
    v_pk_mul_f32 v[104:105], v[104:105], v[120:121]
    v_pk_mul_f32 v[106:107], v[106:107], v[122:123]
    v_pk_fma_f32 v[16:17], v[16:17], v[48:49], v[48:49] op_sel_hi:[1,0,0]
    v_pk_fma_f32 v[18:19], v[18:19], v[48:49], v[48:49] op_sel_hi:[1,0,0]
    v_pk_fma_f32 v[20:21], v[20:21], v[48:49], v[48:49] op_sel_hi:[1,0,0]
    v_pk_fma_f32 v[22:23], v[22:23], v[48:49], v[48:49] op_sel_hi:[1,0,0]
    v_rcp_f32 v16, v16
    v_rcp_f32 v17, v17
    v_rcp_f32 v18, v18
    v_rcp_f32 v19, v19
    v_rcp_f32 v20, v20
    v_rcp_f32 v21, v21
    v_rcp_f32 v22, v22
    v_rcp_f32 v23, v23
    v_pk_mul_f32 v[72:73], v[72:73], v[16:17]
    v_pk_mul_f32 v[74:75], v[74:75], v[18:19]
    v_pk_mul_f32 v[104:105], v[104:105], v[20:21]
    v_pk_mul_f32 v[106:107], v[106:107], v[22:23]
    v_cvt_pk_bf16_f32 v88, v72, v73
    v_cvt_pk_bf16_f32 v89, v74, v75
    v_cvt_pk_bf16_f32 v90, v104, v105
    v_cvt_pk_bf16_f32 v91, v106, v107
    buffer_store_dwordx4 v[88:91], v3, s[8:11], s21 offen offset:0 sc1
    v_pk_mul_f32 v[16:17], v[76:77], v[76:77]
    v_pk_mul_f32 v[18:19], v[78:79], v[78:79]
    v_pk_mul_f32 v[20:21], v[108:109], v[108:109]
    v_pk_mul_f32 v[22:23], v[110:111], v[110:111]
    v_pk_fma_f32 v[16:17], v[16:17], v[52:53], v[50:51] op_sel_hi:[1,0,0]
    v_pk_fma_f32 v[18:19], v[18:19], v[52:53], v[50:51] op_sel_hi:[1,0,0]
    v_pk_fma_f32 v[20:21], v[20:21], v[52:53], v[50:51] op_sel_hi:[1,0,0]
    v_pk_fma_f32 v[22:23], v[22:23], v[52:53], v[50:51] op_sel_hi:[1,0,0]
    v_pk_mul_f32 v[16:17], v[16:17], v[76:77]
    v_pk_mul_f32 v[18:19], v[18:19], v[78:79]
    v_pk_mul_f32 v[20:21], v[20:21], v[108:109]
    v_pk_mul_f32 v[22:23], v[22:23], v[110:111]
    v_exp_f32 v16, v16
    v_exp_f32 v17, v17
    v_exp_f32 v18, v18
    v_exp_f32 v19, v19
    v_exp_f32 v20, v20
    v_exp_f32 v21, v21
    v_exp_f32 v22, v22
    v_exp_f32 v23, v23
    v_pk_mul_f32 v[76:77], v[76:77], v[92:93]
    v_pk_mul_f32 v[78:79], v[78:79], v[94:95]
    v_pk_mul_f32 v[108:109], v[108:109], v[124:125]
    v_pk_mul_f32 v[110:111], v[110:111], v[126:127]
    v_pk_fma_f32 v[16:17], v[16:17], v[54:55], v[54:55] op_sel_hi:[1,0,0]
    v_pk_fma_f32 v[18:19], v[18:19], v[54:55], v[54:55] op_sel_hi:[1,0,0]
    v_pk_fma_f32 v[20:21], v[20:21], v[54:55], v[54:55] op_sel_hi:[1,0,0]
    v_pk_fma_f32 v[22:23], v[22:23], v[54:55], v[54:55] op_sel_hi:[1,0,0]
    v_rcp_f32 v16, v16
    v_rcp_f32 v17, v17
    v_rcp_f32 v18, v18
    v_rcp_f32 v19, v19
    v_rcp_f32 v20, v20
    v_rcp_f32 v21, v21
    v_rcp_f32 v22, v22
    v_rcp_f32 v23, v23
    v_pk_mul_f32 v[76:77], v[76:77], v[16:17]
    v_pk_mul_f32 v[78:79], v[78:79], v[18:19]
    v_pk_mul_f32 v[108:109], v[108:109], v[20:21]
    v_pk_mul_f32 v[110:111], v[110:111], v[22:23]
    v_cvt_pk_bf16_f32 v92, v76, v77
    v_cvt_pk_bf16_f32 v93, v78, v79
    v_cvt_pk_bf16_f32 v94, v108, v109
    v_cvt_pk_bf16_f32 v95, v110, v111
    buffer_store_dwordx4 v[92:95], v15, s[8:11], s21 offen offset:0 sc1
    v_pk_mul_f32 v[16:17], v[128:129], v[128:129]
    v_pk_mul_f32 v[18:19], v[130:131], v[130:131]
    v_pk_mul_f32 v[20:21], v[132:133], v[132:133]
    v_pk_mul_f32 v[22:23], v[134:135], v[134:135]
    v_pk_fma_f32 v[16:17], v[16:17], v[34:35], v[32:33] op_sel_hi:[1,0,0]
    v_pk_fma_f32 v[18:19], v[18:19], v[34:35], v[32:33] op_sel_hi:[1,0,0]
    v_pk_fma_f32 v[20:21], v[20:21], v[40:41], v[38:39] op_sel_hi:[1,0,0]
    v_pk_fma_f32 v[22:23], v[22:23], v[40:41], v[38:39] op_sel_hi:[1,0,0]
    v_pk_mul_f32 v[16:17], v[16:17], v[128:129]
    v_pk_mul_f32 v[18:19], v[18:19], v[130:131]
    v_pk_mul_f32 v[20:21], v[20:21], v[132:133]
    v_pk_mul_f32 v[22:23], v[22:23], v[134:135]
    v_exp_f32 v16, v16
    v_exp_f32 v17, v17
    v_exp_f32 v18, v18
    v_exp_f32 v19, v19
    v_exp_f32 v20, v20
    v_exp_f32 v21, v21
    v_exp_f32 v22, v22
    v_exp_f32 v23, v23
    v_pk_mul_f32 v[128:129], v[128:129], v[144:145]
    v_pk_mul_f32 v[130:131], v[130:131], v[146:147]
    v_pk_mul_f32 v[132:133], v[132:133], v[148:149]
    v_pk_mul_f32 v[134:135], v[134:135], v[150:151]
    v_pk_fma_f32 v[16:17], v[16:17], v[36:37], v[36:37] op_sel_hi:[1,0,0]
    v_pk_fma_f32 v[18:19], v[18:19], v[36:37], v[36:37] op_sel_hi:[1,0,0]
    v_pk_fma_f32 v[20:21], v[20:21], v[42:43], v[42:43] op_sel_hi:[1,0,0]
    v_pk_fma_f32 v[22:23], v[22:23], v[42:43], v[42:43] op_sel_hi:[1,0,0]
    v_rcp_f32 v16, v16
    v_rcp_f32 v17, v17
    v_rcp_f32 v18, v18
    v_rcp_f32 v19, v19
    v_rcp_f32 v20, v20
    v_rcp_f32 v21, v21
    v_rcp_f32 v22, v22
    v_rcp_f32 v23, v23
    v_pk_mul_f32 v[128:129], v[128:129], v[16:17]
    v_pk_mul_f32 v[130:131], v[130:131], v[18:19]
    v_pk_mul_f32 v[132:133], v[132:133], v[20:21]
    v_pk_mul_f32 v[134:135], v[134:135], v[22:23]
    v_cvt_pk_bf16_f32 v144, v128, v129
    v_cvt_pk_bf16_f32 v145, v130, v131
    v_cvt_pk_bf16_f32 v146, v132, v133
    v_cvt_pk_bf16_f32 v147, v134, v135
    s_nop 0
    v_permlane16_swap_b32 v144, v146
    v_permlane16_swap_b32 v145, v147
    buffer_store_dwordx4 v[144:147], v7, s[8:11], s22 offen sc1
    s_nop 0
    v_pk_mul_f32 v[16:17], v[136:137], v[136:137]
    v_pk_mul_f32 v[18:19], v[138:139], v[138:139]
    v_pk_mul_f32 v[20:21], v[140:141], v[140:141]
    v_pk_mul_f32 v[22:23], v[142:143], v[142:143]
    v_pk_fma_f32 v[16:17], v[16:17], v[46:47], v[44:45] op_sel_hi:[1,0,0]
    v_pk_fma_f32 v[18:19], v[18:19], v[46:47], v[44:45] op_sel_hi:[1,0,0]
    v_pk_fma_f32 v[20:21], v[20:21], v[52:53], v[50:51] op_sel_hi:[1,0,0]
    v_pk_fma_f32 v[22:23], v[22:23], v[52:53], v[50:51] op_sel_hi:[1,0,0]
    v_pk_mul_f32 v[16:17], v[16:17], v[136:137]
    v_pk_mul_f32 v[18:19], v[18:19], v[138:139]
    v_pk_mul_f32 v[20:21], v[20:21], v[140:141]
    v_pk_mul_f32 v[22:23], v[22:23], v[142:143]
    v_exp_f32 v16, v16
    v_exp_f32 v17, v17
    v_exp_f32 v18, v18
    v_exp_f32 v19, v19
    v_exp_f32 v20, v20
    v_exp_f32 v21, v21
    v_exp_f32 v22, v22
    v_exp_f32 v23, v23
    v_pk_mul_f32 v[136:137], v[136:137], v[152:153]
    v_pk_mul_f32 v[138:139], v[138:139], v[154:155]
    v_pk_mul_f32 v[140:141], v[140:141], v[156:157]
    v_pk_mul_f32 v[142:143], v[142:143], v[158:159]
    v_pk_fma_f32 v[16:17], v[16:17], v[48:49], v[48:49] op_sel_hi:[1,0,0]
    v_pk_fma_f32 v[18:19], v[18:19], v[48:49], v[48:49] op_sel_hi:[1,0,0]
    v_pk_fma_f32 v[20:21], v[20:21], v[54:55], v[54:55] op_sel_hi:[1,0,0]
    v_pk_fma_f32 v[22:23], v[22:23], v[54:55], v[54:55] op_sel_hi:[1,0,0]
    v_rcp_f32 v16, v16
    v_rcp_f32 v17, v17
    v_rcp_f32 v18, v18
    v_rcp_f32 v19, v19
    v_rcp_f32 v20, v20
    v_rcp_f32 v21, v21
    v_rcp_f32 v22, v22
    v_rcp_f32 v23, v23
    v_pk_mul_f32 v[136:137], v[136:137], v[16:17]
    v_pk_mul_f32 v[138:139], v[138:139], v[18:19]
    v_pk_mul_f32 v[140:141], v[140:141], v[20:21]
    v_pk_mul_f32 v[142:143], v[142:143], v[22:23]
    v_cvt_pk_bf16_f32 v152, v136, v137
    v_cvt_pk_bf16_f32 v153, v138, v139
    v_cvt_pk_bf16_f32 v154, v140, v141
    v_cvt_pk_bf16_f32 v155, v142, v143
    s_nop 0
    v_permlane16_swap_b32 v152, v154
    v_permlane16_swap_b32 v153, v155
    buffer_store_dwordx4 v[152:155], v7, s[8:11], s23 offen sc1
    v_mov_b32 v244, 163328
    v_mov_b32 v245, 1
    s_waitcnt vmcnt(0)
    s_mov_b64 exec, 1
    ds_add_rtn_u32 v245, v244, v245
    s_mov_b64 exec, -1
    s_waitcnt lgkmcnt(0)
    v_readfirstlane_b32 s28, v245
    s_nop 0
    s_cmp_lg_u32 s28, 3
    s_cbranch_scc1 nf_97
    v_mov_b32 v246, s58
    v_mov_b32 v247, 0
    s_mov_b64 exec, 1
    buffer_store_dword v246, v247, s[8:11], s38 offen sc1
    s_mov_b64 exec, -1
nf_97:
    s_and_b32 s6, s2, 3
    s_lshl_b32 s6, s6, 3
    s_bfe_u32 s4, s2, 0x30003
    s_add_u32 s4, s4, s6
    s_bfe_u32 s6, s2, 0x10002
    s_lshl_b32 s6, s6, 2
    s_lshr_b32 s5, s2, 6
    s_add_u32 s5, s5, s6
    s_and_b32 s6, s3, 1
    s_lshr_b32 s7, s3, 1
    v_and_b32 v2, 15, v0
    v_lshrrev_b32 v3, 4, v0
    v_bfe_u32 v5, v0, 4, 1
    v_lshrrev_b32 v7, 5, v0
    v_lshlrev_b32 v22, 4, v0
    v_and_b32 v23, 31, v0
    v_lshlrev_b32 v23, 2, v23
    s_mul_i32 s28, s7, 5120
    v_add_u32_e64 v12, s28, v22
    v_add_u32 v13, 65536, v12
    v_add_u32 v14, 131072, v12
    s_lshl_b32 s20, s4, 1
    s_add_u32 s20, s20, s6
    v_mul_u32_u24 v30, 20480, v5
    v_lshl_add_u32 v30, v7, 8, v30
    v_lshl_add_u32 v30, v2, 4, v30
    s_mul_i32 s21, s20, 40960
    s_mul_i32 s28, s5, 2560
    s_add_u32 s21, s21, s28
    s_add_u32 s27, s21, 12060672
    s_lshl_b32 s28, s7, 10
    s_add_u32 s21, s21, s28
    s_add_u32 s21, s21, 12058624
    s_add_u32 s26, s21, 20480
    s_lshl_b32 s23, s20, 7
    s_add_u32 s23, s23, 30191616
    v_mov_b32 v19, v23
    s_lshl_b32 s28, s6, 12
    s_lshl_b32 s29, s7, 10
    s_add_u32 s28, s28, s29
    v_add_u32 v8, s28, v22
    v_add_u32 v9, 65536, v8
    v_add_u32 v10, 131072, v8
    s_mov_b32 s12, s54
    s_mov_b32 s13, s55
    s_mov_b32 s14, 2621440
    s_mov_b32 s15, 0x20000
    v_mul_u32_u24 v4, 1280, v2
    v_lshl_add_u32 v17, v3, 4, v4
    s_lshl_b32 s28, s7, 6
    v_add_u32 v17, s28, v17
    v_mul_u32_u24 v18, 20480, v5
    v_add_u32 v18, v18, v4
    v_lshl_add_u32 v18, v7, 4, v18
    s_mul_i32 s22, s20, 40960
    s_mul_i32 s28, s5, 160
    s_add_u32 s22, s22, s28
    s_add_u32 s25, s22, 20480
    v_lshl_or_b32 v27, s7, 31, v30
    s_mul_i32 s28, s6, 12288
    s_add_u32 s28, s28, 0
    v_add_u32 v6, s28, v22
    v_and_b32 v248, 15, v0
    v_mul_u32_u24 v248, 128, v248
    s_lshr_b32 s39, s4, 1
    s_mul_i32 s39, s39, 2048
    s_add_u32 s39, s39, 30633984
    s_cmp_lg_u32 s3, 1
    s_cbranch_scc1 np_98
    s_mov_b32 s59, 0x40000
    s_mov_b64 exec, 0xffff
poll_99:
    v_mov_b32 v249, 0
    buffer_atomic_or v249, v248, s[8:11], s39 offen sc0 sc1
    s_waitcnt vmcnt(0)
    v_cmp_ne_u32 vcc, s58, v249
    s_sub_u32 s59, s59, 1
    s_nop 2
    s_cbranch_vccz pollok_100
    s_cmp_eq_u32 s59, 0
    s_cbranch_scc1 pollok_100
    s_sleep 1
    s_branch poll_99
pollok_100:
    s_mov_b64 exec, -1
np_98:
    s_barrier
    buffer_load_dword v24, v19, s[8:11], s23 offen sc1
    buffer_load_dwordx4 v[32:35], v22, s[8:11], s21 offen sc1
    buffer_load_dwordx4 v[36:39], v22, s[8:11], s26 offen sc1
    buffer_load_dwordx4 v[40:43], v27, s[8:11], s27 offen sc1
    s_barrier
    ds_read_b128 v[160:163], v9 offset:36864
    ds_read_b128 v[112:115], v12 offset:0
    ds_read_b128 v[164:167], v9 offset:38912
    ds_read_b128 v[116:119], v12 offset:1024
    ds_read_b128 v[120:123], v12 offset:2048
    ds_read_b128 v[124:127], v12 offset:3072
    ds_read_b128 v[128:131], v12 offset:4096
    s_waitcnt lgkmcnt(0)
    v_mfma_f32_16x16x32_bf16 v[64:67], v[112:115], v[160:163], 0
    s_barrier
    ds_read_b128 v[168:171], v9 offset:47104
    v_mfma_f32_16x16x32_bf16 v[68:71], v[112:115], v[164:167], 0
    ds_read_b128 v[136:139], v12 offset:10240
    v_mfma_f32_16x16x32_bf16 v[72:75], v[116:119], v[160:163], 0
    ds_read_b128 v[172:175], v9 offset:49152
    v_mfma_f32_16x16x32_bf16 v[76:79], v[116:119], v[164:167], 0
    ds_read_b128 v[140:143], v12 offset:11264
    v_mfma_f32_16x16x32_bf16 v[80:83], v[120:123], v[160:163], 0
    ds_read_b128 v[144:147], v12 offset:12288
    v_mfma_f32_16x16x32_bf16 v[84:87], v[120:123], v[164:167], 0
    ds_read_b128 v[148:151], v12 offset:13312
    v_mfma_f32_16x16x32_bf16 v[88:91], v[124:127], v[160:163], 0
    ds_read_b128 v[152:155], v12 offset:14336
    v_mfma_f32_16x16x32_bf16 v[92:95], v[124:127], v[164:167], 0
    v_mfma_f32_16x16x32_bf16 v[96:99], v[128:131], v[160:163], 0
    v_mfma_f32_16x16x32_bf16 v[100:103], v[128:131], v[164:167], 0
    s_waitcnt lgkmcnt(0)
    v_mfma_f32_16x16x32_bf16 v[64:67], v[136:139], v[168:171], v[64:67]
    s_barrier
    ds_read_b128 v[160:163], v9 offset:57344
    v_mfma_f32_16x16x32_bf16 v[68:71], v[136:139], v[172:175], v[68:71]
    ds_read_b128 v[112:115], v12 offset:20480
    v_mfma_f32_16x16x32_bf16 v[72:75], v[140:143], v[168:171], v[72:75]
    ds_read_b128 v[164:167], v9 offset:59392
    v_mfma_f32_16x16x32_bf16 v[76:79], v[140:143], v[172:175], v[76:79]
    ds_read_b128 v[116:119], v12 offset:21504
    v_mfma_f32_16x16x32_bf16 v[80:83], v[144:147], v[168:171], v[80:83]
    ds_read_b128 v[120:123], v12 offset:22528
    v_mfma_f32_16x16x32_bf16 v[84:87], v[144:147], v[172:175], v[84:87]
    ds_read_b128 v[124:127], v12 offset:23552
    v_mfma_f32_16x16x32_bf16 v[88:91], v[148:151], v[168:171], v[88:91]
    ds_read_b128 v[128:131], v12 offset:24576
    v_mfma_f32_16x16x32_bf16 v[92:95], v[148:151], v[172:175], v[92:95]
    v_mfma_f32_16x16x32_bf16 v[96:99], v[152:155], v[168:171], v[96:99]
    v_mfma_f32_16x16x32_bf16 v[100:103], v[152:155], v[172:175], v[100:103]
    s_waitcnt lgkmcnt(0)
    v_mfma_f32_16x16x32_bf16 v[64:67], v[112:115], v[160:163], v[64:67]
    s_barrier
    ds_read_b128 v[168:171], v10 offset:2048
    v_mfma_f32_16x16x32_bf16 v[68:71], v[112:115], v[164:167], v[68:71]
    ds_read_b128 v[136:139], v12 offset:30720
    v_mfma_f32_16x16x32_bf16 v[72:75], v[116:119], v[160:163], v[72:75]
    ds_read_b128 v[172:175], v10 offset:4096
    v_mfma_f32_16x16x32_bf16 v[76:79], v[116:119], v[164:167], v[76:79]
    ds_read_b128 v[140:143], v12 offset:31744
    v_mfma_f32_16x16x32_bf16 v[80:83], v[120:123], v[160:163], v[80:83]
    ds_read_b128 v[144:147], v12 offset:32768
    v_mfma_f32_16x16x32_bf16 v[84:87], v[120:123], v[164:167], v[84:87]
    ds_read_b128 v[148:151], v12 offset:33792
    v_mfma_f32_16x16x32_bf16 v[88:91], v[124:127], v[160:163], v[88:91]
    ds_read_b128 v[152:155], v12 offset:34816
    v_mfma_f32_16x16x32_bf16 v[92:95], v[124:127], v[164:167], v[92:95]
    v_mfma_f32_16x16x32_bf16 v[96:99], v[128:131], v[160:163], v[96:99]
    v_mfma_f32_16x16x32_bf16 v[100:103], v[128:131], v[164:167], v[100:103]
    s_waitcnt lgkmcnt(0)
    v_mfma_f32_16x16x32_bf16 v[64:67], v[136:139], v[168:171], v[64:67]
    s_barrier
    ds_read_b128 v[160:163], v10 offset:12288
    v_mfma_f32_16x16x32_bf16 v[68:71], v[136:139], v[172:175], v[68:71]
    ds_read_b128 v[112:115], v12 offset:40960
    v_mfma_f32_16x16x32_bf16 v[72:75], v[140:143], v[168:171], v[72:75]
    ds_read_b128 v[164:167], v10 offset:14336
    v_mfma_f32_16x16x32_bf16 v[76:79], v[140:143], v[172:175], v[76:79]
    ds_read_b128 v[116:119], v12 offset:41984
    v_mfma_f32_16x16x32_bf16 v[80:83], v[144:147], v[168:171], v[80:83]
    ds_read_b128 v[120:123], v12 offset:43008
    v_mfma_f32_16x16x32_bf16 v[84:87], v[144:147], v[172:175], v[84:87]
    ds_read_b128 v[124:127], v12 offset:44032
    v_mfma_f32_16x16x32_bf16 v[88:91], v[148:151], v[168:171], v[88:91]
    ds_read_b128 v[128:131], v12 offset:45056
    v_mfma_f32_16x16x32_bf16 v[92:95], v[148:151], v[172:175], v[92:95]
    v_mfma_f32_16x16x32_bf16 v[96:99], v[152:155], v[168:171], v[96:99]
    v_mfma_f32_16x16x32_bf16 v[100:103], v[152:155], v[172:175], v[100:103]
    s_waitcnt lgkmcnt(0)
    v_mfma_f32_16x16x32_bf16 v[64:67], v[112:115], v[160:163], v[64:67]
    s_barrier
    ds_read_b128 v[168:171], v10 offset:22528
    v_mfma_f32_16x16x32_bf16 v[68:71], v[112:115], v[164:167], v[68:71]
    ds_read_b128 v[136:139], v12 offset:51200
    v_mfma_f32_16x16x32_bf16 v[72:75], v[116:119], v[160:163], v[72:75]
    ds_read_b128 v[172:175], v10 offset:24576
    v_mfma_f32_16x16x32_bf16 v[76:79], v[116:119], v[164:167], v[76:79]
    ds_read_b128 v[140:143], v12 offset:52224
    v_mfma_f32_16x16x32_bf16 v[80:83], v[120:123], v[160:163], v[80:83]
    ds_read_b128 v[144:147], v12 offset:53248
    v_mfma_f32_16x16x32_bf16 v[84:87], v[120:123], v[164:167], v[84:87]
    ds_read_b128 v[148:151], v12 offset:54272
    v_mfma_f32_16x16x32_bf16 v[88:91], v[124:127], v[160:163], v[88:91]
    ds_read_b128 v[152:155], v12 offset:55296
    v_mfma_f32_16x16x32_bf16 v[92:95], v[124:127], v[164:167], v[92:95]
    v_mfma_f32_16x16x32_bf16 v[96:99], v[128:131], v[160:163], v[96:99]
    v_mfma_f32_16x16x32_bf16 v[100:103], v[128:131], v[164:167], v[100:103]
    s_waitcnt lgkmcnt(0)
    v_mfma_f32_16x16x32_bf16 v[64:67], v[136:139], v[168:171], v[64:67]
    s_barrier
    ds_read_b128 v[160:163], v8 offset:0
    v_mfma_f32_16x16x32_bf16 v[68:71], v[136:139], v[172:175], v[68:71]
    ds_read_b128 v[112:115], v12 offset:61440
    v_mfma_f32_16x16x32_bf16 v[72:75], v[140:143], v[168:171], v[72:75]
    ds_read_b128 v[164:167], v8 offset:2048
    v_mfma_f32_16x16x32_bf16 v[76:79], v[140:143], v[172:175], v[76:79]
    ds_read_b128 v[116:119], v12 offset:62464
    v_mfma_f32_16x16x32_bf16 v[80:83], v[144:147], v[168:171], v[80:83]
    ds_read_b128 v[120:123], v12 offset:63488
    v_mfma_f32_16x16x32_bf16 v[84:87], v[144:147], v[172:175], v[84:87]
    ds_read_b128 v[124:127], v12 offset:64512
    v_mfma_f32_16x16x32_bf16 v[88:91], v[148:151], v[168:171], v[88:91]
    ds_read_b128 v[128:131], v13 offset:0
    v_mfma_f32_16x16x32_bf16 v[92:95], v[148:151], v[172:175], v[92:95]
    v_mfma_f32_16x16x32_bf16 v[96:99], v[152:155], v[168:171], v[96:99]
    v_mfma_f32_16x16x32_bf16 v[100:103], v[152:155], v[172:175], v[100:103]
    s_waitcnt lgkmcnt(0)
    v_mfma_f32_16x16x32_bf16 v[64:67], v[112:115], v[160:163], v[64:67]
    s_barrier
    ds_read_b128 v[168:171], v9 offset:36864
    v_mfma_f32_16x16x32_bf16 v[68:71], v[112:115], v[164:167], v[68:71]
    ds_read_b128 v[136:139], v13 offset:6144
    v_mfma_f32_16x16x32_bf16 v[72:75], v[116:119], v[160:163], v[72:75]
    ds_read_b128 v[172:175], v9 offset:38912
    v_mfma_f32_16x16x32_bf16 v[76:79], v[116:119], v[164:167], v[76:79]
    ds_read_b128 v[140:143], v13 offset:7168
    v_mfma_f32_16x16x32_bf16 v[80:83], v[120:123], v[160:163], v[80:83]
    ds_read_b128 v[144:147], v13 offset:8192
    v_mfma_f32_16x16x32_bf16 v[84:87], v[120:123], v[164:167], v[84:87]
    ds_read_b128 v[148:151], v13 offset:9216
    v_mfma_f32_16x16x32_bf16 v[88:91], v[124:127], v[160:163], v[88:91]
    ds_read_b128 v[152:155], v13 offset:10240
    v_mfma_f32_16x16x32_bf16 v[92:95], v[124:127], v[164:167], v[92:95]
    v_mfma_f32_16x16x32_bf16 v[96:99], v[128:131], v[160:163], v[96:99]
    v_mfma_f32_16x16x32_bf16 v[100:103], v[128:131], v[164:167], v[100:103]
    s_waitcnt lgkmcnt(0)
    v_mfma_f32_16x16x32_bf16 v[64:67], v[136:139], v[168:171], v[64:67]
    s_barrier
    ds_read_b128 v[160:163], v8 offset:10240
    v_mfma_f32_16x16x32_bf16 v[68:71], v[136:139], v[172:175], v[68:71]
    ds_read_b128 v[112:115], v13 offset:16384
    v_mfma_f32_16x16x32_bf16 v[72:75], v[140:143], v[168:171], v[72:75]
    ds_read_b128 v[164:167], v8 offset:12288
    v_mfma_f32_16x16x32_bf16 v[76:79], v[140:143], v[172:175], v[76:79]
    ds_read_b128 v[116:119], v13 offset:17408
    v_mfma_f32_16x16x32_bf16 v[80:83], v[144:147], v[168:171], v[80:83]
    ds_read_b128 v[120:123], v13 offset:18432
    v_mfma_f32_16x16x32_bf16 v[84:87], v[144:147], v[172:175], v[84:87]
    ds_read_b128 v[124:127], v13 offset:19456
    v_mfma_f32_16x16x32_bf16 v[88:91], v[148:151], v[168:171], v[88:91]
    ds_read_b128 v[128:131], v13 offset:20480
    v_mfma_f32_16x16x32_bf16 v[92:95], v[148:151], v[172:175], v[92:95]
    v_mfma_f32_16x16x32_bf16 v[96:99], v[152:155], v[168:171], v[96:99]
    v_mfma_f32_16x16x32_bf16 v[100:103], v[152:155], v[172:175], v[100:103]
    s_waitcnt lgkmcnt(0)
    v_mfma_f32_16x16x32_bf16 v[64:67], v[112:115], v[160:163], v[64:67]
    s_barrier
    ds_read_b128 v[168:171], v9 offset:47104
    v_mfma_f32_16x16x32_bf16 v[68:71], v[112:115], v[164:167], v[68:71]
    ds_read_b128 v[136:139], v13 offset:26624
    v_mfma_f32_16x16x32_bf16 v[72:75], v[116:119], v[160:163], v[72:75]
    ds_read_b128 v[172:175], v9 offset:49152
    v_mfma_f32_16x16x32_bf16 v[76:79], v[116:119], v[164:167], v[76:79]
    ds_read_b128 v[140:143], v13 offset:27648
    v_mfma_f32_16x16x32_bf16 v[80:83], v[120:123], v[160:163], v[80:83]
    ds_read_b128 v[144:147], v13 offset:28672
    v_mfma_f32_16x16x32_bf16 v[84:87], v[120:123], v[164:167], v[84:87]
    ds_read_b128 v[148:151], v13 offset:29696
    v_mfma_f32_16x16x32_bf16 v[88:91], v[124:127], v[160:163], v[88:91]
    ds_read_b128 v[152:155], v13 offset:30720
    v_mfma_f32_16x16x32_bf16 v[92:95], v[124:127], v[164:167], v[92:95]
    v_mfma_f32_16x16x32_bf16 v[96:99], v[128:131], v[160:163], v[96:99]
    v_mfma_f32_16x16x32_bf16 v[100:103], v[128:131], v[164:167], v[100:103]
    s_waitcnt lgkmcnt(0)
    v_mfma_f32_16x16x32_bf16 v[64:67], v[136:139], v[168:171], v[64:67]
    s_barrier
    ds_read_b128 v[160:163], v8 offset:20480
    v_mfma_f32_16x16x32_bf16 v[68:71], v[136:139], v[172:175], v[68:71]
    ds_read_b128 v[112:115], v12 offset:40960
    v_mfma_f32_16x16x32_bf16 v[72:75], v[140:143], v[168:171], v[72:75]
    ds_read_b128 v[164:167], v8 offset:22528
    v_mfma_f32_16x16x32_bf16 v[76:79], v[140:143], v[172:175], v[76:79]
    ds_read_b128 v[116:119], v12 offset:41984
    v_mfma_f32_16x16x32_bf16 v[80:83], v[144:147], v[168:171], v[80:83]
    ds_read_b128 v[120:123], v12 offset:43008
    v_mfma_f32_16x16x32_bf16 v[84:87], v[144:147], v[172:175], v[84:87]
    ds_read_b128 v[124:127], v12 offset:44032
    v_mfma_f32_16x16x32_bf16 v[88:91], v[148:151], v[168:171], v[88:91]
    ds_read_b128 v[128:131], v12 offset:45056
    v_mfma_f32_16x16x32_bf16 v[92:95], v[148:151], v[172:175], v[92:95]
    v_mfma_f32_16x16x32_bf16 v[96:99], v[152:155], v[168:171], v[96:99]
    v_mfma_f32_16x16x32_bf16 v[100:103], v[152:155], v[172:175], v[100:103]
    s_waitcnt lgkmcnt(0)
    v_mfma_f32_16x16x32_bf16 v[64:67], v[112:115], v[160:163], v[64:67]
    s_barrier
    ds_read_b128 v[168:171], v9 offset:57344
    v_mfma_f32_16x16x32_bf16 v[68:71], v[112:115], v[164:167], v[68:71]
    ds_read_b128 v[136:139], v12 offset:51200
    v_mfma_f32_16x16x32_bf16 v[72:75], v[116:119], v[160:163], v[72:75]
    ds_read_b128 v[172:175], v9 offset:59392
    v_mfma_f32_16x16x32_bf16 v[76:79], v[116:119], v[164:167], v[76:79]
    ds_read_b128 v[140:143], v12 offset:52224
    v_mfma_f32_16x16x32_bf16 v[80:83], v[120:123], v[160:163], v[80:83]
    ds_read_b128 v[144:147], v12 offset:53248
    v_mfma_f32_16x16x32_bf16 v[84:87], v[120:123], v[164:167], v[84:87]
    ds_read_b128 v[148:151], v12 offset:54272
    v_mfma_f32_16x16x32_bf16 v[88:91], v[124:127], v[160:163], v[88:91]
    ds_read_b128 v[152:155], v12 offset:55296
    v_mfma_f32_16x16x32_bf16 v[92:95], v[124:127], v[164:167], v[92:95]
    v_mfma_f32_16x16x32_bf16 v[96:99], v[128:131], v[160:163], v[96:99]
    v_mfma_f32_16x16x32_bf16 v[100:103], v[128:131], v[164:167], v[100:103]
    s_waitcnt lgkmcnt(0)
    v_mfma_f32_16x16x32_bf16 v[64:67], v[136:139], v[168:171], v[64:67]
    s_barrier
    ds_read_b128 v[160:163], v8 offset:30720
    v_mfma_f32_16x16x32_bf16 v[68:71], v[136:139], v[172:175], v[68:71]
    ds_read_b128 v[112:115], v12 offset:61440
    v_mfma_f32_16x16x32_bf16 v[72:75], v[140:143], v[168:171], v[72:75]
    ds_read_b128 v[164:167], v8 offset:32768
    v_mfma_f32_16x16x32_bf16 v[76:79], v[140:143], v[172:175], v[76:79]
    ds_read_b128 v[116:119], v12 offset:62464
    v_mfma_f32_16x16x32_bf16 v[80:83], v[144:147], v[168:171], v[80:83]
    ds_read_b128 v[120:123], v12 offset:63488
    v_mfma_f32_16x16x32_bf16 v[84:87], v[144:147], v[172:175], v[84:87]
    ds_read_b128 v[124:127], v12 offset:64512
    v_mfma_f32_16x16x32_bf16 v[88:91], v[148:151], v[168:171], v[88:91]
    ds_read_b128 v[128:131], v13 offset:0
    v_mfma_f32_16x16x32_bf16 v[92:95], v[148:151], v[172:175], v[92:95]
    v_mfma_f32_16x16x32_bf16 v[96:99], v[152:155], v[168:171], v[96:99]
    v_mfma_f32_16x16x32_bf16 v[100:103], v[152:155], v[172:175], v[100:103]
    s_waitcnt lgkmcnt(0)
    v_mfma_f32_16x16x32_bf16 v[64:67], v[112:115], v[160:163], v[64:67]
    s_barrier
    ds_read_b128 v[168:171], v10 offset:2048
    v_mfma_f32_16x16x32_bf16 v[68:71], v[112:115], v[164:167], v[68:71]
    ds_read_b128 v[136:139], v13 offset:6144
    v_mfma_f32_16x16x32_bf16 v[72:75], v[116:119], v[160:163], v[72:75]
    ds_read_b128 v[172:175], v10 offset:4096
    v_mfma_f32_16x16x32_bf16 v[76:79], v[116:119], v[164:167], v[76:79]
    ds_read_b128 v[140:143], v13 offset:7168
    v_mfma_f32_16x16x32_bf16 v[80:83], v[120:123], v[160:163], v[80:83]
    ds_read_b128 v[144:147], v13 offset:8192
    v_mfma_f32_16x16x32_bf16 v[84:87], v[120:123], v[164:167], v[84:87]
    ds_read_b128 v[148:151], v13 offset:9216
    v_mfma_f32_16x16x32_bf16 v[88:91], v[124:127], v[160:163], v[88:91]
    ds_read_b128 v[152:155], v13 offset:10240
    v_mfma_f32_16x16x32_bf16 v[92:95], v[124:127], v[164:167], v[92:95]
    v_mfma_f32_16x16x32_bf16 v[96:99], v[128:131], v[160:163], v[96:99]
    v_mfma_f32_16x16x32_bf16 v[100:103], v[128:131], v[164:167], v[100:103]
    s_waitcnt lgkmcnt(0)
    v_mfma_f32_16x16x32_bf16 v[64:67], v[136:139], v[168:171], v[64:67]
    s_barrier
    ds_read_b128 v[160:163], v10 offset:12288
    v_mfma_f32_16x16x32_bf16 v[68:71], v[136:139], v[172:175], v[68:71]
    ds_read_b128 v[112:115], v13 offset:16384
    v_mfma_f32_16x16x32_bf16 v[72:75], v[140:143], v[168:171], v[72:75]
    ds_read_b128 v[164:167], v10 offset:14336
    v_mfma_f32_16x16x32_bf16 v[76:79], v[140:143], v[172:175], v[76:79]
    ds_read_b128 v[116:119], v13 offset:17408
    v_mfma_f32_16x16x32_bf16 v[80:83], v[144:147], v[168:171], v[80:83]
    ds_read_b128 v[120:123], v13 offset:18432
    v_mfma_f32_16x16x32_bf16 v[84:87], v[144:147], v[172:175], v[84:87]
    ds_read_b128 v[124:127], v13 offset:19456
    v_mfma_f32_16x16x32_bf16 v[88:91], v[148:151], v[168:171], v[88:91]
    ds_read_b128 v[128:131], v13 offset:20480
    v_mfma_f32_16x16x32_bf16 v[92:95], v[148:151], v[172:175], v[92:95]
    v_mfma_f32_16x16x32_bf16 v[96:99], v[152:155], v[168:171], v[96:99]
    v_mfma_f32_16x16x32_bf16 v[100:103], v[152:155], v[172:175], v[100:103]
    s_waitcnt lgkmcnt(0)
    v_mfma_f32_16x16x32_bf16 v[64:67], v[112:115], v[160:163], v[64:67]
    s_barrier
    ds_read_b128 v[168:171], v10 offset:22528
    v_mfma_f32_16x16x32_bf16 v[68:71], v[112:115], v[164:167], v[68:71]
    ds_read_b128 v[136:139], v13 offset:26624
    v_mfma_f32_16x16x32_bf16 v[72:75], v[116:119], v[160:163], v[72:75]
    ds_read_b128 v[172:175], v10 offset:24576
    v_mfma_f32_16x16x32_bf16 v[76:79], v[116:119], v[164:167], v[76:79]
    ds_read_b128 v[140:143], v13 offset:27648
    v_mfma_f32_16x16x32_bf16 v[80:83], v[120:123], v[160:163], v[80:83]
    ds_read_b128 v[144:147], v13 offset:28672
    v_mfma_f32_16x16x32_bf16 v[84:87], v[120:123], v[164:167], v[84:87]
    ds_read_b128 v[148:151], v13 offset:29696
    v_mfma_f32_16x16x32_bf16 v[88:91], v[124:127], v[160:163], v[88:91]
    ds_read_b128 v[152:155], v13 offset:30720
    v_mfma_f32_16x16x32_bf16 v[92:95], v[124:127], v[164:167], v[92:95]
    v_mfma_f32_16x16x32_bf16 v[96:99], v[128:131], v[160:163], v[96:99]
    v_mfma_f32_16x16x32_bf16 v[100:103], v[128:131], v[164:167], v[100:103]
    s_waitcnt lgkmcnt(0)
    v_mfma_f32_16x16x32_bf16 v[64:67], v[136:139], v[168:171], v[64:67]
    s_barrier
    ds_read_b128 v[160:163], v8 offset:0
    v_mfma_f32_16x16x32_bf16 v[68:71], v[136:139], v[172:175], v[68:71]
    ds_read_b128 v[112:115], v12 offset:40960
    v_mfma_f32_16x16x32_bf16 v[72:75], v[140:143], v[168:171], v[72:75]
    ds_read_b128 v[164:167], v8 offset:2048
    v_mfma_f32_16x16x32_bf16 v[76:79], v[140:143], v[172:175], v[76:79]
    ds_read_b128 v[116:119], v12 offset:41984
    v_mfma_f32_16x16x32_bf16 v[80:83], v[144:147], v[168:171], v[80:83]
    ds_read_b128 v[120:123], v12 offset:43008
    v_mfma_f32_16x16x32_bf16 v[84:87], v[144:147], v[172:175], v[84:87]
    ds_read_b128 v[124:127], v12 offset:44032
    v_mfma_f32_16x16x32_bf16 v[88:91], v[148:151], v[168:171], v[88:91]
    ds_read_b128 v[128:131], v12 offset:45056
    v_mfma_f32_16x16x32_bf16 v[92:95], v[148:151], v[172:175], v[92:95]
    v_mfma_f32_16x16x32_bf16 v[96:99], v[152:155], v[168:171], v[96:99]
    v_mfma_f32_16x16x32_bf16 v[100:103], v[152:155], v[172:175], v[100:103]
    s_waitcnt lgkmcnt(0)
    v_mfma_f32_16x16x32_bf16 v[64:67], v[112:115], v[160:163], v[64:67]
    s_barrier
    ds_read_b128 v[168:171], v9 offset:36864
    v_mfma_f32_16x16x32_bf16 v[68:71], v[112:115], v[164:167], v[68:71]
    ds_read_b128 v[136:139], v12 offset:51200
    v_mfma_f32_16x16x32_bf16 v[72:75], v[116:119], v[160:163], v[72:75]
    ds_read_b128 v[172:175], v9 offset:38912
    v_mfma_f32_16x16x32_bf16 v[76:79], v[116:119], v[164:167], v[76:79]
    ds_read_b128 v[140:143], v12 offset:52224
    v_mfma_f32_16x16x32_bf16 v[80:83], v[120:123], v[160:163], v[80:83]
    ds_read_b128 v[144:147], v12 offset:53248
    v_mfma_f32_16x16x32_bf16 v[84:87], v[120:123], v[164:167], v[84:87]
    ds_read_b128 v[148:151], v12 offset:54272
    v_mfma_f32_16x16x32_bf16 v[88:91], v[124:127], v[160:163], v[88:91]
    ds_read_b128 v[152:155], v12 offset:55296
    v_mfma_f32_16x16x32_bf16 v[92:95], v[124:127], v[164:167], v[92:95]
    v_mfma_f32_16x16x32_bf16 v[96:99], v[128:131], v[160:163], v[96:99]
    v_mfma_f32_16x16x32_bf16 v[100:103], v[128:131], v[164:167], v[100:103]
    s_waitcnt lgkmcnt(0)
    v_mfma_f32_16x16x32_bf16 v[64:67], v[136:139], v[168:171], v[64:67]
    s_barrier
    ds_read_b128 v[160:163], v8 offset:10240
    v_mfma_f32_16x16x32_bf16 v[68:71], v[136:139], v[172:175], v[68:71]
    ds_read_b128 v[112:115], v12 offset:61440
    v_mfma_f32_16x16x32_bf16 v[72:75], v[140:143], v[168:171], v[72:75]
    ds_read_b128 v[164:167], v8 offset:12288
    v_mfma_f32_16x16x32_bf16 v[76:79], v[140:143], v[172:175], v[76:79]
    ds_read_b128 v[116:119], v12 offset:62464
    v_mfma_f32_16x16x32_bf16 v[80:83], v[144:147], v[168:171], v[80:83]
    ds_read_b128 v[120:123], v12 offset:63488
    v_mfma_f32_16x16x32_bf16 v[84:87], v[144:147], v[172:175], v[84:87]
    ds_read_b128 v[124:127], v12 offset:64512
    v_mfma_f32_16x16x32_bf16 v[88:91], v[148:151], v[168:171], v[88:91]
    ds_read_b128 v[128:131], v13 offset:0
    v_mfma_f32_16x16x32_bf16 v[92:95], v[148:151], v[172:175], v[92:95]
    v_mfma_f32_16x16x32_bf16 v[96:99], v[152:155], v[168:171], v[96:99]
    v_mfma_f32_16x16x32_bf16 v[100:103], v[152:155], v[172:175], v[100:103]
    s_waitcnt lgkmcnt(0)
    v_mfma_f32_16x16x32_bf16 v[64:67], v[112:115], v[160:163], v[64:67]
    s_barrier
    ds_read_b128 v[168:171], v9 offset:47104
    v_mfma_f32_16x16x32_bf16 v[68:71], v[112:115], v[164:167], v[68:71]
    ds_read_b128 v[136:139], v13 offset:6144
    v_mfma_f32_16x16x32_bf16 v[72:75], v[116:119], v[160:163], v[72:75]
    ds_read_b128 v[172:175], v9 offset:49152
    v_mfma_f32_16x16x32_bf16 v[76:79], v[116:119], v[164:167], v[76:79]
    ds_read_b128 v[140:143], v13 offset:7168
    v_mfma_f32_16x16x32_bf16 v[80:83], v[120:123], v[160:163], v[80:83]
    ds_read_b128 v[144:147], v13 offset:8192
    v_mfma_f32_16x16x32_bf16 v[84:87], v[120:123], v[164:167], v[84:87]
    ds_read_b128 v[148:151], v13 offset:9216
    v_mfma_f32_16x16x32_bf16 v[88:91], v[124:127], v[160:163], v[88:91]
    ds_read_b128 v[152:155], v13 offset:10240
    v_mfma_f32_16x16x32_bf16 v[92:95], v[124:127], v[164:167], v[92:95]
    v_mfma_f32_16x16x32_bf16 v[96:99], v[128:131], v[160:163], v[96:99]
    v_mfma_f32_16x16x32_bf16 v[100:103], v[128:131], v[164:167], v[100:103]
    s_waitcnt lgkmcnt(0)
    v_mfma_f32_16x16x32_bf16 v[64:67], v[136:139], v[168:171], v[64:67]
    s_barrier
    ds_read_b128 v[160:163], v8 offset:20480
    v_mfma_f32_16x16x32_bf16 v[68:71], v[136:139], v[172:175], v[68:71]
    ds_read_b128 v[112:115], v13 offset:16384
    v_mfma_f32_16x16x32_bf16 v[72:75], v[140:143], v[168:171], v[72:75]
    ds_read_b128 v[164:167], v8 offset:22528
    v_mfma_f32_16x16x32_bf16 v[76:79], v[140:143], v[172:175], v[76:79]
    ds_read_b128 v[116:119], v13 offset:17408
    v_mfma_f32_16x16x32_bf16 v[80:83], v[144:147], v[168:171], v[80:83]
    ds_read_b128 v[120:123], v13 offset:18432
    v_mfma_f32_16x16x32_bf16 v[84:87], v[144:147], v[172:175], v[84:87]
    ds_read_b128 v[124:127], v13 offset:19456
    v_mfma_f32_16x16x32_bf16 v[88:91], v[148:151], v[168:171], v[88:91]
    ds_read_b128 v[128:131], v13 offset:20480
    v_mfma_f32_16x16x32_bf16 v[92:95], v[148:151], v[172:175], v[92:95]
    v_mfma_f32_16x16x32_bf16 v[96:99], v[152:155], v[168:171], v[96:99]
    v_mfma_f32_16x16x32_bf16 v[100:103], v[152:155], v[172:175], v[100:103]
    s_waitcnt lgkmcnt(0)
    v_mfma_f32_16x16x32_bf16 v[64:67], v[112:115], v[160:163], v[64:67]
    s_barrier
    ds_read_b128 v[168:171], v9 offset:57344
    v_mfma_f32_16x16x32_bf16 v[68:71], v[112:115], v[164:167], v[68:71]
    ds_read_b128 v[136:139], v14 offset:12288
    v_mfma_f32_16x16x32_bf16 v[72:75], v[116:119], v[160:163], v[72:75]
    ds_read_b128 v[172:175], v9 offset:59392
    v_mfma_f32_16x16x32_bf16 v[76:79], v[116:119], v[164:167], v[76:79]
    ds_read_b128 v[140:143], v14 offset:13312
    v_mfma_f32_16x16x32_bf16 v[80:83], v[120:123], v[160:163], v[80:83]
    ds_read_b128 v[144:147], v14 offset:14336
    v_mfma_f32_16x16x32_bf16 v[84:87], v[120:123], v[164:167], v[84:87]
    ds_read_b128 v[148:151], v14 offset:15360
    v_mfma_f32_16x16x32_bf16 v[88:91], v[124:127], v[160:163], v[88:91]
    ds_read_b128 v[152:155], v14 offset:16384
    v_mfma_f32_16x16x32_bf16 v[92:95], v[124:127], v[164:167], v[92:95]
    v_mfma_f32_16x16x32_bf16 v[96:99], v[128:131], v[160:163], v[96:99]
    v_mfma_f32_16x16x32_bf16 v[100:103], v[128:131], v[164:167], v[100:103]
    s_waitcnt lgkmcnt(0)
    v_mfma_f32_16x16x32_bf16 v[64:67], v[136:139], v[168:171], v[64:67]
    s_barrier
    ds_read_b128 v[160:163], v8 offset:30720
    v_mfma_f32_16x16x32_bf16 v[68:71], v[136:139], v[172:175], v[68:71]
    ds_read_b128 v[112:115], v13 offset:26624
    v_mfma_f32_16x16x32_bf16 v[72:75], v[140:143], v[168:171], v[72:75]
    ds_read_b128 v[164:167], v8 offset:32768
    v_mfma_f32_16x16x32_bf16 v[76:79], v[140:143], v[172:175], v[76:79]
    ds_read_b128 v[116:119], v13 offset:27648
    v_mfma_f32_16x16x32_bf16 v[80:83], v[144:147], v[168:171], v[80:83]
    ds_read_b128 v[120:123], v13 offset:28672
    v_mfma_f32_16x16x32_bf16 v[84:87], v[144:147], v[172:175], v[84:87]
    ds_read_b128 v[124:127], v13 offset:29696
    v_mfma_f32_16x16x32_bf16 v[88:91], v[148:151], v[168:171], v[88:91]
    ds_read_b128 v[128:131], v13 offset:30720
    v_mfma_f32_16x16x32_bf16 v[92:95], v[148:151], v[172:175], v[92:95]
    v_mfma_f32_16x16x32_bf16 v[96:99], v[152:155], v[168:171], v[96:99]
    v_mfma_f32_16x16x32_bf16 v[100:103], v[152:155], v[172:175], v[100:103]
    s_waitcnt lgkmcnt(0)
    v_mfma_f32_16x16x32_bf16 v[64:67], v[112:115], v[160:163], v[64:67]
    s_barrier
    ds_read_b128 v[168:171], v10 offset:2048
    v_mfma_f32_16x16x32_bf16 v[68:71], v[112:115], v[164:167], v[68:71]
    ds_read_b128 v[136:139], v14 offset:22528
    v_mfma_f32_16x16x32_bf16 v[72:75], v[116:119], v[160:163], v[72:75]
    ds_read_b128 v[172:175], v10 offset:4096
    v_mfma_f32_16x16x32_bf16 v[76:79], v[116:119], v[164:167], v[76:79]
    ds_read_b128 v[140:143], v14 offset:23552
    v_mfma_f32_16x16x32_bf16 v[80:83], v[120:123], v[160:163], v[80:83]
    ds_read_b128 v[144:147], v14 offset:24576
    v_mfma_f32_16x16x32_bf16 v[84:87], v[120:123], v[164:167], v[84:87]
    ds_read_b128 v[148:151], v14 offset:25600
    v_mfma_f32_16x16x32_bf16 v[88:91], v[124:127], v[160:163], v[88:91]
    ds_read_b128 v[152:155], v14 offset:26624
    v_mfma_f32_16x16x32_bf16 v[92:95], v[124:127], v[164:167], v[92:95]
    v_mfma_f32_16x16x32_bf16 v[96:99], v[128:131], v[160:163], v[96:99]
    v_mfma_f32_16x16x32_bf16 v[100:103], v[128:131], v[164:167], v[100:103]
    s_waitcnt lgkmcnt(0)
    v_mfma_f32_16x16x32_bf16 v[64:67], v[136:139], v[168:171], v[64:67]
    v_mfma_f32_16x16x32_bf16 v[68:71], v[136:139], v[172:175], v[68:71]
    v_mfma_f32_16x16x32_bf16 v[72:75], v[140:143], v[168:171], v[72:75]
    v_mfma_f32_16x16x32_bf16 v[76:79], v[140:143], v[172:175], v[76:79]
    v_mfma_f32_16x16x32_bf16 v[80:83], v[144:147], v[168:171], v[80:83]
    v_mfma_f32_16x16x32_bf16 v[84:87], v[144:147], v[172:175], v[84:87]
    v_mfma_f32_16x16x32_bf16 v[88:91], v[148:151], v[168:171], v[88:91]
    v_mfma_f32_16x16x32_bf16 v[92:95], v[148:151], v[172:175], v[92:95]
    v_mfma_f32_16x16x32_bf16 v[96:99], v[152:155], v[168:171], v[96:99]
    v_mfma_f32_16x16x32_bf16 v[100:103], v[152:155], v[172:175], v[100:103]
    s_cmp_eq_u32 s7, 1
    s_nop 0
    s_cbranch_scc1 p5_k1_101
    s_nop 0
    ds_write_b128 v6, v[80:83] offset:0
    s_nop 0
    ds_write_b128 v6, v[88:91] offset:1024
    ds_write_b128 v6, v[84:87] offset:2048
    ds_write_b128 v6, v[92:95] offset:3072
    s_waitcnt lgkmcnt(0)
    s_barrier
    ds_read_b128 v[112:115], v6 offset:5120
    ds_read_b128 v[116:119], v6 offset:6144
    ds_read_b128 v[120:123], v6 offset:7168
    ds_read_b128 v[124:127], v6 offset:8192
    ds_read_b128 v[128:131], v6 offset:9216
    ds_read_b128 v[132:135], v6 offset:10240
    s_waitcnt vmcnt(0)
    v_mov_b32 v28, v24
    v_mov_b32 v26, v24
    v_lshlrev_b32 v144, 16, v32
    v_and_b32 v145, 0xffff0000, v32
    v_lshlrev_b32 v146, 16, v33
    v_and_b32 v147, 0xffff0000, v33
    v_lshlrev_b32 v148, 16, v34
    v_and_b32 v149, 0xffff0000, v34
    v_lshlrev_b32 v150, 16, v35
    v_and_b32 v151, 0xffff0000, v35
    v_lshlrev_b32 v152, 16, v36
    v_and_b32 v153, 0xffff0000, v36
    v_lshlrev_b32 v154, 16, v37
    v_and_b32 v155, 0xffff0000, v37
    v_lshlrev_b32 v156, 16, v38
    v_and_b32 v157, 0xffff0000, v38
    v_lshlrev_b32 v158, 16, v39
    v_and_b32 v159, 0xffff0000, v39
    v_lshlrev_b32 v160, 16, v40
    v_and_b32 v161, 0xffff0000, v40
    v_lshlrev_b32_e64 v162, 16, v41
    v_and_b32 v163, 0xffff0000, v41
    v_lshlrev_b32_e64 v164, 16, v42
    v_and_b32 v165, 0xffff0000, v42
    v_lshlrev_b32_e64 v166, 16, v43
    v_and_b32 v167, 0xffff0000, v43
    v_permlane16_swap_b32 v28, v26
    s_nop 0
    v_pk_add_f32 v[64:65], v[64:65], v[144:145]
    v_pk_add_f32 v[66:67], v[66:67], v[146:147]
    v_pk_add_f32 v[72:73], v[72:73], v[148:149]
    v_pk_add_f32 v[74:75], v[74:75], v[150:151]
    v_pk_add_f32 v[68:69], v[68:69], v[152:153]
    v_pk_add_f32 v[70:71], v[70:71], v[154:155]
    v_pk_add_f32 v[76:77], v[76:77], v[156:157]
    v_pk_add_f32 v[78:79], v[78:79], v[158:159]
    s_waitcnt lgkmcnt(0)
    s_nop 0
    v_pk_add_f32 v[64:65], v[64:65], v[112:113]
    v_pk_add_f32 v[66:67], v[66:67], v[114:115]
    v_pk_add_f32 v[72:73], v[72:73], v[116:117]
    v_pk_add_f32 v[74:75], v[74:75], v[118:119]
    v_pk_add_f32 v[64:65], v[64:65], v[28:29] op_sel_hi:[1,0]
    v_pk_add_f32 v[66:67], v[66:67], v[28:29] op_sel_hi:[1,0]
    v_pk_add_f32 v[72:73], v[72:73], v[28:29] op_sel_hi:[1,0]
    v_pk_add_f32 v[74:75], v[74:75], v[28:29] op_sel_hi:[1,0]
    v_cvt_pk_bf16_f32 v112, v64, v65
    v_cvt_pk_bf16_f32 v113, v66, v67
    v_cvt_pk_bf16_f32 v114, v72, v73
    v_cvt_pk_bf16_f32 v115, v74, v75
    buffer_store_dwordx4 v[112:115], v17, s[12:15], s22 offen offset:0
    v_pk_add_f32 v[68:69], v[68:69], v[120:121]
    v_pk_add_f32 v[70:71], v[70:71], v[122:123]
    v_pk_add_f32 v[76:77], v[76:77], v[124:125]
    v_pk_add_f32 v[78:79], v[78:79], v[126:127]
    v_pk_add_f32 v[68:69], v[68:69], v[26:27] op_sel_hi:[1,0]
    v_pk_add_f32 v[70:71], v[70:71], v[26:27] op_sel_hi:[1,0]
    v_pk_add_f32 v[76:77], v[76:77], v[26:27] op_sel_hi:[1,0]
    v_pk_add_f32 v[78:79], v[78:79], v[26:27] op_sel_hi:[1,0]
    v_cvt_pk_bf16_f32 v120, v68, v69
    v_cvt_pk_bf16_f32 v121, v70, v71
    v_cvt_pk_bf16_f32 v122, v76, v77
    v_cvt_pk_bf16_f32 v123, v78, v79
    buffer_store_dwordx4 v[120:123], v17, s[12:15], s25 offen offset:0
    v_pk_add_f32 v[96:97], v[96:97], v[128:129]
    v_pk_add_f32 v[98:99], v[98:99], v[130:131]
    v_pk_add_f32 v[100:101], v[100:101], v[132:133]
    v_pk_add_f32 v[102:103], v[102:103], v[134:135]
    s_nop 0
    v_permlane16_swap_b32 v96, v100
    v_permlane16_swap_b32 v97, v101
    v_permlane16_swap_b32 v98, v102
    v_permlane16_swap_b32 v99, v103
    s_nop 0
    v_pk_add_f32 v[96:97], v[96:97], v[160:161]
    v_pk_add_f32 v[98:99], v[98:99], v[162:163]
    v_pk_add_f32 v[100:101], v[100:101], v[164:165]
    v_pk_add_f32 v[102:103], v[102:103], v[166:167]
    v_pk_add_f32 v[96:97], v[96:97], v[24:25] op_sel_hi:[1,0]
    v_pk_add_f32 v[98:99], v[98:99], v[24:25] op_sel_hi:[1,0]
    v_pk_add_f32 v[100:101], v[100:101], v[24:25] op_sel_hi:[1,0]
    v_pk_add_f32 v[102:103], v[102:103], v[24:25] op_sel_hi:[1,0]
    v_cvt_pk_bf16_f32 v128, v96, v97
    v_cvt_pk_bf16_f32 v129, v98, v99
    v_cvt_pk_bf16_f32 v130, v100, v101
    v_cvt_pk_bf16_f32 v131, v102, v103
    buffer_store_dwordx4 v[128:131], v18, s[12:15], s22 offen offset:128
    s_branch p5_done_102
p5_k1_101:
    ds_write_b128 v6, v[64:67] offset:5120
    ds_write_b128 v6, v[72:75] offset:6144
    ds_write_b128 v6, v[68:71] offset:7168
    ds_write_b128 v6, v[76:79] offset:8192
    ds_write_b128 v6, v[96:99] offset:9216
    ds_write_b128 v6, v[100:103] offset:10240
    s_waitcnt lgkmcnt(0)
    s_barrier
    ds_read_b128 v[112:115], v6 offset:0
    ds_read_b128 v[116:119], v6 offset:1024
    ds_read_b128 v[120:123], v6 offset:2048
    ds_read_b128 v[124:127], v6 offset:3072
    s_waitcnt vmcnt(0)
    v_mov_b32 v28, v24
    v_mov_b32 v26, v24
    v_lshlrev_b32 v144, 16, v32
    v_and_b32 v145, 0xffff0000, v32
    v_lshlrev_b32 v146, 16, v33
    v_and_b32 v147, 0xffff0000, v33
    v_lshlrev_b32 v148, 16, v34
    v_and_b32 v149, 0xffff0000, v34
    v_lshlrev_b32 v150, 16, v35
    v_and_b32 v151, 0xffff0000, v35
    v_lshlrev_b32 v152, 16, v36
    v_and_b32 v153, 0xffff0000, v36
    v_lshlrev_b32 v154, 16, v37
    v_and_b32 v155, 0xffff0000, v37
    v_lshlrev_b32_e64 v156, 16, v38
    v_and_b32 v157, 0xffff0000, v38
    v_lshlrev_b32_e64 v158, 16, v39
    v_and_b32 v159, 0xffff0000, v39
    v_permlane16_swap_b32 v28, v26
    s_nop 0
    v_pk_add_f32 v[80:81], v[80:81], v[144:145]
    v_pk_add_f32 v[82:83], v[82:83], v[146:147]
    v_pk_add_f32 v[88:89], v[88:89], v[148:149]
    v_pk_add_f32 v[90:91], v[90:91], v[150:151]
    v_pk_add_f32 v[84:85], v[84:85], v[152:153]
    v_pk_add_f32 v[86:87], v[86:87], v[154:155]
    v_pk_add_f32 v[92:93], v[92:93], v[156:157]
    v_pk_add_f32 v[94:95], v[94:95], v[158:159]
    s_waitcnt lgkmcnt(0)
    s_nop 0
    v_pk_add_f32 v[80:81], v[80:81], v[112:113]
    v_pk_add_f32 v[82:83], v[82:83], v[114:115]
    v_pk_add_f32 v[88:89], v[88:89], v[116:117]
    v_pk_add_f32 v[90:91], v[90:91], v[118:119]
    v_pk_add_f32 v[80:81], v[80:81], v[28:29] op_sel_hi:[1,0]
    v_pk_add_f32 v[82:83], v[82:83], v[28:29] op_sel_hi:[1,0]
    v_pk_add_f32 v[88:89], v[88:89], v[28:29] op_sel_hi:[1,0]
    v_pk_add_f32 v[90:91], v[90:91], v[28:29] op_sel_hi:[1,0]
    v_cvt_pk_bf16_f32 v112, v80, v81
    v_cvt_pk_bf16_f32 v113, v82, v83
    v_cvt_pk_bf16_f32 v114, v88, v89
    v_cvt_pk_bf16_f32 v115, v90, v91
    buffer_store_dwordx4 v[112:115], v17, s[12:15], s22 offen offset:0
    v_pk_add_f32 v[84:85], v[84:85], v[120:121]
    v_pk_add_f32 v[86:87], v[86:87], v[122:123]
    v_pk_add_f32 v[92:93], v[92:93], v[124:125]
    v_pk_add_f32 v[94:95], v[94:95], v[126:127]
    v_pk_add_f32 v[84:85], v[84:85], v[26:27] op_sel_hi:[1,0]
    v_pk_add_f32 v[86:87], v[86:87], v[26:27] op_sel_hi:[1,0]
    v_pk_add_f32 v[92:93], v[92:93], v[26:27] op_sel_hi:[1,0]
    v_pk_add_f32 v[94:95], v[94:95], v[26:27] op_sel_hi:[1,0]
    v_cvt_pk_bf16_f32 v120, v84, v85
    v_cvt_pk_bf16_f32 v121, v86, v87
    v_cvt_pk_bf16_f32 v122, v92, v93
    v_cvt_pk_bf16_f32 v123, v94, v95
    buffer_store_dwordx4 v[120:123], v17, s[12:15], s25 offen offset:0
p5_done_102:
    s_endpgm
tail_l0:
    v_lshlrev_b32 v2, 4, v0
    s_waitcnt vmcnt(0)
    s_barrier
    s_mov_b32 s29, 30668800
    s_mov_b32 s59, 0x40000
poll_103:
    buffer_load_dwordx4 v[4:7], v2, s[8:11], s29 offen sc1
    s_waitcnt vmcnt(0)
    v_xor_b32 v4, s58, v4
    v_xor_b32 v5, s58, v5
    v_xor_b32 v6, s58, v6
    v_xor_b32 v7, s58, v7
    v_or_b32 v4, v4, v5
    v_or_b32 v4, v4, v6
    v_or_b32 v4, v4, v7
    v_cmp_ne_u32 vcc, 0, v4
    s_sub_u32 s59, s59, 1
    s_nop 2
    s_cbranch_vccz pollok_104
    s_cmp_eq_u32 s59, 0
    s_cbranch_scc1 pollok_104
    s_sleep 1
    s_branch poll_103
pollok_104:
    s_and_b32 s6, s2, 3
    s_lshl_b32 s6, s6, 3
    s_bfe_u32 s4, s2, 0x30003
    s_add_u32 s4, s4, s6
    s_bfe_u32 s6, s2, 0x10002
    s_lshl_b32 s6, s6, 2
    s_lshr_b32 s5, s2, 6
    s_add_u32 s5, s5, s6
    s_mov_b32 s39, 0
    s_mul_i32 s22, s5, 102400
    s_add_u32 s22, s22, 23068672
    s_mul_i32 s29, s39, 10
    s_add_u32 s29, s29, 88
    s_cmp_ge_u32 s29, 100
    s_cselect_b32 s28, 100, 0
    s_sub_u32 s29, s29, s28
    s_add_u32 s22, s22, 90112
    s_mov_b32 m0, 90112
    s_nop 0
    buffer_load_dwordx4 v2, s[8:11], s22 offen offset:0 sc1 lds
    s_add_u32 s22, s22, 1024
    s_mov_b32 m0, 91136
    s_nop 0
    buffer_load_dwordx4 v2, s[8:11], s22 offen offset:0 sc1 lds
    s_add_u32 s22, s22, 1024
    s_mov_b32 m0, 92160
    s_nop 0
    buffer_load_dwordx4 v2, s[8:11], s22 offen offset:0 sc1 lds
    s_add_u32 s22, s22, 1024
    s_mov_b32 s12, s40
    s_mov_b32 s13, s41
    s_mov_b32 s14, 2621440
    s_mov_b32 s15, 0x20000
    s_mul_i32 s24, s4, 81920
    s_mul_i32 s28, s5, 160
    s_add_u32 s24, s24, s28
    v_add_u32 v4, 0, v0
    v_mul_u32_u24 v5, 6554, v4
    v_lshrrev_b32 v5, 16, v5
    v_mul_u32_u24 v6, 10, v5
    v_sub_u32 v4, v4, v6
    v_mul_u32_u24 v5, 1280, v5
    v_lshl_add_u32 v8, v4, 4, v5
    s_mov_b32 m0, 102400
    s_nop 0
    buffer_load_dwordx4 v8, s[12:15], s24 offen lds
    v_add_u32 v4, 256, v0
    v_mul_u32_u24 v5, 6554, v4
    v_lshrrev_b32 v5, 16, v5
    v_mul_u32_u24 v6, 10, v5
    v_sub_u32 v4, v4, v6
    v_mul_u32_u24 v5, 1280, v5
    v_lshl_add_u32 v9, v4, 4, v5
    s_mov_b32 m0, 106496
    s_nop 0
    buffer_load_dwordx4 v9, s[12:15], s24 offen lds
    v_add_u32 v4, 512, v0
    v_mul_u32_u24 v5, 6554, v4
    v_lshrrev_b32 v5, 16, v5
    v_mul_u32_u24 v6, 10, v5
    v_sub_u32 v4, v4, v6
    v_mul_u32_u24 v5, 1280, v5
    v_lshl_add_u32 v10, v4, 4, v5
    s_mov_b32 m0, 110592
    s_nop 0
    buffer_load_dwordx4 v10, s[12:15], s24 offen lds
    s_mul_i32 s20, s4, 81920
    s_add_u32 s20, s20, 8388608
    s_add_u32 s21, s20, 40960
    s_waitcnt vmcnt(0)
    s_barrier
    s_cmp_lg_u32 s2, 0
    s_cbranch_scc1 nonce_105
    s_mov_b32 s29, 30672896
    v_mov_b32 v4, s58
    v_mov_b32 v5, 0
    s_mov_b64 exec, 1
    buffer_store_dword v4, v5, s[8:11], s29 offen sc1
    s_mov_b64 exec, -1
nonce_105:
    s_and_b32 s6, s2, 1
    s_lshl_b32 s6, s6, 3
    s_bfe_u32 s4, s2, 0x30003
    s_add_u32 s4, s4, s6
    s_bfe_u32 s6, s2, 0x20001
    s_lshl_b32 s6, s6, 2
    s_lshr_b32 s5, s2, 6
    s_add_u32 s5, s5, s6
    s_lshl_b32 s29, s4, 2
    s_add_u32 s29, s29, 0
    s_lshl_b32 s24, s29, 7
    s_add_u32 s24, s24, 30199808
    v_and_b32 v3, 31, v0
    v_lshrrev_b32 v4, 5, v0
    v_lshlrev_b32 v5, 2, v3
    v_lshl_add_u32 v5, v4, 16, v5
    s_mul_i32 s20, s29, 40960
    s_add_u32 s20, s20, 12058624
    s_mul_i32 s22, s5, 245760
    s_add_u32 s22, s22, 23887872
    s_add_u32 s21, s20, 20480
    s_add_u32 s23, s22, 245760
    s_barrier
    s_mov_b32 m0, 0
    s_nop 0
    buffer_load_dwordx4 v2, s[8:11], s22 offen offset:0 sc1 lds
    s_waitcnt vmcnt(4)
    buffer_load_dwordx4 v2, s[8:11], s22 offen offset:1024 sc1 lds
    s_waitcnt vmcnt(4)
    buffer_load_dwordx4 v2, s[8:11], s22 offen offset:2048 sc1 lds
    s_waitcnt vmcnt(4)
    s_add_u32 s22, s22, 12288
    s_mov_b32 m0, 12288
    s_nop 0
    buffer_load_dwordx4 v2, s[8:11], s22 offen offset:0 sc1 lds
    s_waitcnt vmcnt(4)
    buffer_load_dwordx4 v2, s[8:11], s22 offen offset:1024 sc1 lds
    s_waitcnt vmcnt(4)
    buffer_load_dwordx4 v2, s[8:11], s22 offen offset:2048 sc1 lds
    s_waitcnt vmcnt(4)
    s_add_u32 s22, s22, 12288
    s_mov_b32 m0, 24576
    s_nop 0
    buffer_load_dwordx4 v2, s[8:11], s22 offen offset:0 sc1 lds
    s_waitcnt vmcnt(4)
    buffer_load_dwordx4 v2, s[8:11], s22 offen offset:1024 sc1 lds
    s_waitcnt vmcnt(4)
    buffer_load_dwordx4 v2, s[8:11], s22 offen offset:2048 sc1 lds
    s_waitcnt vmcnt(4)
    s_add_u32 s22, s22, 12288
    s_mov_b32 m0, 36864
    s_nop 0
    buffer_load_dwordx4 v2, s[8:11], s22 offen offset:0 sc1 lds
    s_waitcnt vmcnt(4)
    buffer_load_dwordx4 v2, s[8:11], s22 offen offset:1024 sc1 lds
    s_waitcnt vmcnt(4)
    buffer_load_dwordx4 v2, s[8:11], s22 offen offset:2048 sc1 lds
    s_waitcnt vmcnt(4)
    s_add_u32 s22, s22, 12288
    s_mov_b32 m0, 49152
    s_nop 0
    buffer_load_dwordx4 v2, s[8:11], s22 offen offset:0 sc1 lds
    s_waitcnt vmcnt(4)
    buffer_load_dwordx4 v2, s[8:11], s22 offen offset:1024 sc1 lds
    s_waitcnt vmcnt(4)
    buffer_load_dwordx4 v2, s[8:11], s22 offen offset:2048 sc1 lds
    s_waitcnt vmcnt(4)
    s_add_u32 s22, s22, 12288
    s_mov_b32 m0, 61440
    s_nop 0
    buffer_load_dwordx4 v2, s[8:11], s22 offen offset:0 sc1 lds
    s_waitcnt vmcnt(4)
    buffer_load_dwordx4 v2, s[8:11], s22 offen offset:1024 sc1 lds
    s_waitcnt vmcnt(4)
    buffer_load_dwordx4 v2, s[8:11], s22 offen offset:2048 sc1 lds
    s_waitcnt vmcnt(4)
    s_add_u32 s22, s22, 12288
    s_mov_b32 m0, 73728
    s_nop 0
    buffer_load_dwordx4 v2, s[8:11], s22 offen offset:0 sc1 lds
    s_waitcnt vmcnt(4)
    buffer_load_dwordx4 v2, s[8:11], s22 offen offset:1024 sc1 lds
    s_waitcnt vmcnt(4)
    buffer_load_dwordx4 v2, s[8:11], s22 offen offset:2048 sc1 lds
    s_waitcnt vmcnt(4)
    s_add_u32 s22, s22, 12288
    s_mov_b32 m0, 86016
    s_nop 0
    buffer_load_dwordx4 v2, s[8:11], s22 offen offset:0 sc1 lds
    s_waitcnt vmcnt(4)
    buffer_load_dwordx4 v2, s[8:11], s22 offen offset:1024 sc1 lds
    s_waitcnt vmcnt(4)
    buffer_load_dwordx4 v2, s[8:11], s22 offen offset:2048 sc1 lds
    s_waitcnt vmcnt(4)
    s_add_u32 s22, s22, 12288
    s_barrier
    s_mov_b32 m0, 98304
    s_nop 0
    buffer_load_dwordx4 v2, s[8:11], s20 offen offset:0 sc1 lds
    s_add_u32 s29, s20, 20480
    s_mov_b32 m0, 99328
    s_nop 0
    buffer_load_dwordx4 v2, s[8:11], s29 offen offset:0 sc1 lds
    s_add_u32 s20, s20, 1024
    s_mov_b32 m0, 110592
    s_nop 0
    buffer_load_dwordx4 v2, s[8:11], s20 offen offset:0 sc1 lds
    s_add_u32 s29, s20, 20480
    s_mov_b32 m0, 111616
    s_nop 0
    buffer_load_dwordx4 v2, s[8:11], s29 offen offset:0 sc1 lds
    s_add_u32 s20, s20, 1024
    s_mov_b32 m0, 122880
    s_nop 0
    buffer_load_dwordx4 v2, s[8:11], s20 offen offset:0 sc1 lds
    s_add_u32 s29, s20, 20480
    s_mov_b32 m0, 123904
    s_nop 0
    buffer_load_dwordx4 v2, s[8:11], s29 offen offset:0 sc1 lds
    s_add_u32 s20, s20, 1024
    s_mov_b32 m0, 135168
    s_nop 0
    buffer_load_dwordx4 v2, s[8:11], s20 offen offset:0 sc1 lds
    s_add_u32 s29, s20, 20480
    s_mov_b32 m0, 136192
    s_nop 0
    buffer_load_dwordx4 v2, s[8:11], s29 offen offset:0 sc1 lds
    s_add_u32 s20, s20, 1024
    s_waitcnt vmcnt(6)
    s_barrier
    s_mov_b32 m0, 147456
    s_nop 0
    buffer_load_dwordx4 v2, s[8:11], s20 offen offset:0 sc1 lds
    s_add_u32 s29, s20, 20480
    s_mov_b32 m0, 148480
    s_nop 0
    buffer_load_dwordx4 v2, s[8:11], s29 offen offset:0 sc1 lds
    s_add_u32 s20, s20, 1024
    buffer_load_dword v8, v5, s[8:11], s24 offen sc1
    s_add_u32 s24, s24, 8192
    buffer_load_dword v9, v5, s[8:11], s24 offen sc1
    s_add_u32 s24, s24, 8192
    buffer_load_dword v10, v5, s[8:11], s24 offen sc1
    s_add_u32 s24, s24, 8192
    buffer_load_dword v11, v5, s[8:11], s24 offen sc1
    s_add_u32 s24, s24, 8192
    buffer_load_dword v12, v5, s[8:11], s24 offen sc1
    s_add_u32 s24, s24, 8192
    buffer_load_dword v13, v5, s[8:11], s24 offen sc1
    s_add_u32 s24, s24, 8192
    buffer_load_dword v14, v5, s[8:11], s24 offen sc1
    s_add_u32 s24, s24, 8192
    buffer_load_dword v15, v5, s[8:11], s24 offen sc1
    s_add_u32 s24, s24, 8192
    s_waitcnt vmcnt(14)
    s_barrier
    s_mov_b32 m0, 0
    s_nop 0
    buffer_load_dwordx4 v2, s[8:11], s20 offen offset:0 sc1 lds
    s_add_u32 s29, s20, 20480
    s_mov_b32 m0, 1024
    s_nop 0
    buffer_load_dwordx4 v2, s[8:11], s29 offen offset:0 sc1 lds
    s_add_u32 s20, s20, 1024
    s_mov_b32 m0, 98304
    s_nop 0
    buffer_load_dwordx4 v2, s[8:11], s20 offen offset:0 sc1 lds
    s_add_u32 s29, s20, 20480
    s_mov_b32 m0, 99328
    s_nop 0
    buffer_load_dwordx4 v2, s[8:11], s29 offen offset:0 sc1 lds
    s_add_u32 s20, s20, 1024
    s_waitcnt vmcnt(16)
    s_barrier
    s_mov_b32 m0, 12288
    s_nop 0
    buffer_load_dwordx4 v2, s[8:11], s20 offen offset:0 sc1 lds
    s_add_u32 s29, s20, 20480
    s_mov_b32 m0, 13312
    s_nop 0
    buffer_load_dwordx4 v2, s[8:11], s29 offen offset:0 sc1 lds
    s_add_u32 s20, s20, 1024
    s_mov_b32 m0, 110592
    s_nop 0
    buffer_load_dwordx4 v2, s[8:11], s20 offen offset:0 sc1 lds
    s_add_u32 s29, s20, 20480
    s_mov_b32 m0, 111616
    s_nop 0
    buffer_load_dwordx4 v2, s[8:11], s29 offen offset:0 sc1 lds
    s_add_u32 s20, s20, 1024
    s_waitcnt vmcnt(18)
    s_barrier
    s_mov_b32 m0, 24576
    s_nop 0
    buffer_load_dwordx4 v2, s[8:11], s20 offen offset:0 sc1 lds
    s_add_u32 s29, s20, 20480
    s_mov_b32 m0, 25600
    s_nop 0
    buffer_load_dwordx4 v2, s[8:11], s29 offen offset:0 sc1 lds
    s_add_u32 s20, s20, 1024
    s_mov_b32 m0, 122880
    s_nop 0
    buffer_load_dwordx4 v2, s[8:11], s22 offen offset:0 sc1 lds
    buffer_load_dwordx4 v2, s[8:11], s22 offen offset:1024 sc1 lds
    s_waitcnt vmcnt(20)
    s_barrier
    s_mov_b32 m0, 122880
    s_nop 0
    buffer_load_dwordx4 v2, s[8:11], s22 offen offset:2048 sc1 lds
    s_add_u32 s22, s22, 12288
    s_mov_b32 m0, 36864
    s_nop 0
    buffer_load_dwordx4 v2, s[8:11], s20 offen offset:0 sc1 lds
    s_add_u32 s29, s20, 20480
    s_mov_b32 m0, 37888
    s_nop 0
    buffer_load_dwordx4 v2, s[8:11], s29 offen offset:0 sc1 lds
    s_add_u32 s20, s20, 1024
    s_mov_b32 m0, 135168
    s_nop 0
    buffer_load_dwordx4 v2, s[8:11], s22 offen offset:0 sc1 lds
    s_waitcnt vmcnt(16)
    v_add_f32 v8, v8, v9
    v_add_f32 v8, v8, v10
    v_add_f32 v8, v8, v11
    v_add_f32 v8, v8, v12
    v_add_f32 v8, v8, v13
    v_add_f32 v8, v8, v14
    v_add_f32 v8, v8, v15
    v_mov_b32 v9, v8
    s_nop 1
    v_permlane32_swap_b32 v8, v9
    v_add_f32 v8, v8, v9
    v_mov_b32 v9, 0x3727c5ac
    v_fmac_f32 v9, 0x3acccccd, v8
    v_rsq_f32 v8, v9
    s_nop 0
    v_mul_f32 v10, v8, v8
    v_mul_f32 v10, v10, v8
    v_mul_f32 v8, 0xc0135761, v8
    v_mul_f32 v10, 0xbdd2d3e8, v10
    s_mov_b32 s29, 159744
    v_lshl_add_u32 v6, v3, 2, s29
    ds_write_b32 v6, v8
    ds_write_b32 v6, v10 offset:512
    ds_write_b32 v6, v9 offset:1024
    v_and_b32 v6, 3, v0
    v_lshlrev_b32 v6, 2, v6
    v_add_u32 v6, 163328, v6
    v_mov_b32 v7, 0
    ds_write_b32 v6, v7
    s_waitcnt lgkmcnt(0)
    s_waitcnt vmcnt(14)
    s_barrier
    s_mov_b32 m0, 135168
    s_nop 0
    buffer_load_dwordx4 v2, s[8:11], s22 offen offset:1024 sc1 lds
    buffer_load_dwordx4 v2, s[8:11], s22 offen offset:2048 sc1 lds
    s_add_u32 s22, s22, 12288
    s_mov_b32 m0, 49152
    s_nop 0
    buffer_load_dwordx4 v2, s[8:11], s20 offen offset:0 sc1 lds
    s_add_u32 s29, s20, 20480
    s_mov_b32 m0, 50176
    s_nop 0
    buffer_load_dwordx4 v2, s[8:11], s29 offen offset:0 sc1 lds
    s_add_u32 s20, s20, 1024
    s_mov_b32 m0, 147456
    s_nop 0
    buffer_load_dwordx4 v2, s[8:11], s22 offen offset:0 sc1 lds
    s_waitcnt vmcnt(17)
    s_barrier
    s_mov_b32 m0, 147456
    s_nop 0
    buffer_load_dwordx4 v2, s[8:11], s22 offen offset:1024 sc1 lds
    buffer_load_dwordx4 v2, s[8:11], s22 offen offset:2048 sc1 lds
    s_add_u32 s22, s22, 12288
    s_mov_b32 m0, 61440
    s_nop 0
    buffer_load_dwordx4 v2, s[8:11], s20 offen offset:0 sc1 lds
    s_add_u32 s29, s20, 20480
    s_mov_b32 m0, 62464
    s_nop 0
    buffer_load_dwordx4 v2, s[8:11], s29 offen offset:0 sc1 lds
    s_add_u32 s20, s20, 1024
    s_waitcnt vmcnt(19)
    s_barrier
    s_mov_b32 m0, 0
    s_nop 0
    buffer_load_dwordx4 v2, s[8:11], s22 offen offset:0 sc1 lds
    buffer_load_dwordx4 v2, s[8:11], s22 offen offset:1024 sc1 lds
    buffer_load_dwordx4 v2, s[8:11], s22 offen offset:2048 sc1 lds
    s_add_u32 s22, s22, 12288
    s_mov_b32 m0, 73728
    s_nop 0
    buffer_load_dwordx4 v2, s[8:11], s20 offen offset:0 sc1 lds
    s_waitcnt vmcnt(16)
    s_barrier
    s_add_u32 s29, s20, 20480
    s_mov_b32 m0, 74752
    s_nop 0
    buffer_load_dwordx4 v2, s[8:11], s29 offen offset:0 sc1 lds
    s_add_u32 s20, s20, 1024
    s_mov_b32 m0, 98304
    s_nop 0
    buffer_load_dwordx4 v2, s[8:11], s22 offen offset:0 sc1 lds
    buffer_load_dwordx4 v2, s[8:11], s22 offen offset:1024 sc1 lds
    buffer_load_dwordx4 v2, s[8:11], s22 offen offset:2048 sc1 lds
    s_add_u32 s22, s22, 12288
    s_waitcnt vmcnt(15)
    s_barrier
    s_mov_b32 m0, 86016
    s_nop 0
    buffer_load_dwordx4 v2, s[8:11], s20 offen offset:0 sc1 lds
    s_add_u32 s29, s20, 20480
    s_mov_b32 m0, 87040
    s_nop 0
    buffer_load_dwordx4 v2, s[8:11], s29 offen offset:0 sc1 lds
    s_add_u32 s20, s20, 1024
    s_mov_b32 m0, 12288
    s_nop 0
    buffer_load_dwordx4 v2, s[8:11], s22 offen offset:0 sc1 lds
    buffer_load_dwordx4 v2, s[8:11], s22 offen offset:1024 sc1 lds
    s_waitcnt vmcnt(14)
    s_barrier
    s_mov_b32 m0, 12288
    s_nop 0
    buffer_load_dwordx4 v2, s[8:11], s22 offen offset:2048 sc1 lds
    s_add_u32 s22, s22, 12288
    s_mov_b32 m0, 122880
    s_nop 0
    buffer_load_dwordx4 v2, s[8:11], s20 offen offset:0 sc1 lds
    s_add_u32 s29, s20, 20480
    s_mov_b32 m0, 123904
    s_nop 0
    buffer_load_dwordx4 v2, s[8:11], s29 offen offset:0 sc1 lds
    s_add_u32 s20, s20, 1024
    s_mov_b32 m0, 110592
    s_nop 0
    buffer_load_dwordx4 v2, s[8:11], s22 offen offset:0 sc1 lds
    buffer_load_dwordx4 v2, s[8:11], s22 offen offset:1024 sc1 lds
    s_waitcnt vmcnt(14)
    s_barrier
    s_mov_b32 m0, 110592
    s_nop 0
    buffer_load_dwordx4 v2, s[8:11], s22 offen offset:2048 sc1 lds
    s_add_u32 s22, s22, 12288
    s_mov_b32 m0, 135168
    s_nop 0
    buffer_load_dwordx4 v2, s[8:11], s20 offen offset:0 sc1 lds
    s_add_u32 s29, s20, 20480
    s_mov_b32 m0, 136192
    s_nop 0
    buffer_load_dwordx4 v2, s[8:11], s29 offen offset:0 sc1 lds
    s_add_u32 s20, s20, 1024
    s_mov_b32 m0, 24576
    s_nop 0
    buffer_load_dwordx4 v2, s[8:11], s22 offen offset:0 sc1 lds
    s_waitcnt vmcnt(13)
    s_barrier
    s_mov_b32 m0, 24576
    s_nop 0
    buffer_load_dwordx4 v2, s[8:11], s22 offen offset:1024 sc1 lds
    buffer_load_dwordx4 v2, s[8:11], s22 offen offset:2048 sc1 lds
    s_add_u32 s22, s22, 12288
    s_mov_b32 m0, 147456
    s_nop 0
    buffer_load_dwordx4 v2, s[8:11], s20 offen offset:0 sc1 lds
    s_add_u32 s29, s20, 20480
    s_mov_b32 m0, 148480
    s_nop 0
    buffer_load_dwordx4 v2, s[8:11], s29 offen offset:0 sc1 lds
    s_add_u32 s20, s20, 1024
    s_waitcnt vmcnt(12)
    s_barrier
    s_mov_b32 m0, 36864
    s_nop 0
    buffer_load_dwordx4 v2, s[8:11], s22 offen offset:0 sc1 lds
    buffer_load_dwordx4 v2, s[8:11], s22 offen offset:1024 sc1 lds
    buffer_load_dwordx4 v2, s[8:11], s22 offen offset:2048 sc1 lds
    s_add_u32 s22, s22, 12288
    s_mov_b32 m0, 0
    s_nop 0
    buffer_load_dwordx4 v2, s[8:11], s20 offen offset:0 sc1 lds
    s_waitcnt vmcnt(11)
    s_barrier
    s_add_u32 s29, s20, 20480
    s_mov_b32 m0, 1024
    s_nop 0
    buffer_load_dwordx4 v2, s[8:11], s29 offen offset:0 sc1 lds
    s_add_u32 s20, s20, 1024
    s_mov_b32 m0, 49152
    s_nop 0
    buffer_load_dwordx4 v2, s[8:11], s22 offen offset:0 sc1 lds
    buffer_load_dwordx4 v2, s[8:11], s22 offen offset:1024 sc1 lds
    buffer_load_dwordx4 v2, s[8:11], s22 offen offset:2048 sc1 lds
    s_add_u32 s22, s22, 12288
    s_waitcnt vmcnt(10)
    s_barrier
    s_mov_b32 m0, 98304
    s_nop 0
    buffer_load_dwordx4 v2, s[8:11], s20 offen offset:0 sc1 lds
    s_add_u32 s29, s20, 20480
    s_mov_b32 m0, 99328
    s_nop 0
    buffer_load_dwordx4 v2, s[8:11], s29 offen offset:0 sc1 lds
    s_add_u32 s20, s20, 1024
    s_mov_b32 m0, 61440
    s_nop 0
    buffer_load_dwordx4 v2, s[8:11], s22 offen offset:0 sc1 lds
    buffer_load_dwordx4 v2, s[8:11], s22 offen offset:1024 sc1 lds
    buffer_load_dwordx4 v2, s[8:11], s22 offen offset:2048 sc1 lds
    s_add_u32 s22, s22, 12288
    s_waitcnt vmcnt(10)
    s_barrier
    s_mov_b32 m0, 12288
    s_nop 0
    buffer_load_dwordx4 v2, s[8:11], s22 offen offset:0 sc1 lds
    buffer_load_dwordx4 v2, s[8:11], s22 offen offset:1024 sc1 lds
    buffer_load_dwordx4 v2, s[8:11], s22 offen offset:2048 sc1 lds
    s_add_u32 s22, s22, 12288
    s_waitcnt vmcnt(8)
    s_barrier
    s_waitcnt vmcnt(3)
    s_barrier
    s_waitcnt vmcnt(0)
    s_barrier
    s_and_b32 s6, s2, 3
    s_lshl_b32 s6, s6, 3
    s_bfe_u32 s4, s2, 0x30003
    s_add_u32 s4, s4, s6
    s_bfe_u32 s6, s2, 0x10002
    s_lshl_b32 s6, s6, 2
    s_lshr_b32 s5, s2, 6
    s_add_u32 s5, s5, s6
    s_and_b32 s39, s5, 3
    s_mul_i32 s39, s39, 1
    s_mul_i32 s22, s5, 245760
    s_add_u32 s22, s22, 28082176
    s_mul_i32 s20, s4, 196608
    s_add_u32 s20, s20, 15728640
    s_add_u32 s21, s20, 49152
    s_mul_i32 s28, s39, 2048
    s_add_u32 s20, s20, s28
    s_add_u32 s23, s22, 245760
    s_mul_i32 s28, s39, 10240
    s_add_u32 s22, s22, s28
    s_barrier
    s_mov_b32 m0, 0
    s_nop 0
    buffer_load_dwordx4 v2, s[8:11], s22 offen offset:0 sc1 lds
    s_waitcnt vmcnt(4)
    buffer_load_dwordx4 v2, s[8:11], s22 offen offset:1024 sc1 lds
    s_waitcnt vmcnt(4)
    buffer_load_dwordx4 v2, s[8:11], s22 offen offset:2048 sc1 lds
    s_waitcnt vmcnt(4)
    s_add_u32 s22, s22, 10240
    s_cmp_ge_u32 s22, s23
    s_cselect_b32 s28, 245760, 0
    s_sub_u32 s22, s22, s28
    s_mov_b32 m0, 10240
    s_nop 0
    buffer_load_dwordx4 v2, s[8:11], s22 offen offset:0 sc1 lds
    s_waitcnt vmcnt(4)
    buffer_load_dwordx4 v2, s[8:11], s22 offen offset:1024 sc1 lds
    s_waitcnt vmcnt(4)
    buffer_load_dwordx4 v2, s[8:11], s22 offen offset:2048 sc1 lds
    s_waitcnt vmcnt(4)
    s_add_u32 s22, s22, 10240
    s_cmp_ge_u32 s22, s23
    s_cselect_b32 s28, 245760, 0
    s_sub_u32 s22, s22, s28
    s_mov_b32 m0, 20480
    s_nop 0
    buffer_load_dwordx4 v2, s[8:11], s22 offen offset:0 sc1 lds
    s_waitcnt vmcnt(4)
    buffer_load_dwordx4 v2, s[8:11], s22 offen offset:1024 sc1 lds
    s_waitcnt vmcnt(4)
    buffer_load_dwordx4 v2, s[8:11], s22 offen offset:2048 sc1 lds
    s_waitcnt vmcnt(4)
    s_add_u32 s22, s22, 10240
    s_cmp_ge_u32 s22, s23
    s_cselect_b32 s28, 245760, 0
    s_sub_u32 s22, s22, s28
    s_mov_b32 m0, 30720
    s_nop 0
    buffer_load_dwordx4 v2, s[8:11], s22 offen offset:0 sc1 lds
    s_waitcnt vmcnt(4)
    buffer_load_dwordx4 v2, s[8:11], s22 offen offset:1024 sc1 lds
    s_waitcnt vmcnt(4)
    buffer_load_dwordx4 v2, s[8:11], s22 offen offset:2048 sc1 lds
    s_waitcnt vmcnt(4)
    s_add_u32 s22, s22, 10240
    s_cmp_ge_u32 s22, s23
    s_cselect_b32 s28, 245760, 0
    s_sub_u32 s22, s22, s28
    s_mov_b32 m0, 40960
    s_nop 0
    buffer_load_dwordx4 v2, s[8:11], s22 offen offset:0 sc1 lds
    s_waitcnt vmcnt(4)
    buffer_load_dwordx4 v2, s[8:11], s22 offen offset:1024 sc1 lds
    s_waitcnt vmcnt(4)
    buffer_load_dwordx4 v2, s[8:11], s22 offen offset:2048 sc1 lds
    s_waitcnt vmcnt(4)
    s_add_u32 s22, s22, 10240
    s_cmp_ge_u32 s22, s23
    s_cselect_b32 s28, 245760, 0
    s_sub_u32 s22, s22, s28
    s_mov_b32 m0, 51200
    s_nop 0
    buffer_load_dwordx4 v2, s[8:11], s22 offen offset:0 sc1 lds
    s_waitcnt vmcnt(4)
    buffer_load_dwordx4 v2, s[8:11], s22 offen offset:1024 sc1 lds
    s_waitcnt vmcnt(4)
    buffer_load_dwordx4 v2, s[8:11], s22 offen offset:2048 sc1 lds
    s_waitcnt vmcnt(4)
    s_add_u32 s22, s22, 10240
    s_cmp_ge_u32 s22, s23
    s_cselect_b32 s28, 245760, 0
    s_sub_u32 s22, s22, s28
    s_mov_b32 m0, 61440
    s_nop 0
    buffer_load_dwordx4 v2, s[8:11], s22 offen offset:0 sc1 lds
    s_waitcnt vmcnt(4)
    buffer_load_dwordx4 v2, s[8:11], s22 offen offset:1024 sc1 lds
    s_waitcnt vmcnt(4)
    buffer_load_dwordx4 v2, s[8:11], s22 offen offset:2048 sc1 lds
    s_waitcnt vmcnt(4)
    s_add_u32 s22, s22, 10240
    s_cmp_ge_u32 s22, s23
    s_cselect_b32 s28, 245760, 0
    s_sub_u32 s22, s22, s28
    s_mov_b32 m0, 71680
    s_nop 0
    buffer_load_dwordx4 v2, s[8:11], s22 offen offset:0 sc1 lds
    s_waitcnt vmcnt(4)
    buffer_load_dwordx4 v2, s[8:11], s22 offen offset:1024 sc1 lds
    s_waitcnt vmcnt(4)
    buffer_load_dwordx4 v2, s[8:11], s22 offen offset:2048 sc1 lds
    s_waitcnt vmcnt(4)
    s_add_u32 s22, s22, 10240
    s_cmp_ge_u32 s22, s23
    s_cselect_b32 s28, 245760, 0
    s_sub_u32 s22, s22, s28
    s_mov_b32 m0, 81920
    s_nop 0
    buffer_load_dwordx4 v2, s[8:11], s22 offen offset:0 sc1 lds
    s_waitcnt vmcnt(4)
    buffer_load_dwordx4 v2, s[8:11], s22 offen offset:1024 sc1 lds
    s_waitcnt vmcnt(4)
    buffer_load_dwordx4 v2, s[8:11], s22 offen offset:2048 sc1 lds
    s_waitcnt vmcnt(4)
    s_add_u32 s22, s22, 10240
    s_cmp_ge_u32 s22, s23
    s_cselect_b32 s28, 245760, 0
    s_sub_u32 s22, s22, s28
    s_mov_b32 m0, 92160
    s_nop 0
    buffer_load_dwordx4 v2, s[8:11], s22 offen offset:0 sc1 lds
    s_waitcnt vmcnt(4)
    buffer_load_dwordx4 v2, s[8:11], s22 offen offset:1024 sc1 lds
    s_waitcnt vmcnt(4)
    buffer_load_dwordx4 v2, s[8:11], s22 offen offset:2048 sc1 lds
    s_waitcnt vmcnt(4)
    s_add_u32 s22, s22, 10240
    s_cmp_ge_u32 s22, s23
    s_cselect_b32 s28, 245760, 0
    s_sub_u32 s22, s22, s28
    s_barrier
    s_mov_b32 m0, 102400
    s_nop 0
    buffer_load_dwordx4 v2, s[8:11], s20 offen offset:0 sc1 lds
    buffer_load_dwordx4 v2, s[8:11], s20 offen offset:1024 sc1 lds
    s_add_u32 s20, s20, 2048
    s_cmp_ge_u32 s20, s21
    s_cselect_b32 s28, 49152, 0
    s_sub_u32 s20, s20, s28
    s_mov_b32 m0, 112640
    s_nop 0
    buffer_load_dwordx4 v2, s[8:11], s20 offen offset:0 sc1 lds
    buffer_load_dwordx4 v2, s[8:11], s20 offen offset:1024 sc1 lds
    s_add_u32 s20, s20, 2048
    s_cmp_ge_u32 s20, s21
    s_cselect_b32 s28, 49152, 0
    s_sub_u32 s20, s20, s28
    s_mov_b32 m0, 122880
    s_nop 0
    buffer_load_dwordx4 v2, s[8:11], s20 offen offset:0 sc1 lds
    buffer_load_dwordx4 v2, s[8:11], s20 offen offset:1024 sc1 lds
    s_add_u32 s20, s20, 2048
    s_cmp_ge_u32 s20, s21
    s_cselect_b32 s28, 49152, 0
    s_sub_u32 s20, s20, s28
    s_mov_b32 m0, 133120
    s_nop 0
    buffer_load_dwordx4 v2, s[8:11], s20 offen offset:0 sc1 lds
    buffer_load_dwordx4 v2, s[8:11], s20 offen offset:1024 sc1 lds
    s_add_u32 s20, s20, 2048
    s_cmp_ge_u32 s20, s21
    s_cselect_b32 s28, 49152, 0
    s_sub_u32 s20, s20, s28
    s_waitcnt vmcnt(6)
    s_barrier
    s_mov_b32 m0, 143360
    s_nop 0
    buffer_load_dwordx4 v2, s[8:11], s20 offen offset:0 sc1 lds
    buffer_load_dwordx4 v2, s[8:11], s20 offen offset:1024 sc1 lds
    s_add_u32 s20, s20, 2048
    s_cmp_ge_u32 s20, s21
    s_cselect_b32 s28, 49152, 0
    s_sub_u32 s20, s20, s28
    s_mov_b32 m0, 153600
    s_nop 0
    buffer_load_dwordx4 v2, s[8:11], s20 offen offset:0 sc1 lds
    buffer_load_dwordx4 v2, s[8:11], s20 offen offset:1024 sc1 lds
    s_add_u32 s20, s20, 2048
    s_cmp_ge_u32 s20, s21
    s_cselect_b32 s28, 49152, 0
    s_sub_u32 s20, s20, s28
    s_waitcnt vmcnt(8)
    s_barrier
    s_mov_b32 m0, 0
    s_nop 0
    buffer_load_dwordx4 v2, s[8:11], s20 offen offset:0 sc1 lds
    buffer_load_dwordx4 v2, s[8:11], s20 offen offset:1024 sc1 lds
    s_add_u32 s20, s20, 2048
    s_cmp_ge_u32 s20, s21
    s_cselect_b32 s28, 49152, 0
    s_sub_u32 s20, s20, s28
    s_mov_b32 m0, 102400
    s_nop 0
    buffer_load_dwordx4 v2, s[8:11], s20 offen offset:0 sc1 lds
    s_waitcnt vmcnt(9)
    s_barrier
    s_mov_b32 m0, 102400
    s_nop 0
    buffer_load_dwordx4 v2, s[8:11], s20 offen offset:1024 sc1 lds
    s_add_u32 s20, s20, 2048
    s_cmp_ge_u32 s20, s21
    s_cselect_b32 s28, 49152, 0
    s_sub_u32 s20, s20, s28
    s_mov_b32 m0, 10240
    s_nop 0
    buffer_load_dwordx4 v2, s[8:11], s20 offen offset:0 sc1 lds
    buffer_load_dwordx4 v2, s[8:11], s20 offen offset:1024 sc1 lds
    s_add_u32 s20, s20, 2048
    s_cmp_ge_u32 s20, s21
    s_cselect_b32 s28, 49152, 0
    s_sub_u32 s20, s20, s28
    s_mov_b32 m0, 112640
    s_nop 0
    buffer_load_dwordx4 v2, s[8:11], s20 offen offset:0 sc1 lds
    s_waitcnt vmcnt(11)
    s_barrier
    s_mov_b32 m0, 112640
    s_nop 0
    buffer_load_dwordx4 v2, s[8:11], s20 offen offset:1024 sc1 lds
    s_add_u32 s20, s20, 2048
    s_cmp_ge_u32 s20, s21
    s_cselect_b32 s28, 49152, 0
    s_sub_u32 s20, s20, s28
    s_mov_b32 m0, 20480
    s_nop 0
    buffer_load_dwordx4 v2, s[8:11], s20 offen offset:0 sc1 lds
    buffer_load_dwordx4 v2, s[8:11], s20 offen offset:1024 sc1 lds
    s_add_u32 s20, s20, 2048
    s_cmp_ge_u32 s20, s21
    s_cselect_b32 s28, 49152, 0
    s_sub_u32 s20, s20, s28
    s_mov_b32 m0, 122880
    s_nop 0
    buffer_load_dwordx4 v2, s[8:11], s20 offen offset:0 sc1 lds
    s_waitcnt vmcnt(13)
    s_barrier
    s_mov_b32 m0, 122880
    s_nop 0
    buffer_load_dwordx4 v2, s[8:11], s20 offen offset:1024 sc1 lds
    s_add_u32 s20, s20, 2048
    s_cmp_ge_u32 s20, s21
    s_cselect_b32 s28, 49152, 0
    s_sub_u32 s20, s20, s28
    s_mov_b32 m0, 30720
    s_nop 0
    buffer_load_dwordx4 v2, s[8:11], s20 offen offset:0 sc1 lds
    buffer_load_dwordx4 v2, s[8:11], s20 offen offset:1024 sc1 lds
    s_add_u32 s20, s20, 2048
    s_cmp_ge_u32 s20, s21
    s_cselect_b32 s28, 49152, 0
    s_sub_u32 s20, s20, s28
    s_mov_b32 m0, 133120
    s_nop 0
    buffer_load_dwordx4 v2, s[8:11], s20 offen offset:0 sc1 lds
    s_waitcnt vmcnt(15)
    s_barrier
    s_mov_b32 m0, 133120
    s_nop 0
    buffer_load_dwordx4 v2, s[8:11], s20 offen offset:1024 sc1 lds
    s_add_u32 s20, s20, 2048
    s_cmp_ge_u32 s20, s21
    s_cselect_b32 s28, 49152, 0
    s_sub_u32 s20, s20, s28
    s_mov_b32 m0, 40960
    s_nop 0
    buffer_load_dwordx4 v2, s[8:11], s22 offen offset:0 sc1 lds
    buffer_load_dwordx4 v2, s[8:11], s22 offen offset:1024 sc1 lds
    buffer_load_dwordx4 v2, s[8:11], s22 offen offset:2048 sc1 lds
    s_add_u32 s22, s22, 10240
    s_cmp_ge_u32 s22, s23
    s_cselect_b32 s28, 245760, 0
    s_sub_u32 s22, s22, s28
    s_waitcnt vmcnt(17)
    s_barrier
    s_mov_b32 m0, 143360
    s_nop 0
    buffer_load_dwordx4 v2, s[8:11], s20 offen offset:0 sc1 lds
    buffer_load_dwordx4 v2, s[8:11], s20 offen offset:1024 sc1 lds
    s_add_u32 s20, s20, 2048
    s_cmp_ge_u32 s20, s21
    s_cselect_b32 s28, 49152, 0
    s_sub_u32 s20, s20, s28
    s_mov_b32 m0, 51200
    s_nop 0
    buffer_load_dwordx4 v2, s[8:11], s22 offen offset:0 sc1 lds
    buffer_load_dwordx4 v2, s[8:11], s22 offen offset:1024 sc1 lds
    s_waitcnt vmcnt(19)
    s_barrier
    s_mov_b32 m0, 51200
    s_nop 0
    buffer_load_dwordx4 v2, s[8:11], s22 offen offset:2048 sc1 lds
    s_add_u32 s22, s22, 10240
    s_cmp_ge_u32 s22, s23
    s_cselect_b32 s28, 245760, 0
    s_sub_u32 s22, s22, s28
    s_mov_b32 m0, 153600
    s_nop 0
    buffer_load_dwordx4 v2, s[8:11], s20 offen offset:0 sc1 lds
    buffer_load_dwordx4 v2, s[8:11], s20 offen offset:1024 sc1 lds
    s_add_u32 s20, s20, 2048
    s_cmp_ge_u32 s20, s21
    s_cselect_b32 s28, 49152, 0
    s_sub_u32 s20, s20, s28
    s_mov_b32 m0, 61440
    s_nop 0
    buffer_load_dwordx4 v2, s[8:11], s22 offen offset:0 sc1 lds
    s_waitcnt vmcnt(21)
    s_barrier
    s_mov_b32 m0, 61440
    s_nop 0
    buffer_load_dwordx4 v2, s[8:11], s22 offen offset:1024 sc1 lds
    buffer_load_dwordx4 v2, s[8:11], s22 offen offset:2048 sc1 lds
    s_add_u32 s22, s22, 10240
    s_cmp_ge_u32 s22, s23
    s_cselect_b32 s28, 245760, 0
    s_sub_u32 s22, s22, s28
    s_mov_b32 m0, 0
    s_nop 0
    buffer_load_dwordx4 v2, s[8:11], s20 offen offset:0 sc1 lds
    buffer_load_dwordx4 v2, s[8:11], s20 offen offset:1024 sc1 lds
    s_add_u32 s20, s20, 2048
    s_cmp_ge_u32 s20, s21
    s_cselect_b32 s28, 49152, 0
    s_sub_u32 s20, s20, s28
    s_waitcnt vmcnt(23)
    s_barrier
    s_mov_b32 m0, 71680
    s_nop 0
    buffer_load_dwordx4 v2, s[8:11], s22 offen offset:0 sc1 lds
    buffer_load_dwordx4 v2, s[8:11], s22 offen offset:1024 sc1 lds
    buffer_load_dwordx4 v2, s[8:11], s22 offen offset:2048 sc1 lds
    s_add_u32 s22, s22, 10240
    s_cmp_ge_u32 s22, s23
    s_cselect_b32 s28, 245760, 0
    s_sub_u32 s22, s22, s28
    s_mov_b32 m0, 102400
    s_nop 0
    buffer_load_dwordx4 v2, s[8:11], s20 offen offset:0 sc1 lds
    s_waitcnt vmcnt(16)
    s_barrier
    s_mov_b32 m0, 102400
    s_nop 0
    buffer_load_dwordx4 v2, s[8:11], s20 offen offset:1024 sc1 lds
    s_add_u32 s20, s20, 2048
    s_cmp_ge_u32 s20, s21
    s_cselect_b32 s28, 49152, 0
    s_sub_u32 s20, s20, s28
    s_mov_b32 m0, 81920
    s_nop 0
    buffer_load_dwordx4 v2, s[8:11], s22 offen offset:0 sc1 lds
    buffer_load_dwordx4 v2, s[8:11], s22 offen offset:1024 sc1 lds
    buffer_load_dwordx4 v2, s[8:11], s22 offen offset:2048 sc1 lds
    s_add_u32 s22, s22, 10240
    s_cmp_ge_u32 s22, s23
    s_cselect_b32 s28, 245760, 0
    s_sub_u32 s22, s22, s28
    s_waitcnt vmcnt(15)
    s_barrier
    s_mov_b32 m0, 10240
    s_nop 0
    buffer_load_dwordx4 v2, s[8:11], s20 offen offset:0 sc1 lds
    buffer_load_dwordx4 v2, s[8:11], s20 offen offset:1024 sc1 lds
    s_add_u32 s20, s20, 2048
    s_cmp_ge_u32 s20, s21
    s_cselect_b32 s28, 49152, 0
    s_sub_u32 s20, s20, s28
    s_mov_b32 m0, 92160
    s_nop 0
    buffer_load_dwordx4 v2, s[8:11], s22 offen offset:0 sc1 lds
    s_waitcnt vmcnt(13)
    s_barrier
    s_mov_b32 m0, 92160
    s_nop 0
    buffer_load_dwordx4 v2, s[8:11], s22 offen offset:1024 sc1 lds
    buffer_load_dwordx4 v2, s[8:11], s22 offen offset:2048 sc1 lds
    s_add_u32 s22, s22, 10240
    s_cmp_ge_u32 s22, s23
    s_cselect_b32 s28, 245760, 0
    s_sub_u32 s22, s22, s28
    s_mov_b32 m0, 112640
    s_nop 0
    buffer_load_dwordx4 v2, s[8:11], s20 offen offset:0 sc1 lds
    buffer_load_dwordx4 v2, s[8:11], s20 offen offset:1024 sc1 lds
    s_add_u32 s20, s20, 2048
    s_cmp_ge_u32 s20, s21
    s_cselect_b32 s28, 49152, 0
    s_sub_u32 s20, s20, s28
    s_waitcnt vmcnt(12)
    s_barrier
    s_mov_b32 m0, 40960
    s_nop 0
    buffer_load_dwordx4 v2, s[8:11], s22 offen offset:0 sc1 lds
    buffer_load_dwordx4 v2, s[8:11], s22 offen offset:1024 sc1 lds
    buffer_load_dwordx4 v2, s[8:11], s22 offen offset:2048 sc1 lds
    s_add_u32 s22, s22, 10240
    s_cmp_ge_u32 s22, s23
    s_cselect_b32 s28, 245760, 0
    s_sub_u32 s22, s22, s28
    s_mov_b32 m0, 20480
    s_nop 0
    buffer_load_dwordx4 v2, s[8:11], s20 offen offset:0 sc1 lds
    s_waitcnt vmcnt(11)
    s_barrier
    s_mov_b32 m0, 20480
    s_nop 0
    buffer_load_dwordx4 v2, s[8:11], s20 offen offset:1024 sc1 lds
    s_add_u32 s20, s20, 2048
    s_cmp_ge_u32 s20, s21
    s_cselect_b32 s28, 49152, 0
    s_sub_u32 s20, s20, s28
    s_mov_b32 m0, 51200
    s_nop 0
    buffer_load_dwordx4 v2, s[8:11], s22 offen offset:0 sc1 lds
    buffer_load_dwordx4 v2, s[8:11], s22 offen offset:1024 sc1 lds
    buffer_load_dwordx4 v2, s[8:11], s22 offen offset:2048 sc1 lds
    s_add_u32 s22, s22, 10240
    s_cmp_ge_u32 s22, s23
    s_cselect_b32 s28, 245760, 0
    s_sub_u32 s22, s22, s28
    s_waitcnt vmcnt(10)
    s_barrier
    s_mov_b32 m0, 122880
    s_nop 0
    buffer_load_dwordx4 v2, s[8:11], s20 offen offset:0 sc1 lds
    buffer_load_dwordx4 v2, s[8:11], s20 offen offset:1024 sc1 lds
    s_add_u32 s20, s20, 2048
    s_cmp_ge_u32 s20, s21
    s_cselect_b32 s28, 49152, 0
    s_sub_u32 s20, s20, s28
    s_mov_b32 m0, 61440
    s_nop 0
    buffer_load_dwordx4 v2, s[8:11], s22 offen offset:0 sc1 lds
    buffer_load_dwordx4 v2, s[8:11], s22 offen offset:1024 sc1 lds
    s_waitcnt vmcnt(9)
    s_barrier
    s_mov_b32 m0, 61440
    s_nop 0
    buffer_load_dwordx4 v2, s[8:11], s22 offen offset:2048 sc1 lds
    s_add_u32 s22, s22, 10240
    s_cmp_ge_u32 s22, s23
    s_cselect_b32 s28, 245760, 0
    s_sub_u32 s22, s22, s28
    s_mov_b32 m0, 30720
    s_nop 0
    buffer_load_dwordx4 v2, s[8:11], s20 offen offset:0 sc1 lds
    buffer_load_dwordx4 v2, s[8:11], s20 offen offset:1024 sc1 lds
    s_add_u32 s20, s20, 2048
    s_cmp_ge_u32 s20, s21
    s_cselect_b32 s28, 49152, 0
    s_sub_u32 s20, s20, s28
    s_mov_b32 m0, 71680
    s_nop 0
    buffer_load_dwordx4 v2, s[8:11], s22 offen offset:0 sc1 lds
    s_waitcnt vmcnt(8)
    s_barrier
    s_mov_b32 m0, 71680
    s_nop 0
    buffer_load_dwordx4 v2, s[8:11], s22 offen offset:1024 sc1 lds
    buffer_load_dwordx4 v2, s[8:11], s22 offen offset:2048 sc1 lds
    s_add_u32 s22, s22, 10240
    s_cmp_ge_u32 s22, s23
    s_cselect_b32 s28, 245760, 0
    s_sub_u32 s22, s22, s28
    s_mov_b32 m0, 133120
    s_nop 0
    buffer_load_dwordx4 v2, s[8:11], s20 offen offset:0 sc1 lds
    buffer_load_dwordx4 v2, s[8:11], s20 offen offset:1024 sc1 lds
    s_add_u32 s20, s20, 2048
    s_cmp_ge_u32 s20, s21
    s_cselect_b32 s28, 49152, 0
    s_sub_u32 s20, s20, s28
    s_waitcnt vmcnt(7)
    s_barrier
    s_mov_b32 m0, 81920
    s_nop 0
    buffer_load_dwordx4 v2, s[8:11], s22 offen offset:0 sc1 lds
    buffer_load_dwordx4 v2, s[8:11], s22 offen offset:1024 sc1 lds
    buffer_load_dwordx4 v2, s[8:11], s22 offen offset:2048 sc1 lds
    s_add_u32 s22, s22, 10240
    s_cmp_ge_u32 s22, s23
    s_cselect_b32 s28, 245760, 0
    s_sub_u32 s22, s22, s28
    s_mov_b32 m0, 143360
    s_nop 0
    buffer_load_dwordx4 v2, s[8:11], s22 offen offset:0 sc1 lds
    s_waitcnt vmcnt(6)
    s_barrier
    s_mov_b32 m0, 143360
    s_nop 0
    buffer_load_dwordx4 v2, s[8:11], s22 offen offset:1024 sc1 lds
    buffer_load_dwordx4 v2, s[8:11], s22 offen offset:2048 sc1 lds
    s_add_u32 s22, s22, 10240
    s_cmp_ge_u32 s22, s23
    s_cselect_b32 s28, 245760, 0
    s_sub_u32 s22, s22, s28
    s_mov_b32 m0, 92160
    s_nop 0
    buffer_load_dwordx4 v2, s[8:11], s22 offen offset:0 sc1 lds
    buffer_load_dwordx4 v2, s[8:11], s22 offen offset:1024 sc1 lds
    s_waitcnt vmcnt(5)
    s_barrier
    s_mov_b32 m0, 92160
    s_nop 0
    buffer_load_dwordx4 v2, s[8:11], s22 offen offset:2048 sc1 lds
    s_add_u32 s22, s22, 10240
    s_cmp_ge_u32 s22, s23
    s_cselect_b32 s28, 245760, 0
    s_sub_u32 s22, s22, s28
    s_mov_b32 m0, 153600
    s_nop 0
    buffer_load_dwordx4 v2, s[8:11], s22 offen offset:0 sc1 lds
    buffer_load_dwordx4 v2, s[8:11], s22 offen offset:1024 sc1 lds
    buffer_load_dwordx4 v2, s[8:11], s22 offen offset:2048 sc1 lds
    s_add_u32 s22, s22, 10240
    s_cmp_ge_u32 s22, s23
    s_cselect_b32 s28, 245760, 0
    s_sub_u32 s22, s22, s28
    s_waitcnt vmcnt(6)
    s_barrier
    s_waitcnt vmcnt(3)
    s_barrier
    s_waitcnt vmcnt(0)
    s_barrier
    s_endpgm
tail_l1:
    v_lshlrev_b32 v2, 4, v0
    s_waitcnt vmcnt(0)
    s_barrier
    s_mov_b32 s29, 30669824
    s_mov_b32 s59, 0x40000
poll_106:
    buffer_load_dwordx4 v[4:7], v2, s[8:11], s29 offen sc1
    s_waitcnt vmcnt(0)
    v_xor_b32 v4, s58, v4
    v_xor_b32 v5, s58, v5
    v_xor_b32 v6, s58, v6
    v_xor_b32 v7, s58, v7
    v_or_b32 v4, v4, v5
    v_or_b32 v4, v4, v6
    v_or_b32 v4, v4, v7
    v_cmp_ne_u32 vcc, 0, v4
    s_sub_u32 s59, s59, 1
    s_nop 2
    s_cbranch_vccz pollok_107
    s_cmp_eq_u32 s59, 0
    s_cbranch_scc1 pollok_107
    s_sleep 1
    s_branch poll_106
pollok_107:
    s_and_b32 s6, s2, 3
    s_lshl_b32 s6, s6, 3
    s_bfe_u32 s4, s2, 0x30003
    s_add_u32 s4, s4, s6
    s_bfe_u32 s6, s2, 0x10002
    s_lshl_b32 s6, s6, 2
    s_lshr_b32 s5, s2, 6
    s_add_u32 s5, s5, s6
    s_mov_b32 s39, 0
    s_mul_i32 s22, s5, 102400
    s_add_u32 s22, s22, 23068672
    s_mul_i32 s29, s39, 10
    s_add_u32 s29, s29, 91
    s_cmp_ge_u32 s29, 100
    s_cselect_b32 s28, 100, 0
    s_sub_u32 s29, s29, s28
    s_add_u32 s22, s22, 93184
    s_mov_b32 m0, 93184
    s_nop 0
    buffer_load_dwordx4 v2, s[8:11], s22 offen offset:0 sc1 lds
    s_add_u32 s22, s22, 1024
    s_mov_b32 m0, 94208
    s_nop 0
    buffer_load_dwordx4 v2, s[8:11], s22 offen offset:0 sc1 lds
    s_add_u32 s22, s22, 1024
    s_mov_b32 m0, 95232
    s_nop 0
    buffer_load_dwordx4 v2, s[8:11], s22 offen offset:0 sc1 lds
    s_add_u32 s22, s22, 1024
    s_mov_b32 s12, s40
    s_mov_b32 s13, s41
    s_mov_b32 s14, 2621440
    s_mov_b32 s15, 0x20000
    s_mul_i32 s24, s4, 81920
    s_mul_i32 s28, s5, 160
    s_add_u32 s24, s24, s28
    v_add_u32 v4, 64, v0
    v_mul_u32_u24 v5, 6554, v4
    v_lshrrev_b32 v5, 16, v5
    v_mul_u32_u24 v6, 10, v5
    v_sub_u32 v4, v4, v6
    v_mul_u32_u24 v5, 1280, v5
    v_lshl_add_u32 v8, v4, 4, v5
    s_mov_b32 m0, 103424
    s_nop 0
    buffer_load_dwordx4 v8, s[12:15], s24 offen lds
    v_add_u32 v4, 320, v0
    v_mul_u32_u24 v5, 6554, v4
    v_lshrrev_b32 v5, 16, v5
    v_mul_u32_u24 v6, 10, v5
    v_sub_u32 v4, v4, v6
    v_mul_u32_u24 v5, 1280, v5
    v_lshl_add_u32 v9, v4, 4, v5
    s_mov_b32 m0, 107520
    s_nop 0
    buffer_load_dwordx4 v9, s[12:15], s24 offen lds
    v_add_u32 v4, 576, v0
    v_mul_u32_u24 v5, 6554, v4
    v_lshrrev_b32 v5, 16, v5
    v_mul_u32_u24 v6, 10, v5
    v_sub_u32 v4, v4, v6
    v_mul_u32_u24 v5, 1280, v5
    v_lshl_add_u32 v10, v4, 4, v5
    s_mov_b32 m0, 111616
    s_nop 0
    buffer_load_dwordx4 v10, s[12:15], s24 offen lds
    s_mul_i32 s20, s4, 81920
    s_add_u32 s20, s20, 8390656
    s_add_u32 s21, s20, 40960
    s_waitcnt vmcnt(0)
    s_barrier
    s_and_b32 s6, s2, 1
    s_lshl_b32 s6, s6, 3
    s_bfe_u32 s4, s2, 0x30003
    s_add_u32 s4, s4, s6
    s_bfe_u32 s6, s2, 0x20001
    s_lshl_b32 s6, s6, 2
    s_lshr_b32 s5, s2, 6
    s_add_u32 s5, s5, s6
    s_lshl_b32 s29, s4, 2
    s_add_u32 s29, s29, 1
    s_lshl_b32 s24, s29, 7
    s_add_u32 s24, s24, 30199808
    v_and_b32 v3, 31, v0
    v_lshrrev_b32 v4, 5, v0
    v_lshlrev_b32 v5, 2, v3
    v_lshl_add_u32 v5, v4, 16, v5
    s_mul_i32 s20, s29, 40960
    s_add_u32 s20, s20, 12058624
    s_mul_i32 s22, s5, 245760
    s_add_u32 s22, s22, 23890944
    s_add_u32 s21, s20, 20480
    s_add_u32 s23, s22, 245760
    s_barrier
    s_mov_b32 m0, 3072
    s_nop 0
    buffer_load_dwordx4 v2, s[8:11], s22 offen offset:0 sc1 lds
    s_waitcnt vmcnt(4)
    buffer_load_dwordx4 v2, s[8:11], s22 offen offset:1024 sc1 lds
    s_waitcnt vmcnt(4)
    buffer_load_dwordx4 v2, s[8:11], s22 offen offset:2048 sc1 lds
    s_waitcnt vmcnt(4)
    s_add_u32 s22, s22, 12288
    s_mov_b32 m0, 15360
    s_nop 0
    buffer_load_dwordx4 v2, s[8:11], s22 offen offset:0 sc1 lds
    s_waitcnt vmcnt(4)
    buffer_load_dwordx4 v2, s[8:11], s22 offen offset:1024 sc1 lds
    s_waitcnt vmcnt(4)
    buffer_load_dwordx4 v2, s[8:11], s22 offen offset:2048 sc1 lds
    s_waitcnt vmcnt(4)
    s_add_u32 s22, s22, 12288
    s_mov_b32 m0, 27648
    s_nop 0
    buffer_load_dwordx4 v2, s[8:11], s22 offen offset:0 sc1 lds
    s_waitcnt vmcnt(4)
    buffer_load_dwordx4 v2, s[8:11], s22 offen offset:1024 sc1 lds
    s_waitcnt vmcnt(4)
    buffer_load_dwordx4 v2, s[8:11], s22 offen offset:2048 sc1 lds
    s_waitcnt vmcnt(4)
    s_add_u32 s22, s22, 12288
    s_mov_b32 m0, 39936
    s_nop 0
    buffer_load_dwordx4 v2, s[8:11], s22 offen offset:0 sc1 lds
    s_waitcnt vmcnt(4)
    buffer_load_dwordx4 v2, s[8:11], s22 offen offset:1024 sc1 lds
    s_waitcnt vmcnt(4)
    buffer_load_dwordx4 v2, s[8:11], s22 offen offset:2048 sc1 lds
    s_waitcnt vmcnt(4)
    s_add_u32 s22, s22, 12288
    s_mov_b32 m0, 52224
    s_nop 0
    buffer_load_dwordx4 v2, s[8:11], s22 offen offset:0 sc1 lds
    s_waitcnt vmcnt(4)
    buffer_load_dwordx4 v2, s[8:11], s22 offen offset:1024 sc1 lds
    s_waitcnt vmcnt(4)
    buffer_load_dwordx4 v2, s[8:11], s22 offen offset:2048 sc1 lds
    s_waitcnt vmcnt(4)
    s_add_u32 s22, s22, 12288
    s_mov_b32 m0, 64512
    s_nop 0
    buffer_load_dwordx4 v2, s[8:11], s22 offen offset:0 sc1 lds
    s_waitcnt vmcnt(4)
    buffer_load_dwordx4 v2, s[8:11], s22 offen offset:1024 sc1 lds
    s_waitcnt vmcnt(4)
    buffer_load_dwordx4 v2, s[8:11], s22 offen offset:2048 sc1 lds
    s_waitcnt vmcnt(4)
    s_add_u32 s22, s22, 12288
    s_mov_b32 m0, 76800
    s_nop 0
    buffer_load_dwordx4 v2, s[8:11], s22 offen offset:0 sc1 lds
    s_waitcnt vmcnt(4)
    buffer_load_dwordx4 v2, s[8:11], s22 offen offset:1024 sc1 lds
    s_waitcnt vmcnt(4)
    buffer_load_dwordx4 v2, s[8:11], s22 offen offset:2048 sc1 lds
    s_waitcnt vmcnt(4)
    s_add_u32 s22, s22, 12288
    s_mov_b32 m0, 89088
    s_nop 0
    buffer_load_dwordx4 v2, s[8:11], s22 offen offset:0 sc1 lds
    s_waitcnt vmcnt(4)
    buffer_load_dwordx4 v2, s[8:11], s22 offen offset:1024 sc1 lds
    s_waitcnt vmcnt(4)
    buffer_load_dwordx4 v2, s[8:11], s22 offen offset:2048 sc1 lds
    s_waitcnt vmcnt(4)
    s_add_u32 s22, s22, 12288
    s_barrier
    s_mov_b32 m0, 100352
    s_nop 0
    buffer_load_dwordx4 v2, s[8:11], s20 offen offset:0 sc1 lds
    s_add_u32 s29, s20, 20480
    s_mov_b32 m0, 101376
    s_nop 0
    buffer_load_dwordx4 v2, s[8:11], s29 offen offset:0 sc1 lds
    s_add_u32 s20, s20, 1024
    s_mov_b32 m0, 112640
    s_nop 0
    buffer_load_dwordx4 v2, s[8:11], s20 offen offset:0 sc1 lds
    s_add_u32 s29, s20, 20480
    s_mov_b32 m0, 113664
    s_nop 0
    buffer_load_dwordx4 v2, s[8:11], s29 offen offset:0 sc1 lds
    s_add_u32 s20, s20, 1024
    s_mov_b32 m0, 124928
    s_nop 0
    buffer_load_dwordx4 v2, s[8:11], s20 offen offset:0 sc1 lds
    s_add_u32 s29, s20, 20480
    s_mov_b32 m0, 125952
    s_nop 0
    buffer_load_dwordx4 v2, s[8:11], s29 offen offset:0 sc1 lds
    s_add_u32 s20, s20, 1024
    s_mov_b32 m0, 137216
    s_nop 0
    buffer_load_dwordx4 v2, s[8:11], s20 offen offset:0 sc1 lds
    s_add_u32 s29, s20, 20480
    s_mov_b32 m0, 138240
    s_nop 0
    buffer_load_dwordx4 v2, s[8:11], s29 offen offset:0 sc1 lds
    s_add_u32 s20, s20, 1024
    s_waitcnt vmcnt(6)
    s_barrier
    s_mov_b32 m0, 149504
    s_nop 0
    buffer_load_dwordx4 v2, s[8:11], s20 offen offset:0 sc1 lds
    s_add_u32 s29, s20, 20480
    s_mov_b32 m0, 150528
    s_nop 0
    buffer_load_dwordx4 v2, s[8:11], s29 offen offset:0 sc1 lds
    s_add_u32 s20, s20, 1024
    buffer_load_dword v8, v5, s[8:11], s24 offen sc1
    s_add_u32 s24, s24, 8192
    buffer_load_dword v9, v5, s[8:11], s24 offen sc1
    s_add_u32 s24, s24, 8192
    buffer_load_dword v10, v5, s[8:11], s24 offen sc1
    s_add_u32 s24, s24, 8192
    buffer_load_dword v11, v5, s[8:11], s24 offen sc1
    s_add_u32 s24, s24, 8192
    buffer_load_dword v12, v5, s[8:11], s24 offen sc1
    s_add_u32 s24, s24, 8192
    buffer_load_dword v13, v5, s[8:11], s24 offen sc1
    s_add_u32 s24, s24, 8192
    buffer_load_dword v14, v5, s[8:11], s24 offen sc1
    s_add_u32 s24, s24, 8192
    buffer_load_dword v15, v5, s[8:11], s24 offen sc1
    s_add_u32 s24, s24, 8192
    s_waitcnt vmcnt(14)
    s_barrier
    s_mov_b32 m0, 2048
    s_nop 0
    buffer_load_dwordx4 v2, s[8:11], s20 offen offset:0 sc1 lds
    s_add_u32 s29, s20, 20480
    s_mov_b32 m0, 3072
    s_nop 0
    buffer_load_dwordx4 v2, s[8:11], s29 offen offset:0 sc1 lds
    s_add_u32 s20, s20, 1024
    s_mov_b32 m0, 100352
    s_nop 0
    buffer_load_dwordx4 v2, s[8:11], s20 offen offset:0 sc1 lds
    s_add_u32 s29, s20, 20480
    s_mov_b32 m0, 101376
    s_nop 0
    buffer_load_dwordx4 v2, s[8:11], s29 offen offset:0 sc1 lds
    s_add_u32 s20, s20, 1024
    s_waitcnt vmcnt(16)
    s_barrier
    s_mov_b32 m0, 14336
    s_nop 0
    buffer_load_dwordx4 v2, s[8:11], s20 offen offset:0 sc1 lds
    s_add_u32 s29, s20, 20480
    s_mov_b32 m0, 15360
    s_nop 0
    buffer_load_dwordx4 v2, s[8:11], s29 offen offset:0 sc1 lds
    s_add_u32 s20, s20, 1024
    s_mov_b32 m0, 112640
    s_nop 0
    buffer_load_dwordx4 v2, s[8:11], s20 offen offset:0 sc1 lds
    s_add_u32 s29, s20, 20480
    s_mov_b32 m0, 113664
    s_nop 0
    buffer_load_dwordx4 v2, s[8:11], s29 offen offset:0 sc1 lds
    s_add_u32 s20, s20, 1024
    s_waitcnt vmcnt(18)
    s_barrier
    s_mov_b32 m0, 26624
    s_nop 0
    buffer_load_dwordx4 v2, s[8:11], s20 offen offset:0 sc1 lds
    s_add_u32 s29, s20, 20480
    s_mov_b32 m0, 27648
    s_nop 0
    buffer_load_dwordx4 v2, s[8:11], s29 offen offset:0 sc1 lds
    s_add_u32 s20, s20, 1024
    s_mov_b32 m0, 125952
    s_nop 0
    buffer_load_dwordx4 v2, s[8:11], s22 offen offset:0 sc1 lds
    buffer_load_dwordx4 v2, s[8:11], s22 offen offset:1024 sc1 lds
    s_waitcnt vmcnt(20)
    s_barrier
    s_mov_b32 m0, 125952
    s_nop 0
    buffer_load_dwordx4 v2, s[8:11], s22 offen offset:2048 sc1 lds
    s_add_u32 s22, s22, 12288
    s_mov_b32 m0, 38912
    s_nop 0
    buffer_load_dwordx4 v2, s[8:11], s20 offen offset:0 sc1 lds
    s_add_u32 s29, s20, 20480
    s_mov_b32 m0, 39936
    s_nop 0
    buffer_load_dwordx4 v2, s[8:11], s29 offen offset:0 sc1 lds
    s_add_u32 s20, s20, 1024
    s_mov_b32 m0, 138240
    s_nop 0
    buffer_load_dwordx4 v2, s[8:11], s22 offen offset:0 sc1 lds
    s_waitcnt vmcnt(16)
    v_add_f32 v8, v8, v9
    v_add_f32 v8, v8, v10
    v_add_f32 v8, v8, v11
    v_add_f32 v8, v8, v12
    v_add_f32 v8, v8, v13
    v_add_f32 v8, v8, v14
    v_add_f32 v8, v8, v15
    v_mov_b32 v9, v8
    s_nop 1
    v_permlane32_swap_b32 v8, v9
    v_add_f32 v8, v8, v9
    v_mov_b32 v9, 0x3727c5ac
    v_fmac_f32 v9, 0x3acccccd, v8
    v_rsq_f32 v8, v9
    s_nop 0
    v_mul_f32 v10, v8, v8
    v_mul_f32 v10, v10, v8
    v_mul_f32 v8, 0xc0135761, v8
    v_mul_f32 v10, 0xbdd2d3e8, v10
    s_mov_b32 s29, 159872
    v_lshl_add_u32 v6, v3, 2, s29
    ds_write_b32 v6, v8
    ds_write_b32 v6, v10 offset:512
    ds_write_b32 v6, v9 offset:1024
    s_waitcnt lgkmcnt(0)
    s_waitcnt vmcnt(14)
    s_barrier
    s_mov_b32 m0, 138240
    s_nop 0
    buffer_load_dwordx4 v2, s[8:11], s22 offen offset:1024 sc1 lds
    buffer_load_dwordx4 v2, s[8:11], s22 offen offset:2048 sc1 lds
    s_add_u32 s22, s22, 12288
    s_mov_b32 m0, 51200
    s_nop 0
    buffer_load_dwordx4 v2, s[8:11], s20 offen offset:0 sc1 lds
    s_add_u32 s29, s20, 20480
    s_mov_b32 m0, 52224
    s_nop 0
    buffer_load_dwordx4 v2, s[8:11], s29 offen offset:0 sc1 lds
    s_add_u32 s20, s20, 1024
    s_mov_b32 m0, 150528
    s_nop 0
    buffer_load_dwordx4 v2, s[8:11], s22 offen offset:0 sc1 lds
    s_waitcnt vmcnt(17)
    s_barrier
    s_mov_b32 m0, 150528
    s_nop 0
    buffer_load_dwordx4 v2, s[8:11], s22 offen offset:1024 sc1 lds
    buffer_load_dwordx4 v2, s[8:11], s22 offen offset:2048 sc1 lds
    s_add_u32 s22, s22, 12288
    s_mov_b32 m0, 63488
    s_nop 0
    buffer_load_dwordx4 v2, s[8:11], s20 offen offset:0 sc1 lds
    s_add_u32 s29, s20, 20480
    s_mov_b32 m0, 64512
    s_nop 0
    buffer_load_dwordx4 v2, s[8:11], s29 offen offset:0 sc1 lds
    s_add_u32 s20, s20, 1024
    s_waitcnt vmcnt(19)
    s_barrier
    s_mov_b32 m0, 3072
    s_nop 0
    buffer_load_dwordx4 v2, s[8:11], s22 offen offset:0 sc1 lds
    buffer_load_dwordx4 v2, s[8:11], s22 offen offset:1024 sc1 lds
    buffer_load_dwordx4 v2, s[8:11], s22 offen offset:2048 sc1 lds
    s_add_u32 s22, s22, 12288
    s_mov_b32 m0, 75776
    s_nop 0
    buffer_load_dwordx4 v2, s[8:11], s20 offen offset:0 sc1 lds
    s_waitcnt vmcnt(16)
    s_barrier
    s_add_u32 s29, s20, 20480
    s_mov_b32 m0, 76800
    s_nop 0
    buffer_load_dwordx4 v2, s[8:11], s29 offen offset:0 sc1 lds
    s_add_u32 s20, s20, 1024
    s_mov_b32 m0, 101376
    s_nop 0
    buffer_load_dwordx4 v2, s[8:11], s22 offen offset:0 sc1 lds
    buffer_load_dwordx4 v2, s[8:11], s22 offen offset:1024 sc1 lds
    buffer_load_dwordx4 v2, s[8:11], s22 offen offset:2048 sc1 lds
    s_add_u32 s22, s22, 12288
    s_waitcnt vmcnt(15)
    s_barrier
    s_mov_b32 m0, 88064
    s_nop 0
    buffer_load_dwordx4 v2, s[8:11], s20 offen offset:0 sc1 lds
    s_add_u32 s29, s20, 20480
    s_mov_b32 m0, 89088
    s_nop 0
    buffer_load_dwordx4 v2, s[8:11], s29 offen offset:0 sc1 lds
    s_add_u32 s20, s20, 1024
    s_mov_b32 m0, 15360
    s_nop 0
    buffer_load_dwordx4 v2, s[8:11], s22 offen offset:0 sc1 lds
    buffer_load_dwordx4 v2, s[8:11], s22 offen offset:1024 sc1 lds
    s_waitcnt vmcnt(14)
    s_barrier
    s_mov_b32 m0, 15360
    s_nop 0
    buffer_load_dwordx4 v2, s[8:11], s22 offen offset:2048 sc1 lds
    s_add_u32 s22, s22, 12288
    s_mov_b32 m0, 124928
    s_nop 0
    buffer_load_dwordx4 v2, s[8:11], s20 offen offset:0 sc1 lds
    s_add_u32 s29, s20, 20480
    s_mov_b32 m0, 125952
    s_nop 0
    buffer_load_dwordx4 v2, s[8:11], s29 offen offset:0 sc1 lds
    s_add_u32 s20, s20, 1024
    s_mov_b32 m0, 113664
    s_nop 0
    buffer_load_dwordx4 v2, s[8:11], s22 offen offset:0 sc1 lds
    buffer_load_dwordx4 v2, s[8:11], s22 offen offset:1024 sc1 lds
    s_waitcnt vmcnt(14)
    s_barrier
    s_mov_b32 m0, 113664
    s_nop 0
    buffer_load_dwordx4 v2, s[8:11], s22 offen offset:2048 sc1 lds
    s_add_u32 s22, s22, 12288
    s_mov_b32 m0, 137216
    s_nop 0
    buffer_load_dwordx4 v2, s[8:11], s20 offen offset:0 sc1 lds
    s_add_u32 s29, s20, 20480
    s_mov_b32 m0, 138240
    s_nop 0
    buffer_load_dwordx4 v2, s[8:11], s29 offen offset:0 sc1 lds
    s_add_u32 s20, s20, 1024
    s_mov_b32 m0, 27648
    s_nop 0
    buffer_load_dwordx4 v2, s[8:11], s22 offen offset:0 sc1 lds
    s_waitcnt vmcnt(13)
    s_barrier
    s_mov_b32 m0, 27648
    s_nop 0
    buffer_load_dwordx4 v2, s[8:11], s22 offen offset:1024 sc1 lds
    buffer_load_dwordx4 v2, s[8:11], s22 offen offset:2048 sc1 lds
    s_add_u32 s22, s22, 12288
    s_mov_b32 m0, 149504
    s_nop 0
    buffer_load_dwordx4 v2, s[8:11], s20 offen offset:0 sc1 lds
    s_add_u32 s29, s20, 20480
    s_mov_b32 m0, 150528
    s_nop 0
    buffer_load_dwordx4 v2, s[8:11], s29 offen offset:0 sc1 lds
    s_add_u32 s20, s20, 1024
    s_waitcnt vmcnt(12)
    s_barrier
    s_mov_b32 m0, 39936
    s_nop 0
    buffer_load_dwordx4 v2, s[8:11], s22 offen offset:0 sc1 lds
    buffer_load_dwordx4 v2, s[8:11], s22 offen offset:1024 sc1 lds
    buffer_load_dwordx4 v2, s[8:11], s22 offen offset:2048 sc1 lds
    s_add_u32 s22, s22, 12288
    s_mov_b32 m0, 2048
    s_nop 0
    buffer_load_dwordx4 v2, s[8:11], s20 offen offset:0 sc1 lds
    s_waitcnt vmcnt(11)
    s_barrier
    s_add_u32 s29, s20, 20480
    s_mov_b32 m0, 3072
    s_nop 0
    buffer_load_dwordx4 v2, s[8:11], s29 offen offset:0 sc1 lds
    s_add_u32 s20, s20, 1024
    s_mov_b32 m0, 52224
    s_nop 0
    buffer_load_dwordx4 v2, s[8:11], s22 offen offset:0 sc1 lds
    buffer_load_dwordx4 v2, s[8:11], s22 offen offset:1024 sc1 lds
    buffer_load_dwordx4 v2, s[8:11], s22 offen offset:2048 sc1 lds
    s_add_u32 s22, s22, 12288
    s_waitcnt vmcnt(10)
    s_barrier
    s_mov_b32 m0, 100352
    s_nop 0
    buffer_load_dwordx4 v2, s[8:11], s20 offen offset:0 sc1 lds
    s_add_u32 s29, s20, 20480
    s_mov_b32 m0, 101376
    s_nop 0
    buffer_load_dwordx4 v2, s[8:11], s29 offen offset:0 sc1 lds
    s_add_u32 s20, s20, 1024
    s_mov_b32 m0, 64512
    s_nop 0
    buffer_load_dwordx4 v2, s[8:11], s22 offen offset:0 sc1 lds
    buffer_load_dwordx4 v2, s[8:11], s22 offen offset:1024 sc1 lds
    buffer_load_dwordx4 v2, s[8:11], s22 offen offset:2048 sc1 lds
    s_add_u32 s22, s22, 12288
    s_waitcnt vmcnt(10)
    s_barrier
    s_mov_b32 m0, 15360
    s_nop 0
    buffer_load_dwordx4 v2, s[8:11], s22 offen offset:0 sc1 lds
    buffer_load_dwordx4 v2, s[8:11], s22 offen offset:1024 sc1 lds
    buffer_load_dwordx4 v2, s[8:11], s22 offen offset:2048 sc1 lds
    s_add_u32 s22, s22, 12288
    s_waitcnt vmcnt(8)
    s_barrier
    s_waitcnt vmcnt(3)
    s_barrier
    s_waitcnt vmcnt(0)
    s_barrier
    s_and_b32 s6, s2, 3
    s_lshl_b32 s6, s6, 3
    s_bfe_u32 s4, s2, 0x30003
    s_add_u32 s4, s4, s6
    s_bfe_u32 s6, s2, 0x10002
    s_lshl_b32 s6, s6, 2
    s_lshr_b32 s5, s2, 6
    s_add_u32 s5, s5, s6
    s_and_b32 s39, s5, 3
    s_mul_i32 s39, s39, 1
    s_mul_i32 s22, s5, 245760
    s_add_u32 s22, s22, 28085248
    s_mul_i32 s20, s4, 196608
    s_add_u32 s20, s20, 15777792
    s_add_u32 s21, s20, 49152
    s_mul_i32 s28, s39, 2048
    s_add_u32 s20, s20, s28
    s_add_u32 s23, s22, 245760
    s_mul_i32 s28, s39, 10240
    s_add_u32 s22, s22, s28
    s_barrier
    s_mov_b32 m0, 3072
    s_nop 0
    buffer_load_dwordx4 v2, s[8:11], s22 offen offset:0 sc1 lds
    s_waitcnt vmcnt(4)
    buffer_load_dwordx4 v2, s[8:11], s22 offen offset:1024 sc1 lds
    s_waitcnt vmcnt(4)
    buffer_load_dwordx4 v2, s[8:11], s22 offen offset:2048 sc1 lds
    s_waitcnt vmcnt(4)
    s_add_u32 s22, s22, 10240
    s_cmp_ge_u32 s22, s23
    s_cselect_b32 s28, 245760, 0
    s_sub_u32 s22, s22, s28
    s_mov_b32 m0, 13312
    s_nop 0
    buffer_load_dwordx4 v2, s[8:11], s22 offen offset:0 sc1 lds
    s_waitcnt vmcnt(4)
    buffer_load_dwordx4 v2, s[8:11], s22 offen offset:1024 sc1 lds
    s_waitcnt vmcnt(4)
    buffer_load_dwordx4 v2, s[8:11], s22 offen offset:2048 sc1 lds
    s_waitcnt vmcnt(4)
    s_add_u32 s22, s22, 10240
    s_cmp_ge_u32 s22, s23
    s_cselect_b32 s28, 245760, 0
    s_sub_u32 s22, s22, s28
    s_mov_b32 m0, 23552
    s_nop 0
    buffer_load_dwordx4 v2, s[8:11], s22 offen offset:0 sc1 lds
    s_waitcnt vmcnt(4)
    buffer_load_dwordx4 v2, s[8:11], s22 offen offset:1024 sc1 lds
    s_waitcnt vmcnt(4)
    buffer_load_dwordx4 v2, s[8:11], s22 offen offset:2048 sc1 lds
    s_waitcnt vmcnt(4)
    s_add_u32 s22, s22, 10240
    s_cmp_ge_u32 s22, s23
    s_cselect_b32 s28, 245760, 0
    s_sub_u32 s22, s22, s28
    s_mov_b32 m0, 33792
    s_nop 0
    buffer_load_dwordx4 v2, s[8:11], s22 offen offset:0 sc1 lds
    s_waitcnt vmcnt(4)
    buffer_load_dwordx4 v2, s[8:11], s22 offen offset:1024 sc1 lds
    s_waitcnt vmcnt(4)
    buffer_load_dwordx4 v2, s[8:11], s22 offen offset:2048 sc1 lds
    s_waitcnt vmcnt(4)
    s_add_u32 s22, s22, 10240
    s_cmp_ge_u32 s22, s23
    s_cselect_b32 s28, 245760, 0
    s_sub_u32 s22, s22, s28
    s_mov_b32 m0, 44032
    s_nop 0
    buffer_load_dwordx4 v2, s[8:11], s22 offen offset:0 sc1 lds
    s_waitcnt vmcnt(4)
    buffer_load_dwordx4 v2, s[8:11], s22 offen offset:1024 sc1 lds
    s_waitcnt vmcnt(4)
    buffer_load_dwordx4 v2, s[8:11], s22 offen offset:2048 sc1 lds
    s_waitcnt vmcnt(4)
    s_add_u32 s22, s22, 10240
    s_cmp_ge_u32 s22, s23
    s_cselect_b32 s28, 245760, 0
    s_sub_u32 s22, s22, s28
    s_mov_b32 m0, 54272
    s_nop 0
    buffer_load_dwordx4 v2, s[8:11], s22 offen offset:0 sc1 lds
    s_waitcnt vmcnt(4)
    buffer_load_dwordx4 v2, s[8:11], s22 offen offset:1024 sc1 lds
    s_waitcnt vmcnt(4)
    buffer_load_dwordx4 v2, s[8:11], s22 offen offset:2048 sc1 lds
    s_waitcnt vmcnt(4)
    s_add_u32 s22, s22, 10240
    s_cmp_ge_u32 s22, s23
    s_cselect_b32 s28, 245760, 0
    s_sub_u32 s22, s22, s28
    s_mov_b32 m0, 64512
    s_nop 0
    buffer_load_dwordx4 v2, s[8:11], s22 offen offset:0 sc1 lds
    s_waitcnt vmcnt(4)
    buffer_load_dwordx4 v2, s[8:11], s22 offen offset:1024 sc1 lds
    s_waitcnt vmcnt(4)
    buffer_load_dwordx4 v2, s[8:11], s22 offen offset:2048 sc1 lds
    s_waitcnt vmcnt(4)
    s_add_u32 s22, s22, 10240
    s_cmp_ge_u32 s22, s23
    s_cselect_b32 s28, 245760, 0
    s_sub_u32 s22, s22, s28
    s_mov_b32 m0, 74752
    s_nop 0
    buffer_load_dwordx4 v2, s[8:11], s22 offen offset:0 sc1 lds
    s_waitcnt vmcnt(4)
    buffer_load_dwordx4 v2, s[8:11], s22 offen offset:1024 sc1 lds
    s_waitcnt vmcnt(4)
    buffer_load_dwordx4 v2, s[8:11], s22 offen offset:2048 sc1 lds
    s_waitcnt vmcnt(4)
    s_add_u32 s22, s22, 10240
    s_cmp_ge_u32 s22, s23
    s_cselect_b32 s28, 245760, 0
    s_sub_u32 s22, s22, s28
    s_mov_b32 m0, 84992
    s_nop 0
    buffer_load_dwordx4 v2, s[8:11], s22 offen offset:0 sc1 lds
    s_waitcnt vmcnt(4)
    buffer_load_dwordx4 v2, s[8:11], s22 offen offset:1024 sc1 lds
    s_waitcnt vmcnt(4)
    buffer_load_dwordx4 v2, s[8:11], s22 offen offset:2048 sc1 lds
    s_waitcnt vmcnt(4)
    s_add_u32 s22, s22, 10240
    s_cmp_ge_u32 s22, s23
    s_cselect_b32 s28, 245760, 0
    s_sub_u32 s22, s22, s28
    s_mov_b32 m0, 95232
    s_nop 0
    buffer_load_dwordx4 v2, s[8:11], s22 offen offset:0 sc1 lds
    s_waitcnt vmcnt(4)
    buffer_load_dwordx4 v2, s[8:11], s22 offen offset:1024 sc1 lds
    s_waitcnt vmcnt(4)
    buffer_load_dwordx4 v2, s[8:11], s22 offen offset:2048 sc1 lds
    s_waitcnt vmcnt(4)
    s_add_u32 s22, s22, 10240
    s_cmp_ge_u32 s22, s23
    s_cselect_b32 s28, 245760, 0
    s_sub_u32 s22, s22, s28
    s_barrier
    s_mov_b32 m0, 104448
    s_nop 0
    buffer_load_dwordx4 v2, s[8:11], s20 offen offset:0 sc1 lds
    buffer_load_dwordx4 v2, s[8:11], s20 offen offset:1024 sc1 lds
    s_add_u32 s20, s20, 2048
    s_cmp_ge_u32 s20, s21
    s_cselect_b32 s28, 49152, 0
    s_sub_u32 s20, s20, s28
    s_mov_b32 m0, 114688
    s_nop 0
    buffer_load_dwordx4 v2, s[8:11], s20 offen offset:0 sc1 lds
    buffer_load_dwordx4 v2, s[8:11], s20 offen offset:1024 sc1 lds
    s_add_u32 s20, s20, 2048
    s_cmp_ge_u32 s20, s21
    s_cselect_b32 s28, 49152, 0
    s_sub_u32 s20, s20, s28
    s_mov_b32 m0, 124928
    s_nop 0
    buffer_load_dwordx4 v2, s[8:11], s20 offen offset:0 sc1 lds
    buffer_load_dwordx4 v2, s[8:11], s20 offen offset:1024 sc1 lds
    s_add_u32 s20, s20, 2048
    s_cmp_ge_u32 s20, s21
    s_cselect_b32 s28, 49152, 0
    s_sub_u32 s20, s20, s28
    s_mov_b32 m0, 135168
    s_nop 0
    buffer_load_dwordx4 v2, s[8:11], s20 offen offset:0 sc1 lds
    buffer_load_dwordx4 v2, s[8:11], s20 offen offset:1024 sc1 lds
    s_add_u32 s20, s20, 2048
    s_cmp_ge_u32 s20, s21
    s_cselect_b32 s28, 49152, 0
    s_sub_u32 s20, s20, s28
    s_waitcnt vmcnt(6)
    s_barrier
    s_mov_b32 m0, 145408
    s_nop 0
    buffer_load_dwordx4 v2, s[8:11], s20 offen offset:0 sc1 lds
    buffer_load_dwordx4 v2, s[8:11], s20 offen offset:1024 sc1 lds
    s_add_u32 s20, s20, 2048
    s_cmp_ge_u32 s20, s21
    s_cselect_b32 s28, 49152, 0
    s_sub_u32 s20, s20, s28
    s_mov_b32 m0, 155648
    s_nop 0
    buffer_load_dwordx4 v2, s[8:11], s20 offen offset:0 sc1 lds
    buffer_load_dwordx4 v2, s[8:11], s20 offen offset:1024 sc1 lds
    s_add_u32 s20, s20, 2048
    s_cmp_ge_u32 s20, s21
    s_cselect_b32 s28, 49152, 0
    s_sub_u32 s20, s20, s28
    s_waitcnt vmcnt(8)
    s_barrier
    s_mov_b32 m0, 2048
    s_nop 0
    buffer_load_dwordx4 v2, s[8:11], s20 offen offset:0 sc1 lds
    buffer_load_dwordx4 v2, s[8:11], s20 offen offset:1024 sc1 lds
    s_add_u32 s20, s20, 2048
    s_cmp_ge_u32 s20, s21
    s_cselect_b32 s28, 49152, 0
    s_sub_u32 s20, s20, s28
    s_mov_b32 m0, 104448
    s_nop 0
    buffer_load_dwordx4 v2, s[8:11], s20 offen offset:0 sc1 lds
    s_waitcnt vmcnt(9)
    s_barrier
    s_mov_b32 m0, 104448
    s_nop 0
    buffer_load_dwordx4 v2, s[8:11], s20 offen offset:1024 sc1 lds
    s_add_u32 s20, s20, 2048
    s_cmp_ge_u32 s20, s21
    s_cselect_b32 s28, 49152, 0
    s_sub_u32 s20, s20, s28
    s_mov_b32 m0, 12288
    s_nop 0
    buffer_load_dwordx4 v2, s[8:11], s20 offen offset:0 sc1 lds
    buffer_load_dwordx4 v2, s[8:11], s20 offen offset:1024 sc1 lds
    s_add_u32 s20, s20, 2048
    s_cmp_ge_u32 s20, s21
    s_cselect_b32 s28, 49152, 0
    s_sub_u32 s20, s20, s28
    s_mov_b32 m0, 114688
    s_nop 0
    buffer_load_dwordx4 v2, s[8:11], s20 offen offset:0 sc1 lds
    s_waitcnt vmcnt(11)
    s_barrier
    s_mov_b32 m0, 114688
    s_nop 0
    buffer_load_dwordx4 v2, s[8:11], s20 offen offset:1024 sc1 lds
    s_add_u32 s20, s20, 2048
    s_cmp_ge_u32 s20, s21
    s_cselect_b32 s28, 49152, 0
    s_sub_u32 s20, s20, s28
    s_mov_b32 m0, 22528
    s_nop 0
    buffer_load_dwordx4 v2, s[8:11], s20 offen offset:0 sc1 lds
    buffer_load_dwordx4 v2, s[8:11], s20 offen offset:1024 sc1 lds
    s_add_u32 s20, s20, 2048
    s_cmp_ge_u32 s20, s21
    s_cselect_b32 s28, 49152, 0
    s_sub_u32 s20, s20, s28
    s_mov_b32 m0, 124928
    s_nop 0
    buffer_load_dwordx4 v2, s[8:11], s20 offen offset:0 sc1 lds
    s_waitcnt vmcnt(13)
    s_barrier
    s_mov_b32 m0, 124928
    s_nop 0
    buffer_load_dwordx4 v2, s[8:11], s20 offen offset:1024 sc1 lds
    s_add_u32 s20, s20, 2048
    s_cmp_ge_u32 s20, s21
    s_cselect_b32 s28, 49152, 0
    s_sub_u32 s20, s20, s28
    s_mov_b32 m0, 32768
    s_nop 0
    buffer_load_dwordx4 v2, s[8:11], s20 offen offset:0 sc1 lds
    buffer_load_dwordx4 v2, s[8:11], s20 offen offset:1024 sc1 lds
    s_add_u32 s20, s20, 2048
    s_cmp_ge_u32 s20, s21
    s_cselect_b32 s28, 49152, 0
    s_sub_u32 s20, s20, s28
    s_mov_b32 m0, 135168
    s_nop 0
    buffer_load_dwordx4 v2, s[8:11], s20 offen offset:0 sc1 lds
    s_waitcnt vmcnt(15)
    s_barrier
    s_mov_b32 m0, 135168
    s_nop 0
    buffer_load_dwordx4 v2, s[8:11], s20 offen offset:1024 sc1 lds
    s_add_u32 s20, s20, 2048
    s_cmp_ge_u32 s20, s21
    s_cselect_b32 s28, 49152, 0
    s_sub_u32 s20, s20, s28
    s_mov_b32 m0, 44032
    s_nop 0
    buffer_load_dwordx4 v2, s[8:11], s22 offen offset:0 sc1 lds
    buffer_load_dwordx4 v2, s[8:11], s22 offen offset:1024 sc1 lds
    buffer_load_dwordx4 v2, s[8:11], s22 offen offset:2048 sc1 lds
    s_add_u32 s22, s22, 10240
    s_cmp_ge_u32 s22, s23
    s_cselect_b32 s28, 245760, 0
    s_sub_u32 s22, s22, s28
    s_waitcnt vmcnt(17)
    s_barrier
    s_mov_b32 m0, 145408
    s_nop 0
    buffer_load_dwordx4 v2, s[8:11], s20 offen offset:0 sc1 lds
    buffer_load_dwordx4 v2, s[8:11], s20 offen offset:1024 sc1 lds
    s_add_u32 s20, s20, 2048
    s_cmp_ge_u32 s20, s21
    s_cselect_b32 s28, 49152, 0
    s_sub_u32 s20, s20, s28
    s_mov_b32 m0, 54272
    s_nop 0
    buffer_load_dwordx4 v2, s[8:11], s22 offen offset:0 sc1 lds
    buffer_load_dwordx4 v2, s[8:11], s22 offen offset:1024 sc1 lds
    s_waitcnt vmcnt(19)
    s_barrier
    s_mov_b32 m0, 54272
    s_nop 0
    buffer_load_dwordx4 v2, s[8:11], s22 offen offset:2048 sc1 lds
    s_add_u32 s22, s22, 10240
    s_cmp_ge_u32 s22, s23
    s_cselect_b32 s28, 245760, 0
    s_sub_u32 s22, s22, s28
    s_mov_b32 m0, 155648
    s_nop 0
    buffer_load_dwordx4 v2, s[8:11], s20 offen offset:0 sc1 lds
    buffer_load_dwordx4 v2, s[8:11], s20 offen offset:1024 sc1 lds
    s_add_u32 s20, s20, 2048
    s_cmp_ge_u32 s20, s21
    s_cselect_b32 s28, 49152, 0
    s_sub_u32 s20, s20, s28
    s_mov_b32 m0, 64512
    s_nop 0
    buffer_load_dwordx4 v2, s[8:11], s22 offen offset:0 sc1 lds
    s_waitcnt vmcnt(21)
    s_barrier
    s_mov_b32 m0, 64512
    s_nop 0
    buffer_load_dwordx4 v2, s[8:11], s22 offen offset:1024 sc1 lds
    buffer_load_dwordx4 v2, s[8:11], s22 offen offset:2048 sc1 lds
    s_add_u32 s22, s22, 10240
    s_cmp_ge_u32 s22, s23
    s_cselect_b32 s28, 245760, 0
    s_sub_u32 s22, s22, s28
    s_mov_b32 m0, 2048
    s_nop 0
    buffer_load_dwordx4 v2, s[8:11], s20 offen offset:0 sc1 lds
    buffer_load_dwordx4 v2, s[8:11], s20 offen offset:1024 sc1 lds
    s_add_u32 s20, s20, 2048
    s_cmp_ge_u32 s20, s21
    s_cselect_b32 s28, 49152, 0
    s_sub_u32 s20, s20, s28
    s_waitcnt vmcnt(23)
    s_barrier
    s_mov_b32 m0, 74752
    s_nop 0
    buffer_load_dwordx4 v2, s[8:11], s22 offen offset:0 sc1 lds
    buffer_load_dwordx4 v2, s[8:11], s22 offen offset:1024 sc1 lds
    buffer_load_dwordx4 v2, s[8:11], s22 offen offset:2048 sc1 lds
    s_add_u32 s22, s22, 10240
    s_cmp_ge_u32 s22, s23
    s_cselect_b32 s28, 245760, 0
    s_sub_u32 s22, s22, s28
    s_mov_b32 m0, 104448
    s_nop 0
    buffer_load_dwordx4 v2, s[8:11], s20 offen offset:0 sc1 lds
    s_waitcnt vmcnt(16)
    s_barrier
    s_mov_b32 m0, 104448
    s_nop 0
    buffer_load_dwordx4 v2, s[8:11], s20 offen offset:1024 sc1 lds
    s_add_u32 s20, s20, 2048
    s_cmp_ge_u32 s20, s21
    s_cselect_b32 s28, 49152, 0
    s_sub_u32 s20, s20, s28
    s_mov_b32 m0, 84992
    s_nop 0
    buffer_load_dwordx4 v2, s[8:11], s22 offen offset:0 sc1 lds
    buffer_load_dwordx4 v2, s[8:11], s22 offen offset:1024 sc1 lds
    buffer_load_dwordx4 v2, s[8:11], s22 offen offset:2048 sc1 lds
    s_add_u32 s22, s22, 10240
    s_cmp_ge_u32 s22, s23
    s_cselect_b32 s28, 245760, 0
    s_sub_u32 s22, s22, s28
    s_waitcnt vmcnt(15)
    s_barrier
    s_mov_b32 m0, 12288
    s_nop 0
    buffer_load_dwordx4 v2, s[8:11], s20 offen offset:0 sc1 lds
    buffer_load_dwordx4 v2, s[8:11], s20 offen offset:1024 sc1 lds
    s_add_u32 s20, s20, 2048
    s_cmp_ge_u32 s20, s21
    s_cselect_b32 s28, 49152, 0
    s_sub_u32 s20, s20, s28
    s_mov_b32 m0, 95232
    s_nop 0
    buffer_load_dwordx4 v2, s[8:11], s22 offen offset:0 sc1 lds
    s_waitcnt vmcnt(13)
    s_barrier
    s_mov_b32 m0, 95232
    s_nop 0
    buffer_load_dwordx4 v2, s[8:11], s22 offen offset:1024 sc1 lds
    buffer_load_dwordx4 v2, s[8:11], s22 offen offset:2048 sc1 lds
    s_add_u32 s22, s22, 10240
    s_cmp_ge_u32 s22, s23
    s_cselect_b32 s28, 245760, 0
    s_sub_u32 s22, s22, s28
    s_mov_b32 m0, 114688
    s_nop 0
    buffer_load_dwordx4 v2, s[8:11], s20 offen offset:0 sc1 lds
    buffer_load_dwordx4 v2, s[8:11], s20 offen offset:1024 sc1 lds
    s_add_u32 s20, s20, 2048
    s_cmp_ge_u32 s20, s21
    s_cselect_b32 s28, 49152, 0
    s_sub_u32 s20, s20, s28
    s_waitcnt vmcnt(12)
    s_barrier
    s_mov_b32 m0, 44032
    s_nop 0
    buffer_load_dwordx4 v2, s[8:11], s22 offen offset:0 sc1 lds
    buffer_load_dwordx4 v2, s[8:11], s22 offen offset:1024 sc1 lds
    buffer_load_dwordx4 v2, s[8:11], s22 offen offset:2048 sc1 lds
    s_add_u32 s22, s22, 10240
    s_cmp_ge_u32 s22, s23
    s_cselect_b32 s28, 245760, 0
    s_sub_u32 s22, s22, s28
    s_mov_b32 m0, 22528
    s_nop 0
    buffer_load_dwordx4 v2, s[8:11], s20 offen offset:0 sc1 lds
    s_waitcnt vmcnt(11)
    s_barrier
    s_mov_b32 m0, 22528
    s_nop 0
    buffer_load_dwordx4 v2, s[8:11], s20 offen offset:1024 sc1 lds
    s_add_u32 s20, s20, 2048
    s_cmp_ge_u32 s20, s21
    s_cselect_b32 s28, 49152, 0
    s_sub_u32 s20, s20, s28
    s_mov_b32 m0, 54272
    s_nop 0
    buffer_load_dwordx4 v2, s[8:11], s22 offen offset:0 sc1 lds
    buffer_load_dwordx4 v2, s[8:11], s22 offen offset:1024 sc1 lds
    buffer_load_dwordx4 v2, s[8:11], s22 offen offset:2048 sc1 lds
    s_add_u32 s22, s22, 10240
    s_cmp_ge_u32 s22, s23
    s_cselect_b32 s28, 245760, 0
    s_sub_u32 s22, s22, s28
    s_waitcnt vmcnt(10)
    s_barrier
    s_mov_b32 m0, 124928
    s_nop 0
    buffer_load_dwordx4 v2, s[8:11], s20 offen offset:0 sc1 lds
    buffer_load_dwordx4 v2, s[8:11], s20 offen offset:1024 sc1 lds
    s_add_u32 s20, s20, 2048
    s_cmp_ge_u32 s20, s21
    s_cselect_b32 s28, 49152, 0
    s_sub_u32 s20, s20, s28
    s_mov_b32 m0, 64512
    s_nop 0
    buffer_load_dwordx4 v2, s[8:11], s22 offen offset:0 sc1 lds
    buffer_load_dwordx4 v2, s[8:11], s22 offen offset:1024 sc1 lds
    s_waitcnt vmcnt(9)
    s_barrier
    s_mov_b32 m0, 64512
    s_nop 0
    buffer_load_dwordx4 v2, s[8:11], s22 offen offset:2048 sc1 lds
    s_add_u32 s22, s22, 10240
    s_cmp_ge_u32 s22, s23
    s_cselect_b32 s28, 245760, 0
    s_sub_u32 s22, s22, s28
    s_mov_b32 m0, 32768
    s_nop 0
    buffer_load_dwordx4 v2, s[8:11], s20 offen offset:0 sc1 lds
    buffer_load_dwordx4 v2, s[8:11], s20 offen offset:1024 sc1 lds
    s_add_u32 s20, s20, 2048
    s_cmp_ge_u32 s20, s21
    s_cselect_b32 s28, 49152, 0
    s_sub_u32 s20, s20, s28
    s_mov_b32 m0, 74752
    s_nop 0
    buffer_load_dwordx4 v2, s[8:11], s22 offen offset:0 sc1 lds
    s_waitcnt vmcnt(8)
    s_barrier
    s_mov_b32 m0, 74752
    s_nop 0
    buffer_load_dwordx4 v2, s[8:11], s22 offen offset:1024 sc1 lds
    buffer_load_dwordx4 v2, s[8:11], s22 offen offset:2048 sc1 lds
    s_add_u32 s22, s22, 10240
    s_cmp_ge_u32 s22, s23
    s_cselect_b32 s28, 245760, 0
    s_sub_u32 s22, s22, s28
    s_mov_b32 m0, 135168
    s_nop 0
    buffer_load_dwordx4 v2, s[8:11], s20 offen offset:0 sc1 lds
    buffer_load_dwordx4 v2, s[8:11], s20 offen offset:1024 sc1 lds
    s_add_u32 s20, s20, 2048
    s_cmp_ge_u32 s20, s21
    s_cselect_b32 s28, 49152, 0
    s_sub_u32 s20, s20, s28
    s_waitcnt vmcnt(7)
    s_barrier
    s_mov_b32 m0, 84992
    s_nop 0
    buffer_load_dwordx4 v2, s[8:11], s22 offen offset:0 sc1 lds
    buffer_load_dwordx4 v2, s[8:11], s22 offen offset:1024 sc1 lds
    buffer_load_dwordx4 v2, s[8:11], s22 offen offset:2048 sc1 lds
    s_add_u32 s22, s22, 10240
    s_cmp_ge_u32 s22, s23
    s_cselect_b32 s28, 245760, 0
    s_sub_u32 s22, s22, s28
    s_mov_b32 m0, 146432
    s_nop 0
    buffer_load_dwordx4 v2, s[8:11], s22 offen offset:0 sc1 lds
    s_waitcnt vmcnt(6)
    s_barrier
    s_mov_b32 m0, 146432
    s_nop 0
    buffer_load_dwordx4 v2, s[8:11], s22 offen offset:1024 sc1 lds
    buffer_load_dwordx4 v2, s[8:11], s22 offen offset:2048 sc1 lds
    s_add_u32 s22, s22, 10240
    s_cmp_ge_u32 s22, s23
    s_cselect_b32 s28, 245760, 0
    s_sub_u32 s22, s22, s28
    s_mov_b32 m0, 95232
    s_nop 0
    buffer_load_dwordx4 v2, s[8:11], s22 offen offset:0 sc1 lds
    buffer_load_dwordx4 v2, s[8:11], s22 offen offset:1024 sc1 lds
    s_waitcnt vmcnt(5)
    s_barrier
    s_mov_b32 m0, 95232
    s_nop 0
    buffer_load_dwordx4 v2, s[8:11], s22 offen offset:2048 sc1 lds
    s_add_u32 s22, s22, 10240
    s_cmp_ge_u32 s22, s23
    s_cselect_b32 s28, 245760, 0
    s_sub_u32 s22, s22, s28
    s_mov_b32 m0, 156672
    s_nop 0
    buffer_load_dwordx4 v2, s[8:11], s22 offen offset:0 sc1 lds
    buffer_load_dwordx4 v2, s[8:11], s22 offen offset:1024 sc1 lds
    buffer_load_dwordx4 v2, s[8:11], s22 offen offset:2048 sc1 lds
    s_add_u32 s22, s22, 10240
    s_cmp_ge_u32 s22, s23
    s_cselect_b32 s28, 245760, 0
    s_sub_u32 s22, s22, s28
    s_waitcnt vmcnt(6)
    s_barrier
    s_waitcnt vmcnt(3)
    s_barrier
    s_waitcnt vmcnt(0)
    s_barrier
    s_endpgm
tail_l2:
    v_lshlrev_b32 v2, 4, v0
    s_waitcnt vmcnt(0)
    s_barrier
    s_mov_b32 s29, 30670848
    s_mov_b32 s59, 0x40000
poll_108:
    buffer_load_dwordx4 v[4:7], v2, s[8:11], s29 offen sc1
    s_waitcnt vmcnt(0)
    v_xor_b32 v4, s58, v4
    v_xor_b32 v5, s58, v5
    v_xor_b32 v6, s58, v6
    v_xor_b32 v7, s58, v7
    v_or_b32 v4, v4, v5
    v_or_b32 v4, v4, v6
    v_or_b32 v4, v4, v7
    v_cmp_ne_u32 vcc, 0, v4
    s_sub_u32 s59, s59, 1
    s_nop 2
    s_cbranch_vccz pollok_109
    s_cmp_eq_u32 s59, 0
    s_cbranch_scc1 pollok_109
    s_sleep 1
    s_branch poll_108
pollok_109:
    s_and_b32 s6, s2, 3
    s_lshl_b32 s6, s6, 3
    s_bfe_u32 s4, s2, 0x30003
    s_add_u32 s4, s4, s6
    s_bfe_u32 s6, s2, 0x10002
    s_lshl_b32 s6, s6, 2
    s_lshr_b32 s5, s2, 6
    s_add_u32 s5, s5, s6
    s_mov_b32 s39, 0
    s_mul_i32 s22, s5, 102400
    s_add_u32 s22, s22, 23068672
    s_mul_i32 s29, s39, 10
    s_add_u32 s29, s29, 94
    s_cmp_ge_u32 s29, 100
    s_cselect_b32 s28, 100, 0
    s_sub_u32 s29, s29, s28
    s_add_u32 s22, s22, 96256
    s_mov_b32 m0, 96256
    s_nop 0
    buffer_load_dwordx4 v2, s[8:11], s22 offen offset:0 sc1 lds
    s_add_u32 s22, s22, 1024
    s_mov_b32 m0, 97280
    s_nop 0
    buffer_load_dwordx4 v2, s[8:11], s22 offen offset:0 sc1 lds
    s_add_u32 s22, s22, 1024
    s_mov_b32 m0, 98304
    s_nop 0
    buffer_load_dwordx4 v2, s[8:11], s22 offen offset:0 sc1 lds
    s_add_u32 s22, s22, 1024
    s_lshl_b32 s29, s39, 7
    s_add_u32 s29, s29, 0
    v_add_u32 v4, s29, v2
    v_subrev_u32 v5, 1280, v4
    v_min_u32 v4, v4, v5
    s_mov_b32 s28, 30179328
    s_mov_b32 m0, 112640
    s_nop 0
    buffer_load_dwordx4 v4, s[8:11], s28 offen sc1 lds
    s_mov_b32 s12, s40
    s_mov_b32 s13, s41
    s_mov_b32 s14, 2621440
    s_mov_b32 s15, 0x20000
    s_mul_i32 s24, s4, 81920
    s_mul_i32 s28, s5, 160
    s_add_u32 s24, s24, s28
    v_add_u32 v4, 128, v0
    v_mul_u32_u24 v5, 6554, v4
    v_lshrrev_b32 v5, 16, v5
    v_mul_u32_u24 v6, 10, v5
    v_sub_u32 v4, v4, v6
    v_mul_u32_u24 v5, 1280, v5
    v_lshl_add_u32 v8, v4, 4, v5
    s_mov_b32 m0, 104448
    s_nop 0
    buffer_load_dwordx4 v8, s[12:15], s24 offen lds
    v_add_u32 v4, 384, v0
    v_mul_u32_u24 v5, 6554, v4
    v_lshrrev_b32 v5, 16, v5
    v_mul_u32_u24 v6, 10, v5
    v_sub_u32 v4, v4, v6
    v_mul_u32_u24 v5, 1280, v5
    v_lshl_add_u32 v9, v4, 4, v5
    s_mov_b32 m0, 108544
    s_nop 0
    buffer_load_dwordx4 v9, s[12:15], s24 offen lds
    s_mul_i32 s20, s4, 81920
    s_add_u32 s20, s20, 8429568
    s_add_u32 s21, s20, 40960
    s_waitcnt vmcnt(0)
    s_barrier
    s_and_b32 s6, s2, 1
    s_lshl_b32 s6, s6, 3
    s_bfe_u32 s4, s2, 0x30003
    s_add_u32 s4, s4, s6
    s_bfe_u32 s6, s2, 0x20001
    s_lshl_b32 s6, s6, 2
    s_lshr_b32 s5, s2, 6
    s_add_u32 s5, s5, s6
    s_lshl_b32 s29, s4, 2
    s_add_u32 s29, s29, 2
    s_lshl_b32 s24, s29, 7
    s_add_u32 s24, s24, 30199808
    v_and_b32 v3, 31, v0
    v_lshrrev_b32 v4, 5, v0
    v_lshlrev_b32 v5, 2, v3
    v_lshl_add_u32 v5, v4, 16, v5
    s_mul_i32 s20, s29, 40960
    s_add_u32 s20, s20, 12058624
    s_mul_i32 s22, s5, 245760
    s_add_u32 s22, s22, 23894016
    s_add_u32 s21, s20, 20480
    s_add_u32 s23, s22, 245760
    s_barrier
    s_mov_b32 m0, 6144
    s_nop 0
    buffer_load_dwordx4 v2, s[8:11], s22 offen offset:0 sc1 lds
    s_waitcnt vmcnt(4)
    buffer_load_dwordx4 v2, s[8:11], s22 offen offset:1024 sc1 lds
    s_waitcnt vmcnt(4)
    buffer_load_dwordx4 v2, s[8:11], s22 offen offset:2048 sc1 lds
    s_waitcnt vmcnt(4)
    s_add_u32 s22, s22, 12288
    s_mov_b32 m0, 18432
    s_nop 0
    buffer_load_dwordx4 v2, s[8:11], s22 offen offset:0 sc1 lds
    s_waitcnt vmcnt(4)
    buffer_load_dwordx4 v2, s[8:11], s22 offen offset:1024 sc1 lds
    s_waitcnt vmcnt(4)
    buffer_load_dwordx4 v2, s[8:11], s22 offen offset:2048 sc1 lds
    s_waitcnt vmcnt(4)
    s_add_u32 s22, s22, 12288
    s_mov_b32 m0, 30720
    s_nop 0
    buffer_load_dwordx4 v2, s[8:11], s22 offen offset:0 sc1 lds
    s_waitcnt vmcnt(4)
    buffer_load_dwordx4 v2, s[8:11], s22 offen offset:1024 sc1 lds
    s_waitcnt vmcnt(4)
    buffer_load_dwordx4 v2, s[8:11], s22 offen offset:2048 sc1 lds
    s_waitcnt vmcnt(4)
    s_add_u32 s22, s22, 12288
    s_mov_b32 m0, 43008
    s_nop 0
    buffer_load_dwordx4 v2, s[8:11], s22 offen offset:0 sc1 lds
    s_waitcnt vmcnt(4)
    buffer_load_dwordx4 v2, s[8:11], s22 offen offset:1024 sc1 lds
    s_waitcnt vmcnt(4)
    buffer_load_dwordx4 v2, s[8:11], s22 offen offset:2048 sc1 lds
    s_waitcnt vmcnt(4)
    s_add_u32 s22, s22, 12288
    s_mov_b32 m0, 55296
    s_nop 0
    buffer_load_dwordx4 v2, s[8:11], s22 offen offset:0 sc1 lds
    s_waitcnt vmcnt(4)
    buffer_load_dwordx4 v2, s[8:11], s22 offen offset:1024 sc1 lds
    s_waitcnt vmcnt(4)
    buffer_load_dwordx4 v2, s[8:11], s22 offen offset:2048 sc1 lds
    s_waitcnt vmcnt(4)
    s_add_u32 s22, s22, 12288
    s_mov_b32 m0, 67584
    s_nop 0
    buffer_load_dwordx4 v2, s[8:11], s22 offen offset:0 sc1 lds
    s_waitcnt vmcnt(4)
    buffer_load_dwordx4 v2, s[8:11], s22 offen offset:1024 sc1 lds
    s_waitcnt vmcnt(4)
    buffer_load_dwordx4 v2, s[8:11], s22 offen offset:2048 sc1 lds
    s_waitcnt vmcnt(4)
    s_add_u32 s22, s22, 12288
    s_mov_b32 m0, 79872
    s_nop 0
    buffer_load_dwordx4 v2, s[8:11], s22 offen offset:0 sc1 lds
    s_waitcnt vmcnt(4)
    buffer_load_dwordx4 v2, s[8:11], s22 offen offset:1024 sc1 lds
    s_waitcnt vmcnt(4)
    buffer_load_dwordx4 v2, s[8:11], s22 offen offset:2048 sc1 lds
    s_waitcnt vmcnt(4)
    s_add_u32 s22, s22, 12288
    s_mov_b32 m0, 92160
    s_nop 0
    buffer_load_dwordx4 v2, s[8:11], s22 offen offset:0 sc1 lds
    s_waitcnt vmcnt(4)
    buffer_load_dwordx4 v2, s[8:11], s22 offen offset:1024 sc1 lds
    s_waitcnt vmcnt(4)
    buffer_load_dwordx4 v2, s[8:11], s22 offen offset:2048 sc1 lds
    s_waitcnt vmcnt(4)
    s_add_u32 s22, s22, 12288
    s_barrier
    s_mov_b32 m0, 102400
    s_nop 0
    buffer_load_dwordx4 v2, s[8:11], s20 offen offset:0 sc1 lds
    s_add_u32 s29, s20, 20480
    s_mov_b32 m0, 103424
    s_nop 0
    buffer_load_dwordx4 v2, s[8:11], s29 offen offset:0 sc1 lds
    s_add_u32 s20, s20, 1024
    s_mov_b32 m0, 114688
    s_nop 0
    buffer_load_dwordx4 v2, s[8:11], s20 offen offset:0 sc1 lds
    s_add_u32 s29, s20, 20480
    s_mov_b32 m0, 115712
    s_nop 0
    buffer_load_dwordx4 v2, s[8:11], s29 offen offset:0 sc1 lds
    s_add_u32 s20, s20, 1024
    s_mov_b32 m0, 126976
    s_nop 0
    buffer_load_dwordx4 v2, s[8:11], s20 offen offset:0 sc1 lds
    s_add_u32 s29, s20, 20480
    s_mov_b32 m0, 128000
    s_nop 0
    buffer_load_dwordx4 v2, s[8:11], s29 offen offset:0 sc1 lds
    s_add_u32 s20, s20, 1024
    s_mov_b32 m0, 139264
    s_nop 0
    buffer_load_dwordx4 v2, s[8:11], s20 offen offset:0 sc1 lds
    s_add_u32 s29, s20, 20480
    s_mov_b32 m0, 140288
    s_nop 0
    buffer_load_dwordx4 v2, s[8:11], s29 offen offset:0 sc1 lds
    s_add_u32 s20, s20, 1024
    s_waitcnt vmcnt(6)
    s_barrier
    s_mov_b32 m0, 151552
    s_nop 0
    buffer_load_dwordx4 v2, s[8:11], s20 offen offset:0 sc1 lds
    s_add_u32 s29, s20, 20480
    s_mov_b32 m0, 152576
    s_nop 0
    buffer_load_dwordx4 v2, s[8:11], s29 offen offset:0 sc1 lds
    s_add_u32 s20, s20, 1024
    buffer_load_dword v8, v5, s[8:11], s24 offen sc1
    s_add_u32 s24, s24, 8192
    buffer_load_dword v9, v5, s[8:11], s24 offen sc1
    s_add_u32 s24, s24, 8192
    buffer_load_dword v10, v5, s[8:11], s24 offen sc1
    s_add_u32 s24, s24, 8192
    buffer_load_dword v11, v5, s[8:11], s24 offen sc1
    s_add_u32 s24, s24, 8192
    buffer_load_dword v12, v5, s[8:11], s24 offen sc1
    s_add_u32 s24, s24, 8192
    buffer_load_dword v13, v5, s[8:11], s24 offen sc1
    s_add_u32 s24, s24, 8192
    buffer_load_dword v14, v5, s[8:11], s24 offen sc1
    s_add_u32 s24, s24, 8192
    buffer_load_dword v15, v5, s[8:11], s24 offen sc1
    s_add_u32 s24, s24, 8192
    s_waitcnt vmcnt(14)
    s_barrier
    s_mov_b32 m0, 4096
    s_nop 0
    buffer_load_dwordx4 v2, s[8:11], s20 offen offset:0 sc1 lds
    s_add_u32 s29, s20, 20480
    s_mov_b32 m0, 5120
    s_nop 0
    buffer_load_dwordx4 v2, s[8:11], s29 offen offset:0 sc1 lds
    s_add_u32 s20, s20, 1024
    s_mov_b32 m0, 102400
    s_nop 0
    buffer_load_dwordx4 v2, s[8:11], s20 offen offset:0 sc1 lds
    s_add_u32 s29, s20, 20480
    s_mov_b32 m0, 103424
    s_nop 0
    buffer_load_dwordx4 v2, s[8:11], s29 offen offset:0 sc1 lds
    s_add_u32 s20, s20, 1024
    s_waitcnt vmcnt(16)
    s_barrier
    s_mov_b32 m0, 16384
    s_nop 0
    buffer_load_dwordx4 v2, s[8:11], s20 offen offset:0 sc1 lds
    s_add_u32 s29, s20, 20480
    s_mov_b32 m0, 17408
    s_nop 0
    buffer_load_dwordx4 v2, s[8:11], s29 offen offset:0 sc1 lds
    s_add_u32 s20, s20, 1024
    s_mov_b32 m0, 114688
    s_nop 0
    buffer_load_dwordx4 v2, s[8:11], s20 offen offset:0 sc1 lds
    s_add_u32 s29, s20, 20480
    s_mov_b32 m0, 115712
    s_nop 0
    buffer_load_dwordx4 v2, s[8:11], s29 offen offset:0 sc1 lds
    s_add_u32 s20, s20, 1024
    s_waitcnt vmcnt(18)
    s_barrier
    s_mov_b32 m0, 28672
    s_nop 0
    buffer_load_dwordx4 v2, s[8:11], s20 offen offset:0 sc1 lds
    s_add_u32 s29, s20, 20480
    s_mov_b32 m0, 29696
    s_nop 0
    buffer_load_dwordx4 v2, s[8:11], s29 offen offset:0 sc1 lds
    s_add_u32 s20, s20, 1024
    s_mov_b32 m0, 129024
    s_nop 0
    buffer_load_dwordx4 v2, s[8:11], s22 offen offset:0 sc1 lds
    buffer_load_dwordx4 v2, s[8:11], s22 offen offset:1024 sc1 lds
    s_waitcnt vmcnt(20)
    s_barrier
    s_mov_b32 m0, 129024
    s_nop 0
    buffer_load_dwordx4 v2, s[8:11], s22 offen offset:2048 sc1 lds
    s_add_u32 s22, s22, 12288
    s_mov_b32 m0, 40960
    s_nop 0
    buffer_load_dwordx4 v2, s[8:11], s20 offen offset:0 sc1 lds
    s_add_u32 s29, s20, 20480
    s_mov_b32 m0, 41984
    s_nop 0
    buffer_load_dwordx4 v2, s[8:11], s29 offen offset:0 sc1 lds
    s_add_u32 s20, s20, 1024
    s_mov_b32 m0, 141312
    s_nop 0
    buffer_load_dwordx4 v2, s[8:11], s22 offen offset:0 sc1 lds
    s_waitcnt vmcnt(16)
    v_add_f32 v8, v8, v9
    v_add_f32 v8, v8, v10
    v_add_f32 v8, v8, v11
    v_add_f32 v8, v8, v12
    v_add_f32 v8, v8, v13
    v_add_f32 v8, v8, v14
    v_add_f32 v8, v8, v15
    v_mov_b32 v9, v8
    s_nop 1
    v_permlane32_swap_b32 v8, v9
    v_add_f32 v8, v8, v9
    v_mov_b32 v9, 0x3727c5ac
    v_fmac_f32 v9, 0x3acccccd, v8
    v_rsq_f32 v8, v9
    s_nop 0
    v_mul_f32 v10, v8, v8
    v_mul_f32 v10, v10, v8
    v_mul_f32 v8, 0xc0135761, v8
    v_mul_f32 v10, 0xbdd2d3e8, v10
    s_mov_b32 s29, 160000
    v_lshl_add_u32 v6, v3, 2, s29
    ds_write_b32 v6, v8
    ds_write_b32 v6, v10 offset:512
    ds_write_b32 v6, v9 offset:1024
    s_waitcnt lgkmcnt(0)
    s_waitcnt vmcnt(14)
    s_barrier
    s_mov_b32 m0, 141312
    s_nop 0
    buffer_load_dwordx4 v2, s[8:11], s22 offen offset:1024 sc1 lds
    buffer_load_dwordx4 v2, s[8:11], s22 offen offset:2048 sc1 lds
    s_add_u32 s22, s22, 12288
    s_mov_b32 m0, 53248
    s_nop 0
    buffer_load_dwordx4 v2, s[8:11], s20 offen offset:0 sc1 lds
    s_add_u32 s29, s20, 20480
    s_mov_b32 m0, 54272
    s_nop 0
    buffer_load_dwordx4 v2, s[8:11], s29 offen offset:0 sc1 lds
    s_add_u32 s20, s20, 1024
    s_mov_b32 m0, 153600
    s_nop 0
    buffer_load_dwordx4 v2, s[8:11], s22 offen offset:0 sc1 lds
    s_waitcnt vmcnt(17)
    s_barrier
    s_mov_b32 m0, 153600
    s_nop 0
    buffer_load_dwordx4 v2, s[8:11], s22 offen offset:1024 sc1 lds
    buffer_load_dwordx4 v2, s[8:11], s22 offen offset:2048 sc1 lds
    s_add_u32 s22, s22, 12288
    s_mov_b32 m0, 65536
    s_nop 0
    buffer_load_dwordx4 v2, s[8:11], s20 offen offset:0 sc1 lds
    s_add_u32 s29, s20, 20480
    s_mov_b32 m0, 66560
    s_nop 0
    buffer_load_dwordx4 v2, s[8:11], s29 offen offset:0 sc1 lds
    s_add_u32 s20, s20, 1024
    s_waitcnt vmcnt(19)
    s_barrier
    s_mov_b32 m0, 6144
    s_nop 0
    buffer_load_dwordx4 v2, s[8:11], s22 offen offset:0 sc1 lds
    buffer_load_dwordx4 v2, s[8:11], s22 offen offset:1024 sc1 lds
    buffer_load_dwordx4 v2, s[8:11], s22 offen offset:2048 sc1 lds
    s_add_u32 s22, s22, 12288
    s_mov_b32 m0, 77824
    s_nop 0
    buffer_load_dwordx4 v2, s[8:11], s20 offen offset:0 sc1 lds
    s_waitcnt vmcnt(16)
    s_barrier
    s_add_u32 s29, s20, 20480
    s_mov_b32 m0, 78848
    s_nop 0
    buffer_load_dwordx4 v2, s[8:11], s29 offen offset:0 sc1 lds
    s_add_u32 s20, s20, 1024
    s_mov_b32 m0, 104448
    s_nop 0
    buffer_load_dwordx4 v2, s[8:11], s22 offen offset:0 sc1 lds
    buffer_load_dwordx4 v2, s[8:11], s22 offen offset:1024 sc1 lds
    buffer_load_dwordx4 v2, s[8:11], s22 offen offset:2048 sc1 lds
    s_add_u32 s22, s22, 12288
    s_waitcnt vmcnt(15)
    s_barrier
    s_mov_b32 m0, 90112
    s_nop 0
    buffer_load_dwordx4 v2, s[8:11], s20 offen offset:0 sc1 lds
    s_add_u32 s29, s20, 20480
    s_mov_b32 m0, 91136
    s_nop 0
    buffer_load_dwordx4 v2, s[8:11], s29 offen offset:0 sc1 lds
    s_add_u32 s20, s20, 1024
    s_mov_b32 m0, 18432
    s_nop 0
    buffer_load_dwordx4 v2, s[8:11], s22 offen offset:0 sc1 lds
    buffer_load_dwordx4 v2, s[8:11], s22 offen offset:1024 sc1 lds
    s_waitcnt vmcnt(14)
    s_barrier
    s_mov_b32 m0, 18432
    s_nop 0
    buffer_load_dwordx4 v2, s[8:11], s22 offen offset:2048 sc1 lds
    s_add_u32 s22, s22, 12288
    s_mov_b32 m0, 126976
    s_nop 0
    buffer_load_dwordx4 v2, s[8:11], s20 offen offset:0 sc1 lds
    s_add_u32 s29, s20, 20480
    s_mov_b32 m0, 128000
    s_nop 0
    buffer_load_dwordx4 v2, s[8:11], s29 offen offset:0 sc1 lds
    s_add_u32 s20, s20, 1024
    s_mov_b32 m0, 116736
    s_nop 0
    buffer_load_dwordx4 v2, s[8:11], s22 offen offset:0 sc1 lds
    buffer_load_dwordx4 v2, s[8:11], s22 offen offset:1024 sc1 lds
    s_waitcnt vmcnt(14)
    s_barrier
    s_mov_b32 m0, 116736
    s_nop 0
    buffer_load_dwordx4 v2, s[8:11], s22 offen offset:2048 sc1 lds
    s_add_u32 s22, s22, 12288
    s_mov_b32 m0, 139264
    s_nop 0
    buffer_load_dwordx4 v2, s[8:11], s20 offen offset:0 sc1 lds
    s_add_u32 s29, s20, 20480
    s_mov_b32 m0, 140288
    s_nop 0
    buffer_load_dwordx4 v2, s[8:11], s29 offen offset:0 sc1 lds
    s_add_u32 s20, s20, 1024
    s_mov_b32 m0, 30720
    s_nop 0
    buffer_load_dwordx4 v2, s[8:11], s22 offen offset:0 sc1 lds
    s_waitcnt vmcnt(13)
    s_barrier
    s_mov_b32 m0, 30720
    s_nop 0
    buffer_load_dwordx4 v2, s[8:11], s22 offen offset:1024 sc1 lds
    buffer_load_dwordx4 v2, s[8:11], s22 offen offset:2048 sc1 lds
    s_add_u32 s22, s22, 12288
    s_mov_b32 m0, 151552
    s_nop 0
    buffer_load_dwordx4 v2, s[8:11], s20 offen offset:0 sc1 lds
    s_add_u32 s29, s20, 20480
    s_mov_b32 m0, 152576
    s_nop 0
    buffer_load_dwordx4 v2, s[8:11], s29 offen offset:0 sc1 lds
    s_add_u32 s20, s20, 1024
    s_waitcnt vmcnt(12)
    s_barrier
    s_mov_b32 m0, 43008
    s_nop 0
    buffer_load_dwordx4 v2, s[8:11], s22 offen offset:0 sc1 lds
    buffer_load_dwordx4 v2, s[8:11], s22 offen offset:1024 sc1 lds
    buffer_load_dwordx4 v2, s[8:11], s22 offen offset:2048 sc1 lds
    s_add_u32 s22, s22, 12288
    s_mov_b32 m0, 4096
    s_nop 0
    buffer_load_dwordx4 v2, s[8:11], s20 offen offset:0 sc1 lds
    s_waitcnt vmcnt(11)
    s_barrier
    s_add_u32 s29, s20, 20480
    s_mov_b32 m0, 5120
    s_nop 0
    buffer_load_dwordx4 v2, s[8:11], s29 offen offset:0 sc1 lds
    s_add_u32 s20, s20, 1024
    s_mov_b32 m0, 55296
    s_nop 0
    buffer_load_dwordx4 v2, s[8:11], s22 offen offset:0 sc1 lds
    buffer_load_dwordx4 v2, s[8:11], s22 offen offset:1024 sc1 lds
    buffer_load_dwordx4 v2, s[8:11], s22 offen offset:2048 sc1 lds
    s_add_u32 s22, s22, 12288
    s_waitcnt vmcnt(10)
    s_barrier
    s_mov_b32 m0, 102400
    s_nop 0
    buffer_load_dwordx4 v2, s[8:11], s20 offen offset:0 sc1 lds
    s_add_u32 s29, s20, 20480
    s_mov_b32 m0, 103424
    s_nop 0
    buffer_load_dwordx4 v2, s[8:11], s29 offen offset:0 sc1 lds
    s_add_u32 s20, s20, 1024
    s_mov_b32 m0, 67584
    s_nop 0
    buffer_load_dwordx4 v2, s[8:11], s22 offen offset:0 sc1 lds
    buffer_load_dwordx4 v2, s[8:11], s22 offen offset:1024 sc1 lds
    buffer_load_dwordx4 v2, s[8:11], s22 offen offset:2048 sc1 lds
    s_add_u32 s22, s22, 12288
    s_waitcnt vmcnt(10)
    s_barrier
    s_mov_b32 m0, 18432
    s_nop 0
    buffer_load_dwordx4 v2, s[8:11], s22 offen offset:0 sc1 lds
    buffer_load_dwordx4 v2, s[8:11], s22 offen offset:1024 sc1 lds
    buffer_load_dwordx4 v2, s[8:11], s22 offen offset:2048 sc1 lds
    s_add_u32 s22, s22, 12288
    s_waitcnt vmcnt(8)
    s_barrier
    s_waitcnt vmcnt(3)
    s_barrier
    s_waitcnt vmcnt(0)
    s_barrier
    s_and_b32 s6, s2, 3
    s_lshl_b32 s6, s6, 3
    s_bfe_u32 s4, s2, 0x30003
    s_add_u32 s4, s4, s6
    s_bfe_u32 s6, s2, 0x10002
    s_lshl_b32 s6, s6, 2
    s_lshr_b32 s5, s2, 6
    s_add_u32 s5, s5, s6
    s_and_b32 s39, s5, 3
    s_mul_i32 s39, s39, 1
    s_mul_i32 s22, s5, 245760
    s_add_u32 s22, s22, 28088320
    s_mul_i32 s20, s4, 196608
    s_add_u32 s20, s20, 15826944
    s_add_u32 s21, s20, 49152
    s_mul_i32 s28, s39, 2048
    s_add_u32 s20, s20, s28
    s_add_u32 s23, s22, 245760
    s_mul_i32 s28, s39, 10240
    s_add_u32 s22, s22, s28
    s_barrier
    s_mov_b32 m0, 6144
    s_nop 0
    buffer_load_dwordx4 v2, s[8:11], s22 offen offset:0 sc1 lds
    s_waitcnt vmcnt(4)
    buffer_load_dwordx4 v2, s[8:11], s22 offen offset:1024 sc1 lds
    s_waitcnt vmcnt(4)
    s_add_u32 s22, s22, 10240
    s_cmp_ge_u32 s22, s23
    s_cselect_b32 s28, 245760, 0
    s_sub_u32 s22, s22, s28
    s_mov_b32 m0, 16384
    s_nop 0
    buffer_load_dwordx4 v2, s[8:11], s22 offen offset:0 sc1 lds
    s_waitcnt vmcnt(4)
    buffer_load_dwordx4 v2, s[8:11], s22 offen offset:1024 sc1 lds
    s_waitcnt vmcnt(4)
    s_add_u32 s22, s22, 10240
    s_cmp_ge_u32 s22, s23
    s_cselect_b32 s28, 245760, 0
    s_sub_u32 s22, s22, s28
    s_mov_b32 m0, 26624
    s_nop 0
    buffer_load_dwordx4 v2, s[8:11], s22 offen offset:0 sc1 lds
    s_waitcnt vmcnt(4)
    buffer_load_dwordx4 v2, s[8:11], s22 offen offset:1024 sc1 lds
    s_waitcnt vmcnt(4)
    s_add_u32 s22, s22, 10240
    s_cmp_ge_u32 s22, s23
    s_cselect_b32 s28, 245760, 0
    s_sub_u32 s22, s22, s28
    s_mov_b32 m0, 36864
    s_nop 0
    buffer_load_dwordx4 v2, s[8:11], s22 offen offset:0 sc1 lds
    s_waitcnt vmcnt(4)
    buffer_load_dwordx4 v2, s[8:11], s22 offen offset:1024 sc1 lds
    s_waitcnt vmcnt(4)
    s_add_u32 s22, s22, 10240
    s_cmp_ge_u32 s22, s23
    s_cselect_b32 s28, 245760, 0
    s_sub_u32 s22, s22, s28
    s_mov_b32 m0, 47104
    s_nop 0
    buffer_load_dwordx4 v2, s[8:11], s22 offen offset:0 sc1 lds
    s_waitcnt vmcnt(4)
    buffer_load_dwordx4 v2, s[8:11], s22 offen offset:1024 sc1 lds
    s_waitcnt vmcnt(4)
    s_add_u32 s22, s22, 10240
    s_cmp_ge_u32 s22, s23
    s_cselect_b32 s28, 245760, 0
    s_sub_u32 s22, s22, s28
    s_mov_b32 m0, 57344
    s_nop 0
    buffer_load_dwordx4 v2, s[8:11], s22 offen offset:0 sc1 lds
    s_waitcnt vmcnt(4)
    buffer_load_dwordx4 v2, s[8:11], s22 offen offset:1024 sc1 lds
    s_waitcnt vmcnt(4)
    s_add_u32 s22, s22, 10240
    s_cmp_ge_u32 s22, s23
    s_cselect_b32 s28, 245760, 0
    s_sub_u32 s22, s22, s28
    s_mov_b32 m0, 67584
    s_nop 0
    buffer_load_dwordx4 v2, s[8:11], s22 offen offset:0 sc1 lds
    s_waitcnt vmcnt(4)
    buffer_load_dwordx4 v2, s[8:11], s22 offen offset:1024 sc1 lds
    s_waitcnt vmcnt(4)
    s_add_u32 s22, s22, 10240
    s_cmp_ge_u32 s22, s23
    s_cselect_b32 s28, 245760, 0
    s_sub_u32 s22, s22, s28
    s_mov_b32 m0, 77824
    s_nop 0
    buffer_load_dwordx4 v2, s[8:11], s22 offen offset:0 sc1 lds
    s_waitcnt vmcnt(4)
    buffer_load_dwordx4 v2, s[8:11], s22 offen offset:1024 sc1 lds
    s_waitcnt vmcnt(4)
    s_add_u32 s22, s22, 10240
    s_cmp_ge_u32 s22, s23
    s_cselect_b32 s28, 245760, 0
    s_sub_u32 s22, s22, s28
    s_mov_b32 m0, 88064
    s_nop 0
    buffer_load_dwordx4 v2, s[8:11], s22 offen offset:0 sc1 lds
    s_waitcnt vmcnt(4)
    buffer_load_dwordx4 v2, s[8:11], s22 offen offset:1024 sc1 lds
    s_waitcnt vmcnt(4)
    s_add_u32 s22, s22, 10240
    s_cmp_ge_u32 s22, s23
    s_cselect_b32 s28, 245760, 0
    s_sub_u32 s22, s22, s28
    s_mov_b32 m0, 98304
    s_nop 0
    buffer_load_dwordx4 v2, s[8:11], s22 offen offset:0 sc1 lds
    s_waitcnt vmcnt(4)
    buffer_load_dwordx4 v2, s[8:11], s22 offen offset:1024 sc1 lds
    s_waitcnt vmcnt(4)
    s_add_u32 s22, s22, 10240
    s_cmp_ge_u32 s22, s23
    s_cselect_b32 s28, 245760, 0
    s_sub_u32 s22, s22, s28
    s_barrier
    s_mov_b32 m0, 106496
    s_nop 0
    buffer_load_dwordx4 v2, s[8:11], s20 offen offset:0 sc1 lds
    buffer_load_dwordx4 v2, s[8:11], s20 offen offset:1024 sc1 lds
    s_add_u32 s20, s20, 2048
    s_cmp_ge_u32 s20, s21
    s_cselect_b32 s28, 49152, 0
    s_sub_u32 s20, s20, s28
    s_mov_b32 m0, 116736
    s_nop 0
    buffer_load_dwordx4 v2, s[8:11], s20 offen offset:0 sc1 lds
    buffer_load_dwordx4 v2, s[8:11], s20 offen offset:1024 sc1 lds
    s_add_u32 s20, s20, 2048
    s_cmp_ge_u32 s20, s21
    s_cselect_b32 s28, 49152, 0
    s_sub_u32 s20, s20, s28
    s_mov_b32 m0, 126976
    s_nop 0
    buffer_load_dwordx4 v2, s[8:11], s20 offen offset:0 sc1 lds
    buffer_load_dwordx4 v2, s[8:11], s20 offen offset:1024 sc1 lds
    s_add_u32 s20, s20, 2048
    s_cmp_ge_u32 s20, s21
    s_cselect_b32 s28, 49152, 0
    s_sub_u32 s20, s20, s28
    s_mov_b32 m0, 137216
    s_nop 0
    buffer_load_dwordx4 v2, s[8:11], s20 offen offset:0 sc1 lds
    buffer_load_dwordx4 v2, s[8:11], s20 offen offset:1024 sc1 lds
    s_add_u32 s20, s20, 2048
    s_cmp_ge_u32 s20, s21
    s_cselect_b32 s28, 49152, 0
    s_sub_u32 s20, s20, s28
    s_waitcnt vmcnt(6)
    s_barrier
    s_mov_b32 m0, 147456
    s_nop 0
    buffer_load_dwordx4 v2, s[8:11], s20 offen offset:0 sc1 lds
    buffer_load_dwordx4 v2, s[8:11], s20 offen offset:1024 sc1 lds
    s_add_u32 s20, s20, 2048
    s_cmp_ge_u32 s20, s21
    s_cselect_b32 s28, 49152, 0
    s_sub_u32 s20, s20, s28
    s_mov_b32 m0, 157696
    s_nop 0
    buffer_load_dwordx4 v2, s[8:11], s20 offen offset:0 sc1 lds
    buffer_load_dwordx4 v2, s[8:11], s20 offen offset:1024 sc1 lds
    s_add_u32 s20, s20, 2048
    s_cmp_ge_u32 s20, s21
    s_cselect_b32 s28, 49152, 0
    s_sub_u32 s20, s20, s28
    s_waitcnt vmcnt(8)
    s_barrier
    s_mov_b32 m0, 4096
    s_nop 0
    buffer_load_dwordx4 v2, s[8:11], s20 offen offset:0 sc1 lds
    buffer_load_dwordx4 v2, s[8:11], s20 offen offset:1024 sc1 lds
    s_add_u32 s20, s20, 2048
    s_cmp_ge_u32 s20, s21
    s_cselect_b32 s28, 49152, 0
    s_sub_u32 s20, s20, s28
    s_mov_b32 m0, 106496
    s_nop 0
    buffer_load_dwordx4 v2, s[8:11], s20 offen offset:0 sc1 lds
    s_waitcnt vmcnt(9)
    s_barrier
    s_mov_b32 m0, 106496
    s_nop 0
    buffer_load_dwordx4 v2, s[8:11], s20 offen offset:1024 sc1 lds
    s_add_u32 s20, s20, 2048
    s_cmp_ge_u32 s20, s21
    s_cselect_b32 s28, 49152, 0
    s_sub_u32 s20, s20, s28
    s_mov_b32 m0, 14336
    s_nop 0
    buffer_load_dwordx4 v2, s[8:11], s20 offen offset:0 sc1 lds
    buffer_load_dwordx4 v2, s[8:11], s20 offen offset:1024 sc1 lds
    s_add_u32 s20, s20, 2048
    s_cmp_ge_u32 s20, s21
    s_cselect_b32 s28, 49152, 0
    s_sub_u32 s20, s20, s28
    s_mov_b32 m0, 116736
    s_nop 0
    buffer_load_dwordx4 v2, s[8:11], s20 offen offset:0 sc1 lds
    s_waitcnt vmcnt(11)
    s_barrier
    s_mov_b32 m0, 116736
    s_nop 0
    buffer_load_dwordx4 v2, s[8:11], s20 offen offset:1024 sc1 lds
    s_add_u32 s20, s20, 2048
    s_cmp_ge_u32 s20, s21
    s_cselect_b32 s28, 49152, 0
    s_sub_u32 s20, s20, s28
    s_mov_b32 m0, 24576
    s_nop 0
    buffer_load_dwordx4 v2, s[8:11], s20 offen offset:0 sc1 lds
    buffer_load_dwordx4 v2, s[8:11], s20 offen offset:1024 sc1 lds
    s_add_u32 s20, s20, 2048
    s_cmp_ge_u32 s20, s21
    s_cselect_b32 s28, 49152, 0
    s_sub_u32 s20, s20, s28
    s_mov_b32 m0, 126976
    s_nop 0
    buffer_load_dwordx4 v2, s[8:11], s20 offen offset:0 sc1 lds
    s_waitcnt vmcnt(13)
    s_barrier
    s_mov_b32 m0, 126976
    s_nop 0
    buffer_load_dwordx4 v2, s[8:11], s20 offen offset:1024 sc1 lds
    s_add_u32 s20, s20, 2048
    s_cmp_ge_u32 s20, s21
    s_cselect_b32 s28, 49152, 0
    s_sub_u32 s20, s20, s28
    s_mov_b32 m0, 34816
    s_nop 0
    buffer_load_dwordx4 v2, s[8:11], s20 offen offset:0 sc1 lds
    buffer_load_dwordx4 v2, s[8:11], s20 offen offset:1024 sc1 lds
    s_add_u32 s20, s20, 2048
    s_cmp_ge_u32 s20, s21
    s_cselect_b32 s28, 49152, 0
    s_sub_u32 s20, s20, s28
    s_mov_b32 m0, 137216
    s_nop 0
    buffer_load_dwordx4 v2, s[8:11], s20 offen offset:0 sc1 lds
    s_waitcnt vmcnt(15)
    s_barrier
    s_mov_b32 m0, 137216
    s_nop 0
    buffer_load_dwordx4 v2, s[8:11], s20 offen offset:1024 sc1 lds
    s_add_u32 s20, s20, 2048
    s_cmp_ge_u32 s20, s21
    s_cselect_b32 s28, 49152, 0
    s_sub_u32 s20, s20, s28
    s_mov_b32 m0, 47104
    s_nop 0
    buffer_load_dwordx4 v2, s[8:11], s22 offen offset:0 sc1 lds
    buffer_load_dwordx4 v2, s[8:11], s22 offen offset:1024 sc1 lds
    s_add_u32 s22, s22, 10240
    s_cmp_ge_u32 s22, s23
    s_cselect_b32 s28, 245760, 0
    s_sub_u32 s22, s22, s28
    s_waitcnt vmcnt(16)
    s_barrier
    s_mov_b32 m0, 147456
    s_nop 0
    buffer_load_dwordx4 v2, s[8:11], s20 offen offset:0 sc1 lds
    buffer_load_dwordx4 v2, s[8:11], s20 offen offset:1024 sc1 lds
    s_add_u32 s20, s20, 2048
    s_cmp_ge_u32 s20, s21
    s_cselect_b32 s28, 49152, 0
    s_sub_u32 s20, s20, s28
    s_mov_b32 m0, 57344
    s_nop 0
    buffer_load_dwordx4 v2, s[8:11], s22 offen offset:0 sc1 lds
    buffer_load_dwordx4 v2, s[8:11], s22 offen offset:1024 sc1 lds
    s_waitcnt vmcnt(18)
    s_barrier
    s_add_u32 s22, s22, 10240
    s_cmp_ge_u32 s22, s23
    s_cselect_b32 s28, 245760, 0
    s_sub_u32 s22, s22, s28
    s_mov_b32 m0, 157696
    s_nop 0
    buffer_load_dwordx4 v2, s[8:11], s20 offen offset:0 sc1 lds
    buffer_load_dwordx4 v2, s[8:11], s20 offen offset:1024 sc1 lds
    s_add_u32 s20, s20, 2048
    s_cmp_ge_u32 s20, s21
    s_cselect_b32 s28, 49152, 0
    s_sub_u32 s20, s20, s28
    s_mov_b32 m0, 67584
    s_nop 0
    buffer_load_dwordx4 v2, s[8:11], s22 offen offset:0 sc1 lds
    s_waitcnt vmcnt(19)
    s_barrier
    s_mov_b32 m0, 67584
    s_nop 0
    buffer_load_dwordx4 v2, s[8:11], s22 offen offset:1024 sc1 lds
    s_add_u32 s22, s22, 10240
    s_cmp_ge_u32 s22, s23
    s_cselect_b32 s28, 245760, 0
    s_sub_u32 s22, s22, s28
    s_mov_b32 m0, 4096
    s_nop 0
    buffer_load_dwordx4 v2, s[8:11], s20 offen offset:0 sc1 lds
    buffer_load_dwordx4 v2, s[8:11], s20 offen offset:1024 sc1 lds
    s_add_u32 s20, s20, 2048
    s_cmp_ge_u32 s20, s21
    s_cselect_b32 s28, 49152, 0
    s_sub_u32 s20, s20, s28
    s_waitcnt vmcnt(20)
    s_barrier
    s_mov_b32 m0, 77824
    s_nop 0
    buffer_load_dwordx4 v2, s[8:11], s22 offen offset:0 sc1 lds
    buffer_load_dwordx4 v2, s[8:11], s22 offen offset:1024 sc1 lds
    s_add_u32 s22, s22, 10240
    s_cmp_ge_u32 s22, s23
    s_cselect_b32 s28, 245760, 0
    s_sub_u32 s22, s22, s28
    s_mov_b32 m0, 106496
    s_nop 0
    buffer_load_dwordx4 v2, s[8:11], s20 offen offset:0 sc1 lds
    s_waitcnt vmcnt(13)
    s_barrier
    s_mov_b32 m0, 106496
    s_nop 0
    buffer_load_dwordx4 v2, s[8:11], s20 offen offset:1024 sc1 lds
    s_add_u32 s20, s20, 2048
    s_cmp_ge_u32 s20, s21
    s_cselect_b32 s28, 49152, 0
    s_sub_u32 s20, s20, s28
    s_mov_b32 m0, 88064
    s_nop 0
    buffer_load_dwordx4 v2, s[8:11], s22 offen offset:0 sc1 lds
    buffer_load_dwordx4 v2, s[8:11], s22 offen offset:1024 sc1 lds
    s_add_u32 s22, s22, 10240
    s_cmp_ge_u32 s22, s23
    s_cselect_b32 s28, 245760, 0
    s_sub_u32 s22, s22, s28
    s_waitcnt vmcnt(12)
    s_barrier
    s_mov_b32 m0, 14336
    s_nop 0
    buffer_load_dwordx4 v2, s[8:11], s20 offen offset:0 sc1 lds
    buffer_load_dwordx4 v2, s[8:11], s20 offen offset:1024 sc1 lds
    s_add_u32 s20, s20, 2048
    s_cmp_ge_u32 s20, s21
    s_cselect_b32 s28, 49152, 0
    s_sub_u32 s20, s20, s28
    s_mov_b32 m0, 98304
    s_nop 0
    buffer_load_dwordx4 v2, s[8:11], s22 offen offset:0 sc1 lds
    s_waitcnt vmcnt(11)
    s_barrier
    s_mov_b32 m0, 98304
    s_nop 0
    buffer_load_dwordx4 v2, s[8:11], s22 offen offset:1024 sc1 lds
    s_add_u32 s22, s22, 10240
    s_cmp_ge_u32 s22, s23
    s_cselect_b32 s28, 245760, 0
    s_sub_u32 s22, s22, s28
    s_mov_b32 m0, 116736
    s_nop 0
    buffer_load_dwordx4 v2, s[8:11], s20 offen offset:0 sc1 lds
    buffer_load_dwordx4 v2, s[8:11], s20 offen offset:1024 sc1 lds
    s_add_u32 s20, s20, 2048
    s_cmp_ge_u32 s20, s21
    s_cselect_b32 s28, 49152, 0
    s_sub_u32 s20, s20, s28
    s_waitcnt vmcnt(10)
    s_barrier
    s_mov_b32 m0, 47104
    s_nop 0
    buffer_load_dwordx4 v2, s[8:11], s22 offen offset:0 sc1 lds
    buffer_load_dwordx4 v2, s[8:11], s22 offen offset:1024 sc1 lds
    s_add_u32 s22, s22, 10240
    s_cmp_ge_u32 s22, s23
    s_cselect_b32 s28, 245760, 0
    s_sub_u32 s22, s22, s28
    s_mov_b32 m0, 24576
    s_nop 0
    buffer_load_dwordx4 v2, s[8:11], s20 offen offset:0 sc1 lds
    s_waitcnt vmcnt(9)
    s_barrier
    s_mov_b32 m0, 24576
    s_nop 0
    buffer_load_dwordx4 v2, s[8:11], s20 offen offset:1024 sc1 lds
    s_add_u32 s20, s20, 2048
    s_cmp_ge_u32 s20, s21
    s_cselect_b32 s28, 49152, 0
    s_sub_u32 s20, s20, s28
    s_mov_b32 m0, 57344
    s_nop 0
    buffer_load_dwordx4 v2, s[8:11], s22 offen offset:0 sc1 lds
    buffer_load_dwordx4 v2, s[8:11], s22 offen offset:1024 sc1 lds
    s_add_u32 s22, s22, 10240
    s_cmp_ge_u32 s22, s23
    s_cselect_b32 s28, 245760, 0
    s_sub_u32 s22, s22, s28
    s_waitcnt vmcnt(8)
    s_barrier
    s_mov_b32 m0, 126976
    s_nop 0
    buffer_load_dwordx4 v2, s[8:11], s20 offen offset:0 sc1 lds
    buffer_load_dwordx4 v2, s[8:11], s20 offen offset:1024 sc1 lds
    s_add_u32 s20, s20, 2048
    s_cmp_ge_u32 s20, s21
    s_cselect_b32 s28, 49152, 0
    s_sub_u32 s20, s20, s28
    s_mov_b32 m0, 67584
    s_nop 0
    buffer_load_dwordx4 v2, s[8:11], s22 offen offset:0 sc1 lds
    buffer_load_dwordx4 v2, s[8:11], s22 offen offset:1024 sc1 lds
    s_waitcnt vmcnt(8)
    s_barrier
    s_add_u32 s22, s22, 10240
    s_cmp_ge_u32 s22, s23
    s_cselect_b32 s28, 245760, 0
    s_sub_u32 s22, s22, s28
    s_mov_b32 m0, 34816
    s_nop 0
    buffer_load_dwordx4 v2, s[8:11], s20 offen offset:0 sc1 lds
    buffer_load_dwordx4 v2, s[8:11], s20 offen offset:1024 sc1 lds
    s_add_u32 s20, s20, 2048
    s_cmp_ge_u32 s20, s21
    s_cselect_b32 s28, 49152, 0
    s_sub_u32 s20, s20, s28
    s_mov_b32 m0, 77824
    s_nop 0
    buffer_load_dwordx4 v2, s[8:11], s22 offen offset:0 sc1 lds
    s_waitcnt vmcnt(7)
    s_barrier
    s_mov_b32 m0, 77824
    s_nop 0
    buffer_load_dwordx4 v2, s[8:11], s22 offen offset:1024 sc1 lds
    s_add_u32 s22, s22, 10240
    s_cmp_ge_u32 s22, s23
    s_cselect_b32 s28, 245760, 0
    s_sub_u32 s22, s22, s28
    s_mov_b32 m0, 137216
    s_nop 0
    buffer_load_dwordx4 v2, s[8:11], s20 offen offset:0 sc1 lds
    buffer_load_dwordx4 v2, s[8:11], s20 offen offset:1024 sc1 lds
    s_add_u32 s20, s20, 2048
    s_cmp_ge_u32 s20, s21
    s_cselect_b32 s28, 49152, 0
    s_sub_u32 s20, s20, s28
    s_waitcnt vmcnt(6)
    s_barrier
    s_mov_b32 m0, 88064
    s_nop 0
    buffer_load_dwordx4 v2, s[8:11], s22 offen offset:0 sc1 lds
    buffer_load_dwordx4 v2, s[8:11], s22 offen offset:1024 sc1 lds
    s_add_u32 s22, s22, 10240
    s_cmp_ge_u32 s22, s23
    s_cselect_b32 s28, 245760, 0
    s_sub_u32 s22, s22, s28
    s_mov_b32 m0, 149504
    s_nop 0
    buffer_load_dwordx4 v2, s[8:11], s22 offen offset:0 sc1 lds
    s_waitcnt vmcnt(5)
    s_barrier
    s_mov_b32 m0, 149504
    s_nop 0
    buffer_load_dwordx4 v2, s[8:11], s22 offen offset:1024 sc1 lds
    s_add_u32 s22, s22, 10240
    s_cmp_ge_u32 s22, s23
    s_cselect_b32 s28, 245760, 0
    s_sub_u32 s22, s22, s28
    s_mov_b32 m0, 98304
    s_nop 0
    buffer_load_dwordx4 v2, s[8:11], s22 offen offset:0 sc1 lds
    buffer_load_dwordx4 v2, s[8:11], s22 offen offset:1024 sc1 lds
    s_waitcnt vmcnt(4)
    s_barrier
    s_add_u32 s22, s22, 10240
    s_cmp_ge_u32 s22, s23
    s_cselect_b32 s28, 245760, 0
    s_sub_u32 s22, s22, s28
    s_mov_b32 m0, 159744
    s_nop 0
    buffer_load_dwordx4 v2, s[8:11], s22 offen offset:0 sc1 lds
    buffer_load_dwordx4 v2, s[8:11], s22 offen offset:1024 sc1 lds
    s_add_u32 s22, s22, 10240
    s_cmp_ge_u32 s22, s23
    s_cselect_b32 s28, 245760, 0
    s_sub_u32 s22, s22, s28
    s_waitcnt vmcnt(4)
    s_barrier
    s_waitcnt vmcnt(2)
    s_barrier
    s_waitcnt vmcnt(0)
    s_barrier
    s_endpgm
tail_l3:
    v_lshlrev_b32 v2, 4, v0
    s_waitcnt vmcnt(0)
    s_barrier
    s_mov_b32 s29, 30671872
    s_mov_b32 s59, 0x40000
poll_110:
    buffer_load_dwordx4 v[4:7], v2, s[8:11], s29 offen sc1
    s_waitcnt vmcnt(0)
    v_xor_b32 v4, s58, v4
    v_xor_b32 v5, s58, v5
    v_xor_b32 v6, s58, v6
    v_xor_b32 v7, s58, v7
    v_or_b32 v4, v4, v5
    v_or_b32 v4, v4, v6
    v_or_b32 v4, v4, v7
    v_cmp_ne_u32 vcc, 0, v4
    s_sub_u32 s59, s59, 1
    s_nop 2
    s_cbranch_vccz pollok_111
    s_cmp_eq_u32 s59, 0
    s_cbranch_scc1 pollok_111
    s_sleep 1
    s_branch poll_110
pollok_111:
    s_and_b32 s6, s2, 3
    s_lshl_b32 s6, s6, 3
    s_bfe_u32 s4, s2, 0x30003
    s_add_u32 s4, s4, s6
    s_bfe_u32 s6, s2, 0x10002
    s_lshl_b32 s6, s6, 2
    s_lshr_b32 s5, s2, 6
    s_add_u32 s5, s5, s6
    s_mov_b32 s39, 0
    s_mul_i32 s22, s5, 102400
    s_add_u32 s22, s22, 23068672
    s_mul_i32 s29, s39, 10
    s_add_u32 s29, s29, 97
    s_cmp_ge_u32 s29, 100
    s_cselect_b32 s28, 100, 0
    s_sub_u32 s29, s29, s28
    s_add_u32 s22, s22, 99328
    s_mov_b32 m0, 99328
    s_nop 0
    buffer_load_dwordx4 v2, s[8:11], s22 offen offset:0 sc1 lds
    s_add_u32 s22, s22, 1024
    s_mov_b32 m0, 100352
    s_nop 0
    buffer_load_dwordx4 v2, s[8:11], s22 offen offset:0 sc1 lds
    s_add_u32 s22, s22, 1024
    s_mov_b32 m0, 101376
    s_nop 0
    buffer_load_dwordx4 v2, s[8:11], s22 offen offset:0 sc1 lds
    s_add_u32 s22, s22, 1024
    s_lshl_b32 s29, s39, 7
    s_add_u32 s29, s29, 1024
    v_add_u32 v4, s29, v2
    v_subrev_u32 v5, 1280, v4
    v_min_u32 v4, v4, v5
    s_mov_b32 s28, 30179328
    s_mov_b32 m0, 113664
    s_mov_b64 exec, 0xffff
    buffer_load_dwordx4 v4, s[8:11], s28 offen sc1 lds
    s_mov_b64 exec, -1
    v_mov_b32 v4, 114176
    v_mov_b32 v5, 0
    ds_write_b32 v4, v5
    s_waitcnt lgkmcnt(0)
    s_mov_b32 s12, s40
    s_mov_b32 s13, s41
    s_mov_b32 s14, 2621440
    s_mov_b32 s15, 0x20000
    s_mul_i32 s24, s4, 81920
    s_mul_i32 s28, s5, 160
    s_add_u32 s24, s24, s28
    v_add_u32 v4, 192, v0
    v_mul_u32_u24 v5, 6554, v4
    v_lshrrev_b32 v5, 16, v5
    v_mul_u32_u24 v6, 10, v5
    v_sub_u32 v4, v4, v6
    v_mul_u32_u24 v5, 1280, v5
    v_lshl_add_u32 v8, v4, 4, v5
    s_mov_b32 m0, 105472
    s_nop 0
    buffer_load_dwordx4 v8, s[12:15], s24 offen lds
    v_add_u32 v4, 448, v0
    v_mul_u32_u24 v5, 6554, v4
    v_lshrrev_b32 v5, 16, v5
    v_mul_u32_u24 v6, 10, v5
    v_sub_u32 v4, v4, v6
    v_mul_u32_u24 v5, 1280, v5
    v_lshl_add_u32 v9, v4, 4, v5
    s_mov_b32 m0, 109568
    s_nop 0
    buffer_load_dwordx4 v9, s[12:15], s24 offen lds
    s_mul_i32 s20, s4, 81920
    s_add_u32 s20, s20, 8431616
    s_add_u32 s21, s20, 40960
    s_waitcnt vmcnt(0)
    s_barrier
    s_and_b32 s6, s2, 1
    s_lshl_b32 s6, s6, 3
    s_bfe_u32 s4, s2, 0x30003
    s_add_u32 s4, s4, s6
    s_bfe_u32 s6, s2, 0x20001
    s_lshl_b32 s6, s6, 2
    s_lshr_b32 s5, s2, 6
    s_add_u32 s5, s5, s6
    s_lshl_b32 s29, s4, 2
    s_add_u32 s29, s29, 3
    s_lshl_b32 s24, s29, 7
    s_add_u32 s24, s24, 30199808
    v_and_b32 v3, 31, v0
    v_lshrrev_b32 v4, 5, v0
    v_lshlrev_b32 v5, 2, v3
    v_lshl_add_u32 v5, v4, 16, v5
    s_mul_i32 s20, s29, 40960
    s_add_u32 s20, s20, 12058624
    s_mul_i32 s22, s5, 245760
    s_add_u32 s22, s22, 23897088
    s_add_u32 s21, s20, 20480
    s_add_u32 s23, s22, 245760
    s_barrier
    s_mov_b32 m0, 9216
    s_nop 0
    buffer_load_dwordx4 v2, s[8:11], s22 offen offset:0 sc1 lds
    s_waitcnt vmcnt(4)
    buffer_load_dwordx4 v2, s[8:11], s22 offen offset:1024 sc1 lds
    s_waitcnt vmcnt(4)
    buffer_load_dwordx4 v2, s[8:11], s22 offen offset:2048 sc1 lds
    s_waitcnt vmcnt(4)
    s_add_u32 s22, s22, 12288
    s_mov_b32 m0, 21504
    s_nop 0
    buffer_load_dwordx4 v2, s[8:11], s22 offen offset:0 sc1 lds
    s_waitcnt vmcnt(4)
    buffer_load_dwordx4 v2, s[8:11], s22 offen offset:1024 sc1 lds
    s_waitcnt vmcnt(4)
    buffer_load_dwordx4 v2, s[8:11], s22 offen offset:2048 sc1 lds
    s_waitcnt vmcnt(4)
    s_add_u32 s22, s22, 12288
    s_mov_b32 m0, 33792
    s_nop 0
    buffer_load_dwordx4 v2, s[8:11], s22 offen offset:0 sc1 lds
    s_waitcnt vmcnt(4)
    buffer_load_dwordx4 v2, s[8:11], s22 offen offset:1024 sc1 lds
    s_waitcnt vmcnt(4)
    buffer_load_dwordx4 v2, s[8:11], s22 offen offset:2048 sc1 lds
    s_waitcnt vmcnt(4)
    s_add_u32 s22, s22, 12288
    s_mov_b32 m0, 46080
    s_nop 0
    buffer_load_dwordx4 v2, s[8:11], s22 offen offset:0 sc1 lds
    s_waitcnt vmcnt(4)
    buffer_load_dwordx4 v2, s[8:11], s22 offen offset:1024 sc1 lds
    s_waitcnt vmcnt(4)
    buffer_load_dwordx4 v2, s[8:11], s22 offen offset:2048 sc1 lds
    s_waitcnt vmcnt(4)
    s_add_u32 s22, s22, 12288
    s_mov_b32 m0, 58368
    s_nop 0
    buffer_load_dwordx4 v2, s[8:11], s22 offen offset:0 sc1 lds
    s_waitcnt vmcnt(4)
    buffer_load_dwordx4 v2, s[8:11], s22 offen offset:1024 sc1 lds
    s_waitcnt vmcnt(4)
    buffer_load_dwordx4 v2, s[8:11], s22 offen offset:2048 sc1 lds
    s_waitcnt vmcnt(4)
    s_add_u32 s22, s22, 12288
    s_mov_b32 m0, 70656
    s_nop 0
    buffer_load_dwordx4 v2, s[8:11], s22 offen offset:0 sc1 lds
    s_waitcnt vmcnt(4)
    buffer_load_dwordx4 v2, s[8:11], s22 offen offset:1024 sc1 lds
    s_waitcnt vmcnt(4)
    buffer_load_dwordx4 v2, s[8:11], s22 offen offset:2048 sc1 lds
    s_waitcnt vmcnt(4)
    s_add_u32 s22, s22, 12288
    s_mov_b32 m0, 82944
    s_nop 0
    buffer_load_dwordx4 v2, s[8:11], s22 offen offset:0 sc1 lds
    s_waitcnt vmcnt(4)
    buffer_load_dwordx4 v2, s[8:11], s22 offen offset:1024 sc1 lds
    s_waitcnt vmcnt(4)
    buffer_load_dwordx4 v2, s[8:11], s22 offen offset:2048 sc1 lds
    s_waitcnt vmcnt(4)
    s_add_u32 s22, s22, 12288
    s_mov_b32 m0, 95232
    s_nop 0
    buffer_load_dwordx4 v2, s[8:11], s22 offen offset:0 sc1 lds
    s_waitcnt vmcnt(4)
    buffer_load_dwordx4 v2, s[8:11], s22 offen offset:1024 sc1 lds
    s_waitcnt vmcnt(4)
    buffer_load_dwordx4 v2, s[8:11], s22 offen offset:2048 sc1 lds
    s_waitcnt vmcnt(4)
    s_add_u32 s22, s22, 12288
    s_barrier
    s_mov_b32 m0, 104448
    s_nop 0
    buffer_load_dwordx4 v2, s[8:11], s20 offen offset:0 sc1 lds
    s_add_u32 s29, s20, 20480
    s_mov_b32 m0, 105472
    s_nop 0
    buffer_load_dwordx4 v2, s[8:11], s29 offen offset:0 sc1 lds
    s_add_u32 s20, s20, 1024
    s_mov_b32 m0, 116736
    s_nop 0
    buffer_load_dwordx4 v2, s[8:11], s20 offen offset:0 sc1 lds
    s_add_u32 s29, s20, 20480
    s_mov_b32 m0, 117760
    s_nop 0
    buffer_load_dwordx4 v2, s[8:11], s29 offen offset:0 sc1 lds
    s_add_u32 s20, s20, 1024
    s_mov_b32 m0, 129024
    s_nop 0
    buffer_load_dwordx4 v2, s[8:11], s20 offen offset:0 sc1 lds
    s_add_u32 s29, s20, 20480
    s_mov_b32 m0, 130048
    s_nop 0
    buffer_load_dwordx4 v2, s[8:11], s29 offen offset:0 sc1 lds
    s_add_u32 s20, s20, 1024
    s_mov_b32 m0, 141312
    s_nop 0
    buffer_load_dwordx4 v2, s[8:11], s20 offen offset:0 sc1 lds
    s_add_u32 s29, s20, 20480
    s_mov_b32 m0, 142336
    s_nop 0
    buffer_load_dwordx4 v2, s[8:11], s29 offen offset:0 sc1 lds
    s_add_u32 s20, s20, 1024
    s_waitcnt vmcnt(6)
    s_barrier
    s_mov_b32 m0, 153600
    s_nop 0
    buffer_load_dwordx4 v2, s[8:11], s20 offen offset:0 sc1 lds
    s_add_u32 s29, s20, 20480
    s_mov_b32 m0, 154624
    s_nop 0
    buffer_load_dwordx4 v2, s[8:11], s29 offen offset:0 sc1 lds
    s_add_u32 s20, s20, 1024
    buffer_load_dword v8, v5, s[8:11], s24 offen sc1
    s_add_u32 s24, s24, 8192
    buffer_load_dword v9, v5, s[8:11], s24 offen sc1
    s_add_u32 s24, s24, 8192
    buffer_load_dword v10, v5, s[8:11], s24 offen sc1
    s_add_u32 s24, s24, 8192
    buffer_load_dword v11, v5, s[8:11], s24 offen sc1
    s_add_u32 s24, s24, 8192
    buffer_load_dword v12, v5, s[8:11], s24 offen sc1
    s_add_u32 s24, s24, 8192
    buffer_load_dword v13, v5, s[8:11], s24 offen sc1
    s_add_u32 s24, s24, 8192
    buffer_load_dword v14, v5, s[8:11], s24 offen sc1
    s_add_u32 s24, s24, 8192
    buffer_load_dword v15, v5, s[8:11], s24 offen sc1
    s_add_u32 s24, s24, 8192
    s_waitcnt vmcnt(14)
    s_barrier
    s_mov_b32 m0, 6144
    s_nop 0
    buffer_load_dwordx4 v2, s[8:11], s20 offen offset:0 sc1 lds
    s_add_u32 s29, s20, 20480
    s_mov_b32 m0, 7168
    s_nop 0
    buffer_load_dwordx4 v2, s[8:11], s29 offen offset:0 sc1 lds
    s_add_u32 s20, s20, 1024
    s_mov_b32 m0, 104448
    s_nop 0
    buffer_load_dwordx4 v2, s[8:11], s20 offen offset:0 sc1 lds
    s_add_u32 s29, s20, 20480
    s_mov_b32 m0, 105472
    s_nop 0
    buffer_load_dwordx4 v2, s[8:11], s29 offen offset:0 sc1 lds
    s_add_u32 s20, s20, 1024
    s_waitcnt vmcnt(16)
    s_barrier
    s_mov_b32 m0, 18432
    s_nop 0
    buffer_load_dwordx4 v2, s[8:11], s20 offen offset:0 sc1 lds
    s_add_u32 s29, s20, 20480
    s_mov_b32 m0, 19456
    s_nop 0
    buffer_load_dwordx4 v2, s[8:11], s29 offen offset:0 sc1 lds
    s_add_u32 s20, s20, 1024
    s_mov_b32 m0, 116736
    s_nop 0
    buffer_load_dwordx4 v2, s[8:11], s20 offen offset:0 sc1 lds
    s_add_u32 s29, s20, 20480
    s_mov_b32 m0, 117760
    s_nop 0
    buffer_load_dwordx4 v2, s[8:11], s29 offen offset:0 sc1 lds
    s_add_u32 s20, s20, 1024
    s_waitcnt vmcnt(18)
    s_barrier
    s_mov_b32 m0, 30720
    s_nop 0
    buffer_load_dwordx4 v2, s[8:11], s20 offen offset:0 sc1 lds
    s_add_u32 s29, s20, 20480
    s_mov_b32 m0, 31744
    s_nop 0
    buffer_load_dwordx4 v2, s[8:11], s29 offen offset:0 sc1 lds
    s_add_u32 s20, s20, 1024
    s_mov_b32 m0, 132096
    s_nop 0
    buffer_load_dwordx4 v2, s[8:11], s22 offen offset:0 sc1 lds
    buffer_load_dwordx4 v2, s[8:11], s22 offen offset:1024 sc1 lds
    s_waitcnt vmcnt(20)
    s_barrier
    s_mov_b32 m0, 132096
    s_nop 0
    buffer_load_dwordx4 v2, s[8:11], s22 offen offset:2048 sc1 lds
    s_add_u32 s22, s22, 12288
    s_mov_b32 m0, 43008
    s_nop 0
    buffer_load_dwordx4 v2, s[8:11], s20 offen offset:0 sc1 lds
    s_add_u32 s29, s20, 20480
    s_mov_b32 m0, 44032
    s_nop 0
    buffer_load_dwordx4 v2, s[8:11], s29 offen offset:0 sc1 lds
    s_add_u32 s20, s20, 1024
    s_mov_b32 m0, 144384
    s_nop 0
    buffer_load_dwordx4 v2, s[8:11], s22 offen offset:0 sc1 lds
    s_waitcnt vmcnt(16)
    v_add_f32 v8, v8, v9
    v_add_f32 v8, v8, v10
    v_add_f32 v8, v8, v11
    v_add_f32 v8, v8, v12
    v_add_f32 v8, v8, v13
    v_add_f32 v8, v8, v14
    v_add_f32 v8, v8, v15
    v_mov_b32 v9, v8
    s_nop 1
    v_permlane32_swap_b32 v8, v9
    v_add_f32 v8, v8, v9
    v_mov_b32 v9, 0x3727c5ac
    v_fmac_f32 v9, 0x3acccccd, v8
    v_rsq_f32 v8, v9
    s_nop 0
    v_mul_f32 v10, v8, v8
    v_mul_f32 v10, v10, v8
    v_mul_f32 v8, 0xc0135761, v8
    v_mul_f32 v10, 0xbdd2d3e8, v10
    s_mov_b32 s29, 160128
    v_lshl_add_u32 v6, v3, 2, s29
    ds_write_b32 v6, v8
    ds_write_b32 v6, v10 offset:512
    ds_write_b32 v6, v9 offset:1024
    s_waitcnt lgkmcnt(0)
    s_waitcnt vmcnt(14)
    s_barrier
    s_mov_b32 m0, 144384
    s_nop 0
    buffer_load_dwordx4 v2, s[8:11], s22 offen offset:1024 sc1 lds
    buffer_load_dwordx4 v2, s[8:11], s22 offen offset:2048 sc1 lds
    s_add_u32 s22, s22, 12288
    s_mov_b32 m0, 55296
    s_nop 0
    buffer_load_dwordx4 v2, s[8:11], s20 offen offset:0 sc1 lds
    s_add_u32 s29, s20, 20480
    s_mov_b32 m0, 56320
    s_nop 0
    buffer_load_dwordx4 v2, s[8:11], s29 offen offset:0 sc1 lds
    s_add_u32 s20, s20, 1024
    s_mov_b32 m0, 156672
    s_nop 0
    buffer_load_dwordx4 v2, s[8:11], s22 offen offset:0 sc1 lds
    s_waitcnt vmcnt(17)
    s_barrier
    s_mov_b32 m0, 156672
    s_nop 0
    buffer_load_dwordx4 v2, s[8:11], s22 offen offset:1024 sc1 lds
    buffer_load_dwordx4 v2, s[8:11], s22 offen offset:2048 sc1 lds
    s_add_u32 s22, s22, 12288
    s_mov_b32 m0, 67584
    s_nop 0
    buffer_load_dwordx4 v2, s[8:11], s20 offen offset:0 sc1 lds
    s_add_u32 s29, s20, 20480
    s_mov_b32 m0, 68608
    s_nop 0
    buffer_load_dwordx4 v2, s[8:11], s29 offen offset:0 sc1 lds
    s_add_u32 s20, s20, 1024
    s_waitcnt vmcnt(19)
    s_barrier
    s_mov_b32 m0, 9216
    s_nop 0
    buffer_load_dwordx4 v2, s[8:11], s22 offen offset:0 sc1 lds
    buffer_load_dwordx4 v2, s[8:11], s22 offen offset:1024 sc1 lds
    buffer_load_dwordx4 v2, s[8:11], s22 offen offset:2048 sc1 lds
    s_add_u32 s22, s22, 12288
    s_mov_b32 m0, 79872
    s_nop 0
    buffer_load_dwordx4 v2, s[8:11], s20 offen offset:0 sc1 lds
    s_waitcnt vmcnt(16)
    s_barrier
    s_add_u32 s29, s20, 20480
    s_mov_b32 m0, 80896
    s_nop 0
    buffer_load_dwordx4 v2, s[8:11], s29 offen offset:0 sc1 lds
    s_add_u32 s20, s20, 1024
    s_mov_b32 m0, 107520
    s_nop 0
    buffer_load_dwordx4 v2, s[8:11], s22 offen offset:0 sc1 lds
    buffer_load_dwordx4 v2, s[8:11], s22 offen offset:1024 sc1 lds
    buffer_load_dwordx4 v2, s[8:11], s22 offen offset:2048 sc1 lds
    s_add_u32 s22, s22, 12288
    s_waitcnt vmcnt(15)
    s_barrier
    s_mov_b32 m0, 92160
    s_nop 0
    buffer_load_dwordx4 v2, s[8:11], s20 offen offset:0 sc1 lds
    s_add_u32 s29, s20, 20480
    s_mov_b32 m0, 93184
    s_nop 0
    buffer_load_dwordx4 v2, s[8:11], s29 offen offset:0 sc1 lds
    s_add_u32 s20, s20, 1024
    s_mov_b32 m0, 21504
    s_nop 0
    buffer_load_dwordx4 v2, s[8:11], s22 offen offset:0 sc1 lds
    buffer_load_dwordx4 v2, s[8:11], s22 offen offset:1024 sc1 lds
    s_waitcnt vmcnt(14)
    s_barrier
    s_mov_b32 m0, 21504
    s_nop 0
    buffer_load_dwordx4 v2, s[8:11], s22 offen offset:2048 sc1 lds
    s_add_u32 s22, s22, 12288
    s_mov_b32 m0, 129024
    s_nop 0
    buffer_load_dwordx4 v2, s[8:11], s20 offen offset:0 sc1 lds
    s_add_u32 s29, s20, 20480
    s_mov_b32 m0, 130048
    s_nop 0
    buffer_load_dwordx4 v2, s[8:11], s29 offen offset:0 sc1 lds
    s_add_u32 s20, s20, 1024
    s_mov_b32 m0, 119808
    s_nop 0
    buffer_load_dwordx4 v2, s[8:11], s22 offen offset:0 sc1 lds
    buffer_load_dwordx4 v2, s[8:11], s22 offen offset:1024 sc1 lds
    s_waitcnt vmcnt(14)
    s_barrier
    s_mov_b32 m0, 119808
    s_nop 0
    buffer_load_dwordx4 v2, s[8:11], s22 offen offset:2048 sc1 lds
    s_add_u32 s22, s22, 12288
    s_mov_b32 m0, 141312
    s_nop 0
    buffer_load_dwordx4 v2, s[8:11], s20 offen offset:0 sc1 lds
    s_add_u32 s29, s20, 20480
    s_mov_b32 m0, 142336
    s_nop 0
    buffer_load_dwordx4 v2, s[8:11], s29 offen offset:0 sc1 lds
    s_add_u32 s20, s20, 1024
    s_mov_b32 m0, 33792
    s_nop 0
    buffer_load_dwordx4 v2, s[8:11], s22 offen offset:0 sc1 lds
    s_waitcnt vmcnt(13)
    s_barrier
    s_mov_b32 m0, 33792
    s_nop 0
    buffer_load_dwordx4 v2, s[8:11], s22 offen offset:1024 sc1 lds
    buffer_load_dwordx4 v2, s[8:11], s22 offen offset:2048 sc1 lds
    s_add_u32 s22, s22, 12288
    s_mov_b32 m0, 153600
    s_nop 0
    buffer_load_dwordx4 v2, s[8:11], s20 offen offset:0 sc1 lds
    s_add_u32 s29, s20, 20480
    s_mov_b32 m0, 154624
    s_nop 0
    buffer_load_dwordx4 v2, s[8:11], s29 offen offset:0 sc1 lds
    s_add_u32 s20, s20, 1024
    s_waitcnt vmcnt(12)
    s_barrier
    s_mov_b32 m0, 46080
    s_nop 0
    buffer_load_dwordx4 v2, s[8:11], s22 offen offset:0 sc1 lds
    buffer_load_dwordx4 v2, s[8:11], s22 offen offset:1024 sc1 lds
    buffer_load_dwordx4 v2, s[8:11], s22 offen offset:2048 sc1 lds
    s_add_u32 s22, s22, 12288
    s_mov_b32 m0, 6144
    s_nop 0
    buffer_load_dwordx4 v2, s[8:11], s20 offen offset:0 sc1 lds
    s_waitcnt vmcnt(11)
    s_barrier
    s_add_u32 s29, s20, 20480
    s_mov_b32 m0, 7168
    s_nop 0
    buffer_load_dwordx4 v2, s[8:11], s29 offen offset:0 sc1 lds
    s_add_u32 s20, s20, 1024
    s_mov_b32 m0, 58368
    s_nop 0
    buffer_load_dwordx4 v2, s[8:11], s22 offen offset:0 sc1 lds
    buffer_load_dwordx4 v2, s[8:11], s22 offen offset:1024 sc1 lds
    buffer_load_dwordx4 v2, s[8:11], s22 offen offset:2048 sc1 lds
    s_add_u32 s22, s22, 12288
    s_waitcnt vmcnt(10)
    s_barrier
    s_mov_b32 m0, 104448
    s_nop 0
    buffer_load_dwordx4 v2, s[8:11], s20 offen offset:0 sc1 lds
    s_add_u32 s29, s20, 20480
    s_mov_b32 m0, 105472
    s_nop 0
    buffer_load_dwordx4 v2, s[8:11], s29 offen offset:0 sc1 lds
    s_add_u32 s20, s20, 1024
    s_mov_b32 m0, 70656
    s_nop 0
    buffer_load_dwordx4 v2, s[8:11], s22 offen offset:0 sc1 lds
    buffer_load_dwordx4 v2, s[8:11], s22 offen offset:1024 sc1 lds
    buffer_load_dwordx4 v2, s[8:11], s22 offen offset:2048 sc1 lds
    s_add_u32 s22, s22, 12288
    s_waitcnt vmcnt(10)
    s_barrier
    s_mov_b32 m0, 21504
    s_nop 0
    buffer_load_dwordx4 v2, s[8:11], s22 offen offset:0 sc1 lds
    buffer_load_dwordx4 v2, s[8:11], s22 offen offset:1024 sc1 lds
    buffer_load_dwordx4 v2, s[8:11], s22 offen offset:2048 sc1 lds
    s_add_u32 s22, s22, 12288
    s_waitcnt vmcnt(8)
    s_barrier
    s_waitcnt vmcnt(3)
    s_barrier
    s_waitcnt vmcnt(0)
    s_barrier
    s_and_b32 s6, s2, 3
    s_lshl_b32 s6, s6, 3
    s_bfe_u32 s4, s2, 0x30003
    s_add_u32 s4, s4, s6
    s_bfe_u32 s6, s2, 0x10002
    s_lshl_b32 s6, s6, 2
    s_lshr_b32 s5, s2, 6
    s_add_u32 s5, s5, s6
    s_and_b32 s39, s5, 3
    s_mul_i32 s39, s39, 1
    s_mul_i32 s22, s5, 245760
    s_add_u32 s22, s22, 28090368
    s_mul_i32 s20, s4, 196608
    s_add_u32 s20, s20, 15876096
    s_add_u32 s21, s20, 49152
    s_mul_i32 s28, s39, 2048
    s_add_u32 s20, s20, s28
    s_add_u32 s23, s22, 245760
    s_mul_i32 s28, s39, 10240
    s_add_u32 s22, s22, s28
    s_barrier
    s_mov_b32 m0, 8192
    s_nop 0
    buffer_load_dwordx4 v2, s[8:11], s22 offen offset:0 sc1 lds
    s_waitcnt vmcnt(4)
    buffer_load_dwordx4 v2, s[8:11], s22 offen offset:1024 sc1 lds
    s_waitcnt vmcnt(4)
    s_add_u32 s22, s22, 10240
    s_cmp_ge_u32 s22, s23
    s_cselect_b32 s28, 245760, 0
    s_sub_u32 s22, s22, s28
    s_mov_b32 m0, 18432
    s_nop 0
    buffer_load_dwordx4 v2, s[8:11], s22 offen offset:0 sc1 lds
    s_waitcnt vmcnt(4)
    buffer_load_dwordx4 v2, s[8:11], s22 offen offset:1024 sc1 lds
    s_waitcnt vmcnt(4)
    s_add_u32 s22, s22, 10240
    s_cmp_ge_u32 s22, s23
    s_cselect_b32 s28, 245760, 0
    s_sub_u32 s22, s22, s28
    s_mov_b32 m0, 28672
    s_nop 0
    buffer_load_dwordx4 v2, s[8:11], s22 offen offset:0 sc1 lds
    s_waitcnt vmcnt(4)
    buffer_load_dwordx4 v2, s[8:11], s22 offen offset:1024 sc1 lds
    s_waitcnt vmcnt(4)
    s_add_u32 s22, s22, 10240
    s_cmp_ge_u32 s22, s23
    s_cselect_b32 s28, 245760, 0
    s_sub_u32 s22, s22, s28
    s_mov_b32 m0, 38912
    s_nop 0
    buffer_load_dwordx4 v2, s[8:11], s22 offen offset:0 sc1 lds
    s_waitcnt vmcnt(4)
    buffer_load_dwordx4 v2, s[8:11], s22 offen offset:1024 sc1 lds
    s_waitcnt vmcnt(4)
    s_add_u32 s22, s22, 10240
    s_cmp_ge_u32 s22, s23
    s_cselect_b32 s28, 245760, 0
    s_sub_u32 s22, s22, s28
    s_mov_b32 m0, 49152
    s_nop 0
    buffer_load_dwordx4 v2, s[8:11], s22 offen offset:0 sc1 lds
    s_waitcnt vmcnt(4)
    buffer_load_dwordx4 v2, s[8:11], s22 offen offset:1024 sc1 lds
    s_waitcnt vmcnt(4)
    s_add_u32 s22, s22, 10240
    s_cmp_ge_u32 s22, s23
    s_cselect_b32 s28, 245760, 0
    s_sub_u32 s22, s22, s28
    s_mov_b32 m0, 59392
    s_nop 0
    buffer_load_dwordx4 v2, s[8:11], s22 offen offset:0 sc1 lds
    s_waitcnt vmcnt(4)
    buffer_load_dwordx4 v2, s[8:11], s22 offen offset:1024 sc1 lds
    s_waitcnt vmcnt(4)
    s_add_u32 s22, s22, 10240
    s_cmp_ge_u32 s22, s23
    s_cselect_b32 s28, 245760, 0
    s_sub_u32 s22, s22, s28
    s_mov_b32 m0, 69632
    s_nop 0
    buffer_load_dwordx4 v2, s[8:11], s22 offen offset:0 sc1 lds
    s_waitcnt vmcnt(4)
    buffer_load_dwordx4 v2, s[8:11], s22 offen offset:1024 sc1 lds
    s_waitcnt vmcnt(4)
    s_add_u32 s22, s22, 10240
    s_cmp_ge_u32 s22, s23
    s_cselect_b32 s28, 245760, 0
    s_sub_u32 s22, s22, s28
    s_mov_b32 m0, 79872
    s_nop 0
    buffer_load_dwordx4 v2, s[8:11], s22 offen offset:0 sc1 lds
    s_waitcnt vmcnt(4)
    buffer_load_dwordx4 v2, s[8:11], s22 offen offset:1024 sc1 lds
    s_waitcnt vmcnt(4)
    s_add_u32 s22, s22, 10240
    s_cmp_ge_u32 s22, s23
    s_cselect_b32 s28, 245760, 0
    s_sub_u32 s22, s22, s28
    s_mov_b32 m0, 90112
    s_nop 0
    buffer_load_dwordx4 v2, s[8:11], s22 offen offset:0 sc1 lds
    s_waitcnt vmcnt(4)
    buffer_load_dwordx4 v2, s[8:11], s22 offen offset:1024 sc1 lds
    s_waitcnt vmcnt(4)
    s_add_u32 s22, s22, 10240
    s_cmp_ge_u32 s22, s23
    s_cselect_b32 s28, 245760, 0
    s_sub_u32 s22, s22, s28
    s_mov_b32 m0, 100352
    s_nop 0
    buffer_load_dwordx4 v2, s[8:11], s22 offen offset:0 sc1 lds
    s_waitcnt vmcnt(4)
    buffer_load_dwordx4 v2, s[8:11], s22 offen offset:1024 sc1 lds
    s_waitcnt vmcnt(4)
    s_add_u32 s22, s22, 10240
    s_cmp_ge_u32 s22, s23
    s_cselect_b32 s28, 245760, 0
    s_sub_u32 s22, s22, s28
    s_barrier
    s_mov_b32 m0, 108544
    s_nop 0
    buffer_load_dwordx4 v2, s[8:11], s20 offen offset:0 sc1 lds
    buffer_load_dwordx4 v2, s[8:11], s20 offen offset:1024 sc1 lds
    s_add_u32 s20, s20, 2048
    s_cmp_ge_u32 s20, s21
    s_cselect_b32 s28, 49152, 0
    s_sub_u32 s20, s20, s28
    s_mov_b32 m0, 118784
    s_nop 0
    buffer_load_dwordx4 v2, s[8:11], s20 offen offset:0 sc1 lds
    buffer_load_dwordx4 v2, s[8:11], s20 offen offset:1024 sc1 lds
    s_add_u32 s20, s20, 2048
    s_cmp_ge_u32 s20, s21
    s_cselect_b32 s28, 49152, 0
    s_sub_u32 s20, s20, s28
    s_mov_b32 m0, 129024
    s_nop 0
    buffer_load_dwordx4 v2, s[8:11], s20 offen offset:0 sc1 lds
    buffer_load_dwordx4 v2, s[8:11], s20 offen offset:1024 sc1 lds
    s_add_u32 s20, s20, 2048
    s_cmp_ge_u32 s20, s21
    s_cselect_b32 s28, 49152, 0
    s_sub_u32 s20, s20, s28
    s_mov_b32 m0, 139264
    s_nop 0
    buffer_load_dwordx4 v2, s[8:11], s20 offen offset:0 sc1 lds
    buffer_load_dwordx4 v2, s[8:11], s20 offen offset:1024 sc1 lds
    s_add_u32 s20, s20, 2048
    s_cmp_ge_u32 s20, s21
    s_cselect_b32 s28, 49152, 0
    s_sub_u32 s20, s20, s28
    s_waitcnt vmcnt(6)
    s_barrier
    s_mov_b32 m0, 149504
    s_nop 0
    buffer_load_dwordx4 v2, s[8:11], s20 offen offset:0 sc1 lds
    buffer_load_dwordx4 v2, s[8:11], s20 offen offset:1024 sc1 lds
    s_add_u32 s20, s20, 2048
    s_cmp_ge_u32 s20, s21
    s_cselect_b32 s28, 49152, 0
    s_sub_u32 s20, s20, s28
    s_mov_b32 m0, 159744
    s_nop 0
    buffer_load_dwordx4 v2, s[8:11], s20 offen offset:0 sc1 lds
    buffer_load_dwordx4 v2, s[8:11], s20 offen offset:1024 sc1 lds
    s_add_u32 s20, s20, 2048
    s_cmp_ge_u32 s20, s21
    s_cselect_b32 s28, 49152, 0
    s_sub_u32 s20, s20, s28
    s_waitcnt vmcnt(8)
    s_barrier
    s_mov_b32 m0, 6144
    s_nop 0
    buffer_load_dwordx4 v2, s[8:11], s20 offen offset:0 sc1 lds
    buffer_load_dwordx4 v2, s[8:11], s20 offen offset:1024 sc1 lds
    s_add_u32 s20, s20, 2048
    s_cmp_ge_u32 s20, s21
    s_cselect_b32 s28, 49152, 0
    s_sub_u32 s20, s20, s28
    s_mov_b32 m0, 108544
    s_nop 0
    buffer_load_dwordx4 v2, s[8:11], s20 offen offset:0 sc1 lds
    s_waitcnt vmcnt(9)
    s_barrier
    s_mov_b32 m0, 108544
    s_nop 0
    buffer_load_dwordx4 v2, s[8:11], s20 offen offset:1024 sc1 lds
    s_add_u32 s20, s20, 2048
    s_cmp_ge_u32 s20, s21
    s_cselect_b32 s28, 49152, 0
    s_sub_u32 s20, s20, s28
    s_mov_b32 m0, 16384
    s_nop 0
    buffer_load_dwordx4 v2, s[8:11], s20 offen offset:0 sc1 lds
    buffer_load_dwordx4 v2, s[8:11], s20 offen offset:1024 sc1 lds
    s_add_u32 s20, s20, 2048
    s_cmp_ge_u32 s20, s21
    s_cselect_b32 s28, 49152, 0
    s_sub_u32 s20, s20, s28
    s_mov_b32 m0, 118784
    s_nop 0
    buffer_load_dwordx4 v2, s[8:11], s20 offen offset:0 sc1 lds
    s_waitcnt vmcnt(11)
    s_barrier
    s_mov_b32 m0, 118784
    s_nop 0
    buffer_load_dwordx4 v2, s[8:11], s20 offen offset:1024 sc1 lds
    s_add_u32 s20, s20, 2048
    s_cmp_ge_u32 s20, s21
    s_cselect_b32 s28, 49152, 0
    s_sub_u32 s20, s20, s28
    s_mov_b32 m0, 26624
    s_nop 0
    buffer_load_dwordx4 v2, s[8:11], s20 offen offset:0 sc1 lds
    buffer_load_dwordx4 v2, s[8:11], s20 offen offset:1024 sc1 lds
    s_add_u32 s20, s20, 2048
    s_cmp_ge_u32 s20, s21
    s_cselect_b32 s28, 49152, 0
    s_sub_u32 s20, s20, s28
    s_mov_b32 m0, 129024
    s_nop 0
    buffer_load_dwordx4 v2, s[8:11], s20 offen offset:0 sc1 lds
    s_waitcnt vmcnt(13)
    s_barrier
    s_mov_b32 m0, 129024
    s_nop 0
    buffer_load_dwordx4 v2, s[8:11], s20 offen offset:1024 sc1 lds
    s_add_u32 s20, s20, 2048
    s_cmp_ge_u32 s20, s21
    s_cselect_b32 s28, 49152, 0
    s_sub_u32 s20, s20, s28
    s_mov_b32 m0, 36864
    s_nop 0
    buffer_load_dwordx4 v2, s[8:11], s20 offen offset:0 sc1 lds
    buffer_load_dwordx4 v2, s[8:11], s20 offen offset:1024 sc1 lds
    s_add_u32 s20, s20, 2048
    s_cmp_ge_u32 s20, s21
    s_cselect_b32 s28, 49152, 0
    s_sub_u32 s20, s20, s28
    s_mov_b32 m0, 139264
    s_nop 0
    buffer_load_dwordx4 v2, s[8:11], s20 offen offset:0 sc1 lds
    s_waitcnt vmcnt(15)
    s_barrier
    s_mov_b32 m0, 139264
    s_nop 0
    buffer_load_dwordx4 v2, s[8:11], s20 offen offset:1024 sc1 lds
    s_add_u32 s20, s20, 2048
    s_cmp_ge_u32 s20, s21
    s_cselect_b32 s28, 49152, 0
    s_sub_u32 s20, s20, s28
    s_mov_b32 m0, 49152
    s_nop 0
    buffer_load_dwordx4 v2, s[8:11], s22 offen offset:0 sc1 lds
    buffer_load_dwordx4 v2, s[8:11], s22 offen offset:1024 sc1 lds
    s_add_u32 s22, s22, 10240
    s_cmp_ge_u32 s22, s23
    s_cselect_b32 s28, 245760, 0
    s_sub_u32 s22, s22, s28
    s_waitcnt vmcnt(16)
    s_barrier
    s_mov_b32 m0, 149504
    s_nop 0
    buffer_load_dwordx4 v2, s[8:11], s20 offen offset:0 sc1 lds
    buffer_load_dwordx4 v2, s[8:11], s20 offen offset:1024 sc1 lds
    s_add_u32 s20, s20, 2048
    s_cmp_ge_u32 s20, s21
    s_cselect_b32 s28, 49152, 0
    s_sub_u32 s20, s20, s28
    s_mov_b32 m0, 59392
    s_nop 0
    buffer_load_dwordx4 v2, s[8:11], s22 offen offset:0 sc1 lds
    buffer_load_dwordx4 v2, s[8:11], s22 offen offset:1024 sc1 lds
    s_waitcnt vmcnt(18)
    s_barrier
    s_add_u32 s22, s22, 10240
    s_cmp_ge_u32 s22, s23
    s_cselect_b32 s28, 245760, 0
    s_sub_u32 s22, s22, s28
    s_mov_b32 m0, 159744
    s_nop 0
    buffer_load_dwordx4 v2, s[8:11], s20 offen offset:0 sc1 lds
    buffer_load_dwordx4 v2, s[8:11], s20 offen offset:1024 sc1 lds
    s_add_u32 s20, s20, 2048
    s_cmp_ge_u32 s20, s21
    s_cselect_b32 s28, 49152, 0
    s_sub_u32 s20, s20, s28
    s_mov_b32 m0, 69632
    s_nop 0
    buffer_load_dwordx4 v2, s[8:11], s22 offen offset:0 sc1 lds
    s_waitcnt vmcnt(19)
    s_barrier
    s_mov_b32 m0, 69632
    s_nop 0
    buffer_load_dwordx4 v2, s[8:11], s22 offen offset:1024 sc1 lds
    s_add_u32 s22, s22, 10240
    s_cmp_ge_u32 s22, s23
    s_cselect_b32 s28, 245760, 0
    s_sub_u32 s22, s22, s28
    s_mov_b32 m0, 6144
    s_nop 0
    buffer_load_dwordx4 v2, s[8:11], s20 offen offset:0 sc1 lds
    buffer_load_dwordx4 v2, s[8:11], s20 offen offset:1024 sc1 lds
    s_add_u32 s20, s20, 2048
    s_cmp_ge_u32 s20, s21
    s_cselect_b32 s28, 49152, 0
    s_sub_u32 s20, s20, s28
    s_waitcnt vmcnt(20)
    s_barrier
    s_mov_b32 m0, 79872
    s_nop 0
    buffer_load_dwordx4 v2, s[8:11], s22 offen offset:0 sc1 lds
    buffer_load_dwordx4 v2, s[8:11], s22 offen offset:1024 sc1 lds
    s_add_u32 s22, s22, 10240
    s_cmp_ge_u32 s22, s23
    s_cselect_b32 s28, 245760, 0
    s_sub_u32 s22, s22, s28
    s_mov_b32 m0, 108544
    s_nop 0
    buffer_load_dwordx4 v2, s[8:11], s20 offen offset:0 sc1 lds
    s_waitcnt vmcnt(13)
    s_barrier
    s_mov_b32 m0, 108544
    s_nop 0
    buffer_load_dwordx4 v2, s[8:11], s20 offen offset:1024 sc1 lds
    s_add_u32 s20, s20, 2048
    s_cmp_ge_u32 s20, s21
    s_cselect_b32 s28, 49152, 0
    s_sub_u32 s20, s20, s28
    s_mov_b32 m0, 90112
    s_nop 0
    buffer_load_dwordx4 v2, s[8:11], s22 offen offset:0 sc1 lds
    buffer_load_dwordx4 v2, s[8:11], s22 offen offset:1024 sc1 lds
    s_add_u32 s22, s22, 10240
    s_cmp_ge_u32 s22, s23
    s_cselect_b32 s28, 245760, 0
    s_sub_u32 s22, s22, s28
    s_waitcnt vmcnt(12)
    s_barrier
    s_mov_b32 m0, 16384
    s_nop 0
    buffer_load_dwordx4 v2, s[8:11], s20 offen offset:0 sc1 lds
    buffer_load_dwordx4 v2, s[8:11], s20 offen offset:1024 sc1 lds
    s_add_u32 s20, s20, 2048
    s_cmp_ge_u32 s20, s21
    s_cselect_b32 s28, 49152, 0
    s_sub_u32 s20, s20, s28
    s_mov_b32 m0, 100352
    s_nop 0
    buffer_load_dwordx4 v2, s[8:11], s22 offen offset:0 sc1 lds
    s_waitcnt vmcnt(11)
    s_barrier
    s_mov_b32 m0, 100352
    s_nop 0
    buffer_load_dwordx4 v2, s[8:11], s22 offen offset:1024 sc1 lds
    s_add_u32 s22, s22, 10240
    s_cmp_ge_u32 s22, s23
    s_cselect_b32 s28, 245760, 0
    s_sub_u32 s22, s22, s28
    s_mov_b32 m0, 118784
    s_nop 0
    buffer_load_dwordx4 v2, s[8:11], s20 offen offset:0 sc1 lds
    buffer_load_dwordx4 v2, s[8:11], s20 offen offset:1024 sc1 lds
    s_add_u32 s20, s20, 2048
    s_cmp_ge_u32 s20, s21
    s_cselect_b32 s28, 49152, 0
    s_sub_u32 s20, s20, s28
    s_waitcnt vmcnt(10)
    s_barrier
    s_mov_b32 m0, 49152
    s_nop 0
    buffer_load_dwordx4 v2, s[8:11], s22 offen offset:0 sc1 lds
    buffer_load_dwordx4 v2, s[8:11], s22 offen offset:1024 sc1 lds
    s_add_u32 s22, s22, 10240
    s_cmp_ge_u32 s22, s23
    s_cselect_b32 s28, 245760, 0
    s_sub_u32 s22, s22, s28
    s_mov_b32 m0, 26624
    s_nop 0
    buffer_load_dwordx4 v2, s[8:11], s20 offen offset:0 sc1 lds
    s_waitcnt vmcnt(9)
    s_barrier
    s_mov_b32 m0, 26624
    s_nop 0
    buffer_load_dwordx4 v2, s[8:11], s20 offen offset:1024 sc1 lds
    s_add_u32 s20, s20, 2048
    s_cmp_ge_u32 s20, s21
    s_cselect_b32 s28, 49152, 0
    s_sub_u32 s20, s20, s28
    s_mov_b32 m0, 59392
    s_nop 0
    buffer_load_dwordx4 v2, s[8:11], s22 offen offset:0 sc1 lds
    buffer_load_dwordx4 v2, s[8:11], s22 offen offset:1024 sc1 lds
    s_add_u32 s22, s22, 10240
    s_cmp_ge_u32 s22, s23
    s_cselect_b32 s28, 245760, 0
    s_sub_u32 s22, s22, s28
    s_waitcnt vmcnt(8)
    s_barrier
    s_mov_b32 m0, 129024
    s_nop 0
    buffer_load_dwordx4 v2, s[8:11], s20 offen offset:0 sc1 lds
    buffer_load_dwordx4 v2, s[8:11], s20 offen offset:1024 sc1 lds
    s_add_u32 s20, s20, 2048
    s_cmp_ge_u32 s20, s21
    s_cselect_b32 s28, 49152, 0
    s_sub_u32 s20, s20, s28
    s_mov_b32 m0, 69632
    s_nop 0
    buffer_load_dwordx4 v2, s[8:11], s22 offen offset:0 sc1 lds
    buffer_load_dwordx4 v2, s[8:11], s22 offen offset:1024 sc1 lds
    s_waitcnt vmcnt(8)
    s_barrier
    s_add_u32 s22, s22, 10240
    s_cmp_ge_u32 s22, s23
    s_cselect_b32 s28, 245760, 0
    s_sub_u32 s22, s22, s28
    s_mov_b32 m0, 36864
    s_nop 0
    buffer_load_dwordx4 v2, s[8:11], s20 offen offset:0 sc1 lds
    buffer_load_dwordx4 v2, s[8:11], s20 offen offset:1024 sc1 lds
    s_add_u32 s20, s20, 2048
    s_cmp_ge_u32 s20, s21
    s_cselect_b32 s28, 49152, 0
    s_sub_u32 s20, s20, s28
    s_mov_b32 m0, 79872
    s_nop 0
    buffer_load_dwordx4 v2, s[8:11], s22 offen offset:0 sc1 lds
    s_waitcnt vmcnt(7)
    s_barrier
    s_mov_b32 m0, 79872
    s_nop 0
    buffer_load_dwordx4 v2, s[8:11], s22 offen offset:1024 sc1 lds
    s_add_u32 s22, s22, 10240
    s_cmp_ge_u32 s22, s23
    s_cselect_b32 s28, 245760, 0
    s_sub_u32 s22, s22, s28
    s_mov_b32 m0, 139264
    s_nop 0
    buffer_load_dwordx4 v2, s[8:11], s20 offen offset:0 sc1 lds
    buffer_load_dwordx4 v2, s[8:11], s20 offen offset:1024 sc1 lds
    s_add_u32 s20, s20, 2048
    s_cmp_ge_u32 s20, s21
    s_cselect_b32 s28, 49152, 0
    s_sub_u32 s20, s20, s28
    s_waitcnt vmcnt(6)
    s_barrier
    s_mov_b32 m0, 90112
    s_nop 0
    buffer_load_dwordx4 v2, s[8:11], s22 offen offset:0 sc1 lds
    buffer_load_dwordx4 v2, s[8:11], s22 offen offset:1024 sc1 lds
    s_add_u32 s22, s22, 10240
    s_cmp_ge_u32 s22, s23
    s_cselect_b32 s28, 245760, 0
    s_sub_u32 s22, s22, s28
    s_mov_b32 m0, 151552
    s_nop 0
    buffer_load_dwordx4 v2, s[8:11], s22 offen offset:0 sc1 lds
    s_waitcnt vmcnt(5)
    s_barrier
    s_mov_b32 m0, 151552
    s_nop 0
    buffer_load_dwordx4 v2, s[8:11], s22 offen offset:1024 sc1 lds
    s_add_u32 s22, s22, 10240
    s_cmp_ge_u32 s22, s23
    s_cselect_b32 s28, 245760, 0
    s_sub_u32 s22, s22, s28
    s_mov_b32 m0, 100352
    s_nop 0
    buffer_load_dwordx4 v2, s[8:11], s22 offen offset:0 sc1 lds
    buffer_load_dwordx4 v2, s[8:11], s22 offen offset:1024 sc1 lds
    s_waitcnt vmcnt(4)
    s_barrier
    s_add_u32 s22, s22, 10240
    s_cmp_ge_u32 s22, s23
    s_cselect_b32 s28, 245760, 0
    s_sub_u32 s22, s22, s28
    s_mov_b32 m0, 161792
    s_nop 0
    buffer_load_dwordx4 v2, s[8:11], s22 offen offset:0 sc1 lds
    buffer_load_dwordx4 v2, s[8:11], s22 offen offset:1024 sc1 lds
    s_add_u32 s22, s22, 10240
    s_cmp_ge_u32 s22, s23
    s_cselect_b32 s28, 245760, 0
    s_sub_u32 s22, s22, s28
    s_waitcnt vmcnt(4)
    s_barrier
    s_waitcnt vmcnt(2)
    s_barrier
    s_waitcnt vmcnt(0)
    s_barrier
    s_endpgm
p2_fallback:
    buffer_load_dwordx4 v[40:43], v3, s[8:11], s67 offen sc1
    buffer_load_dword v44, v4, s[8:11], s67 offen sc1
    v_mov_b32 v45, 0
    v_mov_b32 v53, 0
    v_mov_b32 v112, 0
    v_mov_b32 v113, 0
    v_mov_b32 v114, 0
    v_mov_b32 v115, 0
    v_mov_b32 v116, 0
    v_mov_b32 v117, 0
    v_mov_b32 v118, 0
    v_mov_b32 v119, 0
    v_mov_b32 v120, 0
    v_mov_b32 v121, 0
    v_mov_b32 v122, 0
    v_mov_b32 v123, 0
    v_mov_b32 v124, 0
    v_mov_b32 v125, 0
    v_mov_b32 v126, 0
    v_mov_b32 v127, 0
    v_mov_b32 v20, 0xff800000
    s_mov_b32 s28, s30
    s_mov_b32 s29, s34
    s_mov_b32 s35, 64
p2_fb_loop:
    buffer_load_dwordx4 v[48:51], v3, s[8:11], s28 offen sc1
    buffer_load_dword v52, v4, s[8:11], s28 offen sc1
    buffer_load_dwordx4 v[56:59], v5, s[8:11], s29 offen sc1
    buffer_load_dwordx4 v[60:63], v8, s[8:11], s29 offen sc1
    s_waitcnt vmcnt(0)
    v_mfma_f32_32x32x16_bf16 v[128:143], v[48:51], v[40:43], 0
    v_mfma_f32_32x32x8_bf16 v[128:143], v[52:53], v[44:45], v[128:143]
    s_nop 11
    s_nop 0
    v_max3_f32 v12, v128, v129, v20
    v_max3_f32 v12, v12, v130, v131
    v_max3_f32 v12, v12, v132, v133
    v_max3_f32 v12, v12, v134, v135
    v_max3_f32 v12, v12, v136, v137
    v_max3_f32 v12, v12, v138, v139
    v_max3_f32 v12, v12, v140, v141
    v_max3_f32 v12, v12, v142, v143
    v_mov_b32 v13, v12
    s_nop 1
    v_permlane32_swap_b32 v12, v13
    v_max_f32 v12, v12, v13
    v_sub_f32 v13, v20, v12
    v_exp_f32 v13, v13
    v_mov_b32 v20, v12
    v_sub_f32 v128, v128, v12
    v_sub_f32 v129, v129, v12
    v_sub_f32 v130, v130, v12
    v_sub_f32 v131, v131, v12
    v_sub_f32 v132, v132, v12
    v_sub_f32 v133, v133, v12
    v_sub_f32 v134, v134, v12
    v_sub_f32 v135, v135, v12
    v_sub_f32 v136, v136, v12
    v_sub_f32 v137, v137, v12
    v_sub_f32 v138, v138, v12
    v_sub_f32 v139, v139, v12
    v_sub_f32 v140, v140, v12
    v_sub_f32 v141, v141, v12
    v_sub_f32 v142, v142, v12
    v_sub_f32 v143, v143, v12
    v_exp_f32 v128, v128
    v_exp_f32 v129, v129
    v_exp_f32 v130, v130
    v_exp_f32 v131, v131
    v_exp_f32 v132, v132
    v_exp_f32 v133, v133
    v_exp_f32 v134, v134
    v_exp_f32 v135, v135
    v_exp_f32 v136, v136
    v_exp_f32 v137, v137
    v_exp_f32 v138, v138
    v_exp_f32 v139, v139
    v_exp_f32 v140, v140
    v_exp_f32 v141, v141
    v_exp_f32 v142, v142
    v_exp_f32 v143, v143
    v_mul_f32 v112, v112, v13
    v_mul_f32 v113, v113, v13
    v_mul_f32 v114, v114, v13
    v_mul_f32 v115, v115, v13
    v_mul_f32 v116, v116, v13
    v_mul_f32 v117, v117, v13
    v_mul_f32 v118, v118, v13
    v_mul_f32 v119, v119, v13
    v_mul_f32 v120, v120, v13
    v_mul_f32 v121, v121, v13
    v_mul_f32 v122, v122, v13
    v_mul_f32 v123, v123, v13
    v_mul_f32 v124, v124, v13
    v_mul_f32 v125, v125, v13
    v_mul_f32 v126, v126, v13
    v_mul_f32 v127, v127, v13
    s_nop 1
    v_smfmac_f32_32x32x32_bf16 v[112:127], v[56:59], v[128:135], v2
    v_smfmac_f32_32x32x32_bf16 v[112:127], v[60:63], v[136:143], v2
    s_add_u32 s28, s28, 2560
    s_add_u32 s29, s29, 41472
    s_sub_u32 s35, s35, 1
    s_cmp_lg_u32 s35, 0
    s_nop 7
    s_cbranch_scc1 p2_fb_loop
    s_nop 7
    v_mov_b32 v12, v120
    v_mov_b32 v13, v120
    s_nop 1
    v_permlane32_swap_b32 v12, v13
    v_rcp_f32 v14, v13
    s_nop 1
    s_branch p2_fin
k_end:
    s_endpgm
code_end:
.section .rodata,"a"
.p2align 6
.amdhsa_kernel sequential_preLN__softmax_full_mha__glu_gated_geglu__prompt_kernel
  .amdhsa_next_free_vgpr 256
  .amdhsa_next_free_sgpr 102
  .amdhsa_accum_offset 256
  .amdhsa_group_segment_fixed_size 0
  .amdhsa_kernarg_size 80
  .amdhsa_user_sgpr_count 2
  .amdhsa_user_sgpr_kernarg_segment_ptr 1
  .amdhsa_system_sgpr_workgroup_id_x 1
.end_amdhsa_kernel
```
